```python
import torch

def _softmax(x, axis=-1):
    return torch.softmax(x, dim=axis)
def _gelu(x):
    return torch.nn.functional.gelu(x, approximate="tanh")
def _silu(x):
    return torch.nn.functional.silu(x)
def _sigmoid(x):
    return torch.sigmoid(x)
def _layernorm(x, axis=-1, eps=1e-5):
    m = x.mean(dim=axis, keepdim=True)
    v = x.var(dim=axis, keepdim=True, unbiased=False)
    return (x - m) / torch.sqrt(v + eps)
def _scatter_add(tgt, idx, src, axis=0):
    return tgt.clone().index_add_(axis, idx, src)
def _segment_sum(src, seg, n):
    out = torch.zeros((n,) + src.shape[1:], dtype=src.dtype)
    return out.index_add_(0, seg, src)
def _pad(x, pw):
    flat = tuple(v for pair in reversed(pw) for v in pair)
    return torch.nn.functional.pad(x, flat)

kernel_name = 'concat_heads__gqa_block_cached__mha_block_cached__near_ridge'

def setup_inputs():

    _w = (lambda a: (lambda t: t.to(torch.bfloat16) if t.is_floating_point() else t)(torch.as_tensor(a)))
    def _A_setup():
        B, Sq, D = 8, 64, 448
        Hq, Hkv, Sk, Dh = 16, 8, 512, 256
        assert Hq % Hkv == 0, (Hq, Hkv)
        return {
            "x": _w((lambda *s: torch.randn(*s, dtype=torch.bfloat16) * 0.8)(B, Sq, D)),
            "k_cache": _w((lambda *s: torch.randn(*s, dtype=torch.bfloat16) * 0.8)(B, Hkv, Sk, Dh)),
            "v_cache": _w((lambda *s: torch.randn(*s, dtype=torch.bfloat16) * 0.05)(B, Hkv, Sk, Dh)),
            "wq": _w((lambda *s: torch.randn(*s, dtype=torch.bfloat16) * 0.8)(D, Hq * Dh) * (D ** -0.5)),
            "wo": _w((lambda *s: torch.randn(*s, dtype=torch.bfloat16) * 0.05)(Hq * Dh, D) * ((Hq * Dh) ** -0.5)),
        }
    _A_in = _A_setup()

    def _B_setup():
        B, Sq, D = 8, 64, 448
        H, Sk, Dh = 16, 512, 256
        return {
            "x": _w((lambda *s: torch.randn(*s, dtype=torch.bfloat16) * 0.8)(B, Sq, D)),
            "k_cache": _w((lambda *s: torch.randn(*s, dtype=torch.bfloat16) * 0.8)(B, H, Sk, Dh)),
            "v_cache": _w((lambda *s: torch.randn(*s, dtype=torch.bfloat16) * 0.05)(B, H, Sk, Dh)),
            "wq": _w((lambda *s: torch.randn(*s, dtype=torch.bfloat16) * 0.8)(D, H * Dh) * (D ** -0.5)),
            "wo": _w((lambda *s: torch.randn(*s, dtype=torch.bfloat16) * 0.05)(H * Dh, D) * ((H * Dh) ** -0.5)),
        }
    _B_in = _B_setup()

    return {
        "A_x": _A_in["x"],
        "A_k_cache": _A_in["k_cache"],
        "A_v_cache": _A_in["v_cache"],
        "A_wq": _A_in["wq"],
        "A_wo": _A_in["wo"],
        "B_x": _B_in["x"],
        "B_k_cache": _B_in["k_cache"],
        "B_v_cache": _B_in["v_cache"],
        "B_wq": _B_in["wq"],
        "B_wo": _B_in["wo"],
    }

def reference(A_x, A_k_cache, A_v_cache, A_wq, A_wo, B_x, B_k_cache, B_v_cache, B_wq, B_wo):
    def _A_ref(x, k_cache, v_cache, wq, wo):
        B, Sq, D = x.shape
        Hq, Dh = 16, 256
        Hkv = k_cache.shape[1]
        rep = Hq // Hkv
        q = (lambda x, *d: x.permute(*d))((x @ wq).reshape(B, Sq, Hq, Dh), 0, 2, 1, 3)
        k = (lambda x, n, axis: torch.repeat_interleave(x, n, dim=axis))(k_cache, rep, axis=1)
        v = (lambda x, n, axis: torch.repeat_interleave(x, n, dim=axis))(v_cache, rep, axis=1)
        scores = torch.einsum("bhqd,bhkd->bhqk", q, k) * (Dh ** -0.5)
        p = _softmax(scores, axis=-1)
        o = torch.einsum("bhqk,bhkd->bhqd", p, v)
        return (lambda x, *d: x.permute(*d))(o, 0, 2, 1, 3).reshape(B, Sq, Hq * Dh) @ wo

    def _B_ref(x, k_cache, v_cache, wq, wo):
        B, Sq, D = x.shape
        H, Dh = 16, 256
        q = (lambda x, *d: x.permute(*d))((x @ wq).reshape(B, Sq, H, Dh), 0, 2, 1, 3)
        scores = torch.einsum("bhqd,bhkd->bhqk", q, k_cache) * (Dh ** -0.5)
        p = _softmax(scores, axis=-1)
        o = torch.einsum("bhqk,bhkd->bhqd", p, v_cache)
        return (lambda x, *d: x.permute(*d))(o, 0, 2, 1, 3).reshape(B, Sq, H * Dh) @ wo

    a = _A_ref(A_x, A_k_cache, A_v_cache, A_wq, A_wo)
    b = _B_ref(B_x, B_k_cache, B_v_cache, B_wq, B_wo)
    return torch.concatenate([a, b], axis=-1)
```

```asm
; @launch grid=(256,1,1) block=(256,1,1) lds=163840
.amdgcn_target "amdgcn-amd-amdhsa--gfx950"
.text
.globl concat_heads__gqa_block_cached__mha_block_cached__near_ridge_kernel
.p2align 8
.type concat_heads__gqa_block_cached__mha_block_cached__near_ridge_kernel,@function
concat_heads__gqa_block_cached__mha_block_cached__near_ridge_kernel:
    s_cmp_ge_u32 s2, 256
    s_cbranch_scc1 L_exit
    s_lshr_b32 s41, s2, 7
    s_mul_i32 s5, s41, 40
    s_add_u32 s6, s0, s5
    s_addc_u32 s7, s1, 0
    s_load_dwordx8 s[88:95], s[6:7], 0
    s_getpc_b64 s[14:15]
L_pc:
    s_lshr_b32 s3, s2, 3
    s_mulk_i32 s3, 21
    v_min_u32 v5, 20, v0
    v_add_u32 v5, s3, v5
    v_min_u32 v5, (L_codeend-L_pc)/128-1, v5
    v_lshlrev_b32 v5, 7, v5
    global_load_dword v255, v5, s[14:15]
    v_readfirstlane_b32 s40, v0
    v_lshrrev_b32 v6, 3, v0
    v_lshrrev_b32 v5, 4, v0
    v_xor_b32 v5, v5, v0
    v_and_b32 v5, 7, v5
    v_mul_u32_u24 v6, 56, v6
    v_add_lshl_u32 v8, v5, v6, 4
    s_bfe_u32 s43, s2, 0x30004
    s_cmp_eq_u32 s43, 7
    s_cselect_b32 s62, 3, s43
    s_lshl_b32 s62, s62, 7
    s_lshl_b32 s49, s40, 4
    s_mov_b32 s10, 57344
    s_mul_i32 s48, s43, s10
    s_mov_b32 s11, 0x20000
    s_mov_b32 m0, s49
    s_waitcnt lgkmcnt(0)
    s_add_u32 s8, s88, s48
    s_addc_u32 s9, s89, 0
    buffer_load_dwordx4 v8, s[8:11], s62 offen lds
    s_add_u32 m0, s49, 4096
    v_add_u32 v7, 28672, v8
    s_add_u32 s63, s62, 128
    buffer_load_dwordx4 v7, s[8:11], s62 offen lds
    s_add_u32 m0, s49, 16384
    s_cmpk_lg_u32 s63, 896
    s_cselect_b32 s63, s63, 0
    buffer_load_dwordx4 v8, s[8:11], s63 offen lds
    s_add_u32 m0, s49, 20480
    s_add_u32 s64, s63, 128
    buffer_load_dwordx4 v7, s[8:11], s63 offen lds
    s_load_dwordx2 s[86:87], s[6:7], 32
    s_load_dwordx2 s[28:29], s[0:1], 96
    s_load_dwordx4 s[96:99], s[0:1], 80
    s_add_u32 m0, s49, 32768
    s_cmpk_lg_u32 s64, 896
    s_cselect_b32 s64, s64, 0
    buffer_load_dwordx4 v8, s[8:11], s64 offen lds
    s_add_u32 m0, s49, 36864
    s_add_u32 s65, s64, 128
    buffer_load_dwordx4 v7, s[8:11], s64 offen lds
    s_add_u32 m0, s49, 49152
    s_cmpk_lg_u32 s65, 896
    s_cselect_b32 s65, s65, 0
    buffer_load_dwordx4 v8, s[8:11], s65 offen lds
    s_add_u32 m0, s49, 53248
    s_add_u32 s66, s65, 128
    buffer_load_dwordx4 v7, s[8:11], s65 offen lds
    s_add_u32 m0, s49, 8192
    s_cmpk_lg_u32 s66, 896
    s_cselect_b32 s66, s66, 0
    buffer_load_dwordx4 v8, s[8:11], s66 offen lds
    s_add_u32 m0, s49, 12288
    s_add_u32 s67, s66, 128
    buffer_load_dwordx4 v7, s[8:11], s66 offen lds
    s_add_u32 m0, s49, 24576
    s_cmpk_lg_u32 s67, 896
    s_cselect_b32 s67, s67, 0
    buffer_load_dwordx4 v8, s[8:11], s67 offen lds
    s_add_u32 m0, s49, 28672
    s_add_u32 s68, s67, 128
    buffer_load_dwordx4 v7, s[8:11], s67 offen lds
    s_lshr_b32 s40, s40, 6
    v_and_b32 v1, 63, v0
    v_lshrrev_b32 v2, 3, v1
    v_and_b32 v3, 7, v1
    v_lshrrev_b32 v4, 4, v1
    s_bfe_u32 s4, s2, 0x10003
    s_and_b32 s50, s40, 1
    s_and_b32 s3, s2, 7
    s_lshl_b32 s3, s3, 1
    s_add_u32 s42, s3, s4
    s_and_b32 s84, s43, 1
    s_lshl_b32 s84, s84, 1
    s_add_u32 s84, s84, s41
    s_mul_i32 s44, s40, 24576
    s_add_u32 s44, s44, 65536
    v_and_b32 v5, 1, v4
    v_lshlrev_b32 v5, 2, v5
    v_xor_b32 v5, v5, v3
    s_lshl_b32 s69, s40, 7
    v_lshl_add_u32 v5, v5, 4, s69
    v_lshl_add_u32 v9, v2, 13, v5
    s_lshl_b32 s48, s43, 6
    v_xor_b32 v5, s48, v5
    v_lshl_add_u32 v17, v2, 9, v5
    v_add_u32 v10, 64512, v9
    v_add_u32 v11, 129024, v9
    v_add_u32 v12, 193536, v9
    s_lshl_b32 s48, s42, 9
    s_add_u32 s20, s94, s48
    s_addc_u32 s21, s95, 0
    s_sub_u32 s22, 3670016, s48
    s_mov_b32 s23, 0x20000
    s_lshl_b32 s47, s41, 3
    s_add_u32 s47, s47, s43
    s_mov_b32 s30, 15728640
    s_mov_b32 s31, 0x20000
    v_lshlrev_b32 v41, 4, v1
    s_add_u32 m0, s49, 40960
    s_cmpk_lg_u32 s68, 896
    s_cselect_b32 s68, s68, 0
    buffer_load_dwordx4 v8, s[8:11], s68 offen lds
    s_add_u32 m0, s49, 45056
    s_nop 0
    buffer_load_dwordx4 v7, s[8:11], s68 offen lds
    s_waitcnt lgkmcnt(0)
    s_cmp_lg_u32 s42, 15
    s_cbranch_scc1 L_noclr
    s_lshl_b32 s3, s47, 2
    s_add_u32 s3, s3, s40
    s_lshl_b32 s3, s3, 11
    s_add_u32 s3, s3, 65536
    v_lshrrev_b32 v5, 2, v1
    v_and_b32 v6, 48, v41
    v_lshl_add_u32 v5, v5, 7, v6
    v_mov_b32 v64, 0
    v_mov_b32 v65, 0
    v_mov_b32 v66, 0
    v_mov_b32 v67, 0
    buffer_store_dwordx4 v[64:67], v5, s[28:31], s3 offen sc0 sc1
L_noclr:
    s_add_u32 m0, s44, 0
    s_lshl_b32 s45, s62, 12
    buffer_load_dwordx4 v9, s[20:23], s45 offen lds
    buffer_load_dwordx4 v10, s[20:23], s45 offen offset:1024 lds
    buffer_load_dwordx4 v11, s[20:23], s45 offen offset:2048 lds
    buffer_load_dwordx4 v12, s[20:23], s45 offen offset:3072 lds
    s_add_u32 m0, s44, 4096
    s_lshl_b32 s45, s62, 12
    s_bitset1_b32 s45, 18
    buffer_load_dwordx4 v9, s[20:23], s45 offen lds
    buffer_load_dwordx4 v10, s[20:23], s45 offen offset:1024 lds
    buffer_load_dwordx4 v11, s[20:23], s45 offen offset:2048 lds
    buffer_load_dwordx4 v12, s[20:23], s45 offen offset:3072 lds
    s_lshl_b32 s48, s43, 4
    s_add_u32 s48, s48, s42
    s_xor_b32 s49, s41, 1
    s_lshr_b32 s48, s48, s49
    s_lshl_b32 s48, s48, 18
    s_add_u32 s12, s90, s48
    s_addc_u32 s13, s91, 0
    s_mov_b32 s14, 262144
    s_mov_b32 s15, 0x20000
    s_add_u32 s16, s92, s48
    s_addc_u32 s17, s93, 0
    s_mov_b32 s18, 262144
    s_mov_b32 s19, 0x20000
    s_mul_i32 s48, s42, 229376
    s_add_u32 s24, s86, s48
    s_addc_u32 s25, s87, 0
    s_mov_b32 s26, 229376
    s_mov_b32 s27, 0x20000
    s_mov_b32 s32, s96
    s_mov_b32 s33, s97
    s_mov_b32 s34, 917504
    s_mov_b32 s35, 0x20000
    s_mov_b32 s36, s98
    s_mov_b32 s37, s99
    s_mov_b32 s38, 256
    s_mov_b32 s39, 0x20000
    s_lshl_b32 s60, s47, 4
    s_lshl_b32 s61, s43, 1
    s_mov_b32 s46, 0x3db8aa3b
    v_xor_b32 v5, v3, v4
    s_lshl_b32 s48, s40, 14
    v_lshl_add_u32 v5, v5, 4, s48
    v_lshl_add_u32 v13, v2, 9, v5
    v_xor_b32 v5, 64, v13
    v_add_u32 v14, 3072, v5
    v_add_u32 v15, 6144, v13
    v_add_u32 v16, 9216, v5
    v_add_u32 v18, 3072, v17
    v_add_u32 v19, 6144, v17
    v_add_u32 v20, 9216, v17
    v_add_u32 v42, s48, v41
    v_xor_b32 v45, 16384, v42
    v_xor_b32 v46, 32768, v42
    v_xor_b32 v47, 49152, v42
    s_add_u32 s48, s48, 8192
    v_lshl_add_u32 v8, v1, 3, s48
    v_bfe_u32 v5, v1, 2, 2
    v_xor_b32 v5, v5, v4
    v_add_u32 v5, s50, v5
    v_and_b32 v5, 3, v5
    v_and_b32 v6, 48, v41
    v_lshl_add_u32 v5, v5, 6, v6
    v_mul_u32_u24 v6, 896, v4
    s_mul_i32 s48, s40, 224
    s_lshl_b32 s49, s50, 5
    s_sub_u32 s48, s48, s49
    v_add3_u32 v21, v5, v6, s48
    v_add_u32 v22, 2560, v21
    v_add_u32 v23, 5120, v21
    v_add_u32 v24, 7680, v21
    v_lshrrev_b32 v2, 5, v1
    v_bfe_u32 v3, v1, 1, 3
    v_xor_b32 v3, v3, v2
    v_and_b32 v5, 31, v1
    v_lshlrev_b32 v5, 7, v5
    v_lshl_add_u32 v25, v3, 4, v5
    v_xor_b32 v26, 32, v25
    v_xor_b32 v27, 64, v25
    v_xor_b32 v28, 96, v25
    v_add_u32 v31, s44, v25
    v_add_u32 v32, s44, v26
    v_add_u32 v33, s44, v27
    v_add_u32 v34, s44, v28
    v_and_b32 v3, 16, v41
    v_bfe_u32 v5, v1, 1, 1
    v_lshl_add_u32 v3, v5, 3, v3
    v_and_b32 v5, 1, v4
    v_lshl_add_u32 v3, v5, 5, v3
    v_add_u32 v3, s44, v3
    v_bfe_u32 v5, v1, 2, 2
    v_bfe_u32 v6, v1, 3, 1
    v_lshl_add_u32 v6, v6, 6, v3
    v_lshl_add_u32 v6, v5, 7, v6
    v_lshl_add_u32 v29, v2, 10, v6
    v_lshl_add_u32 v35, v2, 9, v6
    v_xor_b32 v30, 64, v29
    v_xor_b32 v36, 64, v35
    v_mul_u32_u24 v6, 320, v5
    v_add_u32 v6, v6, v3
    v_lshl_add_u32 v37, v2, 11, v6
    v_xor_b32 v38, 64, v37
    v_xor_b32 v39, 128, v37
    v_xor_b32 v40, 192, v37
    s_lshl_b32 s49, s50, 10
    v_add_u32 v43, s49, v41
    v_xor_b32 v44, 0x400, v43
    s_lshl_b32 s48, s40, 9
    s_add_u32 s48, s48, 8192
    v_lshl_add_u32 v6, v1, 3, s48
    s_cmp_eq_u32 s84, 1
    s_cbranch_scc1 L_class1
    s_cmp_eq_u32 s84, 2
    s_cbranch_scc1 L_class2
    s_cmp_eq_u32 s84, 3
    s_cbranch_scc1 L_class3
    s_branch L_class0
L_exit:
    s_endpgm
.p2align 6
L_class0:
    s_waitcnt vmcnt(8)
    s_barrier
    s_cmp_lg_u32 s42, 15
    s_cbranch_scc1 L_noset0
    s_lshl_b32 s3, s40, 2
    s_add_u32 s3, s3, s60
    v_mov_b32 v2, 0
    v_mov_b32 v3, 1
    s_mov_b64 exec, 1
    s_nop 0
    buffer_store_dword v3, v2, s[36:39], s3 offen sc0 sc1
    s_mov_b64 exec, -1
L_noset0:
    s_add_u32 m0, s44, 8192
    s_lshl_b32 s45, s63, 12
    buffer_load_dwordx4 v9, s[20:23], s45 offen lds
    buffer_load_dwordx4 v10, s[20:23], s45 offen offset:1024 lds
    buffer_load_dwordx4 v11, s[20:23], s45 offen offset:2048 lds
    buffer_load_dwordx4 v12, s[20:23], s45 offen offset:3072 lds
    s_add_u32 m0, s44, 12288
    s_lshl_b32 s45, s63, 12
    s_bitset1_b32 s45, 18
    buffer_load_dwordx4 v9, s[20:23], s45 offen lds
    buffer_load_dwordx4 v10, s[20:23], s45 offen offset:1024 lds
    buffer_load_dwordx4 v11, s[20:23], s45 offen offset:2048 lds
    buffer_load_dwordx4 v12, s[20:23], s45 offen offset:3072 lds
    s_mul_i32 s3, s47, 917504
    s_mul_i32 s4, s42, 2048
    s_add_u32 s3, s3, s4
    s_add_u32 s3, s3, 1048576
    s_lshr_b32 s4, s40, 1
    s_mul_i32 s4, s4, 7
    s_mul_i32 s5, s50, 3
    s_add_u32 s4, s4, s5
    s_waitcnt vmcnt(14)
    ds_read_b64_tr_b16 v[64:65], v29 offset:0
    ds_read_b64_tr_b16 v[66:67], v29 offset:512
    ds_read_b128 v[80:83], v25 offset:0
    ds_read_b64_tr_b16 v[68:69], v30 offset:0
    ds_read_b64_tr_b16 v[70:71], v30 offset:512
    ds_read_b128 v[84:87], v25 offset:4096
    s_waitcnt vmcnt(12)
    ds_read_b64_tr_b16 v[72:73], v29 offset:2048
    ds_read_b64_tr_b16 v[74:75], v29 offset:2560
    ds_read_b128 v[88:91], v26 offset:0
    ds_read_b64_tr_b16 v[76:77], v30 offset:2048
    ds_read_b64_tr_b16 v[78:79], v30 offset:2560
    ds_read_b128 v[92:95], v26 offset:4096
    s_add_u32 m0, s44, 16384
    s_lshl_b32 s45, s64, 12
    buffer_load_dwordx4 v9, s[20:23], s45 offen lds
    buffer_load_dwordx4 v10, s[20:23], s45 offen offset:1024 lds
    buffer_load_dwordx4 v11, s[20:23], s45 offen offset:2048 lds
    buffer_load_dwordx4 v12, s[20:23], s45 offen offset:3072 lds
    s_waitcnt lgkmcnt(9)
    v_mfma_f32_32x32x16_bf16 v[128:143], v[64:67], v[80:83], 0
    s_lshl_b32 s7, s50, 1
    s_waitcnt lgkmcnt(7)
    v_mfma_f32_32x32x16_bf16 v[160:175], v[68:71], v[80:83], 0
    s_waitcnt vmcnt(14)
    ds_read_b64_tr_b16 v[96:97], v29 offset:4096
    ds_read_b64_tr_b16 v[98:99], v29 offset:4608
    v_mov_b32 v4, 0
    s_waitcnt lgkmcnt(8)
    v_mfma_f32_32x32x16_bf16 v[144:159], v[64:67], v[84:87], 0
    ds_read_b128 v[112:115], v27 offset:0
    ds_read_b64_tr_b16 v[100:101], v30 offset:4096
    s_add_u32 s5, s50, 0
    v_mfma_f32_32x32x16_bf16 v[176:191], v[68:71], v[84:87], 0
    ds_read_b64_tr_b16 v[102:103], v30 offset:4608
    ds_read_b128 v[116:119], v27 offset:4096
    s_and_b32 s5, s5, 3
    s_waitcnt lgkmcnt(9)
    v_mfma_f32_32x32x16_bf16 v[128:143], v[72:75], v[88:91], v[128:143]
    s_waitcnt vmcnt(12)
    ds_read_b64_tr_b16 v[104:105], v29 offset:6144
    ds_read_b64_tr_b16 v[106:107], v29 offset:6656
    s_add_u32 s5, s5, s4
    s_waitcnt lgkmcnt(9)
    v_mfma_f32_32x32x16_bf16 v[160:175], v[76:79], v[88:91], v[160:175]
    ds_read_b128 v[120:123], v28 offset:0
    ds_read_b64_tr_b16 v[108:109], v30 offset:6144
    s_lshr_b32 s6, s5, 1
    s_waitcnt lgkmcnt(10)
    v_mfma_f32_32x32x16_bf16 v[144:159], v[72:75], v[92:95], v[144:159]
    ds_read_b64_tr_b16 v[110:111], v30 offset:6656
    ds_read_b128 v[124:127], v28 offset:4096
    s_lshl_b32 s6, s6, 2
    v_mfma_f32_32x32x16_bf16 v[176:191], v[76:79], v[92:95], v[176:191]
    s_and_b32 s5, s5, 1
    s_waitcnt lgkmcnt(9)
    v_mfma_f32_32x32x16_bf16 v[128:143], v[96:99], v[112:115], v[128:143]
    s_add_u32 m0, s44, 20480
    s_lshl_b32 s45, s64, 12
    s_bitset1_b32 s45, 18
    buffer_load_dwordx4 v9, s[20:23], s45 offen lds
    s_add_u32 s5, s5, s6
    s_waitcnt lgkmcnt(7)
    v_mfma_f32_32x32x16_bf16 v[160:175], v[100:103], v[112:115], v[160:175]
    s_waitcnt vmcnt(11)
    ds_read_b64_tr_b16 v[64:65], v29 offset:8192
    ds_read_b64_tr_b16 v[66:67], v29 offset:8704
    s_add_u32 s5, s5, s7
    s_waitcnt lgkmcnt(8)
    v_mfma_f32_32x32x16_bf16 v[144:159], v[96:99], v[116:119], v[144:159]
    buffer_load_dwordx4 v10, s[20:23], s45 offen offset:1024 lds
    ds_read_b128 v[80:83], v25 offset:16384
    ds_read_b64_tr_b16 v[68:69], v30 offset:8192
    s_lshl_b32 s6, s5, 15
    v_mfma_f32_32x32x16_bf16 v[176:191], v[100:103], v[116:119], v[176:191]
    ds_read_b64_tr_b16 v[70:71], v30 offset:8704
    ds_read_b128 v[84:87], v25 offset:20480
    s_add_u32 s52, s6, s3
    s_waitcnt lgkmcnt(9)
    v_mfma_f32_32x32x16_bf16 v[128:143], v[104:107], v[120:123], v[128:143]
    buffer_load_dwordx4 v11, s[20:23], s45 offen offset:2048 lds
    s_waitcnt vmcnt(11)
    ds_read_b64_tr_b16 v[72:73], v29 offset:10240
    ds_read_b64_tr_b16 v[74:75], v29 offset:10752
    s_lshl_b32 s6, s5, 8
    s_waitcnt lgkmcnt(9)
    v_mfma_f32_32x32x16_bf16 v[160:175], v[108:111], v[120:123], v[160:175]
    ds_read_b128 v[88:91], v26 offset:16384
    ds_read_b64_tr_b16 v[76:77], v30 offset:10240
    v_writelane_b32 v4, s6, 0
    s_waitcnt lgkmcnt(10)
    v_mfma_f32_32x32x16_bf16 v[144:159], v[104:107], v[124:127], v[144:159]
    buffer_load_dwordx4 v12, s[20:23], s45 offen offset:3072 lds
    ds_read_b64_tr_b16 v[78:79], v30 offset:10752
    ds_read_b128 v[92:95], v26 offset:20480
    s_add_u32 s6, s6, 128
    v_mfma_f32_32x32x16_bf16 v[176:191], v[108:111], v[124:127], v[176:191]
    v_writelane_b32 v4, s6, 1
    s_waitcnt lgkmcnt(9)
    v_mfma_f32_32x32x16_bf16 v[128:143], v[64:67], v[80:83], v[128:143]
    s_add_u32 m0, s44, 0
    s_lshl_b32 s45, s65, 12
    buffer_load_dwordx4 v9, s[20:23], s45 offen lds
    s_xor_b32 s5, s5, 2
    s_waitcnt lgkmcnt(7)
    v_mfma_f32_32x32x16_bf16 v[160:175], v[68:71], v[80:83], v[160:175]
    s_waitcnt vmcnt(11)
    ds_read_b64_tr_b16 v[96:97], v29 offset:12288
    ds_read_b64_tr_b16 v[98:99], v29 offset:12800
    s_lshl_b32 s6, s5, 15
    s_waitcnt lgkmcnt(8)
    v_mfma_f32_32x32x16_bf16 v[144:159], v[64:67], v[84:87], v[144:159]
    buffer_load_dwordx4 v10, s[20:23], s45 offen offset:1024 lds
    ds_read_b128 v[112:115], v27 offset:16384
    ds_read_b64_tr_b16 v[100:101], v30 offset:12288
    s_add_u32 s53, s6, s3
    v_mfma_f32_32x32x16_bf16 v[176:191], v[68:71], v[84:87], v[176:191]
    ds_read_b64_tr_b16 v[102:103], v30 offset:12800
    ds_read_b128 v[116:119], v27 offset:20480
    s_lshl_b32 s6, s5, 8
    s_waitcnt lgkmcnt(9)
    v_mfma_f32_32x32x16_bf16 v[128:143], v[72:75], v[88:91], v[128:143]
    buffer_load_dwordx4 v11, s[20:23], s45 offen offset:2048 lds
    s_waitcnt vmcnt(11)
    ds_read_b64_tr_b16 v[104:105], v29 offset:14336
    ds_read_b64_tr_b16 v[106:107], v29 offset:14848
    v_writelane_b32 v4, s6, 2
    s_waitcnt lgkmcnt(9)
    v_mfma_f32_32x32x16_bf16 v[160:175], v[76:79], v[88:91], v[160:175]
    ds_read_b128 v[120:123], v28 offset:16384
    ds_read_b64_tr_b16 v[108:109], v30 offset:14336
    s_add_u32 s6, s6, 128
    s_waitcnt lgkmcnt(10)
    v_mfma_f32_32x32x16_bf16 v[144:159], v[72:75], v[92:95], v[144:159]
    buffer_load_dwordx4 v12, s[20:23], s45 offen offset:3072 lds
    ds_read_b64_tr_b16 v[110:111], v30 offset:14848
    ds_read_b128 v[124:127], v28 offset:20480
    v_writelane_b32 v4, s6, 3
    v_mfma_f32_32x32x16_bf16 v[176:191], v[76:79], v[92:95], v[176:191]
    s_add_u32 s5, s50, 1
    s_waitcnt lgkmcnt(9)
    v_mfma_f32_32x32x16_bf16 v[128:143], v[96:99], v[112:115], v[128:143]
    s_add_u32 m0, s44, 4096
    s_lshl_b32 s45, s65, 12
    s_bitset1_b32 s45, 18
    buffer_load_dwordx4 v9, s[20:23], s45 offen lds
    s_and_b32 s5, s5, 3
    s_waitcnt lgkmcnt(7)
    v_mfma_f32_32x32x16_bf16 v[160:175], v[100:103], v[112:115], v[160:175]
    s_waitcnt vmcnt(11)
    ds_read_b64_tr_b16 v[64:65], v29 offset:16384
    ds_read_b64_tr_b16 v[66:67], v29 offset:16896
    s_add_u32 s5, s5, s4
    s_waitcnt lgkmcnt(8)
    v_mfma_f32_32x32x16_bf16 v[144:159], v[96:99], v[116:119], v[144:159]
    buffer_load_dwordx4 v10, s[20:23], s45 offen offset:1024 lds
    ds_read_b128 v[80:83], v25 offset:32768
    ds_read_b64_tr_b16 v[68:69], v30 offset:16384
    s_lshr_b32 s6, s5, 1
    v_mfma_f32_32x32x16_bf16 v[176:191], v[100:103], v[116:119], v[176:191]
    ds_read_b64_tr_b16 v[70:71], v30 offset:16896
    ds_read_b128 v[84:87], v25 offset:36864
    s_lshl_b32 s6, s6, 2
    s_waitcnt lgkmcnt(9)
    v_mfma_f32_32x32x16_bf16 v[128:143], v[104:107], v[120:123], v[128:143]
    buffer_load_dwordx4 v11, s[20:23], s45 offen offset:2048 lds
    s_waitcnt vmcnt(11)
    ds_read_b64_tr_b16 v[72:73], v29 offset:18432
    ds_read_b64_tr_b16 v[74:75], v29 offset:18944
    s_and_b32 s5, s5, 1
    s_waitcnt lgkmcnt(9)
    v_mfma_f32_32x32x16_bf16 v[160:175], v[108:111], v[120:123], v[160:175]
    ds_read_b128 v[88:91], v26 offset:32768
    ds_read_b64_tr_b16 v[76:77], v30 offset:18432
    s_add_u32 s5, s5, s6
    s_waitcnt lgkmcnt(10)
    v_mfma_f32_32x32x16_bf16 v[144:159], v[104:107], v[124:127], v[144:159]
    buffer_load_dwordx4 v12, s[20:23], s45 offen offset:3072 lds
    ds_read_b64_tr_b16 v[78:79], v30 offset:18944
    ds_read_b128 v[92:95], v26 offset:36864
    s_add_u32 s5, s5, s7
    v_mfma_f32_32x32x16_bf16 v[176:191], v[108:111], v[124:127], v[176:191]
    s_lshl_b32 s6, s5, 15
    s_waitcnt lgkmcnt(9)
    v_mfma_f32_32x32x16_bf16 v[128:143], v[64:67], v[80:83], v[128:143]
    s_add_u32 m0, s44, 8192
    s_lshl_b32 s45, s66, 12
    buffer_load_dwordx4 v9, s[20:23], s45 offen lds
    s_add_u32 s54, s6, s3
    s_waitcnt lgkmcnt(7)
    v_mfma_f32_32x32x16_bf16 v[160:175], v[68:71], v[80:83], v[160:175]
    s_waitcnt vmcnt(11)
    ds_read_b64_tr_b16 v[96:97], v29 offset:20480
    ds_read_b64_tr_b16 v[98:99], v29 offset:20992
    s_lshl_b32 s6, s5, 8
    s_waitcnt lgkmcnt(8)
    v_mfma_f32_32x32x16_bf16 v[144:159], v[64:67], v[84:87], v[144:159]
    buffer_load_dwordx4 v10, s[20:23], s45 offen offset:1024 lds
    ds_read_b128 v[112:115], v27 offset:32768
    ds_read_b64_tr_b16 v[100:101], v30 offset:20480
    v_writelane_b32 v4, s6, 4
    v_mfma_f32_32x32x16_bf16 v[176:191], v[68:71], v[84:87], v[176:191]
    ds_read_b64_tr_b16 v[102:103], v30 offset:20992
    ds_read_b128 v[116:119], v27 offset:36864
    s_add_u32 s6, s6, 128
    s_waitcnt lgkmcnt(9)
    v_mfma_f32_32x32x16_bf16 v[128:143], v[72:75], v[88:91], v[128:143]
    buffer_load_dwordx4 v11, s[20:23], s45 offen offset:2048 lds
    s_waitcnt vmcnt(11)
    ds_read_b64_tr_b16 v[104:105], v29 offset:22528
    ds_read_b64_tr_b16 v[106:107], v29 offset:23040
    v_writelane_b32 v4, s6, 5
    s_waitcnt lgkmcnt(9)
    v_mfma_f32_32x32x16_bf16 v[160:175], v[76:79], v[88:91], v[160:175]
    ds_read_b128 v[120:123], v28 offset:32768
    ds_read_b64_tr_b16 v[108:109], v30 offset:22528
    s_xor_b32 s5, s5, 2
    s_waitcnt lgkmcnt(10)
    v_mfma_f32_32x32x16_bf16 v[144:159], v[72:75], v[92:95], v[144:159]
    buffer_load_dwordx4 v12, s[20:23], s45 offen offset:3072 lds
    ds_read_b64_tr_b16 v[110:111], v30 offset:23040
    ds_read_b128 v[124:127], v28 offset:36864
    s_lshl_b32 s6, s5, 15
    v_mfma_f32_32x32x16_bf16 v[176:191], v[76:79], v[92:95], v[176:191]
    s_add_u32 s55, s6, s3
    s_waitcnt lgkmcnt(9)
    v_mfma_f32_32x32x16_bf16 v[128:143], v[96:99], v[112:115], v[128:143]
    s_add_u32 m0, s44, 12288
    s_lshl_b32 s45, s66, 12
    s_bitset1_b32 s45, 18
    buffer_load_dwordx4 v9, s[20:23], s45 offen lds
    s_lshl_b32 s6, s5, 8
    s_waitcnt lgkmcnt(7)
    v_mfma_f32_32x32x16_bf16 v[160:175], v[100:103], v[112:115], v[160:175]
    s_waitcnt vmcnt(11)
    ds_read_b64_tr_b16 v[64:65], v29 offset:0
    ds_read_b64_tr_b16 v[66:67], v29 offset:512
    v_writelane_b32 v4, s6, 6
    s_waitcnt lgkmcnt(8)
    v_mfma_f32_32x32x16_bf16 v[144:159], v[96:99], v[116:119], v[144:159]
    buffer_load_dwordx4 v10, s[20:23], s45 offen offset:1024 lds
    ds_read_b128 v[80:83], v25 offset:49152
    ds_read_b64_tr_b16 v[68:69], v30 offset:0
    s_add_u32 s6, s6, 128
    v_mfma_f32_32x32x16_bf16 v[176:191], v[100:103], v[116:119], v[176:191]
    ds_read_b64_tr_b16 v[70:71], v30 offset:512
    ds_read_b128 v[84:87], v25 offset:53248
    v_writelane_b32 v4, s6, 7
    s_waitcnt lgkmcnt(9)
    v_mfma_f32_32x32x16_bf16 v[128:143], v[104:107], v[120:123], v[128:143]
    buffer_load_dwordx4 v11, s[20:23], s45 offen offset:2048 lds
    s_waitcnt vmcnt(11)
    ds_read_b64_tr_b16 v[72:73], v29 offset:2048
    ds_read_b64_tr_b16 v[74:75], v29 offset:2560
    s_add_u32 s5, s50, 2
    s_waitcnt lgkmcnt(9)
    v_mfma_f32_32x32x16_bf16 v[160:175], v[108:111], v[120:123], v[160:175]
    ds_read_b128 v[88:91], v26 offset:49152
    ds_read_b64_tr_b16 v[76:77], v30 offset:2048
    s_and_b32 s5, s5, 3
    s_waitcnt lgkmcnt(10)
    v_mfma_f32_32x32x16_bf16 v[144:159], v[104:107], v[124:127], v[144:159]
    buffer_load_dwordx4 v12, s[20:23], s45 offen offset:3072 lds
    ds_read_b64_tr_b16 v[78:79], v30 offset:2560
    ds_read_b128 v[92:95], v26 offset:53248
    s_add_u32 s5, s5, s4
    v_mfma_f32_32x32x16_bf16 v[176:191], v[108:111], v[124:127], v[176:191]
    s_lshr_b32 s6, s5, 1
    s_waitcnt lgkmcnt(9)
    v_mfma_f32_32x32x16_bf16 v[128:143], v[64:67], v[80:83], v[128:143]
    s_add_u32 m0, s44, 16384
    s_lshl_b32 s45, s67, 12
    buffer_load_dwordx4 v9, s[20:23], s45 offen lds
    s_lshl_b32 s6, s6, 2
    s_waitcnt lgkmcnt(7)
    v_mfma_f32_32x32x16_bf16 v[160:175], v[68:71], v[80:83], v[160:175]
    s_waitcnt vmcnt(11)
    ds_read_b64_tr_b16 v[96:97], v29 offset:4096
    ds_read_b64_tr_b16 v[98:99], v29 offset:4608
    s_and_b32 s5, s5, 1
    s_waitcnt lgkmcnt(8)
    v_mfma_f32_32x32x16_bf16 v[144:159], v[64:67], v[84:87], v[144:159]
    buffer_load_dwordx4 v10, s[20:23], s45 offen offset:1024 lds
    ds_read_b128 v[112:115], v27 offset:49152
    ds_read_b64_tr_b16 v[100:101], v30 offset:4096
    s_add_u32 s5, s5, s6
    v_mfma_f32_32x32x16_bf16 v[176:191], v[68:71], v[84:87], v[176:191]
    ds_read_b64_tr_b16 v[102:103], v30 offset:4608
    ds_read_b128 v[116:119], v27 offset:53248
    s_add_u32 s5, s5, s7
    s_waitcnt lgkmcnt(9)
    v_mfma_f32_32x32x16_bf16 v[128:143], v[72:75], v[88:91], v[128:143]
    buffer_load_dwordx4 v11, s[20:23], s45 offen offset:2048 lds
    s_waitcnt vmcnt(11)
    ds_read_b64_tr_b16 v[104:105], v29 offset:6144
    ds_read_b64_tr_b16 v[106:107], v29 offset:6656
    s_lshl_b32 s6, s5, 15
    s_waitcnt lgkmcnt(9)
    v_mfma_f32_32x32x16_bf16 v[160:175], v[76:79], v[88:91], v[160:175]
    ds_read_b128 v[120:123], v28 offset:49152
    ds_read_b64_tr_b16 v[108:109], v30 offset:6144
    s_add_u32 s56, s6, s3
    s_waitcnt lgkmcnt(10)
    v_mfma_f32_32x32x16_bf16 v[144:159], v[72:75], v[92:95], v[144:159]
    buffer_load_dwordx4 v12, s[20:23], s45 offen offset:3072 lds
    ds_read_b64_tr_b16 v[110:111], v30 offset:6656
    ds_read_b128 v[124:127], v28 offset:53248
    s_lshl_b32 s6, s5, 8
    v_mfma_f32_32x32x16_bf16 v[176:191], v[76:79], v[92:95], v[176:191]
    v_writelane_b32 v4, s6, 8
    s_waitcnt lgkmcnt(9)
    v_mfma_f32_32x32x16_bf16 v[128:143], v[96:99], v[112:115], v[128:143]
    s_add_u32 m0, s44, 20480
    s_lshl_b32 s45, s67, 12
    s_bitset1_b32 s45, 18
    buffer_load_dwordx4 v9, s[20:23], s45 offen lds
    s_add_u32 s6, s6, 128
    s_waitcnt lgkmcnt(7)
    v_mfma_f32_32x32x16_bf16 v[160:175], v[100:103], v[112:115], v[160:175]
    s_waitcnt vmcnt(11)
    ds_read_b64_tr_b16 v[64:65], v29 offset:8192
    ds_read_b64_tr_b16 v[66:67], v29 offset:8704
    v_writelane_b32 v4, s6, 9
    s_waitcnt lgkmcnt(8)
    v_mfma_f32_32x32x16_bf16 v[144:159], v[96:99], v[116:119], v[144:159]
    buffer_load_dwordx4 v10, s[20:23], s45 offen offset:1024 lds
    ds_read_b128 v[80:83], v25 offset:8192
    ds_read_b64_tr_b16 v[68:69], v30 offset:8192
    s_xor_b32 s5, s5, 2
    v_mfma_f32_32x32x16_bf16 v[176:191], v[100:103], v[116:119], v[176:191]
    ds_read_b64_tr_b16 v[70:71], v30 offset:8704
    ds_read_b128 v[84:87], v25 offset:12288
    s_lshl_b32 s6, s5, 15
    s_waitcnt lgkmcnt(9)
    v_mfma_f32_32x32x16_bf16 v[128:143], v[104:107], v[120:123], v[128:143]
    buffer_load_dwordx4 v11, s[20:23], s45 offen offset:2048 lds
    s_waitcnt vmcnt(11)
    ds_read_b64_tr_b16 v[72:73], v29 offset:10240
    ds_read_b64_tr_b16 v[74:75], v29 offset:10752
    s_add_u32 s57, s6, s3
    s_waitcnt lgkmcnt(9)
    v_mfma_f32_32x32x16_bf16 v[160:175], v[108:111], v[120:123], v[160:175]
    ds_read_b128 v[88:91], v26 offset:8192
    ds_read_b64_tr_b16 v[76:77], v30 offset:10240
    s_lshl_b32 s6, s5, 8
    s_waitcnt lgkmcnt(10)
    v_mfma_f32_32x32x16_bf16 v[144:159], v[104:107], v[124:127], v[144:159]
    buffer_load_dwordx4 v12, s[20:23], s45 offen offset:3072 lds
    ds_read_b64_tr_b16 v[78:79], v30 offset:10752
    ds_read_b128 v[92:95], v26 offset:12288
    v_writelane_b32 v4, s6, 10
    v_mfma_f32_32x32x16_bf16 v[176:191], v[108:111], v[124:127], v[176:191]
    s_add_u32 s6, s6, 128
    s_waitcnt lgkmcnt(9)
    v_mfma_f32_32x32x16_bf16 v[128:143], v[64:67], v[80:83], v[128:143]
    s_add_u32 m0, s44, 0
    s_lshl_b32 s45, s68, 12
    buffer_load_dwordx4 v9, s[20:23], s45 offen lds
    v_writelane_b32 v4, s6, 11
    s_waitcnt lgkmcnt(7)
    v_mfma_f32_32x32x16_bf16 v[160:175], v[68:71], v[80:83], v[160:175]
    s_barrier
    s_waitcnt vmcnt(11)
    ds_read_b64_tr_b16 v[96:97], v29 offset:12288
    ds_read_b64_tr_b16 v[98:99], v29 offset:12800
    s_add_u32 s5, s50, 3
    s_waitcnt lgkmcnt(8)
    v_mfma_f32_32x32x16_bf16 v[144:159], v[64:67], v[84:87], v[144:159]
    buffer_load_dwordx4 v10, s[20:23], s45 offen offset:1024 lds
    ds_read_b128 v[112:115], v27 offset:8192
    ds_read_b64_tr_b16 v[100:101], v30 offset:12288
    s_and_b32 s5, s5, 3
    v_mfma_f32_32x32x16_bf16 v[176:191], v[68:71], v[84:87], v[176:191]
    ds_read_b64_tr_b16 v[102:103], v30 offset:12800
    ds_read_b128 v[116:119], v27 offset:12288
    s_add_u32 s5, s5, s4
    s_waitcnt lgkmcnt(9)
    v_mfma_f32_32x32x16_bf16 v[128:143], v[72:75], v[88:91], v[128:143]
    buffer_load_dwordx4 v11, s[20:23], s45 offen offset:2048 lds
    s_waitcnt vmcnt(11)
    ds_read_b64_tr_b16 v[104:105], v29 offset:14336
    ds_read_b64_tr_b16 v[106:107], v29 offset:14848
    s_lshr_b32 s6, s5, 1
    s_waitcnt lgkmcnt(9)
    v_mfma_f32_32x32x16_bf16 v[160:175], v[76:79], v[88:91], v[160:175]
    ds_read_b128 v[120:123], v28 offset:8192
    ds_read_b64_tr_b16 v[108:109], v30 offset:14336
    s_lshl_b32 s6, s6, 2
    s_waitcnt lgkmcnt(10)
    v_mfma_f32_32x32x16_bf16 v[144:159], v[72:75], v[92:95], v[144:159]
    buffer_load_dwordx4 v12, s[20:23], s45 offen offset:3072 lds
    ds_read_b64_tr_b16 v[110:111], v30 offset:14848
    ds_read_b128 v[124:127], v28 offset:12288
    s_and_b32 s5, s5, 1
    v_mfma_f32_32x32x16_bf16 v[176:191], v[76:79], v[92:95], v[176:191]
    s_add_u32 s5, s5, s6
    s_waitcnt lgkmcnt(9)
    v_mfma_f32_32x32x16_bf16 v[128:143], v[96:99], v[112:115], v[128:143]
    s_add_u32 m0, s44, 4096
    s_lshl_b32 s45, s68, 12
    s_bitset1_b32 s45, 18
    buffer_load_dwordx4 v9, s[20:23], s45 offen lds
    s_add_u32 s5, s5, s7
    s_waitcnt lgkmcnt(7)
    v_mfma_f32_32x32x16_bf16 v[160:175], v[100:103], v[112:115], v[160:175]
    s_waitcnt vmcnt(11)
    ds_read_b64_tr_b16 v[64:65], v29 offset:16384
    ds_read_b64_tr_b16 v[66:67], v29 offset:16896
    s_lshl_b32 s6, s5, 15
    s_waitcnt lgkmcnt(8)
    v_mfma_f32_32x32x16_bf16 v[144:159], v[96:99], v[116:119], v[144:159]
    buffer_load_dwordx4 v10, s[20:23], s45 offen offset:1024 lds
    ds_read_b128 v[80:83], v25 offset:24576
    ds_read_b64_tr_b16 v[68:69], v30 offset:16384
    s_add_u32 s58, s6, s3
    v_mfma_f32_32x32x16_bf16 v[176:191], v[100:103], v[116:119], v[176:191]
    ds_read_b64_tr_b16 v[70:71], v30 offset:16896
    ds_read_b128 v[84:87], v25 offset:28672
    s_lshl_b32 s6, s5, 8
    s_waitcnt lgkmcnt(9)
    v_mfma_f32_32x32x16_bf16 v[128:143], v[104:107], v[120:123], v[128:143]
    buffer_load_dwordx4 v11, s[20:23], s45 offen offset:2048 lds
    s_waitcnt vmcnt(11)
    ds_read_b64_tr_b16 v[72:73], v29 offset:18432
    ds_read_b64_tr_b16 v[74:75], v29 offset:18944
    v_writelane_b32 v4, s6, 12
    s_waitcnt lgkmcnt(9)
    v_mfma_f32_32x32x16_bf16 v[160:175], v[108:111], v[120:123], v[160:175]
    ds_read_b128 v[88:91], v26 offset:24576
    ds_read_b64_tr_b16 v[76:77], v30 offset:18432
    s_add_u32 s6, s6, 128
    s_waitcnt lgkmcnt(10)
    v_mfma_f32_32x32x16_bf16 v[144:159], v[104:107], v[124:127], v[144:159]
    buffer_load_dwordx4 v12, s[20:23], s45 offen offset:3072 lds
    ds_read_b64_tr_b16 v[78:79], v30 offset:18944
    ds_read_b128 v[92:95], v26 offset:28672
    v_writelane_b32 v4, s6, 13
    v_mfma_f32_32x32x16_bf16 v[176:191], v[108:111], v[124:127], v[176:191]
    s_waitcnt lgkmcnt(9)
    v_mfma_f32_32x32x16_bf16 v[128:143], v[64:67], v[80:83], v[128:143]
    s_add_u32 m0, s44, 8192
    s_xor_b32 s45, s69, 0
    buffer_load_dwordx4 v13, s[12:15], s45 offen nt lds
    s_waitcnt lgkmcnt(7)
    v_mfma_f32_32x32x16_bf16 v[160:175], v[68:71], v[80:83], v[160:175]
    s_waitcnt vmcnt(11)
    ds_read_b64_tr_b16 v[96:97], v29 offset:20480
    ds_read_b64_tr_b16 v[98:99], v29 offset:20992
    s_waitcnt lgkmcnt(8)
    v_mfma_f32_32x32x16_bf16 v[144:159], v[64:67], v[84:87], v[144:159]
    buffer_load_dwordx4 v14, s[12:15], s45 offen offset:1024 nt lds
    ds_read_b128 v[112:115], v27 offset:24576
    ds_read_b64_tr_b16 v[100:101], v30 offset:20480
    v_mfma_f32_32x32x16_bf16 v[176:191], v[68:71], v[84:87], v[176:191]
    ds_read_b64_tr_b16 v[102:103], v30 offset:20992
    ds_read_b128 v[116:119], v27 offset:28672
    s_waitcnt lgkmcnt(9)
    v_mfma_f32_32x32x16_bf16 v[128:143], v[72:75], v[88:91], v[128:143]
    buffer_load_dwordx4 v15, s[12:15], s45 offen offset:2048 nt lds
    s_waitcnt vmcnt(11)
    ds_read_b64_tr_b16 v[104:105], v29 offset:22528
    ds_read_b64_tr_b16 v[106:107], v29 offset:23040
    s_waitcnt lgkmcnt(9)
    v_mfma_f32_32x32x16_bf16 v[160:175], v[76:79], v[88:91], v[160:175]
    ds_read_b128 v[120:123], v28 offset:24576
    ds_read_b64_tr_b16 v[108:109], v30 offset:22528
    s_waitcnt lgkmcnt(10)
    v_mfma_f32_32x32x16_bf16 v[144:159], v[72:75], v[92:95], v[144:159]
    buffer_load_dwordx4 v16, s[12:15], s45 offen offset:3072 nt lds
    ds_read_b64_tr_b16 v[110:111], v30 offset:23040
    ds_read_b128 v[124:127], v28 offset:28672
    v_mfma_f32_32x32x16_bf16 v[176:191], v[76:79], v[92:95], v[176:191]
    s_waitcnt lgkmcnt(9)
    v_mfma_f32_32x32x16_bf16 v[128:143], v[96:99], v[112:115], v[128:143]
    s_add_u32 m0, s44, 12288
    s_xor_b32 s45, s69, 128
    buffer_load_dwordx4 v13, s[12:15], s45 offen nt lds
    s_waitcnt lgkmcnt(7)
    v_mfma_f32_32x32x16_bf16 v[160:175], v[100:103], v[112:115], v[160:175]
    s_waitcnt vmcnt(11)
    ds_read_b64_tr_b16 v[64:65], v29 offset:0
    ds_read_b64_tr_b16 v[66:67], v29 offset:512
    s_waitcnt lgkmcnt(8)
    v_mfma_f32_32x32x16_bf16 v[144:159], v[96:99], v[116:119], v[144:159]
    buffer_load_dwordx4 v14, s[12:15], s45 offen offset:1024 nt lds
    ds_read_b128 v[80:83], v25 offset:40960
    ds_read_b64_tr_b16 v[68:69], v30 offset:0
    v_mfma_f32_32x32x16_bf16 v[176:191], v[100:103], v[116:119], v[176:191]
    ds_read_b64_tr_b16 v[70:71], v30 offset:512
    ds_read_b128 v[84:87], v25 offset:45056
    s_waitcnt lgkmcnt(9)
    v_mfma_f32_32x32x16_bf16 v[128:143], v[104:107], v[120:123], v[128:143]
    buffer_load_dwordx4 v15, s[12:15], s45 offen offset:2048 nt lds
    s_waitcnt vmcnt(11)
    ds_read_b64_tr_b16 v[72:73], v29 offset:2048
    ds_read_b64_tr_b16 v[74:75], v29 offset:2560
    s_waitcnt lgkmcnt(9)
    v_mfma_f32_32x32x16_bf16 v[160:175], v[108:111], v[120:123], v[160:175]
    ds_read_b128 v[88:91], v26 offset:40960
    ds_read_b64_tr_b16 v[76:77], v30 offset:2048
    s_waitcnt lgkmcnt(10)
    v_mfma_f32_32x32x16_bf16 v[144:159], v[104:107], v[124:127], v[144:159]
    buffer_load_dwordx4 v16, s[12:15], s45 offen offset:3072 nt lds
    ds_read_b64_tr_b16 v[78:79], v30 offset:2560
    ds_read_b128 v[92:95], v26 offset:45056
    v_mfma_f32_32x32x16_bf16 v[176:191], v[108:111], v[124:127], v[176:191]
    s_waitcnt lgkmcnt(9)
    v_mfma_f32_32x32x16_bf16 v[128:143], v[64:67], v[80:83], v[128:143]
    s_add_u32 m0, s44, 16384
    s_xor_b32 s45, s69, 256
    buffer_load_dwordx4 v13, s[12:15], s45 offen nt lds
    s_waitcnt lgkmcnt(7)
    v_mfma_f32_32x32x16_bf16 v[160:175], v[68:71], v[80:83], v[160:175]
    s_waitcnt vmcnt(11)
    ds_read_b64_tr_b16 v[96:97], v29 offset:4096
    ds_read_b64_tr_b16 v[98:99], v29 offset:4608
    s_waitcnt lgkmcnt(8)
    v_mfma_f32_32x32x16_bf16 v[144:159], v[64:67], v[84:87], v[144:159]
    buffer_load_dwordx4 v14, s[12:15], s45 offen offset:1024 nt lds
    ds_read_b128 v[112:115], v27 offset:40960
    ds_read_b64_tr_b16 v[100:101], v30 offset:4096
    v_mfma_f32_32x32x16_bf16 v[176:191], v[68:71], v[84:87], v[176:191]
    ds_read_b64_tr_b16 v[102:103], v30 offset:4608
    ds_read_b128 v[116:119], v27 offset:45056
    s_waitcnt lgkmcnt(9)
    v_mfma_f32_32x32x16_bf16 v[128:143], v[72:75], v[88:91], v[128:143]
    buffer_load_dwordx4 v15, s[12:15], s45 offen offset:2048 nt lds
    s_waitcnt vmcnt(11)
    ds_read_b64_tr_b16 v[104:105], v29 offset:6144
    ds_read_b64_tr_b16 v[106:107], v29 offset:6656
    s_waitcnt lgkmcnt(9)
    v_mfma_f32_32x32x16_bf16 v[160:175], v[76:79], v[88:91], v[160:175]
    ds_read_b128 v[120:123], v28 offset:40960
    ds_read_b64_tr_b16 v[108:109], v30 offset:6144
    s_waitcnt lgkmcnt(10)
    v_mfma_f32_32x32x16_bf16 v[144:159], v[72:75], v[92:95], v[144:159]
    buffer_load_dwordx4 v16, s[12:15], s45 offen offset:3072 nt lds
    ds_read_b64_tr_b16 v[110:111], v30 offset:6656
    ds_read_b128 v[124:127], v28 offset:45056
    v_mfma_f32_32x32x16_bf16 v[176:191], v[76:79], v[92:95], v[176:191]
    s_waitcnt lgkmcnt(9)
    v_mfma_f32_32x32x16_bf16 v[128:143], v[96:99], v[112:115], v[128:143]
    s_add_u32 m0, s44, 20480
    s_xor_b32 s45, s69, 384
    buffer_load_dwordx4 v13, s[12:15], s45 offen nt lds
    s_waitcnt lgkmcnt(3)
    v_mfma_f32_32x32x16_bf16 v[128:143], v[104:107], v[120:123], v[128:143]
    buffer_load_dwordx4 v14, s[12:15], s45 offen offset:1024 nt lds
    v_mfma_f32_32x32x16_bf16 v[144:159], v[96:99], v[116:119], v[144:159]
    buffer_load_dwordx4 v15, s[12:15], s45 offen offset:2048 nt lds
    s_waitcnt lgkmcnt(0)
    v_mfma_f32_32x32x16_bf16 v[144:159], v[104:107], v[124:127], v[144:159]
    buffer_load_dwordx4 v16, s[12:15], s45 offen offset:3072 nt lds
    v_mfma_f32_32x32x16_bf16 v[160:175], v[100:103], v[112:115], v[160:175]
    s_nop 4
    v_cvt_pk_bf16_f32 v64, v128, v129
    v_cvt_pk_bf16_f32 v65, v130, v131
    v_cvt_pk_bf16_f32 v66, v132, v133
    v_cvt_pk_bf16_f32 v67, v134, v135
    ds_write_b128 v42, v[64:67] offset:0
    v_cvt_pk_bf16_f32 v72, v136, v137
    v_cvt_pk_bf16_f32 v73, v138, v139
    v_cvt_pk_bf16_f32 v74, v140, v141
    v_cvt_pk_bf16_f32 v75, v142, v143
    ds_write_b128 v42, v[72:75] offset:2048
    v_mfma_f32_32x32x16_bf16 v[160:175], v[108:111], v[120:123], v[160:175]
    v_mfma_f32_32x32x16_bf16 v[176:191], v[100:103], v[116:119], v[176:191]
    v_cvt_pk_bf16_f32 v68, v144, v145
    v_cvt_pk_bf16_f32 v69, v146, v147
    v_cvt_pk_bf16_f32 v70, v148, v149
    v_cvt_pk_bf16_f32 v71, v150, v151
    ds_write_b128 v42, v[68:71] offset:1024
    v_cvt_pk_bf16_f32 v76, v152, v153
    v_cvt_pk_bf16_f32 v77, v154, v155
    v_cvt_pk_bf16_f32 v78, v156, v157
    v_cvt_pk_bf16_f32 v79, v158, v159
    ds_write_b128 v42, v[76:79] offset:3072
    v_mfma_f32_32x32x16_bf16 v[176:191], v[108:111], v[124:127], v[176:191]
    v_cvt_pk_bf16_f32 v80, v160, v161
    v_cvt_pk_bf16_f32 v81, v162, v163
    v_cvt_pk_bf16_f32 v82, v164, v165
    v_cvt_pk_bf16_f32 v83, v166, v167
    ds_write_b128 v42, v[80:83] offset:4096
    v_cvt_pk_bf16_f32 v88, v168, v169
    v_cvt_pk_bf16_f32 v89, v170, v171
    v_cvt_pk_bf16_f32 v90, v172, v173
    v_cvt_pk_bf16_f32 v91, v174, v175
    ds_write_b128 v42, v[88:91] offset:6144
    s_nop 1
    v_cvt_pk_bf16_f32 v84, v176, v177
    v_cvt_pk_bf16_f32 v85, v178, v179
    v_cvt_pk_bf16_f32 v86, v180, v181
    v_cvt_pk_bf16_f32 v87, v182, v183
    ds_write_b128 v42, v[84:87] offset:5120
    v_cvt_pk_bf16_f32 v92, v184, v185
    v_cvt_pk_bf16_f32 v93, v186, v187
    v_cvt_pk_bf16_f32 v94, v188, v189
    v_cvt_pk_bf16_f32 v95, v190, v191
    ds_write_b128 v42, v[92:95] offset:7168
    s_waitcnt vmcnt(12)
    ds_read_b128 v[96:99], v31 offset:8192
    ds_read_b128 v[100:103], v32 offset:8192
    ds_read_b128 v[104:107], v33 offset:8192
    ds_read_b128 v[108:111], v34 offset:8192
    s_add_u32 m0, s44, 0
    s_xor_b32 s45, s69, 65536
    buffer_load_dwordx4 v13, s[12:15], s45 offen nt lds
    buffer_load_dwordx4 v14, s[12:15], s45 offen offset:1024 nt lds
    buffer_load_dwordx4 v15, s[12:15], s45 offen offset:2048 nt lds
    buffer_load_dwordx4 v16, s[12:15], s45 offen offset:3072 nt lds
    s_waitcnt lgkmcnt(3)
    v_mfma_f32_32x32x16_bf16 v[128:143], v[96:99], v[64:67], 0
    v_mfma_f32_32x32x16_bf16 v[144:159], v[96:99], v[68:71], 0
    s_barrier
    ds_read_b128 a[32:35], v45 offset:0
    ds_read_b128 a[36:39], v45 offset:1024
    s_waitcnt lgkmcnt(4)
    v_mfma_f32_32x32x16_bf16 v[128:143], v[100:103], v[72:75], v[128:143]
    ds_read_b128 a[40:43], v45 offset:2048
    ds_read_b128 a[44:47], v45 offset:3072
    v_mfma_f32_32x32x16_bf16 v[144:159], v[100:103], v[76:79], v[144:159]
    ds_read_b128 a[48:51], v45 offset:4096
    ds_read_b128 a[52:55], v45 offset:5120
    s_waitcnt lgkmcnt(7)
    v_mfma_f32_32x32x16_bf16 v[128:143], v[104:107], v[80:83], v[128:143]
    ds_read_b128 a[56:59], v45 offset:6144
    ds_read_b128 a[60:63], v45 offset:7168
    v_mfma_f32_32x32x16_bf16 v[144:159], v[104:107], v[84:87], v[144:159]
    s_waitcnt vmcnt(12)
    ds_read_b128 v[112:115], v31 offset:12288
    ds_read_b128 v[116:119], v32 offset:12288
    s_waitcnt lgkmcnt(10)
    v_mfma_f32_32x32x16_bf16 v[128:143], v[108:111], v[88:91], v[128:143]
    ds_read_b128 v[120:123], v33 offset:12288
    ds_read_b128 v[124:127], v34 offset:12288
    v_mfma_f32_32x32x16_bf16 v[144:159], v[108:111], v[92:95], v[144:159]
    s_waitcnt lgkmcnt(3)
    v_mfma_f32_32x32x16_bf16 v[128:143], v[112:115], a[32:35], v[128:143]
    s_add_u32 m0, s44, 4096
    s_xor_b32 s45, s69, 65664
    buffer_load_dwordx4 v13, s[12:15], s45 offen nt lds
    v_mfma_f32_32x32x16_bf16 v[144:159], v[112:115], a[36:39], v[144:159]
    ds_read_b128 a[64:67], v46 offset:0
    ds_read_b128 a[68:71], v46 offset:1024
    s_waitcnt lgkmcnt(4)
    v_mfma_f32_32x32x16_bf16 v[128:143], v[116:119], a[40:43], v[128:143]
    buffer_load_dwordx4 v14, s[12:15], s45 offen offset:1024 nt lds
    ds_read_b128 a[72:75], v46 offset:2048
    ds_read_b128 a[76:79], v46 offset:3072
    v_mfma_f32_32x32x16_bf16 v[144:159], v[116:119], a[44:47], v[144:159]
    ds_read_b128 a[80:83], v46 offset:4096
    ds_read_b128 a[84:87], v46 offset:5120
    s_waitcnt lgkmcnt(7)
    v_mfma_f32_32x32x16_bf16 v[128:143], v[120:123], a[48:51], v[128:143]
    buffer_load_dwordx4 v15, s[12:15], s45 offen offset:2048 nt lds
    ds_read_b128 a[88:91], v46 offset:6144
    ds_read_b128 a[92:95], v46 offset:7168
    v_mfma_f32_32x32x16_bf16 v[144:159], v[120:123], a[52:55], v[144:159]
    s_waitcnt vmcnt(11)
    ds_read_b128 v[96:99], v31 offset:16384
    ds_read_b128 v[100:103], v32 offset:16384
    s_waitcnt lgkmcnt(10)
    v_mfma_f32_32x32x16_bf16 v[128:143], v[124:127], a[56:59], v[128:143]
    buffer_load_dwordx4 v16, s[12:15], s45 offen offset:3072 nt lds
    ds_read_b128 v[104:107], v33 offset:16384
    ds_read_b128 v[108:111], v34 offset:16384
    v_mfma_f32_32x32x16_bf16 v[144:159], v[124:127], a[60:63], v[144:159]
    s_waitcnt lgkmcnt(3)
    v_mfma_f32_32x32x16_bf16 v[128:143], v[96:99], a[64:67], v[128:143]
    s_add_u32 m0, s44, 8192
    s_xor_b32 s45, s69, 65792
    buffer_load_dwordx4 v13, s[12:15], s45 offen nt lds
    v_mfma_f32_32x32x16_bf16 v[144:159], v[96:99], a[68:71], v[144:159]
    ds_read_b128 a[96:99], v47 offset:0
    ds_read_b128 a[100:103], v47 offset:1024
    s_waitcnt lgkmcnt(4)
    v_mfma_f32_32x32x16_bf16 v[128:143], v[100:103], a[72:75], v[128:143]
    buffer_load_dwordx4 v14, s[12:15], s45 offen offset:1024 nt lds
    ds_read_b128 a[104:107], v47 offset:2048
    ds_read_b128 a[108:111], v47 offset:3072
    v_mfma_f32_32x32x16_bf16 v[144:159], v[100:103], a[76:79], v[144:159]
    ds_read_b128 a[112:115], v47 offset:4096
    ds_read_b128 a[116:119], v47 offset:5120
    s_waitcnt lgkmcnt(7)
    v_mfma_f32_32x32x16_bf16 v[128:143], v[104:107], a[80:83], v[128:143]
    buffer_load_dwordx4 v15, s[12:15], s45 offen offset:2048 nt lds
    ds_read_b128 a[120:123], v47 offset:6144
    ds_read_b128 a[124:127], v47 offset:7168
    v_mfma_f32_32x32x16_bf16 v[144:159], v[104:107], a[84:87], v[144:159]
    s_waitcnt vmcnt(11)
    ds_read_b128 v[112:115], v31 offset:20480
    ds_read_b128 v[116:119], v32 offset:20480
    s_waitcnt lgkmcnt(10)
    v_mfma_f32_32x32x16_bf16 v[128:143], v[108:111], a[88:91], v[128:143]
    buffer_load_dwordx4 v16, s[12:15], s45 offen offset:3072 nt lds
    ds_read_b128 v[120:123], v33 offset:20480
    ds_read_b128 v[124:127], v34 offset:20480
    v_mfma_f32_32x32x16_bf16 v[144:159], v[108:111], a[92:95], v[144:159]
    s_waitcnt lgkmcnt(3)
    v_mfma_f32_32x32x16_bf16 v[128:143], v[112:115], a[96:99], v[128:143]
    s_add_u32 m0, s44, 12288
    s_xor_b32 s45, s69, 65920
    buffer_load_dwordx4 v13, s[12:15], s45 offen nt lds
    v_mfma_f32_32x32x16_bf16 v[144:159], v[112:115], a[100:103], v[144:159]
    s_waitcnt vmcnt(9)
    ds_read_b128 v[96:99], v31 offset:0
    s_waitcnt lgkmcnt(3)
    v_mfma_f32_32x32x16_bf16 v[128:143], v[116:119], a[104:107], v[128:143]
    buffer_load_dwordx4 v14, s[12:15], s45 offen offset:1024 nt lds
    ds_read_b128 v[100:103], v32 offset:0
    v_mfma_f32_32x32x16_bf16 v[144:159], v[116:119], a[108:111], v[144:159]
    s_waitcnt lgkmcnt(3)
    v_mfma_f32_32x32x16_bf16 v[128:143], v[120:123], a[112:115], v[128:143]
    buffer_load_dwordx4 v15, s[12:15], s45 offen offset:2048 nt lds
    ds_read_b128 v[104:107], v33 offset:0
    v_mfma_f32_32x32x16_bf16 v[144:159], v[120:123], a[116:119], v[144:159]
    ds_read_b128 v[108:111], v34 offset:0
    s_waitcnt lgkmcnt(4)
    v_mfma_f32_32x32x16_bf16 v[128:143], v[124:127], a[120:123], v[128:143]
    buffer_load_dwordx4 v16, s[12:15], s45 offen offset:3072 nt lds
    v_mfma_f32_32x32x16_bf16 v[144:159], v[124:127], a[124:127], v[144:159]
    s_waitcnt lgkmcnt(3)
    v_mfma_f32_32x32x16_bf16 v[160:175], v[96:99], v[64:67], 0
    s_add_u32 m0, s44, 16384
    s_xor_b32 s45, s69, 131072
    buffer_load_dwordx4 v13, s[12:15], s45 offen nt lds
    s_nop 4
    v_max3_f32 v48, v128, v129, v130
    v_max3_f32 v48, v48, v131, v132
    v_max3_f32 v48, v48, v133, v134
    v_max3_f32 v48, v48, v135, v136
    v_max3_f32 v48, v48, v137, v138
    v_mfma_f32_32x32x16_bf16 v[176:191], v[96:99], v[68:71], 0
    s_waitcnt vmcnt(9)
    ds_read_b128 v[112:115], v31 offset:4096
    v_max3_f32 v48, v48, v139, v140
    v_max3_f32 v48, v48, v141, v142
    v_max_f32 v48, v48, v143
    v_mul_f32 v48, s46, v48
    v_fma_f32 v128, v128, s46, -v48
    s_waitcnt lgkmcnt(3)
    v_mfma_f32_32x32x16_bf16 v[160:175], v[100:103], v[72:75], v[160:175]
    buffer_load_dwordx4 v14, s[12:15], s45 offen offset:1024 nt lds
    ds_read_b128 v[116:119], v32 offset:4096
    v_fma_f32 v129, v129, s46, -v48
    v_fma_f32 v130, v130, s46, -v48
    v_fma_f32 v131, v131, s46, -v48
    v_fma_f32 v132, v132, s46, -v48
    v_fma_f32 v133, v133, s46, -v48
    v_mfma_f32_32x32x16_bf16 v[176:191], v[100:103], v[76:79], v[176:191]
    v_fma_f32 v134, v134, s46, -v48
    v_fma_f32 v135, v135, s46, -v48
    v_fma_f32 v136, v136, s46, -v48
    v_fma_f32 v137, v137, s46, -v48
    v_fma_f32 v138, v138, s46, -v48
    s_waitcnt lgkmcnt(3)
    v_mfma_f32_32x32x16_bf16 v[160:175], v[104:107], v[80:83], v[160:175]
    buffer_load_dwordx4 v15, s[12:15], s45 offen offset:2048 nt lds
    ds_read_b128 v[120:123], v33 offset:4096
    v_fma_f32 v139, v139, s46, -v48
    v_fma_f32 v140, v140, s46, -v48
    v_fma_f32 v141, v141, s46, -v48
    v_fma_f32 v142, v142, s46, -v48
    v_fma_f32 v143, v143, s46, -v48
    v_mfma_f32_32x32x16_bf16 v[176:191], v[104:107], v[84:87], v[176:191]
    ds_read_b128 v[124:127], v34 offset:4096
    v_exp_f32 v128, v128
    v_exp_f32 v129, v129
    v_exp_f32 v130, v130
    v_add_f32 v56, v128, v129
    v_exp_f32 v131, v131
    s_waitcnt lgkmcnt(4)
    v_mfma_f32_32x32x16_bf16 v[160:175], v[108:111], v[88:91], v[160:175]
    buffer_load_dwordx4 v16, s[12:15], s45 offen offset:3072 nt lds
    v_add_f32 v56, v56, v130
    v_exp_f32 v132, v132
    v_add_f32 v56, v56, v131
    v_exp_f32 v133, v133
    v_add_f32 v56, v56, v132
    v_mfma_f32_32x32x16_bf16 v[176:191], v[108:111], v[92:95], v[176:191]
    v_exp_f32 v134, v134
    v_add_f32 v56, v56, v133
    v_exp_f32 v135, v135
    v_add_f32 v56, v56, v134
    v_exp_f32 v136, v136
    s_waitcnt lgkmcnt(3)
    v_mfma_f32_32x32x16_bf16 v[160:175], v[112:115], a[32:35], v[160:175]
    s_add_u32 m0, s44, 20480
    s_xor_b32 s45, s69, 131200
    buffer_load_dwordx4 v13, s[12:15], s45 offen nt lds
    v_add_f32 v56, v56, v135
    v_exp_f32 v137, v137
    v_add_f32 v56, v56, v136
    v_exp_f32 v138, v138
    v_add_f32 v56, v56, v137
    v_mfma_f32_32x32x16_bf16 v[176:191], v[112:115], a[36:39], v[176:191]
    s_waitcnt vmcnt(9)
    ds_read_b128 v[96:99], v31 offset:8192
    v_exp_f32 v139, v139
    v_add_f32 v56, v56, v138
    v_exp_f32 v140, v140
    v_add_f32 v56, v56, v139
    v_exp_f32 v141, v141
    s_waitcnt lgkmcnt(3)
    v_mfma_f32_32x32x16_bf16 v[160:175], v[116:119], a[40:43], v[160:175]
    buffer_load_dwordx4 v14, s[12:15], s45 offen offset:1024 nt lds
    ds_read_b128 v[100:103], v32 offset:8192
    v_add_f32 v56, v56, v140
    v_exp_f32 v142, v142
    v_add_f32 v56, v56, v141
    v_exp_f32 v143, v143
    v_add_f32 v56, v56, v142
    v_mfma_f32_32x32x16_bf16 v[176:191], v[116:119], a[44:47], v[176:191]
    v_add_f32 v56, v56, v143
    v_max3_f32 v49, v144, v145, v146
    v_max3_f32 v49, v49, v147, v148
    v_max3_f32 v49, v49, v149, v150
    v_max3_f32 v49, v49, v151, v152
    s_waitcnt lgkmcnt(3)
    v_mfma_f32_32x32x16_bf16 v[160:175], v[120:123], a[48:51], v[160:175]
    buffer_load_dwordx4 v15, s[12:15], s45 offen offset:2048 nt lds
    ds_read_b128 v[104:107], v33 offset:8192
    v_max3_f32 v49, v49, v153, v154
    v_max3_f32 v49, v49, v155, v156
    v_max3_f32 v49, v49, v157, v158
    v_max_f32 v49, v49, v159
    v_mul_f32 v49, s46, v49
    v_mfma_f32_32x32x16_bf16 v[176:191], v[120:123], a[52:55], v[176:191]
    ds_read_b128 v[108:111], v34 offset:8192
    v_fma_f32 v144, v144, s46, -v49
    v_fma_f32 v145, v145, s46, -v49
    v_fma_f32 v146, v146, s46, -v49
    v_fma_f32 v147, v147, s46, -v49
    v_fma_f32 v148, v148, s46, -v49
    s_waitcnt lgkmcnt(4)
    v_mfma_f32_32x32x16_bf16 v[160:175], v[124:127], a[56:59], v[160:175]
    buffer_load_dwordx4 v16, s[12:15], s45 offen offset:3072 nt lds
    v_fma_f32 v149, v149, s46, -v49
    v_fma_f32 v150, v150, s46, -v49
    v_fma_f32 v151, v151, s46, -v49
    v_fma_f32 v152, v152, s46, -v49
    v_fma_f32 v153, v153, s46, -v49
    v_mfma_f32_32x32x16_bf16 v[176:191], v[124:127], a[60:63], v[176:191]
    v_fma_f32 v154, v154, s46, -v49
    v_fma_f32 v155, v155, s46, -v49
    v_fma_f32 v156, v156, s46, -v49
    v_fma_f32 v157, v157, s46, -v49
    v_fma_f32 v158, v158, s46, -v49
    s_waitcnt lgkmcnt(3)
    v_mfma_f32_32x32x16_bf16 v[160:175], v[96:99], a[64:67], v[160:175]
    s_add_u32 m0, s44, 0
    s_xor_b32 s45, s69, 131328
    buffer_load_dwordx4 v13, s[12:15], s45 offen nt lds
    v_fma_f32 v159, v159, s46, -v49
    v_exp_f32 v144, v144
    v_exp_f32 v145, v145
    v_exp_f32 v146, v146
    v_mfma_f32_32x32x16_bf16 v[176:191], v[96:99], a[68:71], v[176:191]
    s_waitcnt vmcnt(9)
    ds_read_b128 v[112:115], v31 offset:12288
    v_add_f32 v57, v144, v145
    v_exp_f32 v147, v147
    v_add_f32 v57, v57, v146
    v_exp_f32 v148, v148
    s_waitcnt lgkmcnt(3)
    v_mfma_f32_32x32x16_bf16 v[160:175], v[100:103], a[72:75], v[160:175]
    buffer_load_dwordx4 v14, s[12:15], s45 offen offset:1024 nt lds
    ds_read_b128 v[116:119], v32 offset:12288
    v_add_f32 v57, v57, v147
    v_exp_f32 v149, v149
    v_add_f32 v57, v57, v148
    v_exp_f32 v150, v150
    v_mfma_f32_32x32x16_bf16 v[176:191], v[100:103], a[76:79], v[176:191]
    v_add_f32 v57, v57, v149
    v_exp_f32 v151, v151
    v_add_f32 v57, v57, v150
    v_exp_f32 v152, v152
    s_waitcnt lgkmcnt(3)
    v_mfma_f32_32x32x16_bf16 v[160:175], v[104:107], a[80:83], v[160:175]
    buffer_load_dwordx4 v15, s[12:15], s45 offen offset:2048 nt lds
    ds_read_b128 v[120:123], v33 offset:12288
    v_add_f32 v57, v57, v151
    v_exp_f32 v153, v153
    v_add_f32 v57, v57, v152
    v_exp_f32 v154, v154
    v_mfma_f32_32x32x16_bf16 v[176:191], v[104:107], a[84:87], v[176:191]
    ds_read_b128 v[124:127], v34 offset:12288
    v_add_f32 v57, v57, v153
    v_exp_f32 v155, v155
    v_add_f32 v57, v57, v154
    v_exp_f32 v156, v156
    s_waitcnt lgkmcnt(4)
    v_mfma_f32_32x32x16_bf16 v[160:175], v[108:111], a[88:91], v[160:175]
    buffer_load_dwordx4 v16, s[12:15], s45 offen offset:3072 nt lds
    v_add_f32 v57, v57, v155
    v_exp_f32 v157, v157
    v_add_f32 v57, v57, v156
    v_exp_f32 v158, v158
    v_mfma_f32_32x32x16_bf16 v[176:191], v[108:111], a[92:95], v[176:191]
    v_add_f32 v57, v57, v157
    v_exp_f32 v159, v159
    v_add_f32 v57, v57, v158
    v_add_f32 v57, v57, v159
    s_waitcnt lgkmcnt(3)
    v_mfma_f32_32x32x16_bf16 v[160:175], v[112:115], a[96:99], v[160:175]
    s_add_u32 m0, s44, 4096
    s_xor_b32 s45, s69, 131456
    buffer_load_dwordx4 v13, s[12:15], s45 offen nt lds
    v_mfma_f32_32x32x16_bf16 v[176:191], v[112:115], a[100:103], v[176:191]
    s_waitcnt vmcnt(9)
    ds_read_b128 v[96:99], v31 offset:16384
    s_waitcnt lgkmcnt(3)
    v_mfma_f32_32x32x16_bf16 v[160:175], v[116:119], a[104:107], v[160:175]
    buffer_load_dwordx4 v14, s[12:15], s45 offen offset:1024 nt lds
    ds_read_b128 v[100:103], v32 offset:16384
    v_mfma_f32_32x32x16_bf16 v[176:191], v[116:119], a[108:111], v[176:191]
    s_waitcnt lgkmcnt(3)
    v_mfma_f32_32x32x16_bf16 v[160:175], v[120:123], a[112:115], v[160:175]
    buffer_load_dwordx4 v15, s[12:15], s45 offen offset:2048 nt lds
    ds_read_b128 v[104:107], v33 offset:16384
    v_mfma_f32_32x32x16_bf16 v[176:191], v[120:123], a[116:119], v[176:191]
    ds_read_b128 v[108:111], v34 offset:16384
    s_waitcnt lgkmcnt(4)
    v_mfma_f32_32x32x16_bf16 v[160:175], v[124:127], a[120:123], v[160:175]
    buffer_load_dwordx4 v16, s[12:15], s45 offen offset:3072 nt lds
    v_mfma_f32_32x32x16_bf16 v[176:191], v[124:127], a[124:127], v[176:191]
    s_waitcnt lgkmcnt(3)
    v_mfma_f32_32x32x16_bf16 v[192:207], v[96:99], v[64:67], 0
    s_add_u32 m0, s44, 8192
    s_xor_b32 s45, s69, 196608
    buffer_load_dwordx4 v13, s[12:15], s45 offen nt lds
    s_nop 4
    v_max3_f32 v50, v160, v161, v162
    v_max3_f32 v50, v50, v163, v164
    v_max3_f32 v50, v50, v165, v166
    v_max3_f32 v50, v50, v167, v168
    v_max3_f32 v50, v50, v169, v170
    v_mfma_f32_32x32x16_bf16 v[208:223], v[96:99], v[68:71], 0
    s_waitcnt vmcnt(9)
    ds_read_b128 v[112:115], v31 offset:20480
    v_max3_f32 v50, v50, v171, v172
    v_max3_f32 v50, v50, v173, v174
    v_max_f32 v50, v50, v175
    v_mul_f32 v50, s46, v50
    v_fma_f32 v160, v160, s46, -v50
    s_waitcnt lgkmcnt(3)
    v_mfma_f32_32x32x16_bf16 v[192:207], v[100:103], v[72:75], v[192:207]
    buffer_load_dwordx4 v14, s[12:15], s45 offen offset:1024 nt lds
    ds_read_b128 v[116:119], v32 offset:20480
    v_fma_f32 v161, v161, s46, -v50
    v_fma_f32 v162, v162, s46, -v50
    v_fma_f32 v163, v163, s46, -v50
    v_fma_f32 v164, v164, s46, -v50
    v_fma_f32 v165, v165, s46, -v50
    v_mfma_f32_32x32x16_bf16 v[208:223], v[100:103], v[76:79], v[208:223]
    v_fma_f32 v166, v166, s46, -v50
    v_fma_f32 v167, v167, s46, -v50
    v_fma_f32 v168, v168, s46, -v50
    v_fma_f32 v169, v169, s46, -v50
    v_fma_f32 v170, v170, s46, -v50
    s_waitcnt lgkmcnt(3)
    v_mfma_f32_32x32x16_bf16 v[192:207], v[104:107], v[80:83], v[192:207]
    buffer_load_dwordx4 v15, s[12:15], s45 offen offset:2048 nt lds
    ds_read_b128 v[120:123], v33 offset:20480
    v_fma_f32 v171, v171, s46, -v50
    v_fma_f32 v172, v172, s46, -v50
    v_fma_f32 v173, v173, s46, -v50
    v_fma_f32 v174, v174, s46, -v50
    v_fma_f32 v175, v175, s46, -v50
    v_mfma_f32_32x32x16_bf16 v[208:223], v[104:107], v[84:87], v[208:223]
    ds_read_b128 v[124:127], v34 offset:20480
    v_exp_f32 v160, v160
    v_exp_f32 v161, v161
    v_exp_f32 v162, v162
    v_add_f32 v58, v160, v161
    v_exp_f32 v163, v163
    s_waitcnt lgkmcnt(4)
    v_mfma_f32_32x32x16_bf16 v[192:207], v[108:111], v[88:91], v[192:207]
    buffer_load_dwordx4 v16, s[12:15], s45 offen offset:3072 nt lds
    v_add_f32 v58, v58, v162
    v_exp_f32 v164, v164
    v_add_f32 v58, v58, v163
    v_exp_f32 v165, v165
    v_add_f32 v58, v58, v164
    v_mfma_f32_32x32x16_bf16 v[208:223], v[108:111], v[92:95], v[208:223]
    v_exp_f32 v166, v166
    v_add_f32 v58, v58, v165
    v_exp_f32 v167, v167
    v_add_f32 v58, v58, v166
    v_exp_f32 v168, v168
    s_waitcnt lgkmcnt(3)
    v_mfma_f32_32x32x16_bf16 v[192:207], v[112:115], a[32:35], v[192:207]
    s_add_u32 m0, s44, 12288
    s_xor_b32 s45, s69, 196736
    buffer_load_dwordx4 v13, s[12:15], s45 offen nt lds
    v_add_f32 v58, v58, v167
    v_exp_f32 v169, v169
    v_add_f32 v58, v58, v168
    v_exp_f32 v170, v170
    v_add_f32 v58, v58, v169
    v_mfma_f32_32x32x16_bf16 v[208:223], v[112:115], a[36:39], v[208:223]
    s_waitcnt vmcnt(9)
    ds_read_b128 v[96:99], v31 offset:0
    v_exp_f32 v171, v171
    v_add_f32 v58, v58, v170
    v_exp_f32 v172, v172
    v_add_f32 v58, v58, v171
    v_exp_f32 v173, v173
    s_waitcnt lgkmcnt(3)
    v_mfma_f32_32x32x16_bf16 v[192:207], v[116:119], a[40:43], v[192:207]
    buffer_load_dwordx4 v14, s[12:15], s45 offen offset:1024 nt lds
    ds_read_b128 v[100:103], v32 offset:0
    v_add_f32 v58, v58, v172
    v_exp_f32 v174, v174
    v_add_f32 v58, v58, v173
    v_exp_f32 v175, v175
    v_add_f32 v58, v58, v174
    v_mfma_f32_32x32x16_bf16 v[208:223], v[116:119], a[44:47], v[208:223]
    v_add_f32 v58, v58, v175
    v_max3_f32 v51, v176, v177, v178
    v_max3_f32 v51, v51, v179, v180
    v_max3_f32 v51, v51, v181, v182
    v_max3_f32 v51, v51, v183, v184
    s_waitcnt lgkmcnt(3)
    v_mfma_f32_32x32x16_bf16 v[192:207], v[120:123], a[48:51], v[192:207]
    buffer_load_dwordx4 v15, s[12:15], s45 offen offset:2048 nt lds
    ds_read_b128 v[104:107], v33 offset:0
    v_max3_f32 v51, v51, v185, v186
    v_max3_f32 v51, v51, v187, v188
    v_max3_f32 v51, v51, v189, v190
    v_max_f32 v51, v51, v191
    v_mul_f32 v51, s46, v51
    v_mfma_f32_32x32x16_bf16 v[208:223], v[120:123], a[52:55], v[208:223]
    ds_read_b128 v[108:111], v34 offset:0
    v_fma_f32 v176, v176, s46, -v51
    v_fma_f32 v177, v177, s46, -v51
    v_fma_f32 v178, v178, s46, -v51
    v_fma_f32 v179, v179, s46, -v51
    v_fma_f32 v180, v180, s46, -v51
    s_waitcnt lgkmcnt(4)
    v_mfma_f32_32x32x16_bf16 v[192:207], v[124:127], a[56:59], v[192:207]
    buffer_load_dwordx4 v16, s[12:15], s45 offen offset:3072 nt lds
    v_fma_f32 v181, v181, s46, -v51
    v_fma_f32 v182, v182, s46, -v51
    v_fma_f32 v183, v183, s46, -v51
    v_fma_f32 v184, v184, s46, -v51
    v_fma_f32 v185, v185, s46, -v51
    v_mfma_f32_32x32x16_bf16 v[208:223], v[124:127], a[60:63], v[208:223]
    v_fma_f32 v186, v186, s46, -v51
    v_fma_f32 v187, v187, s46, -v51
    v_fma_f32 v188, v188, s46, -v51
    v_fma_f32 v189, v189, s46, -v51
    v_fma_f32 v190, v190, s46, -v51
    s_waitcnt lgkmcnt(3)
    v_mfma_f32_32x32x16_bf16 v[192:207], v[96:99], a[64:67], v[192:207]
    s_add_u32 m0, s44, 16384
    s_xor_b32 s45, s69, 196864
    buffer_load_dwordx4 v13, s[12:15], s45 offen nt lds
    v_fma_f32 v191, v191, s46, -v51
    v_exp_f32 v176, v176
    v_exp_f32 v177, v177
    v_exp_f32 v178, v178
    v_mfma_f32_32x32x16_bf16 v[208:223], v[96:99], a[68:71], v[208:223]
    s_waitcnt vmcnt(9)
    ds_read_b128 v[112:115], v31 offset:4096
    v_add_f32 v59, v176, v177
    v_exp_f32 v179, v179
    v_add_f32 v59, v59, v178
    v_exp_f32 v180, v180
    s_waitcnt lgkmcnt(3)
    v_mfma_f32_32x32x16_bf16 v[192:207], v[100:103], a[72:75], v[192:207]
    buffer_load_dwordx4 v14, s[12:15], s45 offen offset:1024 nt lds
    ds_read_b128 v[116:119], v32 offset:4096
    v_add_f32 v59, v59, v179
    v_exp_f32 v181, v181
    v_add_f32 v59, v59, v180
    v_exp_f32 v182, v182
    v_mfma_f32_32x32x16_bf16 v[208:223], v[100:103], a[76:79], v[208:223]
    v_add_f32 v59, v59, v181
    v_exp_f32 v183, v183
    v_add_f32 v59, v59, v182
    v_exp_f32 v184, v184
    s_waitcnt lgkmcnt(3)
    v_mfma_f32_32x32x16_bf16 v[192:207], v[104:107], a[80:83], v[192:207]
    buffer_load_dwordx4 v15, s[12:15], s45 offen offset:2048 nt lds
    ds_read_b128 v[120:123], v33 offset:4096
    v_add_f32 v59, v59, v183
    v_exp_f32 v185, v185
    v_add_f32 v59, v59, v184
    v_exp_f32 v186, v186
    v_mfma_f32_32x32x16_bf16 v[208:223], v[104:107], a[84:87], v[208:223]
    ds_read_b128 v[124:127], v34 offset:4096
    v_add_f32 v59, v59, v185
    v_exp_f32 v187, v187
    v_add_f32 v59, v59, v186
    v_exp_f32 v188, v188
    s_waitcnt lgkmcnt(4)
    v_mfma_f32_32x32x16_bf16 v[192:207], v[108:111], a[88:91], v[192:207]
    buffer_load_dwordx4 v16, s[12:15], s45 offen offset:3072 nt lds
    v_add_f32 v59, v59, v187
    v_exp_f32 v189, v189
    v_add_f32 v59, v59, v188
    v_exp_f32 v190, v190
    v_mfma_f32_32x32x16_bf16 v[208:223], v[108:111], a[92:95], v[208:223]
    v_add_f32 v59, v59, v189
    v_exp_f32 v191, v191
    v_add_f32 v59, v59, v190
    v_add_f32 v59, v59, v191
    s_waitcnt lgkmcnt(3)
    v_mfma_f32_32x32x16_bf16 v[192:207], v[112:115], a[96:99], v[192:207]
    s_add_u32 m0, s44, 20480
    s_xor_b32 s45, s69, 196992
    buffer_load_dwordx4 v13, s[12:15], s45 offen nt lds
    v_mfma_f32_32x32x16_bf16 v[208:223], v[112:115], a[100:103], v[208:223]
    s_waitcnt vmcnt(9)
    ds_read_b128 v[96:99], v31 offset:8192
    s_waitcnt lgkmcnt(3)
    v_mfma_f32_32x32x16_bf16 v[192:207], v[116:119], a[104:107], v[192:207]
    buffer_load_dwordx4 v14, s[12:15], s45 offen offset:1024 nt lds
    ds_read_b128 v[100:103], v32 offset:8192
    v_mfma_f32_32x32x16_bf16 v[208:223], v[116:119], a[108:111], v[208:223]
    s_waitcnt lgkmcnt(3)
    v_mfma_f32_32x32x16_bf16 v[192:207], v[120:123], a[112:115], v[192:207]
    buffer_load_dwordx4 v15, s[12:15], s45 offen offset:2048 nt lds
    ds_read_b128 v[104:107], v33 offset:8192
    v_mfma_f32_32x32x16_bf16 v[208:223], v[120:123], a[116:119], v[208:223]
    ds_read_b128 v[108:111], v34 offset:8192
    s_waitcnt lgkmcnt(4)
    v_mfma_f32_32x32x16_bf16 v[192:207], v[124:127], a[120:123], v[192:207]
    buffer_load_dwordx4 v16, s[12:15], s45 offen offset:3072 nt lds
    v_mfma_f32_32x32x16_bf16 v[208:223], v[124:127], a[124:127], v[208:223]
    s_waitcnt lgkmcnt(3)
    v_mfma_f32_32x32x16_bf16 v[224:239], v[96:99], v[64:67], 0
    s_add_u32 m0, s44, 0
    s_xor_b32 s45, s61, 0
    s_mulk_i32 s45, 14336
    buffer_load_dwordx4 v21, s[24:27], s45 offen lds
    s_nop 3
    v_max3_f32 v52, v192, v193, v194
    v_max3_f32 v52, v52, v195, v196
    v_max3_f32 v52, v52, v197, v198
    v_max3_f32 v52, v52, v199, v200
    v_max3_f32 v52, v52, v201, v202
    v_mfma_f32_32x32x16_bf16 v[240:255], v[96:99], v[68:71], 0
    s_waitcnt vmcnt(9)
    ds_read_b128 v[112:115], v31 offset:12288
    v_max3_f32 v52, v52, v203, v204
    v_max3_f32 v52, v52, v205, v206
    v_max_f32 v52, v52, v207
    v_mul_f32 v52, s46, v52
    v_fma_f32 v192, v192, s46, -v52
    s_waitcnt lgkmcnt(3)
    v_mfma_f32_32x32x16_bf16 v[224:239], v[100:103], v[72:75], v[224:239]
    buffer_load_dwordx4 v22, s[24:27], s45 offen offset:1024 lds
    ds_read_b128 v[116:119], v32 offset:12288
    v_fma_f32 v193, v193, s46, -v52
    v_fma_f32 v194, v194, s46, -v52
    v_fma_f32 v195, v195, s46, -v52
    v_fma_f32 v196, v196, s46, -v52
    v_fma_f32 v197, v197, s46, -v52
    v_mfma_f32_32x32x16_bf16 v[240:255], v[100:103], v[76:79], v[240:255]
    v_fma_f32 v198, v198, s46, -v52
    v_fma_f32 v199, v199, s46, -v52
    v_fma_f32 v200, v200, s46, -v52
    v_fma_f32 v201, v201, s46, -v52
    v_fma_f32 v202, v202, s46, -v52
    s_waitcnt lgkmcnt(3)
    v_mfma_f32_32x32x16_bf16 v[224:239], v[104:107], v[80:83], v[224:239]
    buffer_load_dwordx4 v23, s[24:27], s45 offen offset:2048 lds
    ds_read_b128 v[120:123], v33 offset:12288
    v_fma_f32 v203, v203, s46, -v52
    v_fma_f32 v204, v204, s46, -v52
    v_fma_f32 v205, v205, s46, -v52
    v_fma_f32 v206, v206, s46, -v52
    v_fma_f32 v207, v207, s46, -v52
    v_mfma_f32_32x32x16_bf16 v[240:255], v[104:107], v[84:87], v[240:255]
    ds_read_b128 v[124:127], v34 offset:12288
    v_exp_f32 v192, v192
    v_exp_f32 v193, v193
    v_exp_f32 v194, v194
    v_add_f32 v60, v192, v193
    v_exp_f32 v195, v195
    s_waitcnt lgkmcnt(4)
    v_mfma_f32_32x32x16_bf16 v[224:239], v[108:111], v[88:91], v[224:239]
    buffer_load_dwordx4 v24, s[24:27], s45 offen offset:3072 lds
    v_add_f32 v60, v60, v194
    v_exp_f32 v196, v196
    v_add_f32 v60, v60, v195
    v_exp_f32 v197, v197
    v_add_f32 v60, v60, v196
    v_mfma_f32_32x32x16_bf16 v[240:255], v[108:111], v[92:95], v[240:255]
    v_exp_f32 v198, v198
    v_add_f32 v60, v60, v197
    v_exp_f32 v199, v199
    v_add_f32 v60, v60, v198
    v_exp_f32 v200, v200
    s_waitcnt lgkmcnt(3)
    v_mfma_f32_32x32x16_bf16 v[224:239], v[112:115], a[32:35], v[224:239]
    s_add_u32 m0, s44, 4096
    s_xor_b32 s45, s61, 1
    s_mulk_i32 s45, 14336
    buffer_load_dwordx4 v21, s[24:27], s45 offen lds
    v_add_f32 v60, v60, v199
    v_exp_f32 v201, v201
    v_add_f32 v60, v60, v200
    v_exp_f32 v202, v202
    v_add_f32 v60, v60, v201
    v_mfma_f32_32x32x16_bf16 v[240:255], v[112:115], a[36:39], v[240:255]
    s_waitcnt vmcnt(9)
    ds_read_b128 v[96:99], v31 offset:16384
    v_exp_f32 v203, v203
    v_add_f32 v60, v60, v202
    v_exp_f32 v204, v204
    v_add_f32 v60, v60, v203
    v_exp_f32 v205, v205
    s_waitcnt lgkmcnt(3)
    v_mfma_f32_32x32x16_bf16 v[224:239], v[116:119], a[40:43], v[224:239]
    buffer_load_dwordx4 v22, s[24:27], s45 offen offset:1024 lds
    ds_read_b128 v[100:103], v32 offset:16384
    v_add_f32 v60, v60, v204
    v_exp_f32 v206, v206
    v_add_f32 v60, v60, v205
    v_exp_f32 v207, v207
    v_add_f32 v60, v60, v206
    v_mfma_f32_32x32x16_bf16 v[240:255], v[116:119], a[44:47], v[240:255]
    v_add_f32 v60, v60, v207
    v_max3_f32 v53, v208, v209, v210
    v_max3_f32 v53, v53, v211, v212
    v_max3_f32 v53, v53, v213, v214
    v_max3_f32 v53, v53, v215, v216
    s_waitcnt lgkmcnt(3)
    v_mfma_f32_32x32x16_bf16 v[224:239], v[120:123], a[48:51], v[224:239]
    buffer_load_dwordx4 v23, s[24:27], s45 offen offset:2048 lds
    ds_read_b128 v[104:107], v33 offset:16384
    v_max3_f32 v53, v53, v217, v218
    v_max3_f32 v53, v53, v219, v220
    v_max3_f32 v53, v53, v221, v222
    v_max_f32 v53, v53, v223
    v_mul_f32 v53, s46, v53
    v_mfma_f32_32x32x16_bf16 v[240:255], v[120:123], a[52:55], v[240:255]
    ds_read_b128 v[108:111], v34 offset:16384
    v_fma_f32 v208, v208, s46, -v53
    v_fma_f32 v209, v209, s46, -v53
    v_fma_f32 v210, v210, s46, -v53
    v_fma_f32 v211, v211, s46, -v53
    v_fma_f32 v212, v212, s46, -v53
    s_waitcnt lgkmcnt(4)
    v_mfma_f32_32x32x16_bf16 v[224:239], v[124:127], a[56:59], v[224:239]
    buffer_load_dwordx4 v24, s[24:27], s45 offen offset:3072 lds
    v_fma_f32 v213, v213, s46, -v53
    v_fma_f32 v214, v214, s46, -v53
    v_fma_f32 v215, v215, s46, -v53
    v_fma_f32 v216, v216, s46, -v53
    v_fma_f32 v217, v217, s46, -v53
    v_mfma_f32_32x32x16_bf16 v[240:255], v[124:127], a[60:63], v[240:255]
    v_fma_f32 v218, v218, s46, -v53
    v_fma_f32 v219, v219, s46, -v53
    v_fma_f32 v220, v220, s46, -v53
    v_fma_f32 v221, v221, s46, -v53
    v_fma_f32 v222, v222, s46, -v53
    s_waitcnt lgkmcnt(3)
    v_mfma_f32_32x32x16_bf16 v[224:239], v[96:99], a[64:67], v[224:239]
    s_add_u32 m0, s44, 8192
    s_xor_b32 s45, s61, 2
    s_mulk_i32 s45, 14336
    buffer_load_dwordx4 v21, s[24:27], s45 offen lds
    v_fma_f32 v223, v223, s46, -v53
    v_exp_f32 v208, v208
    v_exp_f32 v209, v209
    v_exp_f32 v210, v210
    v_mfma_f32_32x32x16_bf16 v[240:255], v[96:99], a[68:71], v[240:255]
    s_waitcnt vmcnt(9)
    ds_read_b128 v[112:115], v31 offset:20480
    v_add_f32 v61, v208, v209
    v_exp_f32 v211, v211
    v_add_f32 v61, v61, v210
    v_exp_f32 v212, v212
    s_waitcnt lgkmcnt(3)
    v_mfma_f32_32x32x16_bf16 v[224:239], v[100:103], a[72:75], v[224:239]
    buffer_load_dwordx4 v22, s[24:27], s45 offen offset:1024 lds
    ds_read_b128 v[116:119], v32 offset:20480
    v_add_f32 v61, v61, v211
    v_exp_f32 v213, v213
    v_add_f32 v61, v61, v212
    v_exp_f32 v214, v214
    v_mfma_f32_32x32x16_bf16 v[240:255], v[100:103], a[76:79], v[240:255]
    v_add_f32 v61, v61, v213
    v_exp_f32 v215, v215
    v_add_f32 v61, v61, v214
    v_exp_f32 v216, v216
    s_waitcnt lgkmcnt(3)
    v_mfma_f32_32x32x16_bf16 v[224:239], v[104:107], a[80:83], v[224:239]
    buffer_load_dwordx4 v23, s[24:27], s45 offen offset:2048 lds
    ds_read_b128 v[120:123], v33 offset:20480
    v_add_f32 v61, v61, v215
    v_exp_f32 v217, v217
    v_add_f32 v61, v61, v216
    v_exp_f32 v218, v218
    v_mfma_f32_32x32x16_bf16 v[240:255], v[104:107], a[84:87], v[240:255]
    ds_read_b128 v[124:127], v34 offset:20480
    v_add_f32 v61, v61, v217
    v_exp_f32 v219, v219
    v_add_f32 v61, v61, v218
    v_exp_f32 v220, v220
    s_waitcnt lgkmcnt(4)
    v_mfma_f32_32x32x16_bf16 v[224:239], v[108:111], a[88:91], v[224:239]
    buffer_load_dwordx4 v24, s[24:27], s45 offen offset:3072 lds
    v_add_f32 v61, v61, v219
    v_exp_f32 v221, v221
    v_add_f32 v61, v61, v220
    v_exp_f32 v222, v222
    v_mfma_f32_32x32x16_bf16 v[240:255], v[108:111], a[92:95], v[240:255]
    v_add_f32 v61, v61, v221
    v_exp_f32 v223, v223
    v_add_f32 v61, v61, v222
    v_add_f32 v61, v61, v223
    s_waitcnt lgkmcnt(3)
    v_mfma_f32_32x32x16_bf16 v[224:239], v[112:115], a[96:99], v[224:239]
    s_add_u32 m0, s44, 12288
    s_mov_b32 s45, 0
    buffer_load_dwordx4 v17, s[16:19], s45 offen nt lds
    v_mfma_f32_32x32x16_bf16 v[240:255], v[112:115], a[100:103], v[240:255]
    s_waitcnt lgkmcnt(2)
    v_mfma_f32_32x32x16_bf16 v[224:239], v[116:119], a[104:107], v[224:239]
    buffer_load_dwordx4 v18, s[16:19], s45 offen offset:1024 nt lds
    v_mfma_f32_32x32x16_bf16 v[240:255], v[116:119], a[108:111], v[240:255]
    s_waitcnt lgkmcnt(1)
    v_mfma_f32_32x32x16_bf16 v[224:239], v[120:123], a[112:115], v[224:239]
    buffer_load_dwordx4 v19, s[16:19], s45 offen offset:2048 nt lds
    v_mfma_f32_32x32x16_bf16 v[240:255], v[120:123], a[116:119], v[240:255]
    s_waitcnt lgkmcnt(0)
    v_mfma_f32_32x32x16_bf16 v[224:239], v[124:127], a[120:123], v[224:239]
    buffer_load_dwordx4 v20, s[16:19], s45 offen offset:3072 nt lds
    v_mfma_f32_32x32x16_bf16 v[240:255], v[124:127], a[124:127], v[240:255]
    s_nop 9
    v_max3_f32 v54, v224, v225, v226
    v_max3_f32 v54, v54, v227, v228
    v_max3_f32 v54, v54, v229, v230
    v_max3_f32 v54, v54, v231, v232
    v_max3_f32 v54, v54, v233, v234
    v_max3_f32 v54, v54, v235, v236
    v_max3_f32 v54, v54, v237, v238
    v_max_f32 v54, v54, v239
    v_mul_f32 v54, s46, v54
    v_pk_fma_f32 v[224:225], v[224:225], s[46:47], v[54:55] op_sel:[0,0,0] op_sel_hi:[1,0,0] neg_lo:[0,0,1] neg_hi:[0,0,1]
    v_pk_fma_f32 v[226:227], v[226:227], s[46:47], v[54:55] op_sel:[0,0,0] op_sel_hi:[1,0,0] neg_lo:[0,0,1] neg_hi:[0,0,1]
    v_pk_fma_f32 v[228:229], v[228:229], s[46:47], v[54:55] op_sel:[0,0,0] op_sel_hi:[1,0,0] neg_lo:[0,0,1] neg_hi:[0,0,1]
    v_pk_fma_f32 v[230:231], v[230:231], s[46:47], v[54:55] op_sel:[0,0,0] op_sel_hi:[1,0,0] neg_lo:[0,0,1] neg_hi:[0,0,1]
    v_pk_fma_f32 v[232:233], v[232:233], s[46:47], v[54:55] op_sel:[0,0,0] op_sel_hi:[1,0,0] neg_lo:[0,0,1] neg_hi:[0,0,1]
    v_pk_fma_f32 v[234:235], v[234:235], s[46:47], v[54:55] op_sel:[0,0,0] op_sel_hi:[1,0,0] neg_lo:[0,0,1] neg_hi:[0,0,1]
    v_pk_fma_f32 v[236:237], v[236:237], s[46:47], v[54:55] op_sel:[0,0,0] op_sel_hi:[1,0,0] neg_lo:[0,0,1] neg_hi:[0,0,1]
    v_pk_fma_f32 v[238:239], v[238:239], s[46:47], v[54:55] op_sel:[0,0,0] op_sel_hi:[1,0,0] neg_lo:[0,0,1] neg_hi:[0,0,1]
    v_exp_f32 v224, v224
    v_exp_f32 v225, v225
    v_exp_f32 v226, v226
    v_exp_f32 v227, v227
    v_exp_f32 v228, v228
    v_pk_add_f32 v[2:3], v[224:225], v[226:227]
    v_exp_f32 v229, v229
    v_exp_f32 v230, v230
    v_pk_add_f32 v[2:3], v[2:3], v[228:229]
    v_exp_f32 v231, v231
    v_exp_f32 v232, v232
    v_pk_add_f32 v[2:3], v[2:3], v[230:231]
    s_waitcnt vmcnt(13)
    ds_read_b64_tr_b16 a[128:129], v37 offset:0
    ds_read_b64_tr_b16 a[132:133], v38 offset:0
    ds_read_b64_tr_b16 a[136:137], v39 offset:0
    ds_read_b64_tr_b16 a[140:141], v40 offset:0
    s_waitcnt vmcnt(12)
    ds_read_b64_tr_b16 a[130:131], v37 offset:1024
    ds_read_b64_tr_b16 a[134:135], v38 offset:1024
    ds_read_b64_tr_b16 a[138:139], v39 offset:1024
    ds_read_b64_tr_b16 a[142:143], v40 offset:1024
    s_add_u32 m0, s44, 16384
    s_mov_b32 s45, 16384
    buffer_load_dwordx4 v17, s[16:19], s45 offen nt lds
    buffer_load_dwordx4 v18, s[16:19], s45 offen offset:1024 nt lds
    buffer_load_dwordx4 v19, s[16:19], s45 offen offset:2048 nt lds
    buffer_load_dwordx4 v20, s[16:19], s45 offen offset:3072 nt lds
    s_add_u32 m0, s44, 20480
    s_mov_b32 s45, 32768
    buffer_load_dwordx4 v17, s[16:19], s45 offen nt lds
    buffer_load_dwordx4 v18, s[16:19], s45 offen offset:1024 nt lds
    buffer_load_dwordx4 v19, s[16:19], s45 offen offset:2048 nt lds
    buffer_load_dwordx4 v20, s[16:19], s45 offen offset:3072 nt lds
    v_exp_f32 v233, v233
    v_exp_f32 v234, v234
    v_pk_add_f32 v[2:3], v[2:3], v[232:233]
    v_exp_f32 v235, v235
    v_exp_f32 v236, v236
    v_pk_add_f32 v[2:3], v[2:3], v[234:235]
    v_exp_f32 v237, v237
    v_exp_f32 v238, v238
    v_pk_add_f32 v[2:3], v[2:3], v[236:237]
    v_exp_f32 v239, v239
    s_nop 0
    v_pk_add_f32 v[2:3], v[2:3], v[238:239]
    v_add_f32 v62, v2, v3
    v_max3_f32 v55, v240, v241, v242
    v_max3_f32 v55, v55, v243, v244
    v_max3_f32 v55, v55, v245, v246
    v_max3_f32 v55, v55, v247, v248
    v_max3_f32 v55, v55, v249, v250
    v_max3_f32 v55, v55, v251, v252
    v_max3_f32 v55, v55, v253, v254
    v_max_f32 v55, v55, v255
    v_mul_f32 v55, s46, v55
    v_pk_fma_f32 v[240:241], v[240:241], s[46:47], v[54:55] op_sel:[0,0,1] op_sel_hi:[1,0,1] neg_lo:[0,0,1] neg_hi:[0,0,1]
    v_pk_fma_f32 v[242:243], v[242:243], s[46:47], v[54:55] op_sel:[0,0,1] op_sel_hi:[1,0,1] neg_lo:[0,0,1] neg_hi:[0,0,1]
    v_pk_fma_f32 v[244:245], v[244:245], s[46:47], v[54:55] op_sel:[0,0,1] op_sel_hi:[1,0,1] neg_lo:[0,0,1] neg_hi:[0,0,1]
    v_pk_fma_f32 v[246:247], v[246:247], s[46:47], v[54:55] op_sel:[0,0,1] op_sel_hi:[1,0,1] neg_lo:[0,0,1] neg_hi:[0,0,1]
    v_pk_fma_f32 v[248:249], v[248:249], s[46:47], v[54:55] op_sel:[0,0,1] op_sel_hi:[1,0,1] neg_lo:[0,0,1] neg_hi:[0,0,1]
    v_pk_fma_f32 v[250:251], v[250:251], s[46:47], v[54:55] op_sel:[0,0,1] op_sel_hi:[1,0,1] neg_lo:[0,0,1] neg_hi:[0,0,1]
    v_pk_fma_f32 v[252:253], v[252:253], s[46:47], v[54:55] op_sel:[0,0,1] op_sel_hi:[1,0,1] neg_lo:[0,0,1] neg_hi:[0,0,1]
    v_pk_fma_f32 v[254:255], v[254:255], s[46:47], v[54:55] op_sel:[0,0,1] op_sel_hi:[1,0,1] neg_lo:[0,0,1] neg_hi:[0,0,1]
    v_exp_f32 v240, v240
    v_exp_f32 v241, v241
    v_exp_f32 v242, v242
    v_exp_f32 v243, v243
    v_exp_f32 v244, v244
    v_pk_add_f32 v[2:3], v[240:241], v[242:243]
    v_exp_f32 v245, v245
    v_exp_f32 v246, v246
    v_pk_add_f32 v[2:3], v[2:3], v[244:245]
    v_exp_f32 v247, v247
    v_exp_f32 v248, v248
    v_pk_add_f32 v[2:3], v[2:3], v[246:247]
    v_exp_f32 v249, v249
    v_exp_f32 v250, v250
    v_pk_add_f32 v[2:3], v[2:3], v[248:249]
    v_exp_f32 v251, v251
    v_exp_f32 v252, v252
    v_pk_add_f32 v[2:3], v[2:3], v[250:251]
    v_exp_f32 v253, v253
    v_exp_f32 v254, v254
    v_pk_add_f32 v[2:3], v[2:3], v[252:253]
    v_exp_f32 v255, v255
    s_nop 0
    v_pk_add_f32 v[2:3], v[2:3], v[254:255]
    v_add_f32 v63, v2, v3
    v_max3_f32 v64, v48, v50, v52
    v_max_f32 v64, v64, v54
    v_max3_f32 v65, v49, v51, v53
    v_max_f32 v65, v65, v55
    v_sub_f32 v68, v48, v64
    s_waitcnt vmcnt(17)
    ds_read_b64_tr_b16 a[144:145], v37 offset:4096
    ds_read_b64_tr_b16 a[148:149], v38 offset:4096
    ds_read_b64_tr_b16 a[152:153], v39 offset:4096
    ds_read_b64_tr_b16 a[156:157], v40 offset:4096
    s_waitcnt vmcnt(16)
    ds_read_b64_tr_b16 a[146:147], v37 offset:5120
    ds_read_b64_tr_b16 a[150:151], v38 offset:5120
    ds_read_b64_tr_b16 a[154:155], v39 offset:5120
    ds_read_b64_tr_b16 a[158:159], v40 offset:5120
    s_add_u32 m0, s44, 0
    s_mov_b32 s45, 49152
    s_waitcnt lgkmcnt(8)
    buffer_load_dwordx4 v17, s[16:19], s45 offen nt lds
    buffer_load_dwordx4 v18, s[16:19], s45 offen offset:1024 nt lds
    buffer_load_dwordx4 v19, s[16:19], s45 offen offset:2048 nt lds
    buffer_load_dwordx4 v20, s[16:19], s45 offen offset:3072 nt lds
    v_sub_f32 v69, v49, v65
    v_sub_f32 v70, v50, v64
    v_sub_f32 v71, v51, v65
    v_sub_f32 v72, v52, v64
    v_sub_f32 v73, v53, v65
    v_sub_f32 v74, v54, v64
    v_sub_f32 v75, v55, v65
    v_exp_f32 v68, v68
    v_exp_f32 v69, v69
    v_exp_f32 v70, v70
    v_exp_f32 v71, v71
    v_exp_f32 v72, v72
    v_exp_f32 v73, v73
    v_exp_f32 v74, v74
    v_exp_f32 v75, v75
    v_pk_mul_f32 v[66:67], v[56:57], v[68:69]
    v_pk_fma_f32 v[66:67], v[58:59], v[70:71], v[66:67]
    v_pk_fma_f32 v[66:67], v[60:61], v[72:73], v[66:67]
    v_pk_fma_f32 v[66:67], v[62:63], v[74:75], v[66:67]
    v_permlane32_swap_b32 v64, v65
    s_nop 0
    v_permlane32_swap_b32 v66, v67
    v_max_f32 v72, v64, v65
    v_sub_f32 v68, v64, v72
    v_sub_f32 v69, v65, v72
    v_exp_f32 v68, v68
    v_exp_f32 v69, v69
    v_mul_f32 v73, v66, v68
    v_fmac_f32 v73, v67, v69
    ds_write_b64 v6, v[72:73] offset:0
    ds_write_b64 v6, v[72:73] offset:16384
    ds_write_b64 v6, v[72:73] offset:32768
    ds_write_b64 v6, v[72:73] offset:49152
    s_waitcnt lgkmcnt(0)
    s_barrier
    ds_read_b64 v[74:75], v8 offset:0
    ds_read_b64 v[76:77], v8 offset:512
    ds_read_b64 v[78:79], v8 offset:1024
    ds_read_b64 v[80:81], v8 offset:1536
    s_waitcnt lgkmcnt(1)
    v_max3_f32 v64, v74, v76, v78
    s_waitcnt lgkmcnt(0)
    v_max_f32 v64, v64, v80
    v_sub_f32 v68, v74, v64
    v_sub_f32 v69, v76, v64
    v_sub_f32 v70, v78, v64
    v_sub_f32 v71, v80, v64
    v_exp_f32 v68, v68
    v_exp_f32 v69, v69
    v_exp_f32 v70, v70
    v_exp_f32 v71, v71
    v_mul_f32 v65, v75, v68
    v_fmac_f32 v65, v77, v69
    v_fmac_f32 v65, v79, v70
    v_fmac_f32 v65, v81, v71
    v_log_f32 v65, v65
    s_nop 0
    v_add_f32 v64, v64, v65
    v_mov_b32 v65, v64
    s_nop 1
    v_permlane32_swap_b32 v64, v65
    v_sub_f32 v48, v48, v64
    v_sub_f32 v49, v49, v65
    s_waitcnt vmcnt(17)
    ds_read_b64_tr_b16 a[160:161], v37 offset:8192
    ds_read_b64_tr_b16 a[164:165], v38 offset:8192
    ds_read_b64_tr_b16 a[168:169], v39 offset:8192
    ds_read_b64_tr_b16 a[172:173], v40 offset:8192
    s_waitcnt vmcnt(16)
    ds_read_b64_tr_b16 a[162:163], v37 offset:9216
    ds_read_b64_tr_b16 a[166:167], v38 offset:9216
    ds_read_b64_tr_b16 a[170:171], v39 offset:9216
    ds_read_b64_tr_b16 a[174:175], v40 offset:9216
    s_add_u32 m0, s44, 4096
    s_mov_b32 s45, 65536
    buffer_load_dwordx4 v17, s[16:19], s45 offen nt lds
    buffer_load_dwordx4 v18, s[16:19], s45 offen offset:1024 nt lds
    buffer_load_dwordx4 v19, s[16:19], s45 offen offset:2048 nt lds
    buffer_load_dwordx4 v20, s[16:19], s45 offen offset:3072 nt lds
    v_sub_f32 v50, v50, v64
    v_sub_f32 v51, v51, v65
    v_sub_f32 v52, v52, v64
    v_sub_f32 v53, v53, v65
    v_sub_f32 v54, v54, v64
    v_sub_f32 v55, v55, v65
    v_exp_f32 v48, v48
    v_exp_f32 v49, v49
    v_exp_f32 v50, v50
    v_exp_f32 v51, v51
    v_exp_f32 v52, v52
    v_exp_f32 v53, v53
    v_exp_f32 v54, v54
    v_exp_f32 v55, v55
    v_pk_mul_f32 v[128:129], v[128:129], v[48:49] op_sel:[0,0] op_sel_hi:[1,0]
    v_pk_mul_f32 v[130:131], v[130:131], v[48:49] op_sel:[0,0] op_sel_hi:[1,0]
    v_pk_mul_f32 v[132:133], v[132:133], v[48:49] op_sel:[0,0] op_sel_hi:[1,0]
    v_pk_mul_f32 v[134:135], v[134:135], v[48:49] op_sel:[0,0] op_sel_hi:[1,0]
    v_cvt_pk_bf16_f32 v128, v128, v129
    v_cvt_pk_bf16_f32 v129, v130, v131
    v_cvt_pk_bf16_f32 v130, v132, v133
    v_cvt_pk_bf16_f32 v131, v134, v135
    ds_write_b128 v42, v[128:131] offset:0
    v_pk_mul_f32 v[136:137], v[136:137], v[48:49] op_sel:[0,0] op_sel_hi:[1,0]
    v_pk_mul_f32 v[138:139], v[138:139], v[48:49] op_sel:[0,0] op_sel_hi:[1,0]
    v_pk_mul_f32 v[140:141], v[140:141], v[48:49] op_sel:[0,0] op_sel_hi:[1,0]
    v_pk_mul_f32 v[142:143], v[142:143], v[48:49] op_sel:[0,0] op_sel_hi:[1,0]
    v_cvt_pk_bf16_f32 v136, v136, v137
    v_cvt_pk_bf16_f32 v137, v138, v139
    v_cvt_pk_bf16_f32 v138, v140, v141
    v_cvt_pk_bf16_f32 v139, v142, v143
    ds_write_b128 v42, v[136:139] offset:2048
    v_pk_mul_f32 v[144:145], v[144:145], v[48:49] op_sel:[0,1] op_sel_hi:[1,1]
    v_pk_mul_f32 v[146:147], v[146:147], v[48:49] op_sel:[0,1] op_sel_hi:[1,1]
    v_pk_mul_f32 v[148:149], v[148:149], v[48:49] op_sel:[0,1] op_sel_hi:[1,1]
    v_pk_mul_f32 v[150:151], v[150:151], v[48:49] op_sel:[0,1] op_sel_hi:[1,1]
    v_cvt_pk_bf16_f32 v144, v144, v145
    v_cvt_pk_bf16_f32 v145, v146, v147
    v_cvt_pk_bf16_f32 v146, v148, v149
    v_cvt_pk_bf16_f32 v147, v150, v151
    ds_write_b128 v42, v[144:147] offset:1024
    v_pk_mul_f32 v[152:153], v[152:153], v[48:49] op_sel:[0,1] op_sel_hi:[1,1]
    v_pk_mul_f32 v[154:155], v[154:155], v[48:49] op_sel:[0,1] op_sel_hi:[1,1]
    v_pk_mul_f32 v[156:157], v[156:157], v[48:49] op_sel:[0,1] op_sel_hi:[1,1]
    v_pk_mul_f32 v[158:159], v[158:159], v[48:49] op_sel:[0,1] op_sel_hi:[1,1]
    v_cvt_pk_bf16_f32 v152, v152, v153
    v_cvt_pk_bf16_f32 v153, v154, v155
    v_cvt_pk_bf16_f32 v154, v156, v157
    v_cvt_pk_bf16_f32 v155, v158, v159
    ds_write_b128 v42, v[152:155] offset:3072
    v_pk_mul_f32 v[160:161], v[160:161], v[50:51] op_sel:[0,0] op_sel_hi:[1,0]
    v_pk_mul_f32 v[162:163], v[162:163], v[50:51] op_sel:[0,0] op_sel_hi:[1,0]
    v_pk_mul_f32 v[164:165], v[164:165], v[50:51] op_sel:[0,0] op_sel_hi:[1,0]
    v_pk_mul_f32 v[166:167], v[166:167], v[50:51] op_sel:[0,0] op_sel_hi:[1,0]
    v_cvt_pk_bf16_f32 v160, v160, v161
    v_cvt_pk_bf16_f32 v161, v162, v163
    v_cvt_pk_bf16_f32 v162, v164, v165
    v_cvt_pk_bf16_f32 v163, v166, v167
    s_add_u32 m0, s44, 8192
    s_mov_b32 s45, 81920
    s_waitcnt lgkmcnt(4)
    buffer_load_dwordx4 v17, s[16:19], s45 offen nt lds
    buffer_load_dwordx4 v18, s[16:19], s45 offen offset:1024 nt lds
    buffer_load_dwordx4 v19, s[16:19], s45 offen offset:2048 nt lds
    buffer_load_dwordx4 v20, s[16:19], s45 offen offset:3072 nt lds
    ds_write_b128 v42, v[160:163] offset:4096
    v_pk_mul_f32 v[168:169], v[168:169], v[50:51] op_sel:[0,0] op_sel_hi:[1,0]
    v_pk_mul_f32 v[170:171], v[170:171], v[50:51] op_sel:[0,0] op_sel_hi:[1,0]
    v_pk_mul_f32 v[172:173], v[172:173], v[50:51] op_sel:[0,0] op_sel_hi:[1,0]
    v_pk_mul_f32 v[174:175], v[174:175], v[50:51] op_sel:[0,0] op_sel_hi:[1,0]
    v_cvt_pk_bf16_f32 v168, v168, v169
    v_cvt_pk_bf16_f32 v169, v170, v171
    v_cvt_pk_bf16_f32 v170, v172, v173
    v_cvt_pk_bf16_f32 v171, v174, v175
    ds_write_b128 v42, v[168:171] offset:6144
    v_pk_mul_f32 v[176:177], v[176:177], v[50:51] op_sel:[0,1] op_sel_hi:[1,1]
    v_pk_mul_f32 v[178:179], v[178:179], v[50:51] op_sel:[0,1] op_sel_hi:[1,1]
    v_pk_mul_f32 v[180:181], v[180:181], v[50:51] op_sel:[0,1] op_sel_hi:[1,1]
    v_pk_mul_f32 v[182:183], v[182:183], v[50:51] op_sel:[0,1] op_sel_hi:[1,1]
    v_cvt_pk_bf16_f32 v176, v176, v177
    v_cvt_pk_bf16_f32 v177, v178, v179
    v_cvt_pk_bf16_f32 v178, v180, v181
    v_cvt_pk_bf16_f32 v179, v182, v183
    ds_write_b128 v42, v[176:179] offset:5120
    v_pk_mul_f32 v[184:185], v[184:185], v[50:51] op_sel:[0,1] op_sel_hi:[1,1]
    v_pk_mul_f32 v[186:187], v[186:187], v[50:51] op_sel:[0,1] op_sel_hi:[1,1]
    v_pk_mul_f32 v[188:189], v[188:189], v[50:51] op_sel:[0,1] op_sel_hi:[1,1]
    v_pk_mul_f32 v[190:191], v[190:191], v[50:51] op_sel:[0,1] op_sel_hi:[1,1]
    v_cvt_pk_bf16_f32 v184, v184, v185
    v_cvt_pk_bf16_f32 v185, v186, v187
    v_cvt_pk_bf16_f32 v186, v188, v189
    v_cvt_pk_bf16_f32 v187, v190, v191
    ds_write_b128 v42, v[184:187] offset:7168
    s_waitcnt lgkmcnt(0)
    s_barrier
    v_mul_f32 v192, v192, v52
    v_mul_f32 v193, v193, v52
    v_mul_f32 v194, v194, v52
    v_mul_f32 v195, v195, v52
    v_mul_f32 v196, v196, v52
    v_mul_f32 v197, v197, v52
    v_mul_f32 v198, v198, v52
    v_mul_f32 v199, v199, v52
    v_cvt_pk_bf16_f32 v192, v192, v193
    v_cvt_pk_bf16_f32 v193, v194, v195
    v_cvt_pk_bf16_f32 v194, v196, v197
    v_cvt_pk_bf16_f32 v195, v198, v199
    ds_write_b128 v42, v[192:195] offset:8192
    v_mul_f32 v200, v200, v52
    s_waitcnt vmcnt(23)
    ds_read_b64_tr_b16 v[64:65], v35 offset:12288
    s_waitcnt vmcnt(22)
    ds_read_b64_tr_b16 v[66:67], v35 offset:13312
    ds_read_b128 v[80:83], v43 offset:0
    ds_read_b64_tr_b16 v[68:69], v36 offset:12288
    ds_read_b64_tr_b16 v[70:71], v36 offset:13312
    ds_read_b128 v[84:87], v44 offset:0
    s_waitcnt vmcnt(21)
    ds_read_b64_tr_b16 v[72:73], v35 offset:14336
    s_waitcnt vmcnt(20)
    ds_read_b64_tr_b16 v[74:75], v35 offset:15360
    ds_read_b128 v[88:91], v43 offset:2048
    ds_read_b64_tr_b16 v[76:77], v36 offset:14336
    ds_read_b64_tr_b16 v[78:79], v36 offset:15360
    ds_read_b128 v[92:95], v44 offset:2048
    s_waitcnt lgkmcnt(9)
    v_mfma_f32_32x32x16_bf16 v[128:143], v[64:67], v[80:83], 0
    v_mul_f32 v201, v201, v52
    v_mul_f32 v202, v202, v52
    s_waitcnt lgkmcnt(7)
    v_mfma_f32_32x32x16_bf16 v[160:175], v[68:71], v[80:83], 0
    s_waitcnt vmcnt(19)
    ds_read_b64_tr_b16 v[96:97], v35 offset:16384
    s_waitcnt vmcnt(18)
    ds_read_b64_tr_b16 v[98:99], v35 offset:17408
    v_mul_f32 v203, v203, v52
    v_mul_f32 v204, v204, v52
    s_waitcnt lgkmcnt(8)
    v_mfma_f32_32x32x16_bf16 v[144:159], v[64:67], v[84:87], 0
    ds_read_b128 v[112:115], v43 offset:16384
    ds_read_b64_tr_b16 v[100:101], v36 offset:16384
    v_mul_f32 v205, v205, v52
    v_mul_f32 v206, v206, v52
    v_mfma_f32_32x32x16_bf16 v[176:191], v[68:71], v[84:87], 0
    ds_read_b64_tr_b16 v[102:103], v36 offset:17408
    ds_read_b128 v[116:119], v44 offset:16384
    v_mul_f32 v207, v207, v52
    s_waitcnt lgkmcnt(9)
    v_mfma_f32_32x32x16_bf16 v[128:143], v[72:75], v[88:91], v[128:143]
    s_waitcnt vmcnt(17)
    ds_read_b64_tr_b16 v[104:105], v35 offset:18432
    s_waitcnt vmcnt(16)
    ds_read_b64_tr_b16 v[106:107], v35 offset:19456
    v_cvt_pk_bf16_f32 v200, v200, v201
    v_cvt_pk_bf16_f32 v201, v202, v203
    s_waitcnt lgkmcnt(9)
    v_mfma_f32_32x32x16_bf16 v[160:175], v[76:79], v[88:91], v[160:175]
    ds_read_b128 v[120:123], v43 offset:18432
    ds_read_b64_tr_b16 v[108:109], v36 offset:18432
    v_cvt_pk_bf16_f32 v202, v204, v205
    v_cvt_pk_bf16_f32 v203, v206, v207
    s_waitcnt lgkmcnt(10)
    v_mfma_f32_32x32x16_bf16 v[144:159], v[72:75], v[92:95], v[144:159]
    ds_read_b64_tr_b16 v[110:111], v36 offset:19456
    ds_read_b128 v[124:127], v44 offset:18432
    ds_write_b128 v42, v[200:203] offset:10240
    v_mul_f32 v208, v208, v53
    v_mfma_f32_32x32x16_bf16 v[176:191], v[76:79], v[92:95], v[176:191]
    v_mul_f32 v209, v209, v53
    s_waitcnt lgkmcnt(10)
    v_mfma_f32_32x32x16_bf16 v[128:143], v[96:99], v[112:115], v[128:143]
    v_mul_f32 v210, v210, v53
    v_mul_f32 v211, v211, v53
    s_waitcnt lgkmcnt(8)
    v_mfma_f32_32x32x16_bf16 v[160:175], v[100:103], v[112:115], v[160:175]
    s_waitcnt vmcnt(15)
    ds_read_b64_tr_b16 v[64:65], v35 offset:20480
    s_waitcnt vmcnt(14)
    ds_read_b64_tr_b16 v[66:67], v35 offset:21504
    v_mul_f32 v212, v212, v53
    v_mul_f32 v213, v213, v53
    s_waitcnt lgkmcnt(9)
    v_mfma_f32_32x32x16_bf16 v[144:159], v[96:99], v[116:119], v[144:159]
    ds_read_b128 v[80:83], v43 offset:32768
    ds_read_b64_tr_b16 v[68:69], v36 offset:20480
    v_mul_f32 v214, v214, v53
    v_mul_f32 v215, v215, v53
    v_mfma_f32_32x32x16_bf16 v[176:191], v[100:103], v[116:119], v[176:191]
    ds_read_b64_tr_b16 v[70:71], v36 offset:21504
    ds_read_b128 v[84:87], v44 offset:32768
    v_cvt_pk_bf16_f32 v208, v208, v209
    s_waitcnt lgkmcnt(10)
    v_mfma_f32_32x32x16_bf16 v[128:143], v[104:107], v[120:123], v[128:143]
    s_waitcnt vmcnt(13)
    ds_read_b64_tr_b16 v[72:73], v35 offset:22528
    s_waitcnt vmcnt(12)
    ds_read_b64_tr_b16 v[74:75], v35 offset:23552
    v_cvt_pk_bf16_f32 v209, v210, v211
    v_cvt_pk_bf16_f32 v210, v212, v213
    s_waitcnt lgkmcnt(10)
    v_mfma_f32_32x32x16_bf16 v[160:175], v[108:111], v[120:123], v[160:175]
    ds_read_b128 v[88:91], v43 offset:34816
    ds_read_b64_tr_b16 v[76:77], v36 offset:22528
    v_cvt_pk_bf16_f32 v211, v214, v215
    ds_write_b128 v42, v[208:211] offset:9216
    s_waitcnt lgkmcnt(12)
    v_mfma_f32_32x32x16_bf16 v[144:159], v[104:107], v[124:127], v[144:159]
    ds_read_b64_tr_b16 v[78:79], v36 offset:23552
    ds_read_b128 v[92:95], v44 offset:34816
    v_mul_f32 v216, v216, v53
    v_mul_f32 v217, v217, v53
    v_mfma_f32_32x32x16_bf16 v[176:191], v[108:111], v[124:127], v[176:191]
    v_mul_f32 v218, v218, v53
    s_waitcnt lgkmcnt(10)
    v_mfma_f32_32x32x16_bf16 v[128:143], v[64:67], v[80:83], v[128:143]
    s_add_u32 m0, s44, 12288
    s_mov_b32 s45, 98304
    buffer_load_dwordx4 v17, s[16:19], s45 offen nt lds
    v_mul_f32 v219, v219, v53
    v_mul_f32 v220, v220, v53
    s_waitcnt lgkmcnt(8)
    v_mfma_f32_32x32x16_bf16 v[160:175], v[68:71], v[80:83], v[160:175]
    s_waitcnt vmcnt(12)
    ds_read_b64_tr_b16 v[96:97], v35 offset:0
    s_waitcnt vmcnt(11)
    ds_read_b64_tr_b16 v[98:99], v35 offset:1024
    v_mul_f32 v221, v221, v53
    v_mul_f32 v222, v222, v53
    s_waitcnt lgkmcnt(9)
    v_mfma_f32_32x32x16_bf16 v[144:159], v[64:67], v[84:87], v[144:159]
    buffer_load_dwordx4 v18, s[16:19], s45 offen offset:1024 nt lds
    ds_read_b128 v[112:115], v43 offset:49152
    ds_read_b64_tr_b16 v[100:101], v36 offset:0
    v_mul_f32 v223, v223, v53
    v_cvt_pk_bf16_f32 v216, v216, v217
    v_mfma_f32_32x32x16_bf16 v[176:191], v[68:71], v[84:87], v[176:191]
    ds_read_b64_tr_b16 v[102:103], v36 offset:1024
    ds_read_b128 v[116:119], v44 offset:49152
    v_cvt_pk_bf16_f32 v217, v218, v219
    s_waitcnt lgkmcnt(10)
    v_mfma_f32_32x32x16_bf16 v[128:143], v[72:75], v[88:91], v[128:143]
    buffer_load_dwordx4 v19, s[16:19], s45 offen offset:2048 nt lds
    s_waitcnt vmcnt(12)
    ds_read_b64_tr_b16 v[104:105], v35 offset:2048
    s_waitcnt vmcnt(11)
    ds_read_b64_tr_b16 v[106:107], v35 offset:3072
    v_cvt_pk_bf16_f32 v218, v220, v221
    v_cvt_pk_bf16_f32 v219, v222, v223
    s_waitcnt lgkmcnt(9)
    v_mfma_f32_32x32x16_bf16 v[160:175], v[76:79], v[88:91], v[160:175]
    ds_read_b128 v[120:123], v43 offset:51200
    ds_read_b64_tr_b16 v[108:109], v36 offset:2048
    ds_write_b128 v42, v[216:219] offset:11264
    v_mul_f32 v224, v224, v54
    s_waitcnt lgkmcnt(11)
    v_mfma_f32_32x32x16_bf16 v[144:159], v[72:75], v[92:95], v[144:159]
    buffer_load_dwordx4 v20, s[16:19], s45 offen offset:3072 nt lds
    ds_read_b64_tr_b16 v[110:111], v36 offset:3072
    ds_read_b128 v[124:127], v44 offset:51200
    v_mul_f32 v225, v225, v54
    v_mul_f32 v226, v226, v54
    v_mfma_f32_32x32x16_bf16 v[176:191], v[76:79], v[92:95], v[176:191]
    v_mul_f32 v227, v227, v54
    s_waitcnt lgkmcnt(10)
    v_mfma_f32_32x32x16_bf16 v[128:143], v[96:99], v[112:115], v[128:143]
    s_add_u32 m0, s44, 16384
    s_mov_b32 s45, 114688
    buffer_load_dwordx4 v17, s[16:19], s45 offen nt lds
    v_mul_f32 v228, v228, v54
    v_mul_f32 v229, v229, v54
    s_waitcnt lgkmcnt(8)
    v_mfma_f32_32x32x16_bf16 v[160:175], v[100:103], v[112:115], v[160:175]
    s_waitcnt vmcnt(12)
    ds_read_b64_tr_b16 v[64:65], v35 offset:4096
    s_waitcnt vmcnt(11)
    ds_read_b64_tr_b16 v[66:67], v35 offset:5120
    v_mul_f32 v230, v230, v54
    v_mul_f32 v231, v231, v54
    s_waitcnt lgkmcnt(9)
    v_mfma_f32_32x32x16_bf16 v[144:159], v[96:99], v[116:119], v[144:159]
    buffer_load_dwordx4 v18, s[16:19], s45 offen offset:1024 nt lds
    ds_read_b128 v[80:83], v43 offset:4096
    ds_read_b64_tr_b16 v[68:69], v36 offset:4096
    v_cvt_pk_bf16_f32 v224, v224, v225
    v_cvt_pk_bf16_f32 v225, v226, v227
    v_mfma_f32_32x32x16_bf16 v[176:191], v[100:103], v[116:119], v[176:191]
    ds_read_b64_tr_b16 v[70:71], v36 offset:5120
    ds_read_b128 v[84:87], v44 offset:4096
    v_cvt_pk_bf16_f32 v226, v228, v229
    s_waitcnt lgkmcnt(10)
    v_mfma_f32_32x32x16_bf16 v[128:143], v[104:107], v[120:123], v[128:143]
    buffer_load_dwordx4 v19, s[16:19], s45 offen offset:2048 nt lds
    s_waitcnt vmcnt(12)
    ds_read_b64_tr_b16 v[72:73], v35 offset:6144
    s_waitcnt vmcnt(11)
    ds_read_b64_tr_b16 v[74:75], v35 offset:7168
    v_cvt_pk_bf16_f32 v227, v230, v231
    ds_write_b128 v42, v[224:227] offset:12288
    s_waitcnt lgkmcnt(10)
    v_mfma_f32_32x32x16_bf16 v[160:175], v[108:111], v[120:123], v[160:175]
    ds_read_b128 v[88:91], v43 offset:6144
    ds_read_b64_tr_b16 v[76:77], v36 offset:6144
    v_mul_f32 v232, v232, v54
    v_mul_f32 v233, v233, v54
    s_waitcnt lgkmcnt(11)
    v_mfma_f32_32x32x16_bf16 v[144:159], v[104:107], v[124:127], v[144:159]
    buffer_load_dwordx4 v20, s[16:19], s45 offen offset:3072 nt lds
    ds_read_b64_tr_b16 v[78:79], v36 offset:7168
    ds_read_b128 v[92:95], v44 offset:6144
    v_mul_f32 v234, v234, v54
    v_mul_f32 v235, v235, v54
    v_mfma_f32_32x32x16_bf16 v[176:191], v[108:111], v[124:127], v[176:191]
    v_mul_f32 v236, v236, v54
    s_waitcnt lgkmcnt(10)
    v_mfma_f32_32x32x16_bf16 v[128:143], v[64:67], v[80:83], v[128:143]
    s_add_u32 m0, s44, 20480
    s_mov_b32 s45, 131072
    buffer_load_dwordx4 v17, s[16:19], s45 offen nt lds
    v_mul_f32 v237, v237, v54
    v_mul_f32 v238, v238, v54
    s_waitcnt lgkmcnt(8)
    v_mfma_f32_32x32x16_bf16 v[160:175], v[68:71], v[80:83], v[160:175]
    s_waitcnt vmcnt(12)
    ds_read_b64_tr_b16 v[96:97], v35 offset:8192
    s_waitcnt vmcnt(11)
    ds_read_b64_tr_b16 v[98:99], v35 offset:9216
    v_mul_f32 v239, v239, v54
    v_cvt_pk_bf16_f32 v232, v232, v233
    s_waitcnt lgkmcnt(9)
    v_mfma_f32_32x32x16_bf16 v[144:159], v[64:67], v[84:87], v[144:159]
    buffer_load_dwordx4 v18, s[16:19], s45 offen offset:1024 nt lds
    ds_read_b128 v[112:115], v43 offset:20480
    ds_read_b64_tr_b16 v[100:101], v36 offset:8192
    v_cvt_pk_bf16_f32 v233, v234, v235
    v_cvt_pk_bf16_f32 v234, v236, v237
    v_mfma_f32_32x32x16_bf16 v[176:191], v[68:71], v[84:87], v[176:191]
    ds_read_b64_tr_b16 v[102:103], v36 offset:9216
    ds_read_b128 v[116:119], v44 offset:20480
    v_cvt_pk_bf16_f32 v235, v238, v239
    s_waitcnt lgkmcnt(9)
    v_mfma_f32_32x32x16_bf16 v[128:143], v[72:75], v[88:91], v[128:143]
    buffer_load_dwordx4 v19, s[16:19], s45 offen offset:2048 nt lds
    s_waitcnt vmcnt(12)
    ds_read_b64_tr_b16 v[104:105], v35 offset:10240
    s_waitcnt vmcnt(11)
    ds_read_b64_tr_b16 v[106:107], v35 offset:11264
    ds_write_b128 v42, v[232:235] offset:14336
    v_mul_f32 v240, v240, v55
    s_waitcnt lgkmcnt(10)
    v_mfma_f32_32x32x16_bf16 v[160:175], v[76:79], v[88:91], v[160:175]
    ds_read_b128 v[120:123], v43 offset:22528
    ds_read_b64_tr_b16 v[108:109], v36 offset:10240
    v_mul_f32 v241, v241, v55
    v_mul_f32 v242, v242, v55
    s_waitcnt lgkmcnt(11)
    v_mfma_f32_32x32x16_bf16 v[144:159], v[72:75], v[92:95], v[144:159]
    buffer_load_dwordx4 v20, s[16:19], s45 offen offset:3072 nt lds
    ds_read_b64_tr_b16 v[110:111], v36 offset:11264
    ds_read_b128 v[124:127], v44 offset:22528
    v_mul_f32 v243, v243, v55
    v_mul_f32 v244, v244, v55
    v_mfma_f32_32x32x16_bf16 v[176:191], v[76:79], v[92:95], v[176:191]
    v_mul_f32 v245, v245, v55
    s_waitcnt lgkmcnt(10)
    v_mfma_f32_32x32x16_bf16 v[128:143], v[96:99], v[112:115], v[128:143]
    s_add_u32 m0, s44, 0
    s_mov_b32 s45, 147456
    buffer_load_dwordx4 v17, s[16:19], s45 offen nt lds
    v_mul_f32 v246, v246, v55
    v_mul_f32 v247, v247, v55
    s_waitcnt lgkmcnt(8)
    v_mfma_f32_32x32x16_bf16 v[160:175], v[100:103], v[112:115], v[160:175]
    s_waitcnt vmcnt(12)
    ds_read_b64_tr_b16 v[64:65], v35 offset:12288
    s_waitcnt vmcnt(11)
    ds_read_b64_tr_b16 v[66:67], v35 offset:13312
    v_cvt_pk_bf16_f32 v240, v240, v241
    v_cvt_pk_bf16_f32 v241, v242, v243
    s_waitcnt lgkmcnt(9)
    v_mfma_f32_32x32x16_bf16 v[144:159], v[96:99], v[116:119], v[144:159]
    buffer_load_dwordx4 v18, s[16:19], s45 offen offset:1024 nt lds
    ds_read_b128 v[80:83], v43 offset:36864
    ds_read_b64_tr_b16 v[68:69], v36 offset:12288
    v_cvt_pk_bf16_f32 v242, v244, v245
    v_cvt_pk_bf16_f32 v243, v246, v247
    v_mfma_f32_32x32x16_bf16 v[176:191], v[100:103], v[116:119], v[176:191]
    ds_read_b64_tr_b16 v[70:71], v36 offset:13312
    ds_read_b128 v[84:87], v44 offset:36864
    ds_write_b128 v42, v[240:243] offset:13312
    s_waitcnt lgkmcnt(10)
    v_mfma_f32_32x32x16_bf16 v[128:143], v[104:107], v[120:123], v[128:143]
    buffer_load_dwordx4 v19, s[16:19], s45 offen offset:2048 nt lds
    s_waitcnt vmcnt(12)
    ds_read_b64_tr_b16 v[72:73], v35 offset:14336
    s_waitcnt vmcnt(11)
    ds_read_b64_tr_b16 v[74:75], v35 offset:15360
    v_mul_f32 v248, v248, v55
    v_mul_f32 v249, v249, v55
    s_waitcnt lgkmcnt(10)
    v_mfma_f32_32x32x16_bf16 v[160:175], v[108:111], v[120:123], v[160:175]
    ds_read_b128 v[88:91], v43 offset:38912
    ds_read_b64_tr_b16 v[76:77], v36 offset:14336
    v_mul_f32 v250, v250, v55
    v_mul_f32 v251, v251, v55
    s_waitcnt lgkmcnt(11)
    v_mfma_f32_32x32x16_bf16 v[144:159], v[104:107], v[124:127], v[144:159]
    buffer_load_dwordx4 v20, s[16:19], s45 offen offset:3072 nt lds
    ds_read_b64_tr_b16 v[78:79], v36 offset:15360
    ds_read_b128 v[92:95], v44 offset:38912
    v_mul_f32 v252, v252, v55
    v_mul_f32 v253, v253, v55
    v_mfma_f32_32x32x16_bf16 v[176:191], v[108:111], v[124:127], v[176:191]
    v_mul_f32 v254, v254, v55
    s_waitcnt lgkmcnt(10)
    v_mfma_f32_32x32x16_bf16 v[128:143], v[64:67], v[80:83], v[128:143]
    s_add_u32 m0, s44, 4096
    s_mov_b32 s45, 163840
    buffer_load_dwordx4 v17, s[16:19], s45 offen nt lds
    v_mul_f32 v255, v255, v55
    v_cvt_pk_bf16_f32 v248, v248, v249
    s_waitcnt lgkmcnt(8)
    v_mfma_f32_32x32x16_bf16 v[160:175], v[68:71], v[80:83], v[160:175]
    s_waitcnt vmcnt(12)
    ds_read_b64_tr_b16 v[96:97], v35 offset:16384
    s_waitcnt vmcnt(11)
    ds_read_b64_tr_b16 v[98:99], v35 offset:17408
    v_cvt_pk_bf16_f32 v249, v250, v251
    s_waitcnt lgkmcnt(9)
    v_mfma_f32_32x32x16_bf16 v[144:159], v[64:67], v[84:87], v[144:159]
    buffer_load_dwordx4 v18, s[16:19], s45 offen offset:1024 nt lds
    ds_read_b128 v[112:115], v43 offset:53248
    ds_read_b64_tr_b16 v[100:101], v36 offset:16384
    v_cvt_pk_bf16_f32 v250, v252, v253
    v_cvt_pk_bf16_f32 v251, v254, v255
    v_mfma_f32_32x32x16_bf16 v[176:191], v[68:71], v[84:87], v[176:191]
    ds_read_b64_tr_b16 v[102:103], v36 offset:17408
    ds_read_b128 v[116:119], v44 offset:53248
    ds_write_b128 v42, v[248:251] offset:15360
    s_waitcnt lgkmcnt(10)
    v_mfma_f32_32x32x16_bf16 v[128:143], v[72:75], v[88:91], v[128:143]
    buffer_load_dwordx4 v19, s[16:19], s45 offen offset:2048 nt lds
    s_waitcnt vmcnt(12)
    ds_read_b64_tr_b16 v[104:105], v35 offset:18432
    s_waitcnt vmcnt(11)
    ds_read_b64_tr_b16 v[106:107], v35 offset:19456
    v_mov_b32 v2, 0
    s_waitcnt lgkmcnt(10)
    v_mfma_f32_32x32x16_bf16 v[160:175], v[76:79], v[88:91], v[160:175]
    ds_read_b128 v[120:123], v43 offset:55296
    ds_read_b64_tr_b16 v[108:109], v36 offset:18432
    buffer_load_dwordx4 v[28:31], v2, s[36:39], s60 offen sc1
    s_lshl_b32 s3, s50, 10
    s_waitcnt lgkmcnt(11)
    v_mfma_f32_32x32x16_bf16 v[144:159], v[72:75], v[92:95], v[144:159]
    buffer_load_dwordx4 v20, s[16:19], s45 offen offset:3072 nt lds
    ds_read_b64_tr_b16 v[110:111], v36 offset:19456
    ds_read_b128 v[124:127], v44 offset:55296
    v_add_u32 v16, s3, v42
    v_mfma_f32_32x32x16_bf16 v[176:191], v[76:79], v[92:95], v[176:191]
    v_xor_b32 v12, 0x400, v16
    s_waitcnt lgkmcnt(10)
    v_mfma_f32_32x32x16_bf16 v[128:143], v[96:99], v[112:115], v[128:143]
    s_add_u32 m0, s44, 8192
    s_mov_b32 s45, 180224
    buffer_load_dwordx4 v17, s[16:19], s45 offen nt lds
    s_waitcnt lgkmcnt(8)
    v_mfma_f32_32x32x16_bf16 v[160:175], v[100:103], v[112:115], v[160:175]
    s_waitcnt lgkmcnt(0)
    s_barrier
    s_waitcnt vmcnt(13)
    ds_read_b64_tr_b16 v[64:65], v35 offset:20480
    s_waitcnt vmcnt(12)
    ds_read_b64_tr_b16 v[66:67], v35 offset:21504
    v_mfma_f32_32x32x16_bf16 v[144:159], v[96:99], v[116:119], v[144:159]
    buffer_load_dwordx4 v18, s[16:19], s45 offen offset:1024 nt lds
    ds_read_b128 v[80:83], v43 offset:8192
    ds_read_b64_tr_b16 v[68:69], v36 offset:20480
    v_mfma_f32_32x32x16_bf16 v[176:191], v[100:103], v[116:119], v[176:191]
    ds_read_b64_tr_b16 v[70:71], v36 offset:21504
    ds_read_b128 v[84:87], v44 offset:8192
    v_mfma_f32_32x32x16_bf16 v[128:143], v[104:107], v[120:123], v[128:143]
    buffer_load_dwordx4 v19, s[16:19], s45 offen offset:2048 nt lds
    s_waitcnt vmcnt(13)
    ds_read_b64_tr_b16 v[72:73], v35 offset:22528
    s_waitcnt vmcnt(12)
    ds_read_b64_tr_b16 v[74:75], v35 offset:23552
    v_mfma_f32_32x32x16_bf16 v[160:175], v[108:111], v[120:123], v[160:175]
    ds_read_b128 v[88:91], v43 offset:10240
    ds_read_b64_tr_b16 v[76:77], v36 offset:22528
    v_mfma_f32_32x32x16_bf16 v[144:159], v[104:107], v[124:127], v[144:159]
    buffer_load_dwordx4 v20, s[16:19], s45 offen offset:3072 nt lds
    ds_read_b64_tr_b16 v[78:79], v36 offset:23552
    ds_read_b128 v[92:95], v44 offset:10240
    v_mfma_f32_32x32x16_bf16 v[176:191], v[108:111], v[124:127], v[176:191]
    s_waitcnt lgkmcnt(9)
    v_mfma_f32_32x32x16_bf16 v[128:143], v[64:67], v[80:83], v[128:143]
    s_add_u32 m0, s44, 12288
    s_mov_b32 s45, 196608
    buffer_load_dwordx4 v17, s[16:19], s45 offen nt lds
    s_waitcnt lgkmcnt(7)
    v_mfma_f32_32x32x16_bf16 v[160:175], v[68:71], v[80:83], v[160:175]
    s_waitcnt vmcnt(13)
    ds_read_b64_tr_b16 v[96:97], v35 offset:0
    s_waitcnt vmcnt(12)
    ds_read_b64_tr_b16 v[98:99], v35 offset:1024
    s_waitcnt lgkmcnt(8)
    v_mfma_f32_32x32x16_bf16 v[144:159], v[64:67], v[84:87], v[144:159]
    buffer_load_dwordx4 v18, s[16:19], s45 offen offset:1024 nt lds
    ds_read_b128 v[112:115], v43 offset:24576
    ds_read_b64_tr_b16 v[100:101], v36 offset:0
    v_mfma_f32_32x32x16_bf16 v[176:191], v[68:71], v[84:87], v[176:191]
    ds_read_b64_tr_b16 v[102:103], v36 offset:1024
    ds_read_b128 v[116:119], v44 offset:24576
    s_waitcnt lgkmcnt(9)
    v_mfma_f32_32x32x16_bf16 v[128:143], v[72:75], v[88:91], v[128:143]
    buffer_load_dwordx4 v19, s[16:19], s45 offen offset:2048 nt lds
    s_waitcnt vmcnt(13)
    ds_read_b64_tr_b16 v[104:105], v35 offset:2048
    s_waitcnt vmcnt(12)
    ds_read_b64_tr_b16 v[106:107], v35 offset:3072
    s_waitcnt lgkmcnt(9)
    v_mfma_f32_32x32x16_bf16 v[160:175], v[76:79], v[88:91], v[160:175]
    ds_read_b128 v[120:123], v43 offset:26624
    ds_read_b64_tr_b16 v[108:109], v36 offset:2048
    s_waitcnt lgkmcnt(10)
    v_mfma_f32_32x32x16_bf16 v[144:159], v[72:75], v[92:95], v[144:159]
    buffer_load_dwordx4 v20, s[16:19], s45 offen offset:3072 nt lds
    ds_read_b64_tr_b16 v[110:111], v36 offset:3072
    ds_read_b128 v[124:127], v44 offset:26624
    v_mfma_f32_32x32x16_bf16 v[176:191], v[76:79], v[92:95], v[176:191]
    s_waitcnt lgkmcnt(9)
    v_mfma_f32_32x32x16_bf16 v[128:143], v[96:99], v[112:115], v[128:143]
    s_add_u32 m0, s44, 16384
    s_mov_b32 s45, 212992
    buffer_load_dwordx4 v17, s[16:19], s45 offen nt lds
    s_waitcnt lgkmcnt(7)
    v_mfma_f32_32x32x16_bf16 v[160:175], v[100:103], v[112:115], v[160:175]
    s_waitcnt vmcnt(13)
    ds_read_b64_tr_b16 v[64:65], v35 offset:4096
    s_waitcnt vmcnt(12)
    ds_read_b64_tr_b16 v[66:67], v35 offset:5120
    s_waitcnt lgkmcnt(8)
    v_mfma_f32_32x32x16_bf16 v[144:159], v[96:99], v[116:119], v[144:159]
    buffer_load_dwordx4 v18, s[16:19], s45 offen offset:1024 nt lds
    ds_read_b128 v[80:83], v43 offset:40960
    ds_read_b64_tr_b16 v[68:69], v36 offset:4096
    v_mfma_f32_32x32x16_bf16 v[176:191], v[100:103], v[116:119], v[176:191]
    ds_read_b64_tr_b16 v[70:71], v36 offset:5120
    ds_read_b128 v[84:87], v44 offset:40960
    s_waitcnt lgkmcnt(9)
    v_mfma_f32_32x32x16_bf16 v[128:143], v[104:107], v[120:123], v[128:143]
    buffer_load_dwordx4 v19, s[16:19], s45 offen offset:2048 nt lds
    s_waitcnt vmcnt(13)
    ds_read_b64_tr_b16 v[72:73], v35 offset:6144
    s_waitcnt vmcnt(11)
    ds_read_b64_tr_b16 v[74:75], v35 offset:7168
    s_waitcnt lgkmcnt(9)
    v_mfma_f32_32x32x16_bf16 v[160:175], v[108:111], v[120:123], v[160:175]
    ds_read_b128 v[88:91], v43 offset:43008
    ds_read_b64_tr_b16 v[76:77], v36 offset:6144
    s_waitcnt lgkmcnt(10)
    v_mfma_f32_32x32x16_bf16 v[144:159], v[104:107], v[124:127], v[144:159]
    buffer_load_dwordx4 v20, s[16:19], s45 offen offset:3072 nt lds
    ds_read_b64_tr_b16 v[78:79], v36 offset:7168
    ds_read_b128 v[92:95], v44 offset:43008
    v_mfma_f32_32x32x16_bf16 v[176:191], v[108:111], v[124:127], v[176:191]
    s_waitcnt lgkmcnt(9)
    v_mfma_f32_32x32x16_bf16 v[128:143], v[64:67], v[80:83], v[128:143]
    s_add_u32 m0, s44, 20480
    s_mov_b32 s45, 229376
    buffer_load_dwordx4 v17, s[16:19], s45 offen nt lds
    s_waitcnt lgkmcnt(7)
    v_mfma_f32_32x32x16_bf16 v[160:175], v[68:71], v[80:83], v[160:175]
    s_waitcnt vmcnt(12)
    ds_read_b64_tr_b16 v[96:97], v35 offset:8192
    s_waitcnt vmcnt(11)
    ds_read_b64_tr_b16 v[98:99], v35 offset:9216
    s_waitcnt lgkmcnt(8)
    v_mfma_f32_32x32x16_bf16 v[144:159], v[64:67], v[84:87], v[144:159]
    buffer_load_dwordx4 v18, s[16:19], s45 offen offset:1024 nt lds
    ds_read_b128 v[112:115], v43 offset:57344
    ds_read_b64_tr_b16 v[100:101], v36 offset:8192
    v_mfma_f32_32x32x16_bf16 v[176:191], v[68:71], v[84:87], v[176:191]
    ds_read_b64_tr_b16 v[102:103], v36 offset:9216
    ds_read_b128 v[116:119], v44 offset:57344
    s_waitcnt lgkmcnt(9)
    v_mfma_f32_32x32x16_bf16 v[128:143], v[72:75], v[88:91], v[128:143]
    buffer_load_dwordx4 v19, s[16:19], s45 offen offset:2048 nt lds
    s_waitcnt vmcnt(12)
    ds_read_b64_tr_b16 v[104:105], v35 offset:10240
    s_waitcnt vmcnt(11)
    ds_read_b64_tr_b16 v[106:107], v35 offset:11264
    s_waitcnt lgkmcnt(9)
    v_mfma_f32_32x32x16_bf16 v[160:175], v[76:79], v[88:91], v[160:175]
    ds_read_b128 v[120:123], v43 offset:59392
    ds_read_b64_tr_b16 v[108:109], v36 offset:10240
    s_waitcnt lgkmcnt(10)
    v_mfma_f32_32x32x16_bf16 v[144:159], v[72:75], v[92:95], v[144:159]
    buffer_load_dwordx4 v20, s[16:19], s45 offen offset:3072 nt lds
    ds_read_b64_tr_b16 v[110:111], v36 offset:11264
    ds_read_b128 v[124:127], v44 offset:59392
    v_mfma_f32_32x32x16_bf16 v[176:191], v[76:79], v[92:95], v[176:191]
    s_waitcnt lgkmcnt(9)
    v_mfma_f32_32x32x16_bf16 v[128:143], v[96:99], v[112:115], v[128:143]
    s_add_u32 m0, s44, 0
    s_mov_b32 s45, 245760
    buffer_load_dwordx4 v17, s[16:19], s45 offen nt lds
    s_waitcnt lgkmcnt(7)
    v_mfma_f32_32x32x16_bf16 v[160:175], v[100:103], v[112:115], v[160:175]
    s_waitcnt vmcnt(12)
    ds_read_b64_tr_b16 v[64:65], v35 offset:12288
    s_waitcnt vmcnt(11)
    ds_read_b64_tr_b16 v[66:67], v35 offset:13312
    s_waitcnt lgkmcnt(8)
    v_mfma_f32_32x32x16_bf16 v[144:159], v[96:99], v[116:119], v[144:159]
    buffer_load_dwordx4 v18, s[16:19], s45 offen offset:1024 nt lds
    ds_read_b128 v[80:83], v43 offset:12288
    ds_read_b64_tr_b16 v[68:69], v36 offset:12288
    v_mfma_f32_32x32x16_bf16 v[176:191], v[100:103], v[116:119], v[176:191]
    ds_read_b64_tr_b16 v[70:71], v36 offset:13312
    ds_read_b128 v[84:87], v44 offset:12288
    s_waitcnt lgkmcnt(9)
    v_mfma_f32_32x32x16_bf16 v[128:143], v[104:107], v[120:123], v[128:143]
    buffer_load_dwordx4 v19, s[16:19], s45 offen offset:2048 nt lds
    s_waitcnt vmcnt(12)
    ds_read_b64_tr_b16 v[72:73], v35 offset:14336
    s_waitcnt vmcnt(11)
    ds_read_b64_tr_b16 v[74:75], v35 offset:15360
    s_waitcnt lgkmcnt(9)
    v_mfma_f32_32x32x16_bf16 v[160:175], v[108:111], v[120:123], v[160:175]
    ds_read_b128 v[88:91], v43 offset:14336
    ds_read_b64_tr_b16 v[76:77], v36 offset:14336
    s_waitcnt lgkmcnt(10)
    v_mfma_f32_32x32x16_bf16 v[144:159], v[104:107], v[124:127], v[144:159]
    buffer_load_dwordx4 v20, s[16:19], s45 offen offset:3072 nt lds
    ds_read_b64_tr_b16 v[78:79], v36 offset:15360
    ds_read_b128 v[92:95], v44 offset:14336
    v_mfma_f32_32x32x16_bf16 v[176:191], v[108:111], v[124:127], v[176:191]
    s_waitcnt lgkmcnt(9)
    v_mfma_f32_32x32x16_bf16 v[128:143], v[64:67], v[80:83], v[128:143]
    s_waitcnt lgkmcnt(7)
    v_mfma_f32_32x32x16_bf16 v[160:175], v[68:71], v[80:83], v[160:175]
    s_waitcnt vmcnt(11)
    ds_read_b64_tr_b16 v[96:97], v35 offset:16384
    s_waitcnt vmcnt(10)
    ds_read_b64_tr_b16 v[98:99], v35 offset:17408
    s_waitcnt lgkmcnt(8)
    v_mfma_f32_32x32x16_bf16 v[144:159], v[64:67], v[84:87], v[144:159]
    ds_read_b128 v[112:115], v43 offset:28672
    ds_read_b64_tr_b16 v[100:101], v36 offset:16384
    v_mfma_f32_32x32x16_bf16 v[176:191], v[68:71], v[84:87], v[176:191]
    ds_read_b64_tr_b16 v[102:103], v36 offset:17408
    ds_read_b128 v[116:119], v44 offset:28672
    s_waitcnt lgkmcnt(9)
    v_mfma_f32_32x32x16_bf16 v[128:143], v[72:75], v[88:91], v[128:143]
    s_waitcnt vmcnt(9)
    ds_read_b64_tr_b16 v[104:105], v35 offset:18432
    s_waitcnt vmcnt(8)
    ds_read_b64_tr_b16 v[106:107], v35 offset:19456
    s_waitcnt lgkmcnt(9)
    v_mfma_f32_32x32x16_bf16 v[160:175], v[76:79], v[88:91], v[160:175]
    ds_read_b128 v[120:123], v43 offset:30720
    ds_read_b64_tr_b16 v[108:109], v36 offset:18432
    s_waitcnt lgkmcnt(10)
    v_mfma_f32_32x32x16_bf16 v[144:159], v[72:75], v[92:95], v[144:159]
    ds_read_b64_tr_b16 v[110:111], v36 offset:19456
    ds_read_b128 v[124:127], v44 offset:30720
    v_mfma_f32_32x32x16_bf16 v[176:191], v[76:79], v[92:95], v[176:191]
    s_waitcnt lgkmcnt(9)
    v_mfma_f32_32x32x16_bf16 v[128:143], v[96:99], v[112:115], v[128:143]
    s_add_u32 m0, s44, 4096
    s_xor_b32 s45, s61, 3
    s_mulk_i32 s45, 14336
    buffer_load_dwordx4 v21, s[24:27], s45 offen lds
    s_waitcnt lgkmcnt(7)
    v_mfma_f32_32x32x16_bf16 v[160:175], v[100:103], v[112:115], v[160:175]
    s_waitcnt vmcnt(8)
    ds_read_b64_tr_b16 v[64:65], v35 offset:20480
    s_waitcnt vmcnt(7)
    ds_read_b64_tr_b16 v[66:67], v35 offset:21504
    s_waitcnt lgkmcnt(8)
    v_mfma_f32_32x32x16_bf16 v[144:159], v[96:99], v[116:119], v[144:159]
    buffer_load_dwordx4 v22, s[24:27], s45 offen offset:1024 lds
    ds_read_b128 v[80:83], v43 offset:45056
    ds_read_b64_tr_b16 v[68:69], v36 offset:20480
    v_mfma_f32_32x32x16_bf16 v[176:191], v[100:103], v[116:119], v[176:191]
    ds_read_b64_tr_b16 v[70:71], v36 offset:21504
    ds_read_b128 v[84:87], v44 offset:45056
    s_waitcnt lgkmcnt(9)
    v_mfma_f32_32x32x16_bf16 v[128:143], v[104:107], v[120:123], v[128:143]
    buffer_load_dwordx4 v23, s[24:27], s45 offen offset:2048 lds
    s_waitcnt vmcnt(8)
    ds_read_b64_tr_b16 v[72:73], v35 offset:22528
    s_waitcnt vmcnt(7)
    ds_read_b64_tr_b16 v[74:75], v35 offset:23552
    s_waitcnt lgkmcnt(9)
    v_mfma_f32_32x32x16_bf16 v[160:175], v[108:111], v[120:123], v[160:175]
    ds_read_b128 v[88:91], v43 offset:47104
    ds_read_b64_tr_b16 v[76:77], v36 offset:22528
    s_waitcnt lgkmcnt(10)
    v_mfma_f32_32x32x16_bf16 v[144:159], v[104:107], v[124:127], v[144:159]
    buffer_load_dwordx4 v24, s[24:27], s45 offen offset:3072 lds
    ds_read_b64_tr_b16 v[78:79], v36 offset:23552
    ds_read_b128 v[92:95], v44 offset:47104
    v_mfma_f32_32x32x16_bf16 v[176:191], v[108:111], v[124:127], v[176:191]
    s_waitcnt lgkmcnt(9)
    v_mfma_f32_32x32x16_bf16 v[128:143], v[64:67], v[80:83], v[128:143]
    s_add_u32 m0, s44, 8192
    s_xor_b32 s45, s61, 4
    s_mulk_i32 s45, 14336
    buffer_load_dwordx4 v21, s[24:27], s45 offen lds
    s_waitcnt lgkmcnt(7)
    v_mfma_f32_32x32x16_bf16 v[160:175], v[68:71], v[80:83], v[160:175]
    s_waitcnt vmcnt(8)
    ds_read_b64_tr_b16 v[96:97], v35 offset:0
    s_waitcnt vmcnt(7)
    ds_read_b64_tr_b16 v[98:99], v35 offset:1024
    s_waitcnt lgkmcnt(8)
    v_mfma_f32_32x32x16_bf16 v[144:159], v[64:67], v[84:87], v[144:159]
    buffer_load_dwordx4 v22, s[24:27], s45 offen offset:1024 lds
    ds_read_b128 v[112:115], v43 offset:61440
    ds_read_b64_tr_b16 v[100:101], v36 offset:0
    v_mfma_f32_32x32x16_bf16 v[176:191], v[68:71], v[84:87], v[176:191]
    ds_read_b64_tr_b16 v[102:103], v36 offset:1024
    ds_read_b128 v[116:119], v44 offset:61440
    s_waitcnt lgkmcnt(9)
    v_mfma_f32_32x32x16_bf16 v[128:143], v[72:75], v[88:91], v[128:143]
    buffer_load_dwordx4 v23, s[24:27], s45 offen offset:2048 lds
    s_waitcnt vmcnt(8)
    ds_read_b64_tr_b16 v[104:105], v35 offset:2048
    s_waitcnt vmcnt(7)
    ds_read_b64_tr_b16 v[106:107], v35 offset:3072
    s_waitcnt lgkmcnt(9)
    v_mfma_f32_32x32x16_bf16 v[160:175], v[76:79], v[88:91], v[160:175]
    ds_read_b128 v[120:123], v43 offset:63488
    ds_read_b64_tr_b16 v[108:109], v36 offset:2048
    s_waitcnt lgkmcnt(10)
    v_mfma_f32_32x32x16_bf16 v[144:159], v[72:75], v[92:95], v[144:159]
    buffer_load_dwordx4 v24, s[24:27], s45 offen offset:3072 lds
    ds_read_b64_tr_b16 v[110:111], v36 offset:3072
    ds_read_b128 v[124:127], v44 offset:63488
    v_mfma_f32_32x32x16_bf16 v[176:191], v[76:79], v[92:95], v[176:191]
    s_waitcnt lgkmcnt(9)
    v_mfma_f32_32x32x16_bf16 v[128:143], v[96:99], v[112:115], v[128:143]
    s_waitcnt lgkmcnt(3)
    v_mfma_f32_32x32x16_bf16 v[128:143], v[104:107], v[120:123], v[128:143]
    v_mfma_f32_32x32x16_bf16 v[144:159], v[96:99], v[116:119], v[144:159]
    s_waitcnt lgkmcnt(0)
    v_mfma_f32_32x32x16_bf16 v[144:159], v[104:107], v[124:127], v[144:159]
    v_mfma_f32_32x32x16_bf16 v[160:175], v[100:103], v[112:115], v[160:175]
    s_nop 7
    v_cvt_pk_bf16_f32 v64, v128, v129
    v_cvt_pk_bf16_f32 v65, v130, v131
    v_cvt_pk_bf16_f32 v66, v132, v133
    v_cvt_pk_bf16_f32 v67, v134, v135
    ds_write_b128 v16, v[64:67] offset:0
    v_cvt_pk_bf16_f32 v72, v136, v137
    v_cvt_pk_bf16_f32 v73, v138, v139
    v_cvt_pk_bf16_f32 v74, v140, v141
    v_cvt_pk_bf16_f32 v75, v142, v143
    ds_write_b128 v16, v[72:75] offset:2048
    v_mfma_f32_32x32x16_bf16 v[160:175], v[108:111], v[120:123], v[160:175]
    v_mfma_f32_32x32x16_bf16 v[176:191], v[100:103], v[116:119], v[176:191]
    v_cvt_pk_bf16_f32 v68, v144, v145
    v_cvt_pk_bf16_f32 v69, v146, v147
    v_cvt_pk_bf16_f32 v70, v148, v149
    v_cvt_pk_bf16_f32 v71, v150, v151
    ds_write_b128 v12, v[68:71] offset:0
    v_cvt_pk_bf16_f32 v76, v152, v153
    v_cvt_pk_bf16_f32 v77, v154, v155
    v_cvt_pk_bf16_f32 v78, v156, v157
    v_cvt_pk_bf16_f32 v79, v158, v159
    ds_write_b128 v12, v[76:79] offset:2048
    v_mfma_f32_32x32x16_bf16 v[176:191], v[108:111], v[124:127], v[176:191]
    v_cvt_pk_bf16_f32 v80, v160, v161
    v_cvt_pk_bf16_f32 v81, v162, v163
    v_cvt_pk_bf16_f32 v82, v164, v165
    v_cvt_pk_bf16_f32 v83, v166, v167
    ds_write_b128 v16, v[80:83] offset:4096
    v_cvt_pk_bf16_f32 v88, v168, v169
    v_cvt_pk_bf16_f32 v89, v170, v171
    v_cvt_pk_bf16_f32 v90, v172, v173
    v_cvt_pk_bf16_f32 v91, v174, v175
    ds_write_b128 v16, v[88:91] offset:6144
    s_nop 1
    v_cvt_pk_bf16_f32 v84, v176, v177
    v_cvt_pk_bf16_f32 v85, v178, v179
    v_cvt_pk_bf16_f32 v86, v180, v181
    v_cvt_pk_bf16_f32 v87, v182, v183
    ds_write_b128 v12, v[84:87] offset:4096
    v_cvt_pk_bf16_f32 v92, v184, v185
    v_cvt_pk_bf16_f32 v93, v186, v187
    v_cvt_pk_bf16_f32 v94, v188, v189
    v_cvt_pk_bf16_f32 v95, v190, v191
    ds_write_b128 v12, v[92:95] offset:6144
    s_add_u32 m0, s44, 12288
    s_xor_b32 s45, s61, 5
    s_mulk_i32 s45, 14336
    buffer_load_dwordx4 v21, s[24:27], s45 offen lds
    buffer_load_dwordx4 v22, s[24:27], s45 offen offset:1024 lds
    buffer_load_dwordx4 v23, s[24:27], s45 offen offset:2048 lds
    buffer_load_dwordx4 v24, s[24:27], s45 offen offset:3072 lds
    s_waitcnt lgkmcnt(0)
    s_barrier
    ds_read_b128 v[240:243], v43 offset:0
    ds_read_b128 v[244:247], v44 offset:0
    s_waitcnt lgkmcnt(1)
    v_mfma_f32_32x32x16_bf16 v[128:143], a[128:131], v[240:243], 0
    s_add_u32 m0, s44, 16384
    s_xor_b32 s45, s61, 6
    s_mulk_i32 s45, 14336
    buffer_load_dwordx4 v21, s[24:27], s45 offen lds
    s_lshl_b32 s51, s47, 1
    s_add_u32 s51, s51, s42
    v_mfma_f32_32x32x16_bf16 v[144:159], a[132:135], v[240:243], 0
    buffer_load_dwordx4 v22, s[24:27], s45 offen offset:1024 lds
    ds_read_b128 v[248:251], v43 offset:2048
    ds_read_b128 v[252:255], v44 offset:2048
    ds_read_b128 v[96:99], v43 offset:51200
    s_and_b32 s51, s51, 15
    v_mfma_f32_32x32x16_bf16 v[160:175], a[136:139], v[240:243], 0
    ds_read_b128 v[100:103], v44 offset:51200
    s_waitcnt vmcnt(11)
    ds_read_b64_tr_b16 a[176:177], v37 offset:4096
    s_lshl_b32 s3, s47, 13
    v_mfma_f32_32x32x16_bf16 v[176:191], a[140:143], v[240:243], 0
    buffer_load_dwordx4 v23, s[24:27], s45 offen offset:2048 lds
    ds_read_b64_tr_b16 a[180:181], v38 offset:4096
    ds_read_b64_tr_b16 a[184:185], v39 offset:4096
    ds_read_b64_tr_b16 a[188:189], v40 offset:4096
    s_add_u32 s3, s3, 65536
    s_waitcnt lgkmcnt(8)
    v_mfma_f32_32x32x16_bf16 v[192:207], a[128:131], v[244:247], 0
    s_waitcnt vmcnt(11)
    ds_read_b64_tr_b16 a[178:179], v37 offset:5120
    ds_read_b64_tr_b16 a[182:183], v38 offset:5120
    s_lshl_b32 s5, s51, 2
    v_mfma_f32_32x32x16_bf16 v[208:223], a[132:135], v[244:247], 0
    buffer_load_dwordx4 v24, s[24:27], s45 offen offset:3072 lds
    ds_read_b64_tr_b16 a[186:187], v39 offset:5120
    ds_read_b64_tr_b16 a[190:191], v40 offset:5120
    s_add_u32 s5, s5, s40
    v_mfma_f32_32x32x16_bf16 v[224:239], a[136:139], v[244:247], 0
    s_lshl_b32 s4, s5, 7
    s_waitcnt lgkmcnt(11)
    v_mfma_f32_32x32x16_bf16 v[128:143], a[144:147], v[248:251], v[128:143]
    s_add_u32 m0, s44, 20480
    s_xor_b32 s45, s61, 7
    s_mulk_i32 s45, 14336
    buffer_load_dwordx4 v21, s[24:27], s45 offen lds
    s_add_u32 s59, s3, s4
    v_mov_b32 v5, 1
    v_mfma_f32_32x32x16_bf16 v[144:159], a[148:151], v[248:251], v[144:159]
    buffer_load_dwordx4 v22, s[24:27], s45 offen offset:1024 lds
    ds_read_b128 v[240:243], v43 offset:4096
    ds_read_b128 v[244:247], v44 offset:4096
    ds_read_b128 v[104:107], v43 offset:53248
    v_mov_b32 v7, 0
    v_mfma_f32_32x32x16_bf16 v[160:175], a[152:155], v[248:251], v[160:175]
    ds_read_b128 v[108:111], v44 offset:53248
    s_waitcnt vmcnt(11)
    ds_read_b64_tr_b16 a[192:193], v37 offset:8192
    v_and_b32 v28, v28, v29
    v_mfma_f32_32x32x16_bf16 v[176:191], a[156:159], v[248:251], v[176:191]
    buffer_load_dwordx4 v23, s[24:27], s45 offen offset:2048 lds
    ds_read_b64_tr_b16 a[196:197], v38 offset:8192
    ds_read_b64_tr_b16 a[200:201], v39 offset:8192
    ds_read_b64_tr_b16 a[204:205], v40 offset:8192
    v_and_b32 v30, v30, v31
    s_waitcnt lgkmcnt(14)
    v_mfma_f32_32x32x16_bf16 v[192:207], a[144:147], v[252:255], v[192:207]
    s_waitcnt vmcnt(11)
    ds_read_b64_tr_b16 a[194:195], v37 offset:9216
    ds_read_b64_tr_b16 a[198:199], v38 offset:9216
    v_and_b32 v28, v28, v30
    v_mfma_f32_32x32x16_bf16 v[208:223], a[148:151], v[252:255], v[208:223]
    buffer_load_dwordx4 v24, s[24:27], s45 offen offset:3072 lds
    ds_read_b64_tr_b16 a[202:203], v39 offset:9216
    ds_read_b64_tr_b16 a[206:207], v40 offset:9216
    s_mul_i32 s6, s47, 917504
    v_mfma_f32_32x32x16_bf16 v[224:239], a[152:155], v[252:255], v[224:239]
    s_lshr_b32 s4, s5, 1
    s_waitcnt lgkmcnt(11)
    v_mfma_f32_32x32x16_bf16 v[128:143], a[160:163], v[240:243], v[128:143]
    s_add_u32 m0, s44, 0
    s_xor_b32 s45, s61, 8
    s_mulk_i32 s45, 14336
    buffer_load_dwordx4 v21, s[24:27], s45 offen lds
    s_lshl_b32 s4, s4, 15
    s_add_u32 s6, s6, s4
    v_mfma_f32_32x32x16_bf16 v[144:159], a[164:167], v[240:243], v[144:159]
    buffer_load_dwordx4 v22, s[24:27], s45 offen offset:1024 lds
    ds_read_b128 v[248:251], v43 offset:6144
    ds_read_b128 v[252:255], v44 offset:6144
    ds_read_b128 v[112:115], v43 offset:55296
    s_lshl_b32 s4, s50, 10
    v_mfma_f32_32x32x16_bf16 v[160:175], a[168:171], v[240:243], v[160:175]
    ds_read_b128 v[116:119], v44 offset:55296
    s_waitcnt vmcnt(11)
    ds_read_b64_tr_b16 a[208:209], v37 offset:12288
    s_add_u32 s6, s6, s4
    v_mfma_f32_32x32x16_bf16 v[176:191], a[172:175], v[240:243], v[176:191]
    buffer_load_dwordx4 v23, s[24:27], s45 offen offset:2048 lds
    ds_read_b64_tr_b16 a[212:213], v38 offset:12288
    ds_read_b64_tr_b16 a[216:217], v39 offset:12288
    ds_read_b64_tr_b16 a[220:221], v40 offset:12288
    s_add_u32 s6, s6, 1048576
    s_waitcnt lgkmcnt(14)
    v_mfma_f32_32x32x16_bf16 v[192:207], a[160:163], v[244:247], v[192:207]
    s_waitcnt vmcnt(11)
    ds_read_b64_tr_b16 a[210:211], v37 offset:13312
    ds_read_b64_tr_b16 a[214:215], v38 offset:13312
    s_lshl_b32 s7, s43, 1
    v_mfma_f32_32x32x16_bf16 v[208:223], a[164:167], v[244:247], v[208:223]
    buffer_load_dwordx4 v24, s[24:27], s45 offen offset:3072 lds
    ds_read_b64_tr_b16 a[218:219], v39 offset:13312
    ds_read_b64_tr_b16 a[222:223], v40 offset:13312
    s_and_b32 s4, s51, 1
    v_mfma_f32_32x32x16_bf16 v[224:239], a[168:171], v[244:247], v[224:239]
    s_add_u32 s7, s7, s4
    s_waitcnt lgkmcnt(11)
    v_mfma_f32_32x32x16_bf16 v[128:143], a[176:179], v[248:251], v[128:143]
    s_add_u32 m0, s44, 4096
    s_xor_b32 s45, s61, 9
    s_mulk_i32 s45, 14336
    buffer_load_dwordx4 v21, s[24:27], s45 offen lds
    s_mul_i32 s7, s7, 57344
    s_mul_i32 s4, s41, 896
    v_mfma_f32_32x32x16_bf16 v[144:159], a[180:183], v[248:251], v[144:159]
    buffer_load_dwordx4 v22, s[24:27], s45 offen offset:1024 lds
    ds_read_b128 v[240:243], v43 offset:16384
    ds_read_b128 v[244:247], v44 offset:16384
    s_add_u32 s7, s7, s4
    v_mfma_f32_32x32x16_bf16 v[160:175], a[184:187], v[248:251], v[160:175]
    s_waitcnt vmcnt(11)
    ds_read_b64_tr_b16 a[224:225], v37 offset:16384
    ds_read_b64_tr_b16 a[228:229], v38 offset:16384
    s_lshr_b32 s4, s51, 1
    v_mfma_f32_32x32x16_bf16 v[176:191], a[188:191], v[248:251], v[176:191]
    buffer_load_dwordx4 v23, s[24:27], s45 offen offset:2048 lds
    ds_read_b64_tr_b16 a[232:233], v39 offset:16384
    ds_read_b64_tr_b16 a[236:237], v40 offset:16384
    s_lshl_b32 s4, s4, 7
    s_waitcnt lgkmcnt(14)
    v_mfma_f32_32x32x16_bf16 v[192:207], a[176:179], v[252:255], v[192:207]
    s_waitcnt vmcnt(11)
    ds_read_b64_tr_b16 a[226:227], v37 offset:17408
    ds_read_b64_tr_b16 a[230:231], v38 offset:17408
    s_add_u32 s7, s7, s4
    v_mfma_f32_32x32x16_bf16 v[208:223], a[180:183], v[252:255], v[208:223]
    buffer_load_dwordx4 v24, s[24:27], s45 offen offset:3072 lds
    ds_read_b64_tr_b16 a[234:235], v39 offset:17408
    ds_read_b64_tr_b16 a[238:239], v40 offset:17408
    s_lshl_b32 s4, s40, 5
    v_mfma_f32_32x32x16_bf16 v[224:239], a[184:187], v[252:255], v[224:239]
    s_add_u32 s7, s7, s4
    s_waitcnt lgkmcnt(9)
    v_mfma_f32_32x32x16_bf16 v[128:143], a[192:195], v[240:243], v[128:143]
    s_add_u32 m0, s44, 8192
    s_xor_b32 s45, s61, 10
    s_mulk_i32 s45, 14336
    buffer_load_dwordx4 v21, s[24:27], s45 offen lds
    v_and_b32 v2, 31, v1
    v_mul_u32_u24 v2, 1792, v2
    v_mfma_f32_32x32x16_bf16 v[144:159], a[196:199], v[240:243], v[144:159]
    buffer_load_dwordx4 v22, s[24:27], s45 offen offset:1024 lds
    ds_read_b128 v[248:251], v43 offset:18432
    ds_read_b128 v[252:255], v44 offset:18432
    v_lshrrev_b32 v3, 5, v1
    v_mfma_f32_32x32x16_bf16 v[160:175], a[200:203], v[240:243], v[160:175]
    s_waitcnt vmcnt(11)
    ds_read_b64_tr_b16 a[240:241], v37 offset:20480
    ds_read_b64_tr_b16 a[244:245], v38 offset:20480
    v_lshl_add_u32 v2, v3, 4, v2
    v_mfma_f32_32x32x16_bf16 v[176:191], a[204:207], v[240:243], v[176:191]
    buffer_load_dwordx4 v23, s[24:27], s45 offen offset:2048 lds
    ds_read_b64_tr_b16 a[248:249], v39 offset:20480
    ds_read_b64_tr_b16 a[252:253], v40 offset:20480
    v_bfe_u32 v9, v1, 2, 1
    s_waitcnt lgkmcnt(14)
    v_mfma_f32_32x32x16_bf16 v[192:207], a[192:195], v[244:247], v[192:207]
    s_waitcnt vmcnt(11)
    ds_read_b64_tr_b16 a[242:243], v37 offset:21504
    ds_read_b64_tr_b16 a[246:247], v38 offset:21504
    v_xor_b32 v9, v9, v3
    v_mfma_f32_32x32x16_bf16 v[208:223], a[196:199], v[244:247], v[208:223]
    buffer_load_dwordx4 v24, s[24:27], s45 offen offset:3072 lds
    ds_read_b64_tr_b16 a[250:251], v39 offset:21504
    ds_read_b64_tr_b16 a[254:255], v40 offset:21504
    v_bfe_u32 v10, v1, 4, 1
    v_mfma_f32_32x32x16_bf16 v[224:239], a[200:203], v[244:247], v[224:239]
    v_or_b32 v9, v9, v10
    s_waitcnt lgkmcnt(9)
    v_mfma_f32_32x32x16_bf16 v[128:143], a[208:211], v[248:251], v[128:143]
    s_add_u32 m0, s44, 12288
    s_xor_b32 s45, s61, 11
    s_mulk_i32 s45, 14336
    buffer_load_dwordx4 v21, s[24:27], s45 offen lds
    v_lshlrev_b32 v9, 2, v9
    v_bfe_u32 v10, v1, 3, 1
    v_mfma_f32_32x32x16_bf16 v[144:159], a[212:215], v[248:251], v[144:159]
    buffer_load_dwordx4 v22, s[24:27], s45 offen offset:1024 lds
    ds_read_b128 v[240:243], v43 offset:20480
    ds_read_b128 v[244:247], v44 offset:20480
    v_lshl_add_u32 v9, v10, 1, v9
    v_mfma_f32_32x32x16_bf16 v[160:175], a[216:219], v[248:251], v[160:175]
    s_waitcnt vmcnt(11)
    ds_read_b64_tr_b16 a[0:1], v37 offset:0
    ds_read_b64_tr_b16 a[4:5], v38 offset:0
    v_bfe_u32 v10, v1, 1, 1
    v_mfma_f32_32x32x16_bf16 v[176:191], a[220:223], v[248:251], v[176:191]
    buffer_load_dwordx4 v23, s[24:27], s45 offen offset:2048 lds
    ds_read_b64_tr_b16 a[8:9], v39 offset:0
    ds_read_b64_tr_b16 a[12:13], v40 offset:0
    v_add_u32 v9, v9, v10
    s_waitcnt lgkmcnt(14)
    v_mfma_f32_32x32x16_bf16 v[192:207], a[208:211], v[252:255], v[192:207]
    s_waitcnt vmcnt(11)
    ds_read_b64_tr_b16 a[2:3], v37 offset:1024
    ds_read_b64_tr_b16 a[6:7], v38 offset:1024
    v_and_b32 v10, 1, v1
    v_mfma_f32_32x32x16_bf16 v[208:223], a[212:215], v[252:255], v[208:223]
    buffer_load_dwordx4 v24, s[24:27], s45 offen offset:3072 lds
    ds_read_b64_tr_b16 a[10:11], v39 offset:1024
    ds_read_b64_tr_b16 a[14:15], v40 offset:1024
    v_lshlrev_b32 v10, 4, v10
    v_mfma_f32_32x32x16_bf16 v[224:239], a[216:219], v[252:255], v[224:239]
    v_mov_b32 v11, 0x3f80
    s_waitcnt lgkmcnt(9)
    v_mfma_f32_32x32x16_bf16 v[128:143], a[224:227], v[240:243], v[128:143]
    s_add_u32 m0, s44, 16384
    s_xor_b32 s45, s61, 12
    s_mulk_i32 s45, 14336
    buffer_load_dwordx4 v21, s[24:27], s45 offen lds
    v_lshlrev_b32 v10, v10, v11
    v_cmp_eq_u32 vcc, 0, v9
    v_mfma_f32_32x32x16_bf16 v[144:159], a[228:231], v[240:243], v[144:159]
    buffer_load_dwordx4 v22, s[24:27], s45 offen offset:1024 lds
    ds_read_b128 v[248:251], v43 offset:22528
    ds_read_b128 v[252:255], v44 offset:22528
    v_cndmask_b32 v16, 0, v10, vcc
    v_mfma_f32_32x32x16_bf16 v[160:175], a[232:235], v[240:243], v[160:175]
    s_waitcnt vmcnt(11)
    ds_read_b64_tr_b16 a[16:17], v37 offset:4096
    ds_read_b64_tr_b16 a[20:21], v38 offset:4096
    v_cmp_eq_u32 vcc, 1, v9
    v_mfma_f32_32x32x16_bf16 v[176:191], a[236:239], v[240:243], v[176:191]
    buffer_load_dwordx4 v23, s[24:27], s45 offen offset:2048 lds
    ds_read_b64_tr_b16 a[24:25], v39 offset:4096
    ds_read_b64_tr_b16 a[28:29], v40 offset:4096
    v_cndmask_b32 v17, 0, v10, vcc
    s_waitcnt lgkmcnt(14)
    v_mfma_f32_32x32x16_bf16 v[192:207], a[224:227], v[244:247], v[192:207]
    s_waitcnt vmcnt(11)
    ds_read_b64_tr_b16 a[18:19], v37 offset:5120
    ds_read_b64_tr_b16 a[22:23], v38 offset:5120
    v_cmp_eq_u32 vcc, 2, v9
    v_mfma_f32_32x32x16_bf16 v[208:223], a[228:231], v[244:247], v[208:223]
    buffer_load_dwordx4 v24, s[24:27], s45 offen offset:3072 lds
    ds_read_b64_tr_b16 a[26:27], v39 offset:5120
    ds_read_b64_tr_b16 a[30:31], v40 offset:5120
    v_cndmask_b32 v18, 0, v10, vcc
    v_mfma_f32_32x32x16_bf16 v[224:239], a[232:235], v[244:247], v[224:239]
    v_cmp_eq_u32 vcc, 3, v9
    s_waitcnt lgkmcnt(9)
    v_mfma_f32_32x32x16_bf16 v[128:143], a[240:243], v[248:251], v[128:143]
    s_add_u32 m0, s44, 20480
    s_xor_b32 s45, s61, 13
    s_mulk_i32 s45, 14336
    buffer_load_dwordx4 v21, s[24:27], s45 offen lds
    v_cndmask_b32 v19, 0, v10, vcc
    v_mfma_f32_32x32x16_bf16 v[144:159], a[244:247], v[248:251], v[144:159]
    buffer_load_dwordx4 v22, s[24:27], s45 offen offset:1024 lds
    ds_read_b128 v[240:243], v43 offset:32768
    ds_read_b128 v[244:247], v44 offset:32768
    v_mfma_f32_32x32x16_bf16 v[160:175], a[248:251], v[248:251], v[160:175]
    s_waitcnt vmcnt(11)
    ds_read_b64_tr_b16 a[32:33], v37 offset:8192
    ds_read_b64_tr_b16 a[36:37], v38 offset:8192
    v_mfma_f32_32x32x16_bf16 v[176:191], a[252:255], v[248:251], v[176:191]
    buffer_load_dwordx4 v23, s[24:27], s45 offen offset:2048 lds
    ds_read_b64_tr_b16 a[40:41], v39 offset:8192
    ds_read_b64_tr_b16 a[44:45], v40 offset:8192
    s_waitcnt lgkmcnt(14)
    v_mfma_f32_32x32x16_bf16 v[192:207], a[240:243], v[252:255], v[192:207]
    s_waitcnt vmcnt(11)
    ds_read_b64_tr_b16 a[34:35], v37 offset:9216
    ds_read_b64_tr_b16 a[38:39], v38 offset:9216
    v_mfma_f32_32x32x16_bf16 v[208:223], a[244:247], v[252:255], v[208:223]
    buffer_load_dwordx4 v24, s[24:27], s45 offen offset:3072 lds
    ds_read_b64_tr_b16 a[42:43], v39 offset:9216
    ds_read_b64_tr_b16 a[46:47], v40 offset:9216
    v_mfma_f32_32x32x16_bf16 v[224:239], a[248:251], v[252:255], v[224:239]
    s_waitcnt lgkmcnt(9)
    v_mfma_f32_32x32x16_bf16 v[128:143], a[0:3], v[240:243], v[128:143]
    s_add_u32 m0, s44, 0
    s_xor_b32 s45, s61, 14
    s_mulk_i32 s45, 14336
    buffer_load_dwordx4 v21, s[24:27], s45 offen lds
    v_mfma_f32_32x32x16_bf16 v[144:159], a[4:7], v[240:243], v[144:159]
    buffer_load_dwordx4 v22, s[24:27], s45 offen offset:1024 lds
    ds_read_b128 v[248:251], v43 offset:34816
    ds_read_b128 v[252:255], v44 offset:34816
    v_mfma_f32_32x32x16_bf16 v[160:175], a[8:11], v[240:243], v[160:175]
    s_waitcnt vmcnt(11)
    ds_read_b64_tr_b16 a[48:49], v37 offset:12288
    ds_read_b64_tr_b16 a[52:53], v38 offset:12288
    v_mfma_f32_32x32x16_bf16 v[176:191], a[12:15], v[240:243], v[176:191]
    buffer_load_dwordx4 v23, s[24:27], s45 offen offset:2048 lds
    ds_read_b64_tr_b16 a[56:57], v39 offset:12288
    ds_read_b64_tr_b16 a[60:61], v40 offset:12288
    s_waitcnt lgkmcnt(14)
    v_mfma_f32_32x32x16_bf16 v[192:207], a[0:3], v[244:247], v[192:207]
    s_waitcnt vmcnt(11)
    ds_read_b64_tr_b16 a[50:51], v37 offset:13312
    ds_read_b64_tr_b16 a[54:55], v38 offset:13312
    v_mfma_f32_32x32x16_bf16 v[208:223], a[4:7], v[244:247], v[208:223]
    buffer_load_dwordx4 v24, s[24:27], s45 offen offset:3072 lds
    ds_read_b64_tr_b16 a[58:59], v39 offset:13312
    ds_read_b64_tr_b16 a[62:63], v40 offset:13312
    v_mfma_f32_32x32x16_bf16 v[224:239], a[8:11], v[244:247], v[224:239]
    s_waitcnt lgkmcnt(9)
    v_mfma_f32_32x32x16_bf16 v[128:143], a[16:19], v[248:251], v[128:143]
    s_add_u32 m0, s44, 4096
    s_xor_b32 s45, s61, 15
    s_mulk_i32 s45, 14336
    buffer_load_dwordx4 v21, s[24:27], s45 offen lds
    v_mfma_f32_32x32x16_bf16 v[144:159], a[20:23], v[248:251], v[144:159]
    buffer_load_dwordx4 v22, s[24:27], s45 offen offset:1024 lds
    ds_read_b128 v[240:243], v43 offset:36864
    ds_read_b128 v[244:247], v44 offset:36864
    v_mfma_f32_32x32x16_bf16 v[160:175], a[24:27], v[248:251], v[160:175]
    s_waitcnt vmcnt(11)
    ds_read_b64_tr_b16 a[64:65], v37 offset:16384
    ds_read_b64_tr_b16 a[68:69], v38 offset:16384
    v_mfma_f32_32x32x16_bf16 v[176:191], a[28:31], v[248:251], v[176:191]
    buffer_load_dwordx4 v23, s[24:27], s45 offen offset:2048 lds
    ds_read_b64_tr_b16 a[72:73], v39 offset:16384
    ds_read_b64_tr_b16 a[76:77], v40 offset:16384
    s_waitcnt lgkmcnt(14)
    v_mfma_f32_32x32x16_bf16 v[192:207], a[16:19], v[252:255], v[192:207]
    s_waitcnt vmcnt(11)
    ds_read_b64_tr_b16 a[66:67], v37 offset:17408
    ds_read_b64_tr_b16 a[70:71], v38 offset:17408
    v_mfma_f32_32x32x16_bf16 v[208:223], a[20:23], v[252:255], v[208:223]
    buffer_load_dwordx4 v24, s[24:27], s45 offen offset:3072 lds
    ds_read_b64_tr_b16 a[74:75], v39 offset:17408
    ds_read_b64_tr_b16 a[78:79], v40 offset:17408
    v_mfma_f32_32x32x16_bf16 v[224:239], a[24:27], v[252:255], v[224:239]
    s_waitcnt lgkmcnt(9)
    v_mfma_f32_32x32x16_bf16 v[128:143], a[32:35], v[240:243], v[128:143]
    v_mfma_f32_32x32x16_bf16 v[144:159], a[36:39], v[240:243], v[144:159]
    ds_read_b128 v[248:251], v43 offset:38912
    ds_read_b128 v[252:255], v44 offset:38912
    v_mfma_f32_32x32x16_bf16 v[160:175], a[40:43], v[240:243], v[160:175]
    s_waitcnt vmcnt(9)
    ds_read_b64_tr_b16 a[80:81], v37 offset:20480
    ds_read_b64_tr_b16 a[84:85], v38 offset:20480
    v_mfma_f32_32x32x16_bf16 v[176:191], a[44:47], v[240:243], v[176:191]
    ds_read_b64_tr_b16 a[88:89], v39 offset:20480
    ds_read_b64_tr_b16 a[92:93], v40 offset:20480
    s_waitcnt lgkmcnt(14)
    v_mfma_f32_32x32x16_bf16 v[192:207], a[32:35], v[244:247], v[192:207]
    s_waitcnt vmcnt(8)
    ds_read_b64_tr_b16 a[82:83], v37 offset:21504
    ds_read_b64_tr_b16 a[86:87], v38 offset:21504
    v_mfma_f32_32x32x16_bf16 v[208:223], a[36:39], v[244:247], v[208:223]
    ds_read_b64_tr_b16 a[90:91], v39 offset:21504
    ds_read_b64_tr_b16 a[94:95], v40 offset:21504
    v_mfma_f32_32x32x16_bf16 v[224:239], a[40:43], v[244:247], v[224:239]
    s_waitcnt lgkmcnt(9)
    v_mfma_f32_32x32x16_bf16 v[128:143], a[48:51], v[248:251], v[128:143]
    v_mfma_f32_32x32x16_bf16 v[144:159], a[52:55], v[248:251], v[144:159]
    ds_read_b128 v[240:243], v43 offset:49152
    ds_read_b128 v[244:247], v44 offset:49152
    v_mfma_f32_32x32x16_bf16 v[160:175], a[56:59], v[248:251], v[160:175]
    s_waitcnt vmcnt(5)
    ds_read_b64_tr_b16 a[96:97], v37 offset:0
    ds_read_b64_tr_b16 a[100:101], v38 offset:0
    v_mfma_f32_32x32x16_bf16 v[176:191], a[60:63], v[248:251], v[176:191]
    ds_read_b64_tr_b16 a[104:105], v39 offset:0
    ds_read_b64_tr_b16 a[108:109], v40 offset:0
    s_waitcnt lgkmcnt(14)
    v_mfma_f32_32x32x16_bf16 v[192:207], a[48:51], v[252:255], v[192:207]
    s_waitcnt vmcnt(4)
    ds_read_b64_tr_b16 a[98:99], v37 offset:1024
    ds_read_b64_tr_b16 a[102:103], v38 offset:1024
    v_mfma_f32_32x32x16_bf16 v[208:223], a[52:55], v[252:255], v[208:223]
    ds_read_b64_tr_b16 a[106:107], v39 offset:1024
    ds_read_b64_tr_b16 a[110:111], v40 offset:1024
    v_mfma_f32_32x32x16_bf16 v[224:239], a[56:59], v[252:255], v[224:239]
    s_waitcnt lgkmcnt(9)
    v_mfma_f32_32x32x16_bf16 v[128:143], a[64:67], v[240:243], v[128:143]
    v_mfma_f32_32x32x16_bf16 v[144:159], a[68:71], v[240:243], v[144:159]
    s_waitcnt vmcnt(1)
    ds_read_b64_tr_b16 a[112:113], v37 offset:4096
    ds_read_b64_tr_b16 a[116:117], v38 offset:4096
    v_mfma_f32_32x32x16_bf16 v[160:175], a[72:75], v[240:243], v[160:175]
    ds_read_b64_tr_b16 a[120:121], v39 offset:4096
    ds_read_b64_tr_b16 a[124:125], v40 offset:4096
    v_mfma_f32_32x32x16_bf16 v[176:191], a[76:79], v[240:243], v[176:191]
    s_waitcnt vmcnt(0)
    ds_read_b64_tr_b16 a[114:115], v37 offset:5120
    s_waitcnt lgkmcnt(13)
    v_mfma_f32_32x32x16_bf16 v[192:207], a[64:67], v[244:247], v[192:207]
    ds_read_b64_tr_b16 a[118:119], v38 offset:5120
    ds_read_b64_tr_b16 a[122:123], v39 offset:5120
    v_mfma_f32_32x32x16_bf16 v[208:223], a[68:71], v[244:247], v[208:223]
    ds_read_b64_tr_b16 a[126:127], v40 offset:5120
    v_mfma_f32_32x32x16_bf16 v[224:239], a[72:75], v[244:247], v[224:239]
    v_mfma_f32_32x32x16_bf16 v[128:143], a[80:83], v[96:99], v[128:143]
    s_waitcnt lgkmcnt(11)
    v_mfma_f32_32x32x16_bf16 v[128:143], a[96:99], v[104:107], v[128:143]
    s_waitcnt lgkmcnt(3)
    v_mfma_f32_32x32x16_bf16 v[128:143], a[112:115], v[112:115], v[128:143]
    v_mfma_f32_32x32x16_bf16 v[144:159], a[84:87], v[96:99], v[144:159]
    v_mfma_f32_32x32x16_bf16 v[144:159], a[100:103], v[104:107], v[144:159]
    s_nop 9
    v_cvt_pk_bf16_f32 v48, v128, v129
    v_cvt_pk_bf16_f32 v49, v130, v131
    v_cvt_pk_bf16_f32 v50, v132, v133
    v_cvt_pk_bf16_f32 v51, v134, v135
    buffer_store_dwordx4 v[48:51], v41, s[28:31], s52 offen sc0 sc1
    s_waitcnt lgkmcnt(2)
    v_mfma_f32_32x32x16_bf16 v[144:159], a[116:119], v[112:115], v[144:159]
    v_cvt_pk_bf16_f32 v52, v136, v137
    v_cvt_pk_bf16_f32 v53, v138, v139
    v_cvt_pk_bf16_f32 v54, v140, v141
    v_cvt_pk_bf16_f32 v55, v142, v143
    buffer_store_dwordx4 v[52:55], v41, s[28:31], s52 offen offset:1024 sc0 sc1
    v_mfma_f32_32x32x16_bf16 v[160:175], a[88:91], v[96:99], v[160:175]
    v_mfma_f32_32x32x16_bf16 v[160:175], a[104:107], v[104:107], v[160:175]
    s_nop 4
    v_cvt_pk_bf16_f32 v56, v144, v145
    v_cvt_pk_bf16_f32 v57, v146, v147
    v_cvt_pk_bf16_f32 v58, v148, v149
    v_cvt_pk_bf16_f32 v59, v150, v151
    buffer_store_dwordx4 v[56:59], v41, s[28:31], s54 offen sc0 sc1
    s_waitcnt lgkmcnt(1)
    v_mfma_f32_32x32x16_bf16 v[160:175], a[120:123], v[112:115], v[160:175]
    v_cvt_pk_bf16_f32 v60, v152, v153
    v_cvt_pk_bf16_f32 v61, v154, v155
    v_cvt_pk_bf16_f32 v62, v156, v157
    v_cvt_pk_bf16_f32 v63, v158, v159
    buffer_store_dwordx4 v[60:63], v41, s[28:31], s54 offen offset:1024 sc0 sc1
    v_mfma_f32_32x32x16_bf16 v[176:191], a[92:95], v[96:99], v[176:191]
    v_mfma_f32_32x32x16_bf16 v[176:191], a[108:111], v[104:107], v[176:191]
    s_nop 4
    v_cvt_pk_bf16_f32 v32, v160, v161
    v_cvt_pk_bf16_f32 v33, v162, v163
    v_cvt_pk_bf16_f32 v34, v164, v165
    v_cvt_pk_bf16_f32 v35, v166, v167
    buffer_store_dwordx4 v[32:35], v41, s[28:31], s56 offen sc0 sc1
    s_waitcnt lgkmcnt(0)
    v_mfma_f32_32x32x16_bf16 v[176:191], a[124:127], v[112:115], v[176:191]
    v_cvt_pk_bf16_f32 v36, v168, v169
    v_cvt_pk_bf16_f32 v37, v170, v171
    v_cvt_pk_bf16_f32 v38, v172, v173
    v_cvt_pk_bf16_f32 v39, v174, v175
    buffer_store_dwordx4 v[36:39], v41, s[28:31], s56 offen offset:1024 sc0 sc1
    v_mfma_f32_32x32x16_bf16 v[192:207], a[80:83], v[100:103], v[192:207]
    v_mfma_f32_32x32x16_bf16 v[192:207], a[96:99], v[108:111], v[192:207]
    s_nop 4
    v_cvt_pk_bf16_f32 v48, v176, v177
    v_cvt_pk_bf16_f32 v49, v178, v179
    v_cvt_pk_bf16_f32 v50, v180, v181
    v_cvt_pk_bf16_f32 v51, v182, v183
    buffer_store_dwordx4 v[48:51], v41, s[28:31], s58 offen sc0 sc1
    v_mfma_f32_32x32x16_bf16 v[192:207], a[112:115], v[116:119], v[192:207]
    v_cvt_pk_bf16_f32 v52, v184, v185
    v_cvt_pk_bf16_f32 v53, v186, v187
    v_cvt_pk_bf16_f32 v54, v188, v189
    v_cvt_pk_bf16_f32 v55, v190, v191
    buffer_store_dwordx4 v[52:55], v41, s[28:31], s58 offen offset:1024 sc0 sc1
    v_mfma_f32_32x32x16_bf16 v[208:223], a[84:87], v[100:103], v[208:223]
    v_mfma_f32_32x32x16_bf16 v[208:223], a[100:103], v[108:111], v[208:223]
    s_nop 4
    v_cvt_pk_bf16_f32 v56, v192, v193
    v_cvt_pk_bf16_f32 v57, v194, v195
    v_cvt_pk_bf16_f32 v58, v196, v197
    v_cvt_pk_bf16_f32 v59, v198, v199
    buffer_store_dwordx4 v[56:59], v41, s[28:31], s53 offen sc0 sc1
    v_mfma_f32_32x32x16_bf16 v[208:223], a[116:119], v[116:119], v[208:223]
    v_cvt_pk_bf16_f32 v60, v200, v201
    v_cvt_pk_bf16_f32 v61, v202, v203
    v_cvt_pk_bf16_f32 v62, v204, v205
    v_cvt_pk_bf16_f32 v63, v206, v207
    buffer_store_dwordx4 v[60:63], v41, s[28:31], s53 offen offset:1024 sc0 sc1
    v_mfma_f32_32x32x16_bf16 v[224:239], a[88:91], v[100:103], v[224:239]
    v_mfma_f32_32x32x16_bf16 v[224:239], a[104:107], v[108:111], v[224:239]
    s_nop 4
    v_cvt_pk_bf16_f32 v32, v208, v209
    v_cvt_pk_bf16_f32 v33, v210, v211
    v_cvt_pk_bf16_f32 v34, v212, v213
    v_cvt_pk_bf16_f32 v35, v214, v215
    buffer_store_dwordx4 v[32:35], v41, s[28:31], s55 offen sc0 sc1
    v_mfma_f32_32x32x16_bf16 v[224:239], a[120:123], v[116:119], v[224:239]
    v_cvt_pk_bf16_f32 v36, v216, v217
    v_cvt_pk_bf16_f32 v37, v218, v219
    v_cvt_pk_bf16_f32 v38, v220, v221
    v_cvt_pk_bf16_f32 v39, v222, v223
    buffer_store_dwordx4 v[36:39], v41, s[28:31], s55 offen offset:1024 sc0 sc1
    s_nop 6
    v_cvt_pk_bf16_f32 v48, v224, v225
    v_cvt_pk_bf16_f32 v49, v226, v227
    v_cvt_pk_bf16_f32 v50, v228, v229
    v_cvt_pk_bf16_f32 v51, v230, v231
    buffer_store_dwordx4 v[48:51], v41, s[28:31], s57 offen sc0 sc1
    v_cvt_pk_bf16_f32 v52, v232, v233
    v_cvt_pk_bf16_f32 v53, v234, v235
    v_cvt_pk_bf16_f32 v54, v236, v237
    v_cvt_pk_bf16_f32 v55, v238, v239
    buffer_store_dwordx4 v[52:55], v41, s[28:31], s57 offen offset:1024 sc0 sc1
    v_cmp_eq_u32 vcc, 1, v28
    s_mov_b32 s5, 100000
    s_nop 2
    s_cbranch_vccnz L_go0
L_ready0:
    buffer_load_dwordx4 v[28:31], v7, s[36:39], s60 offen sc0 sc1
    s_sub_u32 s5, s5, 1
    s_cmp_eq_u32 s5, 0
    s_waitcnt vmcnt(0)
    s_cbranch_scc1 L_go0
    v_and_b32 v28, v28, v29
    v_and_b32 v30, v30, v31
    v_and_b32 v28, v28, v30
    v_cmp_eq_u32 vcc, 1, v28
    s_nop 3
    s_cbranch_vccz L_ready0
L_go0:
    s_mov_b64 exec, 0x333
    s_waitcnt vmcnt(8)
    buffer_atomic_add v5, v4, s[28:31], s3 offen sc1
    s_mov_b64 exec, 0x300c
    s_waitcnt vmcnt(5)
    buffer_atomic_add v5, v4, s[28:31], s3 offen sc1
    s_mov_b64 exec, 0xcc0
    s_waitcnt vmcnt(2)
    buffer_atomic_add v5, v4, s[28:31], s3 offen sc1
    s_mov_b64 exec, -1
    s_cmp_ge_u32 s51, 14
    s_cbranch_scc1 L_fin0
    s_mov_b32 s5, 100000
    s_mov_b64 exec, 1
L_poll0:
    s_nop 0
    v_mov_b32 v3, 0
    buffer_atomic_add v3, v7, s[28:31], s59 offen sc0 sc1
    s_waitcnt vmcnt(0)
    v_cmp_eq_u32 vcc, 16, v3
    s_nop 3
    s_cbranch_vccnz L_polled0
    s_sub_u32 s5, s5, 1
    s_cmp_lg_u32 s5, 0
    s_cbranch_scc1 L_poll0
L_polled0:
    s_mov_b64 exec, -1
    s_nop 0
    buffer_load_dwordx4 v[64:67], v41, s[28:31], s6 offen sc0 sc1
    buffer_load_dwordx4 v[68:71], v41, s[28:31], s6 offen offset:2048 sc0 sc1
    s_addk_i32 s6, 4096
    buffer_load_dwordx4 v[72:75], v41, s[28:31], s6 offen sc0 sc1
    buffer_load_dwordx4 v[76:79], v41, s[28:31], s6 offen offset:2048 sc0 sc1
    s_addk_i32 s6, 4096
    buffer_load_dwordx4 v[80:83], v41, s[28:31], s6 offen sc0 sc1
    buffer_load_dwordx4 v[84:87], v41, s[28:31], s6 offen offset:2048 sc0 sc1
    s_addk_i32 s6, 4096
    buffer_load_dwordx4 v[88:91], v41, s[28:31], s6 offen sc0 sc1
    buffer_load_dwordx4 v[92:95], v41, s[28:31], s6 offen offset:2048 sc0 sc1
    s_addk_i32 s6, 4096
    buffer_load_dwordx4 v[96:99], v41, s[28:31], s6 offen sc0 sc1
    buffer_load_dwordx4 v[100:103], v41, s[28:31], s6 offen offset:2048 sc0 sc1
    s_addk_i32 s6, 4096
    buffer_load_dwordx4 v[104:107], v41, s[28:31], s6 offen sc0 sc1
    buffer_load_dwordx4 v[108:111], v41, s[28:31], s6 offen offset:2048 sc0 sc1
    s_addk_i32 s6, 4096
    buffer_load_dwordx4 v[112:115], v41, s[28:31], s6 offen sc0 sc1
    buffer_load_dwordx4 v[116:119], v41, s[28:31], s6 offen offset:2048 sc0 sc1
    s_addk_i32 s6, 4096
    buffer_load_dwordx4 v[120:123], v41, s[28:31], s6 offen sc0 sc1
    buffer_load_dwordx4 v[124:127], v41, s[28:31], s6 offen offset:2048 sc0 sc1
    s_waitcnt vmcnt(15)
    v_mfma_f32_32x32x16_bf16 v[128:143], v[16:19], v[64:67], 0
    s_waitcnt vmcnt(14)
    v_mfma_f32_32x32x16_bf16 v[128:143], v[16:19], v[68:71], v[128:143]
    s_waitcnt vmcnt(13)
    v_mfma_f32_32x32x16_bf16 v[128:143], v[16:19], v[72:75], v[128:143]
    s_waitcnt vmcnt(12)
    v_mfma_f32_32x32x16_bf16 v[128:143], v[16:19], v[76:79], v[128:143]
    s_waitcnt vmcnt(11)
    v_mfma_f32_32x32x16_bf16 v[128:143], v[16:19], v[80:83], v[128:143]
    s_waitcnt vmcnt(10)
    v_mfma_f32_32x32x16_bf16 v[128:143], v[16:19], v[84:87], v[128:143]
    s_waitcnt vmcnt(9)
    v_mfma_f32_32x32x16_bf16 v[128:143], v[16:19], v[88:91], v[128:143]
    s_waitcnt vmcnt(8)
    v_mfma_f32_32x32x16_bf16 v[128:143], v[16:19], v[92:95], v[128:143]
    s_waitcnt vmcnt(7)
    v_mfma_f32_32x32x16_bf16 v[128:143], v[16:19], v[96:99], v[128:143]
    s_waitcnt vmcnt(6)
    v_mfma_f32_32x32x16_bf16 v[128:143], v[16:19], v[100:103], v[128:143]
    s_waitcnt vmcnt(5)
    v_mfma_f32_32x32x16_bf16 v[128:143], v[16:19], v[104:107], v[128:143]
    s_waitcnt vmcnt(4)
    v_mfma_f32_32x32x16_bf16 v[128:143], v[16:19], v[108:111], v[128:143]
    s_waitcnt vmcnt(3)
    v_mfma_f32_32x32x16_bf16 v[128:143], v[16:19], v[112:115], v[128:143]
    s_waitcnt vmcnt(2)
    v_mfma_f32_32x32x16_bf16 v[128:143], v[16:19], v[116:119], v[128:143]
    s_waitcnt vmcnt(1)
    v_mfma_f32_32x32x16_bf16 v[128:143], v[16:19], v[120:123], v[128:143]
    s_waitcnt vmcnt(0)
    v_mfma_f32_32x32x16_bf16 v[128:143], v[16:19], v[124:127], v[128:143]
    s_nop 11
    v_cvt_pk_bf16_f32 v56, v128, v129
    v_cvt_pk_bf16_f32 v57, v130, v131
    v_cvt_pk_bf16_f32 v58, v132, v133
    v_cvt_pk_bf16_f32 v59, v134, v135
    buffer_store_dwordx4 v[56:59], v2, s[32:35], s7 offen
L_fin0:
    s_endpgm
.p2align 6
L_class1:
    s_waitcnt vmcnt(8)
    s_barrier
    s_cmp_lg_u32 s42, 15
    s_cbranch_scc1 L_noset1
    s_lshl_b32 s3, s40, 2
    s_add_u32 s3, s3, s60
    v_mov_b32 v2, 0
    v_mov_b32 v3, 1
    s_mov_b64 exec, 1
    s_nop 0
    buffer_store_dword v3, v2, s[36:39], s3 offen sc0 sc1
    s_mov_b64 exec, -1
L_noset1:
    s_add_u32 m0, s44, 8192
    s_xor_b32 s45, s69, 0
    buffer_load_dwordx4 v13, s[12:15], s45 offen nt lds
    buffer_load_dwordx4 v14, s[12:15], s45 offen offset:1024 nt lds
    buffer_load_dwordx4 v15, s[12:15], s45 offen offset:2048 nt lds
    buffer_load_dwordx4 v16, s[12:15], s45 offen offset:3072 nt lds
    s_add_u32 m0, s44, 12288
    s_xor_b32 s45, s69, 128
    buffer_load_dwordx4 v13, s[12:15], s45 offen nt lds
    buffer_load_dwordx4 v14, s[12:15], s45 offen offset:1024 nt lds
    buffer_load_dwordx4 v15, s[12:15], s45 offen offset:2048 nt lds
    buffer_load_dwordx4 v16, s[12:15], s45 offen offset:3072 nt lds
    s_mul_i32 s3, s47, 917504
    s_mul_i32 s4, s42, 2048
    s_add_u32 s3, s3, s4
    s_add_u32 s3, s3, 1048576
    s_lshr_b32 s4, s40, 1
    s_mul_i32 s4, s4, 7
    s_mul_i32 s5, s50, 3
    s_add_u32 s4, s4, s5
    s_waitcnt vmcnt(14)
    ds_read_b64_tr_b16 v[64:65], v29 offset:0
    ds_read_b64_tr_b16 v[66:67], v29 offset:512
    ds_read_b128 v[80:83], v25 offset:0
    ds_read_b64_tr_b16 v[68:69], v30 offset:0
    ds_read_b64_tr_b16 v[70:71], v30 offset:512
    ds_read_b128 v[84:87], v25 offset:4096
    s_waitcnt vmcnt(12)
    ds_read_b64_tr_b16 v[72:73], v29 offset:2048
    ds_read_b64_tr_b16 v[74:75], v29 offset:2560
    ds_read_b128 v[88:91], v26 offset:0
    ds_read_b64_tr_b16 v[76:77], v30 offset:2048
    ds_read_b64_tr_b16 v[78:79], v30 offset:2560
    ds_read_b128 v[92:95], v26 offset:4096
    s_add_u32 m0, s44, 16384
    s_xor_b32 s45, s69, 256
    buffer_load_dwordx4 v13, s[12:15], s45 offen nt lds
    buffer_load_dwordx4 v14, s[12:15], s45 offen offset:1024 nt lds
    buffer_load_dwordx4 v15, s[12:15], s45 offen offset:2048 nt lds
    buffer_load_dwordx4 v16, s[12:15], s45 offen offset:3072 nt lds
    s_waitcnt lgkmcnt(9)
    v_mfma_f32_32x32x16_bf16 v[128:143], v[64:67], v[80:83], 0
    s_lshl_b32 s7, s50, 1
    s_waitcnt lgkmcnt(7)
    v_mfma_f32_32x32x16_bf16 v[160:175], v[68:71], v[80:83], 0
    s_waitcnt vmcnt(14)
    ds_read_b64_tr_b16 v[96:97], v29 offset:4096
    ds_read_b64_tr_b16 v[98:99], v29 offset:4608
    v_mov_b32 v4, 0
    s_waitcnt lgkmcnt(8)
    v_mfma_f32_32x32x16_bf16 v[144:159], v[64:67], v[84:87], 0
    ds_read_b128 v[112:115], v27 offset:0
    ds_read_b64_tr_b16 v[100:101], v30 offset:4096
    s_add_u32 s5, s50, 0
    v_mfma_f32_32x32x16_bf16 v[176:191], v[68:71], v[84:87], 0
    ds_read_b64_tr_b16 v[102:103], v30 offset:4608
    ds_read_b128 v[116:119], v27 offset:4096
    s_and_b32 s5, s5, 3
    s_waitcnt lgkmcnt(9)
    v_mfma_f32_32x32x16_bf16 v[128:143], v[72:75], v[88:91], v[128:143]
    s_waitcnt vmcnt(12)
    ds_read_b64_tr_b16 v[104:105], v29 offset:6144
    ds_read_b64_tr_b16 v[106:107], v29 offset:6656
    s_add_u32 s5, s5, s4
    s_waitcnt lgkmcnt(9)
    v_mfma_f32_32x32x16_bf16 v[160:175], v[76:79], v[88:91], v[160:175]
    ds_read_b128 v[120:123], v28 offset:0
    ds_read_b64_tr_b16 v[108:109], v30 offset:6144
    s_lshr_b32 s6, s5, 1
    s_waitcnt lgkmcnt(10)
    v_mfma_f32_32x32x16_bf16 v[144:159], v[72:75], v[92:95], v[144:159]
    ds_read_b64_tr_b16 v[110:111], v30 offset:6656
    ds_read_b128 v[124:127], v28 offset:4096
    s_lshl_b32 s6, s6, 2
    v_mfma_f32_32x32x16_bf16 v[176:191], v[76:79], v[92:95], v[176:191]
    s_and_b32 s5, s5, 1
    s_waitcnt lgkmcnt(9)
    v_mfma_f32_32x32x16_bf16 v[128:143], v[96:99], v[112:115], v[128:143]
    s_add_u32 m0, s44, 20480
    s_xor_b32 s45, s69, 384
    buffer_load_dwordx4 v13, s[12:15], s45 offen nt lds
    s_add_u32 s5, s5, s6
    s_waitcnt lgkmcnt(7)
    v_mfma_f32_32x32x16_bf16 v[160:175], v[100:103], v[112:115], v[160:175]
    s_waitcnt vmcnt(9)
    ds_read_b128 a[128:131], v31 offset:8192
    s_add_u32 s5, s5, s7
    s_waitcnt lgkmcnt(7)
    v_mfma_f32_32x32x16_bf16 v[144:159], v[96:99], v[116:119], v[144:159]
    buffer_load_dwordx4 v14, s[12:15], s45 offen offset:1024 nt lds
    ds_read_b128 a[132:135], v32 offset:8192
    s_lshl_b32 s6, s5, 15
    v_mfma_f32_32x32x16_bf16 v[176:191], v[100:103], v[116:119], v[176:191]
    s_add_u32 s52, s6, s3
    s_waitcnt lgkmcnt(5)
    v_mfma_f32_32x32x16_bf16 v[128:143], v[104:107], v[120:123], v[128:143]
    buffer_load_dwordx4 v15, s[12:15], s45 offen offset:2048 nt lds
    ds_read_b128 a[136:139], v33 offset:8192
    s_lshl_b32 s6, s5, 8
    s_waitcnt lgkmcnt(4)
    v_mfma_f32_32x32x16_bf16 v[160:175], v[108:111], v[120:123], v[160:175]
    ds_read_b128 a[140:143], v34 offset:8192
    v_writelane_b32 v4, s6, 0
    s_waitcnt lgkmcnt(4)
    v_mfma_f32_32x32x16_bf16 v[144:159], v[104:107], v[124:127], v[144:159]
    buffer_load_dwordx4 v16, s[12:15], s45 offen offset:3072 nt lds
    s_add_u32 s6, s6, 128
    v_mfma_f32_32x32x16_bf16 v[176:191], v[108:111], v[124:127], v[176:191]
    v_writelane_b32 v4, s6, 1
    s_xor_b32 s5, s5, 2
    s_lshl_b32 s6, s5, 15
    s_add_u32 s53, s6, s3
    s_lshl_b32 s6, s5, 8
    v_writelane_b32 v4, s6, 2
    s_add_u32 s6, s6, 128
    v_writelane_b32 v4, s6, 3
    s_add_u32 s5, s50, 1
    s_waitcnt vmcnt(8)
    ds_read_b128 a[144:147], v31 offset:12288
    ds_read_b128 a[148:151], v32 offset:12288
    ds_read_b128 a[152:155], v33 offset:12288
    ds_read_b128 a[156:159], v34 offset:12288
    s_add_u32 m0, s44, 0
    s_xor_b32 s45, s69, 65536
    buffer_load_dwordx4 v13, s[12:15], s45 offen nt lds
    buffer_load_dwordx4 v14, s[12:15], s45 offen offset:1024 nt lds
    buffer_load_dwordx4 v15, s[12:15], s45 offen offset:2048 nt lds
    buffer_load_dwordx4 v16, s[12:15], s45 offen offset:3072 nt lds
    s_add_u32 m0, s44, 4096
    s_xor_b32 s45, s69, 65664
    buffer_load_dwordx4 v13, s[12:15], s45 offen nt lds
    buffer_load_dwordx4 v14, s[12:15], s45 offen offset:1024 nt lds
    buffer_load_dwordx4 v15, s[12:15], s45 offen offset:2048 nt lds
    buffer_load_dwordx4 v16, s[12:15], s45 offen offset:3072 nt lds
    s_and_b32 s5, s5, 3
    s_add_u32 s5, s5, s4
    s_lshr_b32 s6, s5, 1
    s_lshl_b32 s6, s6, 2
    s_and_b32 s5, s5, 1
    s_add_u32 s5, s5, s6
    s_add_u32 s5, s5, s7
    s_lshl_b32 s6, s5, 15
    s_waitcnt vmcnt(12)
    ds_read_b128 a[160:163], v31 offset:16384
    ds_read_b128 a[164:167], v32 offset:16384
    ds_read_b128 a[168:171], v33 offset:16384
    ds_read_b128 a[172:175], v34 offset:16384
    s_add_u32 m0, s44, 8192
    s_xor_b32 s45, s69, 65792
    s_waitcnt lgkmcnt(8)
    buffer_load_dwordx4 v13, s[12:15], s45 offen nt lds
    buffer_load_dwordx4 v14, s[12:15], s45 offen offset:1024 nt lds
    buffer_load_dwordx4 v15, s[12:15], s45 offen offset:2048 nt lds
    buffer_load_dwordx4 v16, s[12:15], s45 offen offset:3072 nt lds
    s_add_u32 s54, s6, s3
    s_lshl_b32 s6, s5, 8
    v_writelane_b32 v4, s6, 4
    s_add_u32 s6, s6, 128
    v_writelane_b32 v4, s6, 5
    s_xor_b32 s5, s5, 2
    s_lshl_b32 s6, s5, 15
    s_add_u32 s55, s6, s3
    s_waitcnt vmcnt(12)
    ds_read_b128 a[176:179], v31 offset:20480
    ds_read_b128 a[180:183], v32 offset:20480
    ds_read_b128 a[184:187], v33 offset:20480
    ds_read_b128 a[188:191], v34 offset:20480
    s_add_u32 m0, s44, 12288
    s_lshl_b32 s45, s63, 12
    s_waitcnt lgkmcnt(8)
    buffer_load_dwordx4 v9, s[20:23], s45 offen lds
    buffer_load_dwordx4 v10, s[20:23], s45 offen offset:1024 lds
    buffer_load_dwordx4 v11, s[20:23], s45 offen offset:2048 lds
    buffer_load_dwordx4 v12, s[20:23], s45 offen offset:3072 lds
    s_lshl_b32 s6, s5, 8
    v_writelane_b32 v4, s6, 6
    s_add_u32 s6, s6, 128
    v_writelane_b32 v4, s6, 7
    s_add_u32 s5, s50, 2
    s_and_b32 s5, s5, 3
    s_add_u32 s5, s5, s4
    s_lshr_b32 s6, s5, 1
    s_waitcnt vmcnt(12)
    ds_read_b128 a[192:195], v31 offset:0
    ds_read_b128 a[196:199], v32 offset:0
    ds_read_b128 a[200:203], v33 offset:0
    ds_read_b128 a[204:207], v34 offset:0
    s_add_u32 m0, s44, 16384
    s_lshl_b32 s45, s63, 12
    s_bitset1_b32 s45, 18
    s_waitcnt lgkmcnt(8)
    buffer_load_dwordx4 v9, s[20:23], s45 offen lds
    buffer_load_dwordx4 v10, s[20:23], s45 offen offset:1024 lds
    buffer_load_dwordx4 v11, s[20:23], s45 offen offset:2048 lds
    buffer_load_dwordx4 v12, s[20:23], s45 offen offset:3072 lds
    s_lshl_b32 s6, s6, 2
    s_and_b32 s5, s5, 1
    s_add_u32 s5, s5, s6
    s_add_u32 s5, s5, s7
    s_lshl_b32 s6, s5, 15
    s_add_u32 s56, s6, s3
    s_lshl_b32 s6, s5, 8
    v_writelane_b32 v4, s6, 8
    s_waitcnt vmcnt(12)
    ds_read_b128 a[208:211], v31 offset:4096
    ds_read_b128 a[212:215], v32 offset:4096
    ds_read_b128 a[216:219], v33 offset:4096
    ds_read_b128 a[220:223], v34 offset:4096
    s_add_u32 m0, s44, 20480
    s_lshl_b32 s45, s64, 12
    s_waitcnt lgkmcnt(8)
    buffer_load_dwordx4 v9, s[20:23], s45 offen lds
    buffer_load_dwordx4 v10, s[20:23], s45 offen offset:1024 lds
    buffer_load_dwordx4 v11, s[20:23], s45 offen offset:2048 lds
    buffer_load_dwordx4 v12, s[20:23], s45 offen offset:3072 lds
    s_add_u32 s6, s6, 128
    v_writelane_b32 v4, s6, 9
    s_xor_b32 s5, s5, 2
    s_lshl_b32 s6, s5, 15
    s_add_u32 s57, s6, s3
    s_lshl_b32 s6, s5, 8
    v_writelane_b32 v4, s6, 10
    s_add_u32 s6, s6, 128
    s_waitcnt vmcnt(12)
    ds_read_b128 a[224:227], v31 offset:8192
    ds_read_b128 a[228:231], v32 offset:8192
    ds_read_b128 a[232:235], v33 offset:8192
    ds_read_b128 a[236:239], v34 offset:8192
    s_add_u32 m0, s44, 0
    s_lshl_b32 s45, s64, 12
    s_bitset1_b32 s45, 18
    s_waitcnt lgkmcnt(8)
    buffer_load_dwordx4 v9, s[20:23], s45 offen lds
    buffer_load_dwordx4 v10, s[20:23], s45 offen offset:1024 lds
    buffer_load_dwordx4 v11, s[20:23], s45 offen offset:2048 lds
    buffer_load_dwordx4 v12, s[20:23], s45 offen offset:3072 lds
    v_writelane_b32 v4, s6, 11
    s_add_u32 s5, s50, 3
    s_and_b32 s5, s5, 3
    s_add_u32 s5, s5, s4
    s_lshr_b32 s6, s5, 1
    s_lshl_b32 s6, s6, 2
    s_and_b32 s5, s5, 1
    s_add_u32 s5, s5, s6
    s_waitcnt vmcnt(14)
    ds_read_b64_tr_b16 v[64:65], v29 offset:12288
    ds_read_b64_tr_b16 v[66:67], v29 offset:12800
    ds_read_b128 v[80:83], v25 offset:16384
    ds_read_b64_tr_b16 v[68:69], v30 offset:12288
    ds_read_b64_tr_b16 v[70:71], v30 offset:12800
    ds_read_b128 v[84:87], v25 offset:20480
    s_waitcnt vmcnt(12)
    ds_read_b64_tr_b16 v[72:73], v29 offset:14336
    ds_read_b64_tr_b16 v[74:75], v29 offset:14848
    ds_read_b128 v[88:91], v26 offset:16384
    ds_read_b64_tr_b16 v[76:77], v30 offset:14336
    ds_read_b64_tr_b16 v[78:79], v30 offset:14848
    ds_read_b128 v[92:95], v26 offset:20480
    s_add_u32 m0, s44, 4096
    s_lshl_b32 s45, s65, 12
    s_waitcnt lgkmcnt(14)
    buffer_load_dwordx4 v9, s[20:23], s45 offen lds
    buffer_load_dwordx4 v10, s[20:23], s45 offen offset:1024 lds
    buffer_load_dwordx4 v11, s[20:23], s45 offen offset:2048 lds
    buffer_load_dwordx4 v12, s[20:23], s45 offen offset:3072 lds
    s_waitcnt lgkmcnt(9)
    v_mfma_f32_32x32x16_bf16 v[128:143], v[64:67], v[80:83], v[128:143]
    s_add_u32 s5, s5, s7
    s_waitcnt lgkmcnt(7)
    v_mfma_f32_32x32x16_bf16 v[160:175], v[68:71], v[80:83], v[160:175]
    s_waitcnt vmcnt(14)
    ds_read_b64_tr_b16 v[96:97], v29 offset:16384
    ds_read_b64_tr_b16 v[98:99], v29 offset:16896
    s_lshl_b32 s6, s5, 15
    s_waitcnt lgkmcnt(8)
    v_mfma_f32_32x32x16_bf16 v[144:159], v[64:67], v[84:87], v[144:159]
    ds_read_b128 v[112:115], v27 offset:16384
    ds_read_b64_tr_b16 v[100:101], v30 offset:16384
    s_add_u32 s58, s6, s3
    v_mfma_f32_32x32x16_bf16 v[176:191], v[68:71], v[84:87], v[176:191]
    ds_read_b64_tr_b16 v[102:103], v30 offset:16896
    ds_read_b128 v[116:119], v27 offset:20480
    s_lshl_b32 s6, s5, 8
    s_waitcnt lgkmcnt(9)
    v_mfma_f32_32x32x16_bf16 v[128:143], v[72:75], v[88:91], v[128:143]
    s_waitcnt vmcnt(12)
    ds_read_b64_tr_b16 v[104:105], v29 offset:18432
    ds_read_b64_tr_b16 v[106:107], v29 offset:18944
    v_writelane_b32 v4, s6, 12
    s_waitcnt lgkmcnt(9)
    v_mfma_f32_32x32x16_bf16 v[160:175], v[76:79], v[88:91], v[160:175]
    ds_read_b128 v[120:123], v28 offset:16384
    ds_read_b64_tr_b16 v[108:109], v30 offset:18432
    s_add_u32 s6, s6, 128
    s_waitcnt lgkmcnt(10)
    v_mfma_f32_32x32x16_bf16 v[144:159], v[72:75], v[92:95], v[144:159]
    ds_read_b64_tr_b16 v[110:111], v30 offset:18944
    ds_read_b128 v[124:127], v28 offset:20480
    v_writelane_b32 v4, s6, 13
    v_mfma_f32_32x32x16_bf16 v[176:191], v[76:79], v[92:95], v[176:191]
    s_waitcnt lgkmcnt(9)
    v_mfma_f32_32x32x16_bf16 v[128:143], v[96:99], v[112:115], v[128:143]
    s_add_u32 m0, s44, 8192
    s_lshl_b32 s45, s65, 12
    s_bitset1_b32 s45, 18
    buffer_load_dwordx4 v9, s[20:23], s45 offen lds
    s_waitcnt lgkmcnt(7)
    v_mfma_f32_32x32x16_bf16 v[160:175], v[100:103], v[112:115], v[160:175]
    s_waitcnt vmcnt(11)
    ds_read_b64_tr_b16 v[64:65], v29 offset:20480
    ds_read_b64_tr_b16 v[66:67], v29 offset:20992
    s_waitcnt lgkmcnt(8)
    v_mfma_f32_32x32x16_bf16 v[144:159], v[96:99], v[116:119], v[144:159]
    buffer_load_dwordx4 v10, s[20:23], s45 offen offset:1024 lds
    ds_read_b128 v[80:83], v25 offset:32768
    ds_read_b64_tr_b16 v[68:69], v30 offset:20480
    v_mfma_f32_32x32x16_bf16 v[176:191], v[100:103], v[116:119], v[176:191]
    ds_read_b64_tr_b16 v[70:71], v30 offset:20992
    ds_read_b128 v[84:87], v25 offset:36864
    s_waitcnt lgkmcnt(9)
    v_mfma_f32_32x32x16_bf16 v[128:143], v[104:107], v[120:123], v[128:143]
    buffer_load_dwordx4 v11, s[20:23], s45 offen offset:2048 lds
    s_waitcnt vmcnt(11)
    ds_read_b64_tr_b16 v[72:73], v29 offset:22528
    ds_read_b64_tr_b16 v[74:75], v29 offset:23040
    s_waitcnt lgkmcnt(9)
    v_mfma_f32_32x32x16_bf16 v[160:175], v[108:111], v[120:123], v[160:175]
    ds_read_b128 v[88:91], v26 offset:32768
    ds_read_b64_tr_b16 v[76:77], v30 offset:22528
    s_waitcnt lgkmcnt(10)
    v_mfma_f32_32x32x16_bf16 v[144:159], v[104:107], v[124:127], v[144:159]
    buffer_load_dwordx4 v12, s[20:23], s45 offen offset:3072 lds
    ds_read_b64_tr_b16 v[78:79], v30 offset:23040
    ds_read_b128 v[92:95], v26 offset:36864
    v_mfma_f32_32x32x16_bf16 v[176:191], v[108:111], v[124:127], v[176:191]
    s_waitcnt lgkmcnt(9)
    v_mfma_f32_32x32x16_bf16 v[128:143], v[64:67], v[80:83], v[128:143]
    s_add_u32 m0, s44, 12288
    s_lshl_b32 s45, s66, 12
    buffer_load_dwordx4 v9, s[20:23], s45 offen lds
    s_waitcnt lgkmcnt(7)
    v_mfma_f32_32x32x16_bf16 v[160:175], v[68:71], v[80:83], v[160:175]
    s_waitcnt vmcnt(11)
    ds_read_b64_tr_b16 v[96:97], v29 offset:0
    ds_read_b64_tr_b16 v[98:99], v29 offset:512
    s_waitcnt lgkmcnt(8)
    v_mfma_f32_32x32x16_bf16 v[144:159], v[64:67], v[84:87], v[144:159]
    buffer_load_dwordx4 v10, s[20:23], s45 offen offset:1024 lds
    ds_read_b128 v[112:115], v27 offset:32768
    ds_read_b64_tr_b16 v[100:101], v30 offset:0
    v_mfma_f32_32x32x16_bf16 v[176:191], v[68:71], v[84:87], v[176:191]
    ds_read_b64_tr_b16 v[102:103], v30 offset:512
    ds_read_b128 v[116:119], v27 offset:36864
    s_waitcnt lgkmcnt(9)
    v_mfma_f32_32x32x16_bf16 v[128:143], v[72:75], v[88:91], v[128:143]
    buffer_load_dwordx4 v11, s[20:23], s45 offen offset:2048 lds
    s_waitcnt vmcnt(11)
    ds_read_b64_tr_b16 v[104:105], v29 offset:2048
    ds_read_b64_tr_b16 v[106:107], v29 offset:2560
    s_waitcnt lgkmcnt(9)
    v_mfma_f32_32x32x16_bf16 v[160:175], v[76:79], v[88:91], v[160:175]
    ds_read_b128 v[120:123], v28 offset:32768
    ds_read_b64_tr_b16 v[108:109], v30 offset:2048
    s_waitcnt lgkmcnt(10)
    v_mfma_f32_32x32x16_bf16 v[144:159], v[72:75], v[92:95], v[144:159]
    buffer_load_dwordx4 v12, s[20:23], s45 offen offset:3072 lds
    ds_read_b64_tr_b16 v[110:111], v30 offset:2560
    ds_read_b128 v[124:127], v28 offset:36864
    v_mfma_f32_32x32x16_bf16 v[176:191], v[76:79], v[92:95], v[176:191]
    s_waitcnt lgkmcnt(9)
    v_mfma_f32_32x32x16_bf16 v[128:143], v[96:99], v[112:115], v[128:143]
    s_add_u32 m0, s44, 16384
    s_lshl_b32 s45, s66, 12
    s_bitset1_b32 s45, 18
    buffer_load_dwordx4 v9, s[20:23], s45 offen lds
    s_waitcnt lgkmcnt(7)
    v_mfma_f32_32x32x16_bf16 v[160:175], v[100:103], v[112:115], v[160:175]
    s_waitcnt vmcnt(11)
    ds_read_b64_tr_b16 v[64:65], v29 offset:4096
    ds_read_b64_tr_b16 v[66:67], v29 offset:4608
    s_waitcnt lgkmcnt(8)
    v_mfma_f32_32x32x16_bf16 v[144:159], v[96:99], v[116:119], v[144:159]
    buffer_load_dwordx4 v10, s[20:23], s45 offen offset:1024 lds
    ds_read_b128 v[80:83], v25 offset:49152
    ds_read_b64_tr_b16 v[68:69], v30 offset:4096
    v_mfma_f32_32x32x16_bf16 v[176:191], v[100:103], v[116:119], v[176:191]
    ds_read_b64_tr_b16 v[70:71], v30 offset:4608
    ds_read_b128 v[84:87], v25 offset:53248
    s_waitcnt lgkmcnt(9)
    v_mfma_f32_32x32x16_bf16 v[128:143], v[104:107], v[120:123], v[128:143]
    buffer_load_dwordx4 v11, s[20:23], s45 offen offset:2048 lds
    s_waitcnt vmcnt(11)
    ds_read_b64_tr_b16 v[72:73], v29 offset:6144
    ds_read_b64_tr_b16 v[74:75], v29 offset:6656
    s_waitcnt lgkmcnt(9)
    v_mfma_f32_32x32x16_bf16 v[160:175], v[108:111], v[120:123], v[160:175]
    ds_read_b128 v[88:91], v26 offset:49152
    ds_read_b64_tr_b16 v[76:77], v30 offset:6144
    s_waitcnt lgkmcnt(10)
    v_mfma_f32_32x32x16_bf16 v[144:159], v[104:107], v[124:127], v[144:159]
    buffer_load_dwordx4 v12, s[20:23], s45 offen offset:3072 lds
    ds_read_b64_tr_b16 v[78:79], v30 offset:6656
    ds_read_b128 v[92:95], v26 offset:53248
    v_mfma_f32_32x32x16_bf16 v[176:191], v[108:111], v[124:127], v[176:191]
    s_waitcnt lgkmcnt(9)
    v_mfma_f32_32x32x16_bf16 v[128:143], v[64:67], v[80:83], v[128:143]
    s_add_u32 m0, s44, 20480
    s_lshl_b32 s45, s67, 12
    buffer_load_dwordx4 v9, s[20:23], s45 offen lds
    s_waitcnt lgkmcnt(7)
    v_mfma_f32_32x32x16_bf16 v[160:175], v[68:71], v[80:83], v[160:175]
    s_waitcnt vmcnt(11)
    ds_read_b64_tr_b16 v[96:97], v29 offset:8192
    ds_read_b64_tr_b16 v[98:99], v29 offset:8704
    s_waitcnt lgkmcnt(8)
    v_mfma_f32_32x32x16_bf16 v[144:159], v[64:67], v[84:87], v[144:159]
    buffer_load_dwordx4 v10, s[20:23], s45 offen offset:1024 lds
    ds_read_b128 v[112:115], v27 offset:49152
    ds_read_b64_tr_b16 v[100:101], v30 offset:8192
    v_mfma_f32_32x32x16_bf16 v[176:191], v[68:71], v[84:87], v[176:191]
    ds_read_b64_tr_b16 v[102:103], v30 offset:8704
    ds_read_b128 v[116:119], v27 offset:53248
    s_waitcnt lgkmcnt(9)
    v_mfma_f32_32x32x16_bf16 v[128:143], v[72:75], v[88:91], v[128:143]
    buffer_load_dwordx4 v11, s[20:23], s45 offen offset:2048 lds
    s_waitcnt vmcnt(11)
    ds_read_b64_tr_b16 v[104:105], v29 offset:10240
    ds_read_b64_tr_b16 v[106:107], v29 offset:10752
    s_waitcnt lgkmcnt(9)
    v_mfma_f32_32x32x16_bf16 v[160:175], v[76:79], v[88:91], v[160:175]
    ds_read_b128 v[120:123], v28 offset:49152
    ds_read_b64_tr_b16 v[108:109], v30 offset:10240
    s_waitcnt lgkmcnt(10)
    v_mfma_f32_32x32x16_bf16 v[144:159], v[72:75], v[92:95], v[144:159]
    buffer_load_dwordx4 v12, s[20:23], s45 offen offset:3072 lds
    ds_read_b64_tr_b16 v[110:111], v30 offset:10752
    ds_read_b128 v[124:127], v28 offset:53248
    v_mfma_f32_32x32x16_bf16 v[176:191], v[76:79], v[92:95], v[176:191]
    s_waitcnt lgkmcnt(9)
    v_mfma_f32_32x32x16_bf16 v[128:143], v[96:99], v[112:115], v[128:143]
    s_add_u32 m0, s44, 0
    s_lshl_b32 s45, s67, 12
    s_bitset1_b32 s45, 18
    buffer_load_dwordx4 v9, s[20:23], s45 offen lds
    s_waitcnt lgkmcnt(7)
    v_mfma_f32_32x32x16_bf16 v[160:175], v[100:103], v[112:115], v[160:175]
    s_waitcnt vmcnt(11)
    ds_read_b64_tr_b16 v[64:65], v29 offset:12288
    ds_read_b64_tr_b16 v[66:67], v29 offset:12800
    s_waitcnt lgkmcnt(8)
    v_mfma_f32_32x32x16_bf16 v[144:159], v[96:99], v[116:119], v[144:159]
    buffer_load_dwordx4 v10, s[20:23], s45 offen offset:1024 lds
    ds_read_b128 v[80:83], v25 offset:8192
    ds_read_b64_tr_b16 v[68:69], v30 offset:12288
    v_mfma_f32_32x32x16_bf16 v[176:191], v[100:103], v[116:119], v[176:191]
    ds_read_b64_tr_b16 v[70:71], v30 offset:12800
    ds_read_b128 v[84:87], v25 offset:12288
    s_waitcnt lgkmcnt(9)
    v_mfma_f32_32x32x16_bf16 v[128:143], v[104:107], v[120:123], v[128:143]
    buffer_load_dwordx4 v11, s[20:23], s45 offen offset:2048 lds
    s_waitcnt vmcnt(11)
    ds_read_b64_tr_b16 v[72:73], v29 offset:14336
    ds_read_b64_tr_b16 v[74:75], v29 offset:14848
    s_waitcnt lgkmcnt(9)
    v_mfma_f32_32x32x16_bf16 v[160:175], v[108:111], v[120:123], v[160:175]
    ds_read_b128 v[88:91], v26 offset:8192
    ds_read_b64_tr_b16 v[76:77], v30 offset:14336
    s_waitcnt lgkmcnt(10)
    v_mfma_f32_32x32x16_bf16 v[144:159], v[104:107], v[124:127], v[144:159]
    buffer_load_dwordx4 v12, s[20:23], s45 offen offset:3072 lds
    ds_read_b64_tr_b16 v[78:79], v30 offset:14848
    ds_read_b128 v[92:95], v26 offset:12288
    v_mfma_f32_32x32x16_bf16 v[176:191], v[108:111], v[124:127], v[176:191]
    s_waitcnt lgkmcnt(9)
    v_mfma_f32_32x32x16_bf16 v[128:143], v[64:67], v[80:83], v[128:143]
    s_add_u32 m0, s44, 4096
    s_lshl_b32 s45, s68, 12
    buffer_load_dwordx4 v9, s[20:23], s45 offen lds
    s_waitcnt lgkmcnt(7)
    v_mfma_f32_32x32x16_bf16 v[160:175], v[68:71], v[80:83], v[160:175]
    s_barrier
    s_waitcnt vmcnt(11)
    ds_read_b64_tr_b16 v[96:97], v29 offset:16384
    ds_read_b64_tr_b16 v[98:99], v29 offset:16896
    s_waitcnt lgkmcnt(8)
    v_mfma_f32_32x32x16_bf16 v[144:159], v[64:67], v[84:87], v[144:159]
    buffer_load_dwordx4 v10, s[20:23], s45 offen offset:1024 lds
    ds_read_b128 v[112:115], v27 offset:8192
    ds_read_b64_tr_b16 v[100:101], v30 offset:16384
    v_mfma_f32_32x32x16_bf16 v[176:191], v[68:71], v[84:87], v[176:191]
    ds_read_b64_tr_b16 v[102:103], v30 offset:16896
    ds_read_b128 v[116:119], v27 offset:12288
    s_waitcnt lgkmcnt(9)
    v_mfma_f32_32x32x16_bf16 v[128:143], v[72:75], v[88:91], v[128:143]
    buffer_load_dwordx4 v11, s[20:23], s45 offen offset:2048 lds
    s_waitcnt vmcnt(11)
    ds_read_b64_tr_b16 v[104:105], v29 offset:18432
    ds_read_b64_tr_b16 v[106:107], v29 offset:18944
    s_waitcnt lgkmcnt(9)
    v_mfma_f32_32x32x16_bf16 v[160:175], v[76:79], v[88:91], v[160:175]
    ds_read_b128 v[120:123], v28 offset:8192
    ds_read_b64_tr_b16 v[108:109], v30 offset:18432
    s_waitcnt lgkmcnt(10)
    v_mfma_f32_32x32x16_bf16 v[144:159], v[72:75], v[92:95], v[144:159]
    buffer_load_dwordx4 v12, s[20:23], s45 offen offset:3072 lds
    ds_read_b64_tr_b16 v[110:111], v30 offset:18944
    ds_read_b128 v[124:127], v28 offset:12288
    v_mfma_f32_32x32x16_bf16 v[176:191], v[76:79], v[92:95], v[176:191]
    s_waitcnt lgkmcnt(9)
    v_mfma_f32_32x32x16_bf16 v[128:143], v[96:99], v[112:115], v[128:143]
    s_add_u32 m0, s44, 8192
    s_lshl_b32 s45, s68, 12
    s_bitset1_b32 s45, 18
    buffer_load_dwordx4 v9, s[20:23], s45 offen lds
    s_waitcnt lgkmcnt(7)
    v_mfma_f32_32x32x16_bf16 v[160:175], v[100:103], v[112:115], v[160:175]
    s_waitcnt vmcnt(11)
    ds_read_b64_tr_b16 v[64:65], v29 offset:20480
    ds_read_b64_tr_b16 v[66:67], v29 offset:20992
    s_waitcnt lgkmcnt(8)
    v_mfma_f32_32x32x16_bf16 v[144:159], v[96:99], v[116:119], v[144:159]
    buffer_load_dwordx4 v10, s[20:23], s45 offen offset:1024 lds
    ds_read_b128 v[80:83], v25 offset:24576
    ds_read_b64_tr_b16 v[68:69], v30 offset:20480
    v_mfma_f32_32x32x16_bf16 v[176:191], v[100:103], v[116:119], v[176:191]
    ds_read_b64_tr_b16 v[70:71], v30 offset:20992
    ds_read_b128 v[84:87], v25 offset:28672
    s_waitcnt lgkmcnt(9)
    v_mfma_f32_32x32x16_bf16 v[128:143], v[104:107], v[120:123], v[128:143]
    buffer_load_dwordx4 v11, s[20:23], s45 offen offset:2048 lds
    s_waitcnt vmcnt(11)
    ds_read_b64_tr_b16 v[72:73], v29 offset:22528
    ds_read_b64_tr_b16 v[74:75], v29 offset:23040
    s_waitcnt lgkmcnt(9)
    v_mfma_f32_32x32x16_bf16 v[160:175], v[108:111], v[120:123], v[160:175]
    ds_read_b128 v[88:91], v26 offset:24576
    ds_read_b64_tr_b16 v[76:77], v30 offset:22528
    s_waitcnt lgkmcnt(10)
    v_mfma_f32_32x32x16_bf16 v[144:159], v[104:107], v[124:127], v[144:159]
    buffer_load_dwordx4 v12, s[20:23], s45 offen offset:3072 lds
    ds_read_b64_tr_b16 v[78:79], v30 offset:23040
    ds_read_b128 v[92:95], v26 offset:28672
    v_mfma_f32_32x32x16_bf16 v[176:191], v[108:111], v[124:127], v[176:191]
    s_waitcnt lgkmcnt(9)
    v_mfma_f32_32x32x16_bf16 v[128:143], v[64:67], v[80:83], v[128:143]
    s_add_u32 m0, s44, 12288
    s_xor_b32 s45, s69, 65920
    buffer_load_dwordx4 v13, s[12:15], s45 offen nt lds
    s_waitcnt lgkmcnt(7)
    v_mfma_f32_32x32x16_bf16 v[160:175], v[68:71], v[80:83], v[160:175]
    s_waitcnt vmcnt(11)
    ds_read_b64_tr_b16 v[96:97], v29 offset:0
    ds_read_b64_tr_b16 v[98:99], v29 offset:512
    s_waitcnt lgkmcnt(8)
    v_mfma_f32_32x32x16_bf16 v[144:159], v[64:67], v[84:87], v[144:159]
    buffer_load_dwordx4 v14, s[12:15], s45 offen offset:1024 nt lds
    ds_read_b128 v[112:115], v27 offset:24576
    ds_read_b64_tr_b16 v[100:101], v30 offset:0
    v_mfma_f32_32x32x16_bf16 v[176:191], v[68:71], v[84:87], v[176:191]
    ds_read_b64_tr_b16 v[102:103], v30 offset:512
    ds_read_b128 v[116:119], v27 offset:28672
    s_waitcnt lgkmcnt(9)
    v_mfma_f32_32x32x16_bf16 v[128:143], v[72:75], v[88:91], v[128:143]
    buffer_load_dwordx4 v15, s[12:15], s45 offen offset:2048 nt lds
    s_waitcnt vmcnt(11)
    ds_read_b64_tr_b16 v[104:105], v29 offset:2048
    ds_read_b64_tr_b16 v[106:107], v29 offset:2560
    s_waitcnt lgkmcnt(9)
    v_mfma_f32_32x32x16_bf16 v[160:175], v[76:79], v[88:91], v[160:175]
    ds_read_b128 v[120:123], v28 offset:24576
    ds_read_b64_tr_b16 v[108:109], v30 offset:2048
    s_waitcnt lgkmcnt(10)
    v_mfma_f32_32x32x16_bf16 v[144:159], v[72:75], v[92:95], v[144:159]
    buffer_load_dwordx4 v16, s[12:15], s45 offen offset:3072 nt lds
    ds_read_b64_tr_b16 v[110:111], v30 offset:2560
    ds_read_b128 v[124:127], v28 offset:28672
    v_mfma_f32_32x32x16_bf16 v[176:191], v[76:79], v[92:95], v[176:191]
    s_waitcnt lgkmcnt(9)
    v_mfma_f32_32x32x16_bf16 v[128:143], v[96:99], v[112:115], v[128:143]
    s_add_u32 m0, s44, 16384
    s_xor_b32 s45, s69, 131072
    buffer_load_dwordx4 v13, s[12:15], s45 offen nt lds
    s_waitcnt lgkmcnt(7)
    v_mfma_f32_32x32x16_bf16 v[160:175], v[100:103], v[112:115], v[160:175]
    s_waitcnt vmcnt(11)
    ds_read_b64_tr_b16 v[64:65], v29 offset:4096
    ds_read_b64_tr_b16 v[66:67], v29 offset:4608
    s_waitcnt lgkmcnt(8)
    v_mfma_f32_32x32x16_bf16 v[144:159], v[96:99], v[116:119], v[144:159]
    buffer_load_dwordx4 v14, s[12:15], s45 offen offset:1024 nt lds
    ds_read_b128 v[80:83], v25 offset:40960
    ds_read_b64_tr_b16 v[68:69], v30 offset:4096
    v_mfma_f32_32x32x16_bf16 v[176:191], v[100:103], v[116:119], v[176:191]
    ds_read_b64_tr_b16 v[70:71], v30 offset:4608
    ds_read_b128 v[84:87], v25 offset:45056
    s_waitcnt lgkmcnt(9)
    v_mfma_f32_32x32x16_bf16 v[128:143], v[104:107], v[120:123], v[128:143]
    buffer_load_dwordx4 v15, s[12:15], s45 offen offset:2048 nt lds
    s_waitcnt vmcnt(11)
    ds_read_b64_tr_b16 v[72:73], v29 offset:6144
    ds_read_b64_tr_b16 v[74:75], v29 offset:6656
    s_waitcnt lgkmcnt(9)
    v_mfma_f32_32x32x16_bf16 v[160:175], v[108:111], v[120:123], v[160:175]
    ds_read_b128 v[88:91], v26 offset:40960
    ds_read_b64_tr_b16 v[76:77], v30 offset:6144
    s_waitcnt lgkmcnt(10)
    v_mfma_f32_32x32x16_bf16 v[144:159], v[104:107], v[124:127], v[144:159]
    buffer_load_dwordx4 v16, s[12:15], s45 offen offset:3072 nt lds
    ds_read_b64_tr_b16 v[78:79], v30 offset:6656
    ds_read_b128 v[92:95], v26 offset:45056
    v_mfma_f32_32x32x16_bf16 v[176:191], v[108:111], v[124:127], v[176:191]
    s_waitcnt lgkmcnt(9)
    v_mfma_f32_32x32x16_bf16 v[128:143], v[64:67], v[80:83], v[128:143]
    s_add_u32 m0, s44, 20480
    s_xor_b32 s45, s69, 131200
    buffer_load_dwordx4 v13, s[12:15], s45 offen nt lds
    s_waitcnt lgkmcnt(7)
    v_mfma_f32_32x32x16_bf16 v[160:175], v[68:71], v[80:83], v[160:175]
    s_waitcnt vmcnt(11)
    ds_read_b64_tr_b16 v[96:97], v29 offset:8192
    ds_read_b64_tr_b16 v[98:99], v29 offset:8704
    s_waitcnt lgkmcnt(8)
    v_mfma_f32_32x32x16_bf16 v[144:159], v[64:67], v[84:87], v[144:159]
    buffer_load_dwordx4 v14, s[12:15], s45 offen offset:1024 nt lds
    ds_read_b128 v[112:115], v27 offset:40960
    ds_read_b64_tr_b16 v[100:101], v30 offset:8192
    v_mfma_f32_32x32x16_bf16 v[176:191], v[68:71], v[84:87], v[176:191]
    ds_read_b64_tr_b16 v[102:103], v30 offset:8704
    ds_read_b128 v[116:119], v27 offset:45056
    s_waitcnt lgkmcnt(9)
    v_mfma_f32_32x32x16_bf16 v[128:143], v[72:75], v[88:91], v[128:143]
    buffer_load_dwordx4 v15, s[12:15], s45 offen offset:2048 nt lds
    s_waitcnt vmcnt(11)
    ds_read_b64_tr_b16 v[104:105], v29 offset:10240
    ds_read_b64_tr_b16 v[106:107], v29 offset:10752
    s_waitcnt lgkmcnt(9)
    v_mfma_f32_32x32x16_bf16 v[160:175], v[76:79], v[88:91], v[160:175]
    ds_read_b128 v[120:123], v28 offset:40960
    ds_read_b64_tr_b16 v[108:109], v30 offset:10240
    s_waitcnt lgkmcnt(10)
    v_mfma_f32_32x32x16_bf16 v[144:159], v[72:75], v[92:95], v[144:159]
    buffer_load_dwordx4 v16, s[12:15], s45 offen offset:3072 nt lds
    ds_read_b64_tr_b16 v[110:111], v30 offset:10752
    ds_read_b128 v[124:127], v28 offset:45056
    v_mfma_f32_32x32x16_bf16 v[176:191], v[76:79], v[92:95], v[176:191]
    s_waitcnt lgkmcnt(9)
    v_mfma_f32_32x32x16_bf16 v[128:143], v[96:99], v[112:115], v[128:143]
    s_add_u32 m0, s44, 0
    s_xor_b32 s45, s69, 131328
    buffer_load_dwordx4 v13, s[12:15], s45 offen nt lds
    s_waitcnt lgkmcnt(3)
    v_mfma_f32_32x32x16_bf16 v[128:143], v[104:107], v[120:123], v[128:143]
    buffer_load_dwordx4 v14, s[12:15], s45 offen offset:1024 nt lds
    v_mfma_f32_32x32x16_bf16 v[144:159], v[96:99], v[116:119], v[144:159]
    buffer_load_dwordx4 v15, s[12:15], s45 offen offset:2048 nt lds
    s_waitcnt lgkmcnt(0)
    v_mfma_f32_32x32x16_bf16 v[144:159], v[104:107], v[124:127], v[144:159]
    buffer_load_dwordx4 v16, s[12:15], s45 offen offset:3072 nt lds
    v_mfma_f32_32x32x16_bf16 v[160:175], v[100:103], v[112:115], v[160:175]
    s_nop 4
    v_cvt_pk_bf16_f32 v64, v128, v129
    v_cvt_pk_bf16_f32 v65, v130, v131
    v_cvt_pk_bf16_f32 v66, v132, v133
    v_cvt_pk_bf16_f32 v67, v134, v135
    ds_write_b128 v42, v[64:67] offset:0
    v_cvt_pk_bf16_f32 v72, v136, v137
    v_cvt_pk_bf16_f32 v73, v138, v139
    v_cvt_pk_bf16_f32 v74, v140, v141
    v_cvt_pk_bf16_f32 v75, v142, v143
    ds_write_b128 v42, v[72:75] offset:2048
    v_mfma_f32_32x32x16_bf16 v[160:175], v[108:111], v[120:123], v[160:175]
    v_mfma_f32_32x32x16_bf16 v[176:191], v[100:103], v[116:119], v[176:191]
    v_cvt_pk_bf16_f32 v68, v144, v145
    v_cvt_pk_bf16_f32 v69, v146, v147
    v_cvt_pk_bf16_f32 v70, v148, v149
    v_cvt_pk_bf16_f32 v71, v150, v151
    ds_write_b128 v42, v[68:71] offset:1024
    v_cvt_pk_bf16_f32 v76, v152, v153
    v_cvt_pk_bf16_f32 v77, v154, v155
    v_cvt_pk_bf16_f32 v78, v156, v157
    v_cvt_pk_bf16_f32 v79, v158, v159
    ds_write_b128 v42, v[76:79] offset:3072
    v_mfma_f32_32x32x16_bf16 v[176:191], v[108:111], v[124:127], v[176:191]
    v_cvt_pk_bf16_f32 v80, v160, v161
    v_cvt_pk_bf16_f32 v81, v162, v163
    v_cvt_pk_bf16_f32 v82, v164, v165
    v_cvt_pk_bf16_f32 v83, v166, v167
    ds_write_b128 v42, v[80:83] offset:4096
    v_cvt_pk_bf16_f32 v88, v168, v169
    v_cvt_pk_bf16_f32 v89, v170, v171
    v_cvt_pk_bf16_f32 v90, v172, v173
    v_cvt_pk_bf16_f32 v91, v174, v175
    ds_write_b128 v42, v[88:91] offset:6144
    s_nop 1
    v_cvt_pk_bf16_f32 v84, v176, v177
    v_cvt_pk_bf16_f32 v85, v178, v179
    v_cvt_pk_bf16_f32 v86, v180, v181
    v_cvt_pk_bf16_f32 v87, v182, v183
    ds_write_b128 v42, v[84:87] offset:5120
    v_cvt_pk_bf16_f32 v92, v184, v185
    v_cvt_pk_bf16_f32 v93, v186, v187
    v_cvt_pk_bf16_f32 v94, v188, v189
    v_cvt_pk_bf16_f32 v95, v190, v191
    ds_write_b128 v42, v[92:95] offset:7168
    s_add_u32 m0, s44, 4096
    s_xor_b32 s45, s69, 131456
    buffer_load_dwordx4 v13, s[12:15], s45 offen nt lds
    buffer_load_dwordx4 v14, s[12:15], s45 offen offset:1024 nt lds
    buffer_load_dwordx4 v15, s[12:15], s45 offen offset:2048 nt lds
    buffer_load_dwordx4 v16, s[12:15], s45 offen offset:3072 nt lds
    v_mfma_f32_32x32x16_bf16 v[128:143], a[128:131], v[64:67], 0
    v_mfma_f32_32x32x16_bf16 v[144:159], a[128:131], v[68:71], 0
    v_mfma_f32_32x32x16_bf16 v[128:143], a[132:135], v[72:75], v[128:143]
    v_mfma_f32_32x32x16_bf16 v[144:159], a[132:135], v[76:79], v[144:159]
    v_mfma_f32_32x32x16_bf16 v[128:143], a[136:139], v[80:83], v[128:143]
    v_mfma_f32_32x32x16_bf16 v[144:159], a[136:139], v[84:87], v[144:159]
    v_mfma_f32_32x32x16_bf16 v[128:143], a[140:143], v[88:91], v[128:143]
    v_mfma_f32_32x32x16_bf16 v[144:159], a[140:143], v[92:95], v[144:159]
    v_mfma_f32_32x32x16_bf16 v[160:175], a[192:195], v[64:67], 0
    v_mfma_f32_32x32x16_bf16 v[176:191], a[192:195], v[68:71], 0
    s_waitcnt lgkmcnt(0)
    s_barrier
    ds_read_b128 a[96:99], v47 offset:0
    ds_read_b128 a[100:103], v47 offset:1024
    v_mfma_f32_32x32x16_bf16 v[160:175], a[196:199], v[72:75], v[160:175]
    ds_read_b128 a[104:107], v47 offset:2048
    ds_read_b128 a[108:111], v47 offset:3072
    v_mfma_f32_32x32x16_bf16 v[176:191], a[196:199], v[76:79], v[176:191]
    ds_read_b128 a[112:115], v47 offset:4096
    ds_read_b128 a[116:119], v47 offset:5120
    v_mfma_f32_32x32x16_bf16 v[160:175], a[200:203], v[80:83], v[160:175]
    ds_read_b128 a[120:123], v47 offset:6144
    ds_read_b128 a[124:127], v47 offset:7168
    v_mfma_f32_32x32x16_bf16 v[176:191], a[200:203], v[84:87], v[176:191]
    s_waitcnt vmcnt(16)
    ds_read_b128 v[96:99], v31 offset:12288
    ds_read_b128 v[100:103], v32 offset:12288
    v_mfma_f32_32x32x16_bf16 v[160:175], a[204:207], v[88:91], v[160:175]
    ds_read_b128 v[104:107], v33 offset:12288
    ds_read_b128 v[108:111], v34 offset:12288
    v_mfma_f32_32x32x16_bf16 v[176:191], a[204:207], v[92:95], v[176:191]
    s_waitcnt lgkmcnt(3)
    v_mfma_f32_32x32x16_bf16 v[160:175], v[96:99], a[96:99], v[160:175]
    v_mfma_f32_32x32x16_bf16 v[176:191], v[96:99], a[100:103], v[176:191]
    ds_read_b128 a[32:35], v45 offset:0
    ds_read_b128 a[36:39], v45 offset:1024
    s_waitcnt lgkmcnt(4)
    v_mfma_f32_32x32x16_bf16 v[160:175], v[100:103], a[104:107], v[160:175]
    ds_read_b128 a[40:43], v45 offset:2048
    v_mfma_f32_32x32x16_bf16 v[176:191], v[100:103], a[108:111], v[176:191]
    ds_read_b128 a[44:47], v45 offset:3072
    s_waitcnt lgkmcnt(5)
    v_mfma_f32_32x32x16_bf16 v[160:175], v[104:107], a[112:115], v[160:175]
    ds_read_b128 a[48:51], v45 offset:4096
    ds_read_b128 a[52:55], v45 offset:5120
    v_mfma_f32_32x32x16_bf16 v[176:191], v[104:107], a[116:119], v[176:191]
    ds_read_b128 a[56:59], v45 offset:6144
    s_waitcnt lgkmcnt(7)
    v_mfma_f32_32x32x16_bf16 v[160:175], v[108:111], a[120:123], v[160:175]
    ds_read_b128 a[60:63], v45 offset:7168
    v_mfma_f32_32x32x16_bf16 v[176:191], v[108:111], a[124:127], v[176:191]
    s_waitcnt lgkmcnt(7)
    v_mfma_f32_32x32x16_bf16 v[128:143], a[144:147], a[32:35], v[128:143]
    s_waitcnt lgkmcnt(6)
    v_mfma_f32_32x32x16_bf16 v[144:159], a[144:147], a[36:39], v[144:159]
    ds_read_b128 a[64:67], v46 offset:0
    ds_read_b128 a[68:71], v46 offset:1024
    s_waitcnt lgkmcnt(7)
    v_mfma_f32_32x32x16_bf16 v[128:143], a[148:151], a[40:43], v[128:143]
    ds_read_b128 a[72:75], v46 offset:2048
    s_waitcnt lgkmcnt(7)
    v_mfma_f32_32x32x16_bf16 v[144:159], a[148:151], a[44:47], v[144:159]
    ds_read_b128 a[76:79], v46 offset:3072
    s_waitcnt lgkmcnt(7)
    v_mfma_f32_32x32x16_bf16 v[128:143], a[152:155], a[48:51], v[128:143]
    ds_read_b128 a[80:83], v46 offset:4096
    ds_read_b128 a[84:87], v46 offset:5120
    s_waitcnt lgkmcnt(8)
    v_mfma_f32_32x32x16_bf16 v[144:159], a[152:155], a[52:55], v[144:159]
    ds_read_b128 a[88:91], v46 offset:6144
    s_waitcnt lgkmcnt(8)
    v_mfma_f32_32x32x16_bf16 v[128:143], a[156:159], a[56:59], v[128:143]
    ds_read_b128 a[92:95], v46 offset:7168
    s_waitcnt lgkmcnt(8)
    v_mfma_f32_32x32x16_bf16 v[144:159], a[156:159], a[60:63], v[144:159]
    s_waitcnt lgkmcnt(7)
    v_mfma_f32_32x32x16_bf16 v[128:143], a[160:163], a[64:67], v[128:143]
    s_waitcnt lgkmcnt(6)
    v_mfma_f32_32x32x16_bf16 v[144:159], a[160:163], a[68:71], v[144:159]
    s_waitcnt vmcnt(12)
    ds_read_b128 v[112:115], v31 offset:16384
    s_waitcnt lgkmcnt(6)
    v_mfma_f32_32x32x16_bf16 v[128:143], a[164:167], a[72:75], v[128:143]
    ds_read_b128 v[116:119], v32 offset:16384
    s_waitcnt lgkmcnt(6)
    v_mfma_f32_32x32x16_bf16 v[144:159], a[164:167], a[76:79], v[144:159]
    s_waitcnt lgkmcnt(5)
    v_mfma_f32_32x32x16_bf16 v[128:143], a[168:171], a[80:83], v[128:143]
    ds_read_b128 v[120:123], v33 offset:16384
    s_waitcnt lgkmcnt(5)
    v_mfma_f32_32x32x16_bf16 v[144:159], a[168:171], a[84:87], v[144:159]
    ds_read_b128 v[124:127], v34 offset:16384
    s_waitcnt lgkmcnt(5)
    v_mfma_f32_32x32x16_bf16 v[128:143], a[172:175], a[88:91], v[128:143]
    s_waitcnt lgkmcnt(4)
    v_mfma_f32_32x32x16_bf16 v[144:159], a[172:175], a[92:95], v[144:159]
    s_waitcnt lgkmcnt(3)
    v_mfma_f32_32x32x16_bf16 v[192:207], v[112:115], v[64:67], 0
    s_add_u32 m0, s44, 8192
    s_xor_b32 s45, s69, 196608
    buffer_load_dwordx4 v13, s[12:15], s45 offen nt lds
    v_mfma_f32_32x32x16_bf16 v[208:223], v[112:115], v[68:71], 0
    s_waitcnt lgkmcnt(2)
    v_mfma_f32_32x32x16_bf16 v[192:207], v[116:119], v[72:75], v[192:207]
    buffer_load_dwordx4 v14, s[12:15], s45 offen offset:1024 nt lds
    v_mfma_f32_32x32x16_bf16 v[208:223], v[116:119], v[76:79], v[208:223]
    s_waitcnt lgkmcnt(1)
    v_mfma_f32_32x32x16_bf16 v[192:207], v[120:123], v[80:83], v[192:207]
    buffer_load_dwordx4 v15, s[12:15], s45 offen offset:2048 nt lds
    v_mfma_f32_32x32x16_bf16 v[208:223], v[120:123], v[84:87], v[208:223]
    s_waitcnt lgkmcnt(0)
    v_mfma_f32_32x32x16_bf16 v[192:207], v[124:127], v[88:91], v[192:207]
    buffer_load_dwordx4 v16, s[12:15], s45 offen offset:3072 nt lds
    v_mfma_f32_32x32x16_bf16 v[208:223], v[124:127], v[92:95], v[208:223]
    v_mfma_f32_32x32x16_bf16 v[128:143], a[176:179], a[96:99], v[128:143]
    v_mfma_f32_32x32x16_bf16 v[144:159], a[176:179], a[100:103], v[144:159]
    v_mfma_f32_32x32x16_bf16 v[128:143], a[180:183], a[104:107], v[128:143]
    v_mfma_f32_32x32x16_bf16 v[144:159], a[180:183], a[108:111], v[144:159]
    v_mfma_f32_32x32x16_bf16 v[128:143], a[184:187], a[112:115], v[128:143]
    v_mfma_f32_32x32x16_bf16 v[144:159], a[184:187], a[116:119], v[144:159]
    v_mfma_f32_32x32x16_bf16 v[128:143], a[188:191], a[120:123], v[128:143]
    v_mfma_f32_32x32x16_bf16 v[144:159], a[188:191], a[124:127], v[144:159]
    v_mfma_f32_32x32x16_bf16 v[160:175], a[208:211], a[32:35], v[160:175]
    s_nop 9
    v_max3_f32 v48, v128, v129, v130
    v_max3_f32 v48, v48, v131, v132
    v_max3_f32 v48, v48, v133, v134
    v_max3_f32 v48, v48, v135, v136
    v_max3_f32 v48, v48, v137, v138
    v_mfma_f32_32x32x16_bf16 v[176:191], a[208:211], a[36:39], v[176:191]
    s_waitcnt vmcnt(12)
    ds_read_b128 v[96:99], v31 offset:20480
    v_max3_f32 v48, v48, v139, v140
    v_max3_f32 v48, v48, v141, v142
    v_max_f32 v48, v48, v143
    v_mul_f32 v48, s46, v48
    v_fma_f32 v128, v128, s46, -v48
    v_mfma_f32_32x32x16_bf16 v[160:175], a[212:215], a[40:43], v[160:175]
    ds_read_b128 v[100:103], v32 offset:20480
    v_fma_f32 v129, v129, s46, -v48
    v_fma_f32 v130, v130, s46, -v48
    v_fma_f32 v131, v131, s46, -v48
    v_fma_f32 v132, v132, s46, -v48
    v_fma_f32 v133, v133, s46, -v48
    v_mfma_f32_32x32x16_bf16 v[176:191], a[212:215], a[44:47], v[176:191]
    v_fma_f32 v134, v134, s46, -v48
    v_fma_f32 v135, v135, s46, -v48
    v_fma_f32 v136, v136, s46, -v48
    v_fma_f32 v137, v137, s46, -v48
    v_fma_f32 v138, v138, s46, -v48
    v_mfma_f32_32x32x16_bf16 v[160:175], a[216:219], a[48:51], v[160:175]
    ds_read_b128 v[104:107], v33 offset:20480
    v_fma_f32 v139, v139, s46, -v48
    v_fma_f32 v140, v140, s46, -v48
    v_fma_f32 v141, v141, s46, -v48
    v_fma_f32 v142, v142, s46, -v48
    v_fma_f32 v143, v143, s46, -v48
    v_mfma_f32_32x32x16_bf16 v[176:191], a[216:219], a[52:55], v[176:191]
    ds_read_b128 v[108:111], v34 offset:20480
    v_exp_f32 v128, v128
    v_exp_f32 v129, v129
    v_exp_f32 v130, v130
    v_add_f32 v56, v128, v129
    v_exp_f32 v131, v131
    v_mfma_f32_32x32x16_bf16 v[160:175], a[220:223], a[56:59], v[160:175]
    v_add_f32 v56, v56, v130
    v_exp_f32 v132, v132
    v_add_f32 v56, v56, v131
    v_exp_f32 v133, v133
    v_add_f32 v56, v56, v132
    v_mfma_f32_32x32x16_bf16 v[176:191], a[220:223], a[60:63], v[176:191]
    v_exp_f32 v134, v134
    v_add_f32 v56, v56, v133
    v_exp_f32 v135, v135
    v_add_f32 v56, v56, v134
    v_exp_f32 v136, v136
    s_waitcnt lgkmcnt(3)
    v_mfma_f32_32x32x16_bf16 v[192:207], v[96:99], a[32:35], v[192:207]
    s_add_u32 m0, s44, 12288
    s_xor_b32 s45, s69, 196736
    buffer_load_dwordx4 v13, s[12:15], s45 offen nt lds
    v_add_f32 v56, v56, v135
    v_exp_f32 v137, v137
    v_add_f32 v56, v56, v136
    v_exp_f32 v138, v138
    v_add_f32 v56, v56, v137
    v_mfma_f32_32x32x16_bf16 v[208:223], v[96:99], a[36:39], v[208:223]
    v_exp_f32 v139, v139
    v_add_f32 v56, v56, v138
    v_exp_f32 v140, v140
    v_add_f32 v56, v56, v139
    v_exp_f32 v141, v141
    s_waitcnt lgkmcnt(2)
    v_mfma_f32_32x32x16_bf16 v[192:207], v[100:103], a[40:43], v[192:207]
    buffer_load_dwordx4 v14, s[12:15], s45 offen offset:1024 nt lds
    v_add_f32 v56, v56, v140
    v_exp_f32 v142, v142
    v_add_f32 v56, v56, v141
    v_exp_f32 v143, v143
    v_add_f32 v56, v56, v142
    v_mfma_f32_32x32x16_bf16 v[208:223], v[100:103], a[44:47], v[208:223]
    v_add_f32 v56, v56, v143
    v_max3_f32 v49, v144, v145, v146
    v_max3_f32 v49, v49, v147, v148
    v_max3_f32 v49, v49, v149, v150
    v_max3_f32 v49, v49, v151, v152
    s_waitcnt lgkmcnt(1)
    v_mfma_f32_32x32x16_bf16 v[192:207], v[104:107], a[48:51], v[192:207]
    buffer_load_dwordx4 v15, s[12:15], s45 offen offset:2048 nt lds
    v_max3_f32 v49, v49, v153, v154
    v_max3_f32 v49, v49, v155, v156
    v_max3_f32 v49, v49, v157, v158
    v_max_f32 v49, v49, v159
    v_mul_f32 v49, s46, v49
    v_mfma_f32_32x32x16_bf16 v[208:223], v[104:107], a[52:55], v[208:223]
    v_fma_f32 v144, v144, s46, -v49
    v_fma_f32 v145, v145, s46, -v49
    v_fma_f32 v146, v146, s46, -v49
    v_fma_f32 v147, v147, s46, -v49
    v_fma_f32 v148, v148, s46, -v49
    s_waitcnt lgkmcnt(0)
    v_mfma_f32_32x32x16_bf16 v[192:207], v[108:111], a[56:59], v[192:207]
    buffer_load_dwordx4 v16, s[12:15], s45 offen offset:3072 nt lds
    v_fma_f32 v149, v149, s46, -v49
    v_fma_f32 v150, v150, s46, -v49
    v_fma_f32 v151, v151, s46, -v49
    v_fma_f32 v152, v152, s46, -v49
    v_fma_f32 v153, v153, s46, -v49
    v_mfma_f32_32x32x16_bf16 v[208:223], v[108:111], a[60:63], v[208:223]
    v_fma_f32 v154, v154, s46, -v49
    v_fma_f32 v155, v155, s46, -v49
    v_fma_f32 v156, v156, s46, -v49
    v_fma_f32 v157, v157, s46, -v49
    v_fma_f32 v158, v158, s46, -v49
    v_mfma_f32_32x32x16_bf16 v[160:175], a[224:227], a[64:67], v[160:175]
    v_fma_f32 v159, v159, s46, -v49
    v_exp_f32 v144, v144
    v_exp_f32 v145, v145
    v_exp_f32 v146, v146
    v_mfma_f32_32x32x16_bf16 v[176:191], a[224:227], a[68:71], v[176:191]
    s_waitcnt vmcnt(12)
    ds_read_b128 v[112:115], v31 offset:0
    v_add_f32 v57, v144, v145
    v_exp_f32 v147, v147
    v_add_f32 v57, v57, v146
    v_exp_f32 v148, v148
    v_mfma_f32_32x32x16_bf16 v[160:175], a[228:231], a[72:75], v[160:175]
    ds_read_b128 v[116:119], v32 offset:0
    v_add_f32 v57, v57, v147
    v_exp_f32 v149, v149
    v_add_f32 v57, v57, v148
    v_exp_f32 v150, v150
    v_mfma_f32_32x32x16_bf16 v[176:191], a[228:231], a[76:79], v[176:191]
    v_add_f32 v57, v57, v149
    v_exp_f32 v151, v151
    v_add_f32 v57, v57, v150
    v_exp_f32 v152, v152
    v_mfma_f32_32x32x16_bf16 v[160:175], a[232:235], a[80:83], v[160:175]
    ds_read_b128 v[120:123], v33 offset:0
    v_add_f32 v57, v57, v151
    v_exp_f32 v153, v153
    v_add_f32 v57, v57, v152
    v_exp_f32 v154, v154
    v_mfma_f32_32x32x16_bf16 v[176:191], a[232:235], a[84:87], v[176:191]
    ds_read_b128 v[124:127], v34 offset:0
    v_add_f32 v57, v57, v153
    v_exp_f32 v155, v155
    v_add_f32 v57, v57, v154
    v_exp_f32 v156, v156
    v_mfma_f32_32x32x16_bf16 v[160:175], a[236:239], a[88:91], v[160:175]
    v_add_f32 v57, v57, v155
    v_exp_f32 v157, v157
    v_add_f32 v57, v57, v156
    v_exp_f32 v158, v158
    v_mfma_f32_32x32x16_bf16 v[176:191], a[236:239], a[92:95], v[176:191]
    v_add_f32 v57, v57, v157
    v_exp_f32 v159, v159
    v_add_f32 v57, v57, v158
    v_add_f32 v57, v57, v159
    s_waitcnt lgkmcnt(3)
    v_mfma_f32_32x32x16_bf16 v[192:207], v[112:115], a[64:67], v[192:207]
    s_add_u32 m0, s44, 16384
    s_xor_b32 s45, s69, 196864
    buffer_load_dwordx4 v13, s[12:15], s45 offen nt lds
    v_max3_f32 v50, v160, v161, v162
    v_max3_f32 v50, v50, v163, v164
    v_max3_f32 v50, v50, v165, v166
    v_max3_f32 v50, v50, v167, v168
    v_max3_f32 v50, v50, v169, v170
    v_mfma_f32_32x32x16_bf16 v[208:223], v[112:115], a[68:71], v[208:223]
    s_waitcnt vmcnt(9)
    ds_read_b128 v[96:99], v31 offset:4096
    v_max3_f32 v50, v50, v171, v172
    v_max3_f32 v50, v50, v173, v174
    v_max_f32 v50, v50, v175
    v_mul_f32 v50, s46, v50
    v_fma_f32 v160, v160, s46, -v50
    s_waitcnt lgkmcnt(3)
    v_mfma_f32_32x32x16_bf16 v[192:207], v[116:119], a[72:75], v[192:207]
    buffer_load_dwordx4 v14, s[12:15], s45 offen offset:1024 nt lds
    ds_read_b128 v[100:103], v32 offset:4096
    v_fma_f32 v161, v161, s46, -v50
    v_fma_f32 v162, v162, s46, -v50
    v_fma_f32 v163, v163, s46, -v50
    v_fma_f32 v164, v164, s46, -v50
    v_fma_f32 v165, v165, s46, -v50
    v_mfma_f32_32x32x16_bf16 v[208:223], v[116:119], a[76:79], v[208:223]
    v_fma_f32 v166, v166, s46, -v50
    v_fma_f32 v167, v167, s46, -v50
    v_fma_f32 v168, v168, s46, -v50
    v_fma_f32 v169, v169, s46, -v50
    v_fma_f32 v170, v170, s46, -v50
    s_waitcnt lgkmcnt(3)
    v_mfma_f32_32x32x16_bf16 v[192:207], v[120:123], a[80:83], v[192:207]
    buffer_load_dwordx4 v15, s[12:15], s45 offen offset:2048 nt lds
    ds_read_b128 v[104:107], v33 offset:4096
    v_fma_f32 v171, v171, s46, -v50
    v_fma_f32 v172, v172, s46, -v50
    v_fma_f32 v173, v173, s46, -v50
    v_fma_f32 v174, v174, s46, -v50
    v_fma_f32 v175, v175, s46, -v50
    v_mfma_f32_32x32x16_bf16 v[208:223], v[120:123], a[84:87], v[208:223]
    ds_read_b128 v[108:111], v34 offset:4096
    v_exp_f32 v160, v160
    v_exp_f32 v161, v161
    v_exp_f32 v162, v162
    v_add_f32 v58, v160, v161
    v_exp_f32 v163, v163
    s_waitcnt lgkmcnt(4)
    v_mfma_f32_32x32x16_bf16 v[192:207], v[124:127], a[88:91], v[192:207]
    buffer_load_dwordx4 v16, s[12:15], s45 offen offset:3072 nt lds
    v_add_f32 v58, v58, v162
    v_exp_f32 v164, v164
    v_add_f32 v58, v58, v163
    v_exp_f32 v165, v165
    v_add_f32 v58, v58, v164
    v_mfma_f32_32x32x16_bf16 v[208:223], v[124:127], a[92:95], v[208:223]
    v_exp_f32 v166, v166
    v_add_f32 v58, v58, v165
    v_exp_f32 v167, v167
    v_add_f32 v58, v58, v166
    v_exp_f32 v168, v168
    s_waitcnt lgkmcnt(3)
    v_mfma_f32_32x32x16_bf16 v[192:207], v[96:99], a[96:99], v[192:207]
    s_add_u32 m0, s44, 20480
    s_xor_b32 s45, s69, 196992
    buffer_load_dwordx4 v13, s[12:15], s45 offen nt lds
    v_add_f32 v58, v58, v167
    v_exp_f32 v169, v169
    v_add_f32 v58, v58, v168
    v_exp_f32 v170, v170
    v_add_f32 v58, v58, v169
    v_mfma_f32_32x32x16_bf16 v[208:223], v[96:99], a[100:103], v[208:223]
    s_waitcnt vmcnt(9)
    ds_read_b128 v[112:115], v31 offset:8192
    v_exp_f32 v171, v171
    v_add_f32 v58, v58, v170
    v_exp_f32 v172, v172
    v_add_f32 v58, v58, v171
    v_exp_f32 v173, v173
    s_waitcnt lgkmcnt(3)
    v_mfma_f32_32x32x16_bf16 v[192:207], v[100:103], a[104:107], v[192:207]
    buffer_load_dwordx4 v14, s[12:15], s45 offen offset:1024 nt lds
    ds_read_b128 v[116:119], v32 offset:8192
    v_add_f32 v58, v58, v172
    v_exp_f32 v174, v174
    v_add_f32 v58, v58, v173
    v_exp_f32 v175, v175
    v_add_f32 v58, v58, v174
    v_mfma_f32_32x32x16_bf16 v[208:223], v[100:103], a[108:111], v[208:223]
    v_add_f32 v58, v58, v175
    v_max3_f32 v51, v176, v177, v178
    v_max3_f32 v51, v51, v179, v180
    v_max3_f32 v51, v51, v181, v182
    v_max3_f32 v51, v51, v183, v184
    s_waitcnt lgkmcnt(3)
    v_mfma_f32_32x32x16_bf16 v[192:207], v[104:107], a[112:115], v[192:207]
    buffer_load_dwordx4 v15, s[12:15], s45 offen offset:2048 nt lds
    ds_read_b128 v[120:123], v33 offset:8192
    v_max3_f32 v51, v51, v185, v186
    v_max3_f32 v51, v51, v187, v188
    v_max3_f32 v51, v51, v189, v190
    v_max_f32 v51, v51, v191
    v_mul_f32 v51, s46, v51
    v_mfma_f32_32x32x16_bf16 v[208:223], v[104:107], a[116:119], v[208:223]
    ds_read_b128 v[124:127], v34 offset:8192
    v_fma_f32 v176, v176, s46, -v51
    v_fma_f32 v177, v177, s46, -v51
    v_fma_f32 v178, v178, s46, -v51
    v_fma_f32 v179, v179, s46, -v51
    v_fma_f32 v180, v180, s46, -v51
    s_waitcnt lgkmcnt(4)
    v_mfma_f32_32x32x16_bf16 v[192:207], v[108:111], a[120:123], v[192:207]
    buffer_load_dwordx4 v16, s[12:15], s45 offen offset:3072 nt lds
    v_fma_f32 v181, v181, s46, -v51
    v_fma_f32 v182, v182, s46, -v51
    v_fma_f32 v183, v183, s46, -v51
    v_fma_f32 v184, v184, s46, -v51
    v_fma_f32 v185, v185, s46, -v51
    v_mfma_f32_32x32x16_bf16 v[208:223], v[108:111], a[124:127], v[208:223]
    v_fma_f32 v186, v186, s46, -v51
    v_fma_f32 v187, v187, s46, -v51
    v_fma_f32 v188, v188, s46, -v51
    v_fma_f32 v189, v189, s46, -v51
    v_fma_f32 v190, v190, s46, -v51
    s_waitcnt lgkmcnt(3)
    v_mfma_f32_32x32x16_bf16 v[224:239], v[112:115], v[64:67], 0
    s_add_u32 m0, s44, 0
    s_xor_b32 s45, s61, 0
    s_mulk_i32 s45, 14336
    buffer_load_dwordx4 v21, s[24:27], s45 offen lds
    v_fma_f32 v191, v191, s46, -v51
    v_exp_f32 v176, v176
    v_exp_f32 v177, v177
    v_exp_f32 v178, v178
    v_add_f32 v59, v176, v177
    v_mfma_f32_32x32x16_bf16 v[240:255], v[112:115], v[68:71], 0
    s_waitcnt vmcnt(9)
    ds_read_b128 v[96:99], v31 offset:12288
    v_exp_f32 v179, v179
    v_add_f32 v59, v59, v178
    v_exp_f32 v180, v180
    v_add_f32 v59, v59, v179
    v_exp_f32 v181, v181
    s_waitcnt lgkmcnt(3)
    v_mfma_f32_32x32x16_bf16 v[224:239], v[116:119], v[72:75], v[224:239]
    buffer_load_dwordx4 v22, s[24:27], s45 offen offset:1024 lds
    ds_read_b128 v[100:103], v32 offset:12288
    v_add_f32 v59, v59, v180
    v_exp_f32 v182, v182
    v_add_f32 v59, v59, v181
    v_exp_f32 v183, v183
    v_add_f32 v59, v59, v182
    v_mfma_f32_32x32x16_bf16 v[240:255], v[116:119], v[76:79], v[240:255]
    v_exp_f32 v184, v184
    v_add_f32 v59, v59, v183
    v_exp_f32 v185, v185
    v_add_f32 v59, v59, v184
    v_exp_f32 v186, v186
    s_waitcnt lgkmcnt(3)
    v_mfma_f32_32x32x16_bf16 v[224:239], v[120:123], v[80:83], v[224:239]
    buffer_load_dwordx4 v23, s[24:27], s45 offen offset:2048 lds
    ds_read_b128 v[104:107], v33 offset:12288
    v_add_f32 v59, v59, v185
    v_exp_f32 v187, v187
    v_add_f32 v59, v59, v186
    v_exp_f32 v188, v188
    v_add_f32 v59, v59, v187
    v_mfma_f32_32x32x16_bf16 v[240:255], v[120:123], v[84:87], v[240:255]
    ds_read_b128 v[108:111], v34 offset:12288
    v_exp_f32 v189, v189
    v_add_f32 v59, v59, v188
    v_exp_f32 v190, v190
    v_add_f32 v59, v59, v189
    v_exp_f32 v191, v191
    s_waitcnt lgkmcnt(4)
    v_mfma_f32_32x32x16_bf16 v[224:239], v[124:127], v[88:91], v[224:239]
    buffer_load_dwordx4 v24, s[24:27], s45 offen offset:3072 lds
    v_add_f32 v59, v59, v190
    v_add_f32 v59, v59, v191
    v_max3_f32 v52, v192, v193, v194
    v_max3_f32 v52, v52, v195, v196
    v_max3_f32 v52, v52, v197, v198
    v_mfma_f32_32x32x16_bf16 v[240:255], v[124:127], v[92:95], v[240:255]
    v_max3_f32 v52, v52, v199, v200
    v_max3_f32 v52, v52, v201, v202
    v_max3_f32 v52, v52, v203, v204
    v_max3_f32 v52, v52, v205, v206
    v_max_f32 v52, v52, v207
    s_waitcnt lgkmcnt(3)
    v_mfma_f32_32x32x16_bf16 v[224:239], v[96:99], a[32:35], v[224:239]
    s_add_u32 m0, s44, 4096
    s_xor_b32 s45, s61, 1
    s_mulk_i32 s45, 14336
    buffer_load_dwordx4 v21, s[24:27], s45 offen lds
    v_mul_f32 v52, s46, v52
    v_fma_f32 v192, v192, s46, -v52
    v_fma_f32 v193, v193, s46, -v52
    v_fma_f32 v194, v194, s46, -v52
    v_fma_f32 v195, v195, s46, -v52
    v_mfma_f32_32x32x16_bf16 v[240:255], v[96:99], a[36:39], v[240:255]
    s_waitcnt vmcnt(9)
    ds_read_b128 v[112:115], v31 offset:16384
    v_fma_f32 v196, v196, s46, -v52
    v_fma_f32 v197, v197, s46, -v52
    v_fma_f32 v198, v198, s46, -v52
    v_fma_f32 v199, v199, s46, -v52
    v_fma_f32 v200, v200, s46, -v52
    s_waitcnt lgkmcnt(3)
    v_mfma_f32_32x32x16_bf16 v[224:239], v[100:103], a[40:43], v[224:239]
    buffer_load_dwordx4 v22, s[24:27], s45 offen offset:1024 lds
    ds_read_b128 v[116:119], v32 offset:16384
    v_fma_f32 v201, v201, s46, -v52
    v_fma_f32 v202, v202, s46, -v52
    v_fma_f32 v203, v203, s46, -v52
    v_fma_f32 v204, v204, s46, -v52
    v_fma_f32 v205, v205, s46, -v52
    v_mfma_f32_32x32x16_bf16 v[240:255], v[100:103], a[44:47], v[240:255]
    v_fma_f32 v206, v206, s46, -v52
    v_fma_f32 v207, v207, s46, -v52
    v_exp_f32 v192, v192
    v_exp_f32 v193, v193
    v_exp_f32 v194, v194
    s_waitcnt lgkmcnt(3)
    v_mfma_f32_32x32x16_bf16 v[224:239], v[104:107], a[48:51], v[224:239]
    buffer_load_dwordx4 v23, s[24:27], s45 offen offset:2048 lds
    ds_read_b128 v[120:123], v33 offset:16384
    v_add_f32 v60, v192, v193
    v_exp_f32 v195, v195
    v_add_f32 v60, v60, v194
    v_exp_f32 v196, v196
    v_add_f32 v60, v60, v195
    v_mfma_f32_32x32x16_bf16 v[240:255], v[104:107], a[52:55], v[240:255]
    ds_read_b128 v[124:127], v34 offset:16384
    v_exp_f32 v197, v197
    v_add_f32 v60, v60, v196
    v_exp_f32 v198, v198
    v_add_f32 v60, v60, v197
    v_exp_f32 v199, v199
    s_waitcnt lgkmcnt(4)
    v_mfma_f32_32x32x16_bf16 v[224:239], v[108:111], a[56:59], v[224:239]
    buffer_load_dwordx4 v24, s[24:27], s45 offen offset:3072 lds
    v_add_f32 v60, v60, v198
    v_exp_f32 v200, v200
    v_add_f32 v60, v60, v199
    v_exp_f32 v201, v201
    v_add_f32 v60, v60, v200
    v_mfma_f32_32x32x16_bf16 v[240:255], v[108:111], a[60:63], v[240:255]
    v_exp_f32 v202, v202
    v_add_f32 v60, v60, v201
    v_exp_f32 v203, v203
    v_add_f32 v60, v60, v202
    v_exp_f32 v204, v204
    s_waitcnt lgkmcnt(3)
    v_mfma_f32_32x32x16_bf16 v[224:239], v[112:115], a[64:67], v[224:239]
    s_add_u32 m0, s44, 8192
    s_mov_b32 s45, 0
    buffer_load_dwordx4 v17, s[16:19], s45 offen nt lds
    v_add_f32 v60, v60, v203
    v_exp_f32 v205, v205
    v_add_f32 v60, v60, v204
    v_exp_f32 v206, v206
    v_add_f32 v60, v60, v205
    v_mfma_f32_32x32x16_bf16 v[240:255], v[112:115], a[68:71], v[240:255]
    s_waitcnt vmcnt(9)
    ds_read_b128 v[96:99], v31 offset:20480
    v_exp_f32 v207, v207
    v_add_f32 v60, v60, v206
    v_add_f32 v60, v60, v207
    v_max3_f32 v53, v208, v209, v210
    v_max3_f32 v53, v53, v211, v212
    s_waitcnt lgkmcnt(3)
    v_mfma_f32_32x32x16_bf16 v[224:239], v[116:119], a[72:75], v[224:239]
    buffer_load_dwordx4 v18, s[16:19], s45 offen offset:1024 nt lds
    ds_read_b128 v[100:103], v32 offset:20480
    v_max3_f32 v53, v53, v213, v214
    v_max3_f32 v53, v53, v215, v216
    v_max3_f32 v53, v53, v217, v218
    v_max3_f32 v53, v53, v219, v220
    v_max3_f32 v53, v53, v221, v222
    v_mfma_f32_32x32x16_bf16 v[240:255], v[116:119], a[76:79], v[240:255]
    v_max_f32 v53, v53, v223
    v_mul_f32 v53, s46, v53
    v_fma_f32 v208, v208, s46, -v53
    v_fma_f32 v209, v209, s46, -v53
    v_fma_f32 v210, v210, s46, -v53
    s_waitcnt lgkmcnt(3)
    v_mfma_f32_32x32x16_bf16 v[224:239], v[120:123], a[80:83], v[224:239]
    buffer_load_dwordx4 v19, s[16:19], s45 offen offset:2048 nt lds
    ds_read_b128 v[104:107], v33 offset:20480
    v_fma_f32 v211, v211, s46, -v53
    v_fma_f32 v212, v212, s46, -v53
    v_fma_f32 v213, v213, s46, -v53
    v_fma_f32 v214, v214, s46, -v53
    v_fma_f32 v215, v215, s46, -v53
    v_mfma_f32_32x32x16_bf16 v[240:255], v[120:123], a[84:87], v[240:255]
    ds_read_b128 v[108:111], v34 offset:20480
    v_fma_f32 v216, v216, s46, -v53
    v_fma_f32 v217, v217, s46, -v53
    v_fma_f32 v218, v218, s46, -v53
    v_fma_f32 v219, v219, s46, -v53
    v_fma_f32 v220, v220, s46, -v53
    s_waitcnt lgkmcnt(4)
    v_mfma_f32_32x32x16_bf16 v[224:239], v[124:127], a[88:91], v[224:239]
    buffer_load_dwordx4 v20, s[16:19], s45 offen offset:3072 nt lds
    v_fma_f32 v221, v221, s46, -v53
    v_fma_f32 v222, v222, s46, -v53
    v_fma_f32 v223, v223, s46, -v53
    v_exp_f32 v208, v208
    v_exp_f32 v209, v209
    v_mfma_f32_32x32x16_bf16 v[240:255], v[124:127], a[92:95], v[240:255]
    v_exp_f32 v210, v210
    v_add_f32 v61, v208, v209
    v_exp_f32 v211, v211
    v_add_f32 v61, v61, v210
    v_exp_f32 v212, v212
    s_waitcnt lgkmcnt(3)
    v_mfma_f32_32x32x16_bf16 v[224:239], v[96:99], a[96:99], v[224:239]
    s_add_u32 m0, s44, 12288
    s_mov_b32 s45, 16384
    buffer_load_dwordx4 v17, s[16:19], s45 offen nt lds
    v_add_f32 v61, v61, v211
    v_exp_f32 v213, v213
    v_add_f32 v61, v61, v212
    v_mfma_f32_32x32x16_bf16 v[240:255], v[96:99], a[100:103], v[240:255]
    v_exp_f32 v214, v214
    v_add_f32 v61, v61, v213
    v_exp_f32 v215, v215
    s_waitcnt lgkmcnt(2)
    v_mfma_f32_32x32x16_bf16 v[224:239], v[100:103], a[104:107], v[224:239]
    buffer_load_dwordx4 v18, s[16:19], s45 offen offset:1024 nt lds
    v_add_f32 v61, v61, v214
    v_exp_f32 v216, v216
    v_add_f32 v61, v61, v215
    v_mfma_f32_32x32x16_bf16 v[240:255], v[100:103], a[108:111], v[240:255]
    v_exp_f32 v217, v217
    v_add_f32 v61, v61, v216
    v_exp_f32 v218, v218
    s_waitcnt lgkmcnt(1)
    v_mfma_f32_32x32x16_bf16 v[224:239], v[104:107], a[112:115], v[224:239]
    buffer_load_dwordx4 v19, s[16:19], s45 offen offset:2048 nt lds
    v_add_f32 v61, v61, v217
    v_exp_f32 v219, v219
    v_add_f32 v61, v61, v218
    v_mfma_f32_32x32x16_bf16 v[240:255], v[104:107], a[116:119], v[240:255]
    v_exp_f32 v220, v220
    v_add_f32 v61, v61, v219
    v_exp_f32 v221, v221
    s_waitcnt lgkmcnt(0)
    v_mfma_f32_32x32x16_bf16 v[224:239], v[108:111], a[120:123], v[224:239]
    buffer_load_dwordx4 v20, s[16:19], s45 offen offset:3072 nt lds
    v_add_f32 v61, v61, v220
    v_exp_f32 v222, v222
    v_add_f32 v61, v61, v221
    v_mfma_f32_32x32x16_bf16 v[240:255], v[108:111], a[124:127], v[240:255]
    v_exp_f32 v223, v223
    v_add_f32 v61, v61, v222
    v_add_f32 v61, v61, v223
    s_nop 3
    v_max3_f32 v54, v224, v225, v226
    v_max3_f32 v54, v54, v227, v228
    v_max3_f32 v54, v54, v229, v230
    v_max3_f32 v54, v54, v231, v232
    v_max3_f32 v54, v54, v233, v234
    v_max3_f32 v54, v54, v235, v236
    v_max3_f32 v54, v54, v237, v238
    v_max_f32 v54, v54, v239
    v_mul_f32 v54, s46, v54
    v_pk_fma_f32 v[224:225], v[224:225], s[46:47], v[54:55] op_sel:[0,0,0] op_sel_hi:[1,0,0] neg_lo:[0,0,1] neg_hi:[0,0,1]
    v_pk_fma_f32 v[226:227], v[226:227], s[46:47], v[54:55] op_sel:[0,0,0] op_sel_hi:[1,0,0] neg_lo:[0,0,1] neg_hi:[0,0,1]
    v_pk_fma_f32 v[228:229], v[228:229], s[46:47], v[54:55] op_sel:[0,0,0] op_sel_hi:[1,0,0] neg_lo:[0,0,1] neg_hi:[0,0,1]
    v_pk_fma_f32 v[230:231], v[230:231], s[46:47], v[54:55] op_sel:[0,0,0] op_sel_hi:[1,0,0] neg_lo:[0,0,1] neg_hi:[0,0,1]
    v_pk_fma_f32 v[232:233], v[232:233], s[46:47], v[54:55] op_sel:[0,0,0] op_sel_hi:[1,0,0] neg_lo:[0,0,1] neg_hi:[0,0,1]
    v_pk_fma_f32 v[234:235], v[234:235], s[46:47], v[54:55] op_sel:[0,0,0] op_sel_hi:[1,0,0] neg_lo:[0,0,1] neg_hi:[0,0,1]
    v_pk_fma_f32 v[236:237], v[236:237], s[46:47], v[54:55] op_sel:[0,0,0] op_sel_hi:[1,0,0] neg_lo:[0,0,1] neg_hi:[0,0,1]
    v_pk_fma_f32 v[238:239], v[238:239], s[46:47], v[54:55] op_sel:[0,0,0] op_sel_hi:[1,0,0] neg_lo:[0,0,1] neg_hi:[0,0,1]
    v_exp_f32 v224, v224
    v_exp_f32 v225, v225
    v_exp_f32 v226, v226
    v_exp_f32 v227, v227
    v_exp_f32 v228, v228
    v_pk_add_f32 v[2:3], v[224:225], v[226:227]
    v_exp_f32 v229, v229
    v_exp_f32 v230, v230
    v_pk_add_f32 v[2:3], v[2:3], v[228:229]
    v_exp_f32 v231, v231
    v_exp_f32 v232, v232
    v_pk_add_f32 v[2:3], v[2:3], v[230:231]
    v_exp_f32 v233, v233
    v_exp_f32 v234, v234
    v_pk_add_f32 v[2:3], v[2:3], v[232:233]
    v_exp_f32 v235, v235
    v_exp_f32 v236, v236
    v_pk_add_f32 v[2:3], v[2:3], v[234:235]
    v_exp_f32 v237, v237
    v_exp_f32 v238, v238
    v_pk_add_f32 v[2:3], v[2:3], v[236:237]
    v_exp_f32 v239, v239
    s_waitcnt vmcnt(13)
    ds_read_b64_tr_b16 a[128:129], v37 offset:0
    ds_read_b64_tr_b16 a[132:133], v38 offset:0
    ds_read_b64_tr_b16 a[136:137], v39 offset:0
    ds_read_b64_tr_b16 a[140:141], v40 offset:0
    s_waitcnt vmcnt(12)
    ds_read_b64_tr_b16 a[130:131], v37 offset:1024
    ds_read_b64_tr_b16 a[134:135], v38 offset:1024
    ds_read_b64_tr_b16 a[138:139], v39 offset:1024
    ds_read_b64_tr_b16 a[142:143], v40 offset:1024
    s_add_u32 m0, s44, 16384
    s_mov_b32 s45, 32768
    buffer_load_dwordx4 v17, s[16:19], s45 offen nt lds
    buffer_load_dwordx4 v18, s[16:19], s45 offen offset:1024 nt lds
    buffer_load_dwordx4 v19, s[16:19], s45 offen offset:2048 nt lds
    buffer_load_dwordx4 v20, s[16:19], s45 offen offset:3072 nt lds
    s_add_u32 m0, s44, 20480
    s_mov_b32 s45, 49152
    buffer_load_dwordx4 v17, s[16:19], s45 offen nt lds
    buffer_load_dwordx4 v18, s[16:19], s45 offen offset:1024 nt lds
    buffer_load_dwordx4 v19, s[16:19], s45 offen offset:2048 nt lds
    buffer_load_dwordx4 v20, s[16:19], s45 offen offset:3072 nt lds
    v_pk_add_f32 v[2:3], v[2:3], v[238:239]
    v_add_f32 v62, v2, v3
    v_max3_f32 v55, v240, v241, v242
    v_max3_f32 v55, v55, v243, v244
    v_max3_f32 v55, v55, v245, v246
    v_max3_f32 v55, v55, v247, v248
    v_max3_f32 v55, v55, v249, v250
    v_max3_f32 v55, v55, v251, v252
    v_max3_f32 v55, v55, v253, v254
    v_max_f32 v55, v55, v255
    v_mul_f32 v55, s46, v55
    v_pk_fma_f32 v[240:241], v[240:241], s[46:47], v[54:55] op_sel:[0,0,1] op_sel_hi:[1,0,1] neg_lo:[0,0,1] neg_hi:[0,0,1]
    v_pk_fma_f32 v[242:243], v[242:243], s[46:47], v[54:55] op_sel:[0,0,1] op_sel_hi:[1,0,1] neg_lo:[0,0,1] neg_hi:[0,0,1]
    v_pk_fma_f32 v[244:245], v[244:245], s[46:47], v[54:55] op_sel:[0,0,1] op_sel_hi:[1,0,1] neg_lo:[0,0,1] neg_hi:[0,0,1]
    v_pk_fma_f32 v[246:247], v[246:247], s[46:47], v[54:55] op_sel:[0,0,1] op_sel_hi:[1,0,1] neg_lo:[0,0,1] neg_hi:[0,0,1]
    v_pk_fma_f32 v[248:249], v[248:249], s[46:47], v[54:55] op_sel:[0,0,1] op_sel_hi:[1,0,1] neg_lo:[0,0,1] neg_hi:[0,0,1]
    v_pk_fma_f32 v[250:251], v[250:251], s[46:47], v[54:55] op_sel:[0,0,1] op_sel_hi:[1,0,1] neg_lo:[0,0,1] neg_hi:[0,0,1]
    v_pk_fma_f32 v[252:253], v[252:253], s[46:47], v[54:55] op_sel:[0,0,1] op_sel_hi:[1,0,1] neg_lo:[0,0,1] neg_hi:[0,0,1]
    v_pk_fma_f32 v[254:255], v[254:255], s[46:47], v[54:55] op_sel:[0,0,1] op_sel_hi:[1,0,1] neg_lo:[0,0,1] neg_hi:[0,0,1]
    v_exp_f32 v240, v240
    v_exp_f32 v241, v241
    v_exp_f32 v242, v242
    v_exp_f32 v243, v243
    v_exp_f32 v244, v244
    v_pk_add_f32 v[2:3], v[240:241], v[242:243]
    v_exp_f32 v245, v245
    v_exp_f32 v246, v246
    v_pk_add_f32 v[2:3], v[2:3], v[244:245]
    v_exp_f32 v247, v247
    v_exp_f32 v248, v248
    v_pk_add_f32 v[2:3], v[2:3], v[246:247]
    v_exp_f32 v249, v249
    v_exp_f32 v250, v250
    v_pk_add_f32 v[2:3], v[2:3], v[248:249]
    v_exp_f32 v251, v251
    v_exp_f32 v252, v252
    v_pk_add_f32 v[2:3], v[2:3], v[250:251]
    v_exp_f32 v253, v253
    v_exp_f32 v254, v254
    v_pk_add_f32 v[2:3], v[2:3], v[252:253]
    v_exp_f32 v255, v255
    s_nop 0
    v_pk_add_f32 v[2:3], v[2:3], v[254:255]
    v_add_f32 v63, v2, v3
    v_max3_f32 v64, v48, v50, v52
    v_max_f32 v64, v64, v54
    v_max3_f32 v65, v49, v51, v53
    v_max_f32 v65, v65, v55
    v_sub_f32 v68, v48, v64
    v_sub_f32 v69, v49, v65
    v_sub_f32 v70, v50, v64
    v_sub_f32 v71, v51, v65
    v_sub_f32 v72, v52, v64
    v_sub_f32 v73, v53, v65
    v_sub_f32 v74, v54, v64
    v_sub_f32 v75, v55, v65
    v_exp_f32 v68, v68
    v_exp_f32 v69, v69
    v_exp_f32 v70, v70
    v_exp_f32 v71, v71
    v_exp_f32 v72, v72
    v_exp_f32 v73, v73
    v_exp_f32 v74, v74
    v_exp_f32 v75, v75
    v_pk_mul_f32 v[66:67], v[56:57], v[68:69]
    v_pk_fma_f32 v[66:67], v[58:59], v[70:71], v[66:67]
    v_pk_fma_f32 v[66:67], v[60:61], v[72:73], v[66:67]
    v_pk_fma_f32 v[66:67], v[62:63], v[74:75], v[66:67]
    v_permlane32_swap_b32 v64, v65
    s_nop 0
    v_permlane32_swap_b32 v66, v67
    v_max_f32 v72, v64, v65
    v_sub_f32 v68, v64, v72
    v_sub_f32 v69, v65, v72
    v_exp_f32 v68, v68
    v_exp_f32 v69, v69
    v_mul_f32 v73, v66, v68
    v_fmac_f32 v73, v67, v69
    s_waitcnt vmcnt(17)
    ds_read_b64_tr_b16 a[144:145], v37 offset:4096
    ds_read_b64_tr_b16 a[148:149], v38 offset:4096
    ds_read_b64_tr_b16 a[152:153], v39 offset:4096
    ds_read_b64_tr_b16 a[156:157], v40 offset:4096
    s_waitcnt vmcnt(16)
    ds_read_b64_tr_b16 a[146:147], v37 offset:5120
    ds_read_b64_tr_b16 a[150:151], v38 offset:5120
    ds_read_b64_tr_b16 a[154:155], v39 offset:5120
    ds_read_b64_tr_b16 a[158:159], v40 offset:5120
    s_add_u32 m0, s44, 0
    s_mov_b32 s45, 65536
    s_waitcnt lgkmcnt(8)
    buffer_load_dwordx4 v17, s[16:19], s45 offen nt lds
    buffer_load_dwordx4 v18, s[16:19], s45 offen offset:1024 nt lds
    buffer_load_dwordx4 v19, s[16:19], s45 offen offset:2048 nt lds
    buffer_load_dwordx4 v20, s[16:19], s45 offen offset:3072 nt lds
    ds_write_b64 v6, v[72:73] offset:0
    ds_write_b64 v6, v[72:73] offset:16384
    ds_write_b64 v6, v[72:73] offset:32768
    ds_write_b64 v6, v[72:73] offset:49152
    s_waitcnt lgkmcnt(0)
    s_barrier
    ds_read_b64 v[74:75], v8 offset:0
    ds_read_b64 v[76:77], v8 offset:512
    ds_read_b64 v[78:79], v8 offset:1024
    ds_read_b64 v[80:81], v8 offset:1536
    s_waitcnt lgkmcnt(1)
    v_max3_f32 v64, v74, v76, v78
    s_waitcnt lgkmcnt(0)
    v_max_f32 v64, v64, v80
    v_sub_f32 v68, v74, v64
    v_sub_f32 v69, v76, v64
    v_sub_f32 v70, v78, v64
    v_sub_f32 v71, v80, v64
    v_exp_f32 v68, v68
    v_exp_f32 v69, v69
    v_exp_f32 v70, v70
    v_exp_f32 v71, v71
    v_mul_f32 v65, v75, v68
    v_fmac_f32 v65, v77, v69
    v_fmac_f32 v65, v79, v70
    v_fmac_f32 v65, v81, v71
    v_log_f32 v65, v65
    s_nop 0
    v_add_f32 v64, v64, v65
    v_mov_b32 v65, v64
    s_nop 1
    v_permlane32_swap_b32 v64, v65
    v_sub_f32 v48, v48, v64
    v_sub_f32 v49, v49, v65
    v_sub_f32 v50, v50, v64
    v_sub_f32 v51, v51, v65
    v_sub_f32 v52, v52, v64
    v_sub_f32 v53, v53, v65
    v_sub_f32 v54, v54, v64
    v_sub_f32 v55, v55, v65
    v_exp_f32 v48, v48
    v_exp_f32 v49, v49
    v_exp_f32 v50, v50
    v_exp_f32 v51, v51
    v_exp_f32 v52, v52
    v_exp_f32 v53, v53
    v_exp_f32 v54, v54
    v_exp_f32 v55, v55
    v_pk_mul_f32 v[128:129], v[128:129], v[48:49] op_sel:[0,0] op_sel_hi:[1,0]
    v_pk_mul_f32 v[130:131], v[130:131], v[48:49] op_sel:[0,0] op_sel_hi:[1,0]
    v_pk_mul_f32 v[132:133], v[132:133], v[48:49] op_sel:[0,0] op_sel_hi:[1,0]
    v_pk_mul_f32 v[134:135], v[134:135], v[48:49] op_sel:[0,0] op_sel_hi:[1,0]
    v_cvt_pk_bf16_f32 v128, v128, v129
    v_cvt_pk_bf16_f32 v129, v130, v131
    v_cvt_pk_bf16_f32 v130, v132, v133
    v_cvt_pk_bf16_f32 v131, v134, v135
    ds_write_b128 v42, v[128:131] offset:0
    v_pk_mul_f32 v[136:137], v[136:137], v[48:49] op_sel:[0,0] op_sel_hi:[1,0]
    v_pk_mul_f32 v[138:139], v[138:139], v[48:49] op_sel:[0,0] op_sel_hi:[1,0]
    v_pk_mul_f32 v[140:141], v[140:141], v[48:49] op_sel:[0,0] op_sel_hi:[1,0]
    v_pk_mul_f32 v[142:143], v[142:143], v[48:49] op_sel:[0,0] op_sel_hi:[1,0]
    v_cvt_pk_bf16_f32 v136, v136, v137
    v_cvt_pk_bf16_f32 v137, v138, v139
    v_cvt_pk_bf16_f32 v138, v140, v141
    v_cvt_pk_bf16_f32 v139, v142, v143
    ds_write_b128 v42, v[136:139] offset:2048
    v_pk_mul_f32 v[144:145], v[144:145], v[48:49] op_sel:[0,1] op_sel_hi:[1,1]
    v_pk_mul_f32 v[146:147], v[146:147], v[48:49] op_sel:[0,1] op_sel_hi:[1,1]
    v_pk_mul_f32 v[148:149], v[148:149], v[48:49] op_sel:[0,1] op_sel_hi:[1,1]
    v_pk_mul_f32 v[150:151], v[150:151], v[48:49] op_sel:[0,1] op_sel_hi:[1,1]
    v_cvt_pk_bf16_f32 v144, v144, v145
    v_cvt_pk_bf16_f32 v145, v146, v147
    v_cvt_pk_bf16_f32 v146, v148, v149
    v_cvt_pk_bf16_f32 v147, v150, v151
    ds_write_b128 v42, v[144:147] offset:1024
    v_pk_mul_f32 v[152:153], v[152:153], v[48:49] op_sel:[0,1] op_sel_hi:[1,1]
    v_pk_mul_f32 v[154:155], v[154:155], v[48:49] op_sel:[0,1] op_sel_hi:[1,1]
    v_pk_mul_f32 v[156:157], v[156:157], v[48:49] op_sel:[0,1] op_sel_hi:[1,1]
    v_pk_mul_f32 v[158:159], v[158:159], v[48:49] op_sel:[0,1] op_sel_hi:[1,1]
    v_cvt_pk_bf16_f32 v152, v152, v153
    v_cvt_pk_bf16_f32 v153, v154, v155
    v_cvt_pk_bf16_f32 v154, v156, v157
    s_add_u32 m0, s44, 4096
    s_mov_b32 s45, 81920
    buffer_load_dwordx4 v17, s[16:19], s45 offen nt lds
    buffer_load_dwordx4 v18, s[16:19], s45 offen offset:1024 nt lds
    buffer_load_dwordx4 v19, s[16:19], s45 offen offset:2048 nt lds
    buffer_load_dwordx4 v20, s[16:19], s45 offen offset:3072 nt lds
    v_cvt_pk_bf16_f32 v155, v158, v159
    ds_write_b128 v42, v[152:155] offset:3072
    v_pk_mul_f32 v[160:161], v[160:161], v[50:51] op_sel:[0,0] op_sel_hi:[1,0]
    v_pk_mul_f32 v[162:163], v[162:163], v[50:51] op_sel:[0,0] op_sel_hi:[1,0]
    v_pk_mul_f32 v[164:165], v[164:165], v[50:51] op_sel:[0,0] op_sel_hi:[1,0]
    v_pk_mul_f32 v[166:167], v[166:167], v[50:51] op_sel:[0,0] op_sel_hi:[1,0]
    v_cvt_pk_bf16_f32 v160, v160, v161
    v_cvt_pk_bf16_f32 v161, v162, v163
    v_cvt_pk_bf16_f32 v162, v164, v165
    v_cvt_pk_bf16_f32 v163, v166, v167
    ds_write_b128 v42, v[160:163] offset:4096
    v_pk_mul_f32 v[168:169], v[168:169], v[50:51] op_sel:[0,0] op_sel_hi:[1,0]
    v_pk_mul_f32 v[170:171], v[170:171], v[50:51] op_sel:[0,0] op_sel_hi:[1,0]
    v_pk_mul_f32 v[172:173], v[172:173], v[50:51] op_sel:[0,0] op_sel_hi:[1,0]
    v_pk_mul_f32 v[174:175], v[174:175], v[50:51] op_sel:[0,0] op_sel_hi:[1,0]
    v_cvt_pk_bf16_f32 v168, v168, v169
    v_cvt_pk_bf16_f32 v169, v170, v171
    v_cvt_pk_bf16_f32 v170, v172, v173
    v_cvt_pk_bf16_f32 v171, v174, v175
    ds_write_b128 v42, v[168:171] offset:6144
    v_pk_mul_f32 v[176:177], v[176:177], v[50:51] op_sel:[0,1] op_sel_hi:[1,1]
    v_pk_mul_f32 v[178:179], v[178:179], v[50:51] op_sel:[0,1] op_sel_hi:[1,1]
    v_pk_mul_f32 v[180:181], v[180:181], v[50:51] op_sel:[0,1] op_sel_hi:[1,1]
    v_pk_mul_f32 v[182:183], v[182:183], v[50:51] op_sel:[0,1] op_sel_hi:[1,1]
    v_cvt_pk_bf16_f32 v176, v176, v177
    v_cvt_pk_bf16_f32 v177, v178, v179
    v_cvt_pk_bf16_f32 v178, v180, v181
    v_cvt_pk_bf16_f32 v179, v182, v183
    ds_write_b128 v42, v[176:179] offset:5120
    v_pk_mul_f32 v[184:185], v[184:185], v[50:51] op_sel:[0,1] op_sel_hi:[1,1]
    v_pk_mul_f32 v[186:187], v[186:187], v[50:51] op_sel:[0,1] op_sel_hi:[1,1]
    v_pk_mul_f32 v[188:189], v[188:189], v[50:51] op_sel:[0,1] op_sel_hi:[1,1]
    v_pk_mul_f32 v[190:191], v[190:191], v[50:51] op_sel:[0,1] op_sel_hi:[1,1]
    v_cvt_pk_bf16_f32 v184, v184, v185
    v_cvt_pk_bf16_f32 v185, v186, v187
    v_cvt_pk_bf16_f32 v186, v188, v189
    v_cvt_pk_bf16_f32 v187, v190, v191
    ds_write_b128 v42, v[184:187] offset:7168
    s_waitcnt lgkmcnt(0)
    s_barrier
    v_mul_f32 v192, v192, v52
    v_mul_f32 v193, v193, v52
    v_mul_f32 v194, v194, v52
    v_mul_f32 v195, v195, v52
    v_mul_f32 v196, v196, v52
    v_mul_f32 v197, v197, v52
    v_mul_f32 v198, v198, v52
    v_mul_f32 v199, v199, v52
    v_cvt_pk_bf16_f32 v192, v192, v193
    v_cvt_pk_bf16_f32 v193, v194, v195
    v_cvt_pk_bf16_f32 v194, v196, v197
    v_cvt_pk_bf16_f32 v195, v198, v199
    ds_write_b128 v42, v[192:195] offset:8192
    v_mul_f32 v200, v200, v52
    s_waitcnt vmcnt(23)
    ds_read_b64_tr_b16 v[64:65], v35 offset:8192
    s_waitcnt vmcnt(22)
    ds_read_b64_tr_b16 v[66:67], v35 offset:9216
    ds_read_b128 v[80:83], v43 offset:0
    ds_read_b64_tr_b16 v[68:69], v36 offset:8192
    ds_read_b64_tr_b16 v[70:71], v36 offset:9216
    ds_read_b128 v[84:87], v44 offset:0
    s_waitcnt vmcnt(21)
    ds_read_b64_tr_b16 v[72:73], v35 offset:10240
    s_waitcnt vmcnt(20)
    ds_read_b64_tr_b16 v[74:75], v35 offset:11264
    ds_read_b128 v[88:91], v43 offset:2048
    ds_read_b64_tr_b16 v[76:77], v36 offset:10240
    ds_read_b64_tr_b16 v[78:79], v36 offset:11264
    ds_read_b128 v[92:95], v44 offset:2048
    s_waitcnt lgkmcnt(9)
    v_mfma_f32_32x32x16_bf16 v[128:143], v[64:67], v[80:83], 0
    v_mul_f32 v201, v201, v52
    v_mul_f32 v202, v202, v52
    s_waitcnt lgkmcnt(7)
    v_mfma_f32_32x32x16_bf16 v[160:175], v[68:71], v[80:83], 0
    s_waitcnt vmcnt(19)
    ds_read_b64_tr_b16 v[96:97], v35 offset:12288
    s_waitcnt vmcnt(18)
    ds_read_b64_tr_b16 v[98:99], v35 offset:13312
    v_mul_f32 v203, v203, v52
    v_mul_f32 v204, v204, v52
    s_waitcnt lgkmcnt(8)
    v_mfma_f32_32x32x16_bf16 v[144:159], v[64:67], v[84:87], 0
    ds_read_b128 v[112:115], v43 offset:16384
    ds_read_b64_tr_b16 v[100:101], v36 offset:12288
    v_mul_f32 v205, v205, v52
    v_mul_f32 v206, v206, v52
    v_mfma_f32_32x32x16_bf16 v[176:191], v[68:71], v[84:87], 0
    ds_read_b64_tr_b16 v[102:103], v36 offset:13312
    ds_read_b128 v[116:119], v44 offset:16384
    v_mul_f32 v207, v207, v52
    s_waitcnt lgkmcnt(9)
    v_mfma_f32_32x32x16_bf16 v[128:143], v[72:75], v[88:91], v[128:143]
    s_waitcnt vmcnt(17)
    ds_read_b64_tr_b16 v[104:105], v35 offset:14336
    s_waitcnt vmcnt(16)
    ds_read_b64_tr_b16 v[106:107], v35 offset:15360
    v_cvt_pk_bf16_f32 v200, v200, v201
    v_cvt_pk_bf16_f32 v201, v202, v203
    s_waitcnt lgkmcnt(9)
    v_mfma_f32_32x32x16_bf16 v[160:175], v[76:79], v[88:91], v[160:175]
    ds_read_b128 v[120:123], v43 offset:18432
    ds_read_b64_tr_b16 v[108:109], v36 offset:14336
    v_cvt_pk_bf16_f32 v202, v204, v205
    v_cvt_pk_bf16_f32 v203, v206, v207
    s_waitcnt lgkmcnt(10)
    v_mfma_f32_32x32x16_bf16 v[144:159], v[72:75], v[92:95], v[144:159]
    ds_read_b64_tr_b16 v[110:111], v36 offset:15360
    ds_read_b128 v[124:127], v44 offset:18432
    ds_write_b128 v42, v[200:203] offset:10240
    v_mul_f32 v208, v208, v53
    v_mfma_f32_32x32x16_bf16 v[176:191], v[76:79], v[92:95], v[176:191]
    v_mul_f32 v209, v209, v53
    s_waitcnt lgkmcnt(10)
    v_mfma_f32_32x32x16_bf16 v[128:143], v[96:99], v[112:115], v[128:143]
    v_mul_f32 v210, v210, v53
    v_mul_f32 v211, v211, v53
    s_waitcnt lgkmcnt(8)
    v_mfma_f32_32x32x16_bf16 v[160:175], v[100:103], v[112:115], v[160:175]
    s_waitcnt vmcnt(15)
    ds_read_b64_tr_b16 v[64:65], v35 offset:16384
    s_waitcnt vmcnt(14)
    ds_read_b64_tr_b16 v[66:67], v35 offset:17408
    v_mul_f32 v212, v212, v53
    v_mul_f32 v213, v213, v53
    s_waitcnt lgkmcnt(9)
    v_mfma_f32_32x32x16_bf16 v[144:159], v[96:99], v[116:119], v[144:159]
    ds_read_b128 v[80:83], v43 offset:32768
    ds_read_b64_tr_b16 v[68:69], v36 offset:16384
    v_mul_f32 v214, v214, v53
    v_mul_f32 v215, v215, v53
    v_mfma_f32_32x32x16_bf16 v[176:191], v[100:103], v[116:119], v[176:191]
    ds_read_b64_tr_b16 v[70:71], v36 offset:17408
    ds_read_b128 v[84:87], v44 offset:32768
    v_cvt_pk_bf16_f32 v208, v208, v209
    s_waitcnt lgkmcnt(10)
    v_mfma_f32_32x32x16_bf16 v[128:143], v[104:107], v[120:123], v[128:143]
    s_waitcnt vmcnt(13)
    ds_read_b64_tr_b16 v[72:73], v35 offset:18432
    s_waitcnt vmcnt(12)
    ds_read_b64_tr_b16 v[74:75], v35 offset:19456
    v_cvt_pk_bf16_f32 v209, v210, v211
    v_cvt_pk_bf16_f32 v210, v212, v213
    s_waitcnt lgkmcnt(10)
    v_mfma_f32_32x32x16_bf16 v[160:175], v[108:111], v[120:123], v[160:175]
    ds_read_b128 v[88:91], v43 offset:34816
    ds_read_b64_tr_b16 v[76:77], v36 offset:18432
    v_cvt_pk_bf16_f32 v211, v214, v215
    ds_write_b128 v42, v[208:211] offset:9216
    s_waitcnt lgkmcnt(12)
    v_mfma_f32_32x32x16_bf16 v[144:159], v[104:107], v[124:127], v[144:159]
    ds_read_b64_tr_b16 v[78:79], v36 offset:19456
    ds_read_b128 v[92:95], v44 offset:34816
    v_mul_f32 v216, v216, v53
    v_mul_f32 v217, v217, v53
    v_mfma_f32_32x32x16_bf16 v[176:191], v[108:111], v[124:127], v[176:191]
    v_mul_f32 v218, v218, v53
    s_waitcnt lgkmcnt(10)
    v_mfma_f32_32x32x16_bf16 v[128:143], v[64:67], v[80:83], v[128:143]
    s_add_u32 m0, s44, 8192
    s_mov_b32 s45, 98304
    buffer_load_dwordx4 v17, s[16:19], s45 offen nt lds
    v_mul_f32 v219, v219, v53
    v_mul_f32 v220, v220, v53
    s_waitcnt lgkmcnt(8)
    v_mfma_f32_32x32x16_bf16 v[160:175], v[68:71], v[80:83], v[160:175]
    s_waitcnt vmcnt(12)
    ds_read_b64_tr_b16 v[96:97], v35 offset:20480
    s_waitcnt vmcnt(11)
    ds_read_b64_tr_b16 v[98:99], v35 offset:21504
    v_mul_f32 v221, v221, v53
    v_mul_f32 v222, v222, v53
    s_waitcnt lgkmcnt(9)
    v_mfma_f32_32x32x16_bf16 v[144:159], v[64:67], v[84:87], v[144:159]
    buffer_load_dwordx4 v18, s[16:19], s45 offen offset:1024 nt lds
    ds_read_b128 v[112:115], v43 offset:49152
    ds_read_b64_tr_b16 v[100:101], v36 offset:20480
    v_mul_f32 v223, v223, v53
    v_cvt_pk_bf16_f32 v216, v216, v217
    v_mfma_f32_32x32x16_bf16 v[176:191], v[68:71], v[84:87], v[176:191]
    ds_read_b64_tr_b16 v[102:103], v36 offset:21504
    ds_read_b128 v[116:119], v44 offset:49152
    v_cvt_pk_bf16_f32 v217, v218, v219
    s_waitcnt lgkmcnt(10)
    v_mfma_f32_32x32x16_bf16 v[128:143], v[72:75], v[88:91], v[128:143]
    buffer_load_dwordx4 v19, s[16:19], s45 offen offset:2048 nt lds
    s_waitcnt vmcnt(12)
    ds_read_b64_tr_b16 v[104:105], v35 offset:22528
    s_waitcnt vmcnt(11)
    ds_read_b64_tr_b16 v[106:107], v35 offset:23552
    v_cvt_pk_bf16_f32 v218, v220, v221
    v_cvt_pk_bf16_f32 v219, v222, v223
    s_waitcnt lgkmcnt(9)
    v_mfma_f32_32x32x16_bf16 v[160:175], v[76:79], v[88:91], v[160:175]
    ds_read_b128 v[120:123], v43 offset:51200
    ds_read_b64_tr_b16 v[108:109], v36 offset:22528
    ds_write_b128 v42, v[216:219] offset:11264
    v_mul_f32 v224, v224, v54
    s_waitcnt lgkmcnt(11)
    v_mfma_f32_32x32x16_bf16 v[144:159], v[72:75], v[92:95], v[144:159]
    buffer_load_dwordx4 v20, s[16:19], s45 offen offset:3072 nt lds
    ds_read_b64_tr_b16 v[110:111], v36 offset:23552
    ds_read_b128 v[124:127], v44 offset:51200
    v_mul_f32 v225, v225, v54
    v_mul_f32 v226, v226, v54
    v_mfma_f32_32x32x16_bf16 v[176:191], v[76:79], v[92:95], v[176:191]
    v_mul_f32 v227, v227, v54
    s_waitcnt lgkmcnt(10)
    v_mfma_f32_32x32x16_bf16 v[128:143], v[96:99], v[112:115], v[128:143]
    s_add_u32 m0, s44, 12288
    s_mov_b32 s45, 114688
    buffer_load_dwordx4 v17, s[16:19], s45 offen nt lds
    v_mul_f32 v228, v228, v54
    v_mul_f32 v229, v229, v54
    s_waitcnt lgkmcnt(8)
    v_mfma_f32_32x32x16_bf16 v[160:175], v[100:103], v[112:115], v[160:175]
    s_waitcnt vmcnt(12)
    ds_read_b64_tr_b16 v[64:65], v35 offset:0
    s_waitcnt vmcnt(11)
    ds_read_b64_tr_b16 v[66:67], v35 offset:1024
    v_mul_f32 v230, v230, v54
    v_mul_f32 v231, v231, v54
    s_waitcnt lgkmcnt(9)
    v_mfma_f32_32x32x16_bf16 v[144:159], v[96:99], v[116:119], v[144:159]
    buffer_load_dwordx4 v18, s[16:19], s45 offen offset:1024 nt lds
    ds_read_b128 v[80:83], v43 offset:4096
    ds_read_b64_tr_b16 v[68:69], v36 offset:0
    v_cvt_pk_bf16_f32 v224, v224, v225
    v_cvt_pk_bf16_f32 v225, v226, v227
    v_mfma_f32_32x32x16_bf16 v[176:191], v[100:103], v[116:119], v[176:191]
    ds_read_b64_tr_b16 v[70:71], v36 offset:1024
    ds_read_b128 v[84:87], v44 offset:4096
    v_cvt_pk_bf16_f32 v226, v228, v229
    s_waitcnt lgkmcnt(10)
    v_mfma_f32_32x32x16_bf16 v[128:143], v[104:107], v[120:123], v[128:143]
    buffer_load_dwordx4 v19, s[16:19], s45 offen offset:2048 nt lds
    s_waitcnt vmcnt(12)
    ds_read_b64_tr_b16 v[72:73], v35 offset:2048
    s_waitcnt vmcnt(11)
    ds_read_b64_tr_b16 v[74:75], v35 offset:3072
    v_cvt_pk_bf16_f32 v227, v230, v231
    ds_write_b128 v42, v[224:227] offset:12288
    s_waitcnt lgkmcnt(10)
    v_mfma_f32_32x32x16_bf16 v[160:175], v[108:111], v[120:123], v[160:175]
    ds_read_b128 v[88:91], v43 offset:6144
    ds_read_b64_tr_b16 v[76:77], v36 offset:2048
    v_mul_f32 v232, v232, v54
    v_mul_f32 v233, v233, v54
    s_waitcnt lgkmcnt(11)
    v_mfma_f32_32x32x16_bf16 v[144:159], v[104:107], v[124:127], v[144:159]
    buffer_load_dwordx4 v20, s[16:19], s45 offen offset:3072 nt lds
    ds_read_b64_tr_b16 v[78:79], v36 offset:3072
    ds_read_b128 v[92:95], v44 offset:6144
    v_mul_f32 v234, v234, v54
    v_mul_f32 v235, v235, v54
    v_mfma_f32_32x32x16_bf16 v[176:191], v[108:111], v[124:127], v[176:191]
    v_mul_f32 v236, v236, v54
    s_waitcnt lgkmcnt(10)
    v_mfma_f32_32x32x16_bf16 v[128:143], v[64:67], v[80:83], v[128:143]
    s_add_u32 m0, s44, 16384
    s_mov_b32 s45, 131072
    buffer_load_dwordx4 v17, s[16:19], s45 offen nt lds
    v_mul_f32 v237, v237, v54
    v_mul_f32 v238, v238, v54
    s_waitcnt lgkmcnt(8)
    v_mfma_f32_32x32x16_bf16 v[160:175], v[68:71], v[80:83], v[160:175]
    s_waitcnt vmcnt(12)
    ds_read_b64_tr_b16 v[96:97], v35 offset:4096
    s_waitcnt vmcnt(11)
    ds_read_b64_tr_b16 v[98:99], v35 offset:5120
    v_mul_f32 v239, v239, v54
    v_cvt_pk_bf16_f32 v232, v232, v233
    s_waitcnt lgkmcnt(9)
    v_mfma_f32_32x32x16_bf16 v[144:159], v[64:67], v[84:87], v[144:159]
    buffer_load_dwordx4 v18, s[16:19], s45 offen offset:1024 nt lds
    ds_read_b128 v[112:115], v43 offset:20480
    ds_read_b64_tr_b16 v[100:101], v36 offset:4096
    v_cvt_pk_bf16_f32 v233, v234, v235
    v_cvt_pk_bf16_f32 v234, v236, v237
    v_mfma_f32_32x32x16_bf16 v[176:191], v[68:71], v[84:87], v[176:191]
    ds_read_b64_tr_b16 v[102:103], v36 offset:5120
    ds_read_b128 v[116:119], v44 offset:20480
    v_cvt_pk_bf16_f32 v235, v238, v239
    s_waitcnt lgkmcnt(9)
    v_mfma_f32_32x32x16_bf16 v[128:143], v[72:75], v[88:91], v[128:143]
    buffer_load_dwordx4 v19, s[16:19], s45 offen offset:2048 nt lds
    s_waitcnt vmcnt(12)
    ds_read_b64_tr_b16 v[104:105], v35 offset:6144
    s_waitcnt vmcnt(11)
    ds_read_b64_tr_b16 v[106:107], v35 offset:7168
    ds_write_b128 v42, v[232:235] offset:14336
    v_mul_f32 v240, v240, v55
    s_waitcnt lgkmcnt(10)
    v_mfma_f32_32x32x16_bf16 v[160:175], v[76:79], v[88:91], v[160:175]
    ds_read_b128 v[120:123], v43 offset:22528
    ds_read_b64_tr_b16 v[108:109], v36 offset:6144
    v_mul_f32 v241, v241, v55
    v_mul_f32 v242, v242, v55
    s_waitcnt lgkmcnt(11)
    v_mfma_f32_32x32x16_bf16 v[144:159], v[72:75], v[92:95], v[144:159]
    buffer_load_dwordx4 v20, s[16:19], s45 offen offset:3072 nt lds
    ds_read_b64_tr_b16 v[110:111], v36 offset:7168
    ds_read_b128 v[124:127], v44 offset:22528
    v_mul_f32 v243, v243, v55
    v_mul_f32 v244, v244, v55
    v_mfma_f32_32x32x16_bf16 v[176:191], v[76:79], v[92:95], v[176:191]
    v_mul_f32 v245, v245, v55
    s_waitcnt lgkmcnt(10)
    v_mfma_f32_32x32x16_bf16 v[128:143], v[96:99], v[112:115], v[128:143]
    s_add_u32 m0, s44, 20480
    s_xor_b32 s45, s61, 2
    s_mulk_i32 s45, 14336
    buffer_load_dwordx4 v21, s[24:27], s45 offen lds
    v_mul_f32 v246, v246, v55
    v_mul_f32 v247, v247, v55
    s_waitcnt lgkmcnt(8)
    v_mfma_f32_32x32x16_bf16 v[160:175], v[100:103], v[112:115], v[160:175]
    s_waitcnt vmcnt(12)
    ds_read_b64_tr_b16 v[64:65], v35 offset:8192
    s_waitcnt vmcnt(11)
    ds_read_b64_tr_b16 v[66:67], v35 offset:9216
    v_cvt_pk_bf16_f32 v240, v240, v241
    v_cvt_pk_bf16_f32 v241, v242, v243
    s_waitcnt lgkmcnt(9)
    v_mfma_f32_32x32x16_bf16 v[144:159], v[96:99], v[116:119], v[144:159]
    buffer_load_dwordx4 v22, s[24:27], s45 offen offset:1024 lds
    ds_read_b128 v[80:83], v43 offset:36864
    ds_read_b64_tr_b16 v[68:69], v36 offset:8192
    v_cvt_pk_bf16_f32 v242, v244, v245
    v_cvt_pk_bf16_f32 v243, v246, v247
    v_mfma_f32_32x32x16_bf16 v[176:191], v[100:103], v[116:119], v[176:191]
    ds_read_b64_tr_b16 v[70:71], v36 offset:9216
    ds_read_b128 v[84:87], v44 offset:36864
    ds_write_b128 v42, v[240:243] offset:13312
    s_waitcnt lgkmcnt(10)
    v_mfma_f32_32x32x16_bf16 v[128:143], v[104:107], v[120:123], v[128:143]
    buffer_load_dwordx4 v23, s[24:27], s45 offen offset:2048 lds
    s_waitcnt vmcnt(12)
    ds_read_b64_tr_b16 v[72:73], v35 offset:10240
    s_waitcnt vmcnt(11)
    ds_read_b64_tr_b16 v[74:75], v35 offset:11264
    v_mul_f32 v248, v248, v55
    v_mul_f32 v249, v249, v55
    s_waitcnt lgkmcnt(10)
    v_mfma_f32_32x32x16_bf16 v[160:175], v[108:111], v[120:123], v[160:175]
    ds_read_b128 v[88:91], v43 offset:38912
    ds_read_b64_tr_b16 v[76:77], v36 offset:10240
    v_mul_f32 v250, v250, v55
    v_mul_f32 v251, v251, v55
    s_waitcnt lgkmcnt(11)
    v_mfma_f32_32x32x16_bf16 v[144:159], v[104:107], v[124:127], v[144:159]
    buffer_load_dwordx4 v24, s[24:27], s45 offen offset:3072 lds
    ds_read_b64_tr_b16 v[78:79], v36 offset:11264
    ds_read_b128 v[92:95], v44 offset:38912
    v_mul_f32 v252, v252, v55
    v_mul_f32 v253, v253, v55
    v_mfma_f32_32x32x16_bf16 v[176:191], v[108:111], v[124:127], v[176:191]
    v_mul_f32 v254, v254, v55
    s_waitcnt lgkmcnt(10)
    v_mfma_f32_32x32x16_bf16 v[128:143], v[64:67], v[80:83], v[128:143]
    s_add_u32 m0, s44, 0
    s_xor_b32 s45, s61, 3
    s_mulk_i32 s45, 14336
    buffer_load_dwordx4 v21, s[24:27], s45 offen lds
    v_mul_f32 v255, v255, v55
    v_cvt_pk_bf16_f32 v248, v248, v249
    s_waitcnt lgkmcnt(8)
    v_mfma_f32_32x32x16_bf16 v[160:175], v[68:71], v[80:83], v[160:175]
    s_waitcnt vmcnt(12)
    ds_read_b64_tr_b16 v[96:97], v35 offset:12288
    s_waitcnt vmcnt(11)
    ds_read_b64_tr_b16 v[98:99], v35 offset:13312
    v_cvt_pk_bf16_f32 v249, v250, v251
    s_waitcnt lgkmcnt(9)
    v_mfma_f32_32x32x16_bf16 v[144:159], v[64:67], v[84:87], v[144:159]
    buffer_load_dwordx4 v22, s[24:27], s45 offen offset:1024 lds
    ds_read_b128 v[112:115], v43 offset:53248
    ds_read_b64_tr_b16 v[100:101], v36 offset:12288
    v_cvt_pk_bf16_f32 v250, v252, v253
    v_cvt_pk_bf16_f32 v251, v254, v255
    v_mfma_f32_32x32x16_bf16 v[176:191], v[68:71], v[84:87], v[176:191]
    ds_read_b64_tr_b16 v[102:103], v36 offset:13312
    ds_read_b128 v[116:119], v44 offset:53248
    ds_write_b128 v42, v[248:251] offset:15360
    s_waitcnt lgkmcnt(10)
    v_mfma_f32_32x32x16_bf16 v[128:143], v[72:75], v[88:91], v[128:143]
    buffer_load_dwordx4 v23, s[24:27], s45 offen offset:2048 lds
    s_waitcnt vmcnt(12)
    ds_read_b64_tr_b16 v[104:105], v35 offset:14336
    s_waitcnt vmcnt(11)
    ds_read_b64_tr_b16 v[106:107], v35 offset:15360
    v_mov_b32 v2, 0
    s_waitcnt lgkmcnt(10)
    v_mfma_f32_32x32x16_bf16 v[160:175], v[76:79], v[88:91], v[160:175]
    ds_read_b128 v[120:123], v43 offset:55296
    ds_read_b64_tr_b16 v[108:109], v36 offset:14336
    buffer_load_dwordx4 v[28:31], v2, s[36:39], s60 offen sc1
    s_lshl_b32 s3, s50, 10
    s_waitcnt lgkmcnt(11)
    v_mfma_f32_32x32x16_bf16 v[144:159], v[72:75], v[92:95], v[144:159]
    buffer_load_dwordx4 v24, s[24:27], s45 offen offset:3072 lds
    ds_read_b64_tr_b16 v[110:111], v36 offset:15360
    ds_read_b128 v[124:127], v44 offset:55296
    v_add_u32 v16, s3, v42
    v_mfma_f32_32x32x16_bf16 v[176:191], v[76:79], v[92:95], v[176:191]
    v_xor_b32 v12, 0x400, v16
    s_waitcnt lgkmcnt(10)
    v_mfma_f32_32x32x16_bf16 v[128:143], v[96:99], v[112:115], v[128:143]
    s_add_u32 m0, s44, 4096
    s_xor_b32 s45, s61, 4
    s_mulk_i32 s45, 14336
    buffer_load_dwordx4 v21, s[24:27], s45 offen lds
    s_waitcnt lgkmcnt(8)
    v_mfma_f32_32x32x16_bf16 v[160:175], v[100:103], v[112:115], v[160:175]
    s_waitcnt lgkmcnt(0)
    s_barrier
    s_waitcnt vmcnt(13)
    ds_read_b64_tr_b16 v[64:65], v35 offset:16384
    s_waitcnt vmcnt(12)
    ds_read_b64_tr_b16 v[66:67], v35 offset:17408
    v_mfma_f32_32x32x16_bf16 v[144:159], v[96:99], v[116:119], v[144:159]
    buffer_load_dwordx4 v22, s[24:27], s45 offen offset:1024 lds
    ds_read_b128 v[80:83], v43 offset:8192
    ds_read_b64_tr_b16 v[68:69], v36 offset:16384
    v_mfma_f32_32x32x16_bf16 v[176:191], v[100:103], v[116:119], v[176:191]
    ds_read_b64_tr_b16 v[70:71], v36 offset:17408
    ds_read_b128 v[84:87], v44 offset:8192
    v_mfma_f32_32x32x16_bf16 v[128:143], v[104:107], v[120:123], v[128:143]
    buffer_load_dwordx4 v23, s[24:27], s45 offen offset:2048 lds
    s_waitcnt vmcnt(13)
    ds_read_b64_tr_b16 v[72:73], v35 offset:18432
    s_waitcnt vmcnt(12)
    ds_read_b64_tr_b16 v[74:75], v35 offset:19456
    v_mfma_f32_32x32x16_bf16 v[160:175], v[108:111], v[120:123], v[160:175]
    ds_read_b128 v[88:91], v43 offset:10240
    ds_read_b64_tr_b16 v[76:77], v36 offset:18432
    v_mfma_f32_32x32x16_bf16 v[144:159], v[104:107], v[124:127], v[144:159]
    buffer_load_dwordx4 v24, s[24:27], s45 offen offset:3072 lds
    ds_read_b64_tr_b16 v[78:79], v36 offset:19456
    ds_read_b128 v[92:95], v44 offset:10240
    v_mfma_f32_32x32x16_bf16 v[176:191], v[108:111], v[124:127], v[176:191]
    s_waitcnt lgkmcnt(9)
    v_mfma_f32_32x32x16_bf16 v[128:143], v[64:67], v[80:83], v[128:143]
    s_add_u32 m0, s44, 8192
    s_xor_b32 s45, s61, 5
    s_mulk_i32 s45, 14336
    buffer_load_dwordx4 v21, s[24:27], s45 offen lds
    s_waitcnt lgkmcnt(7)
    v_mfma_f32_32x32x16_bf16 v[160:175], v[68:71], v[80:83], v[160:175]
    s_waitcnt vmcnt(11)
    ds_read_b64_tr_b16 a[160:161], v37 offset:20480
    ds_read_b64_tr_b16 a[164:165], v38 offset:20480
    s_waitcnt lgkmcnt(8)
    v_mfma_f32_32x32x16_bf16 v[144:159], v[64:67], v[84:87], v[144:159]
    buffer_load_dwordx4 v22, s[24:27], s45 offen offset:1024 lds
    ds_read_b64_tr_b16 a[168:169], v39 offset:20480
    v_mfma_f32_32x32x16_bf16 v[176:191], v[68:71], v[84:87], v[176:191]
    ds_read_b64_tr_b16 a[172:173], v40 offset:20480
    s_waitcnt lgkmcnt(7)
    v_mfma_f32_32x32x16_bf16 v[128:143], v[72:75], v[88:91], v[128:143]
    buffer_load_dwordx4 v23, s[24:27], s45 offen offset:2048 lds
    s_waitcnt vmcnt(12)
    ds_read_b64_tr_b16 a[162:163], v37 offset:21504
    ds_read_b64_tr_b16 a[166:167], v38 offset:21504
    s_waitcnt lgkmcnt(7)
    v_mfma_f32_32x32x16_bf16 v[160:175], v[76:79], v[88:91], v[160:175]
    ds_read_b64_tr_b16 a[170:171], v39 offset:21504
    s_waitcnt lgkmcnt(7)
    v_mfma_f32_32x32x16_bf16 v[144:159], v[72:75], v[92:95], v[144:159]
    buffer_load_dwordx4 v24, s[24:27], s45 offen offset:3072 lds
    ds_read_b64_tr_b16 a[174:175], v40 offset:21504
    v_mfma_f32_32x32x16_bf16 v[176:191], v[76:79], v[92:95], v[176:191]
    s_waitcnt vmcnt(10)
    ds_read_b64_tr_b16 a[176:177], v37 offset:0
    ds_read_b64_tr_b16 a[180:181], v38 offset:0
    ds_read_b64_tr_b16 a[184:185], v39 offset:0
    ds_read_b64_tr_b16 a[188:189], v40 offset:0
    s_waitcnt vmcnt(8)
    ds_read_b64_tr_b16 a[178:179], v37 offset:1024
    ds_read_b64_tr_b16 a[182:183], v38 offset:1024
    ds_read_b64_tr_b16 a[186:187], v39 offset:1024
    ds_read_b64_tr_b16 a[190:191], v40 offset:1024
    s_add_u32 m0, s44, 12288
    s_mov_b32 s45, 147456
    buffer_load_dwordx4 v17, s[16:19], s45 offen nt lds
    buffer_load_dwordx4 v18, s[16:19], s45 offen offset:1024 nt lds
    buffer_load_dwordx4 v19, s[16:19], s45 offen offset:2048 nt lds
    buffer_load_dwordx4 v20, s[16:19], s45 offen offset:3072 nt lds
    s_add_u32 m0, s44, 16384
    s_mov_b32 s45, 163840
    buffer_load_dwordx4 v17, s[16:19], s45 offen nt lds
    buffer_load_dwordx4 v18, s[16:19], s45 offen offset:1024 nt lds
    buffer_load_dwordx4 v19, s[16:19], s45 offen offset:2048 nt lds
    buffer_load_dwordx4 v20, s[16:19], s45 offen offset:3072 nt lds
    s_waitcnt vmcnt(13)
    ds_read_b64_tr_b16 a[192:193], v37 offset:4096
    ds_read_b64_tr_b16 a[196:197], v38 offset:4096
    ds_read_b64_tr_b16 a[200:201], v39 offset:4096
    ds_read_b64_tr_b16 a[204:205], v40 offset:4096
    s_waitcnt vmcnt(12)
    ds_read_b64_tr_b16 a[194:195], v37 offset:5120
    ds_read_b64_tr_b16 a[198:199], v38 offset:5120
    ds_read_b64_tr_b16 a[202:203], v39 offset:5120
    ds_read_b64_tr_b16 a[206:207], v40 offset:5120
    s_add_u32 m0, s44, 20480
    s_mov_b32 s45, 180224
    s_waitcnt lgkmcnt(14)
    buffer_load_dwordx4 v17, s[16:19], s45 offen nt lds
    buffer_load_dwordx4 v18, s[16:19], s45 offen offset:1024 nt lds
    buffer_load_dwordx4 v19, s[16:19], s45 offen offset:2048 nt lds
    buffer_load_dwordx4 v20, s[16:19], s45 offen offset:3072 nt lds
    s_waitcnt vmcnt(13)
    ds_read_b64_tr_b16 a[208:209], v37 offset:8192
    ds_read_b64_tr_b16 a[212:213], v38 offset:8192
    ds_read_b64_tr_b16 a[216:217], v39 offset:8192
    ds_read_b64_tr_b16 a[220:221], v40 offset:8192
    s_waitcnt vmcnt(12)
    ds_read_b64_tr_b16 a[210:211], v37 offset:9216
    ds_read_b64_tr_b16 a[214:215], v38 offset:9216
    ds_read_b64_tr_b16 a[218:219], v39 offset:9216
    ds_read_b64_tr_b16 a[222:223], v40 offset:9216
    s_add_u32 m0, s44, 0
    s_mov_b32 s45, 196608
    s_waitcnt lgkmcnt(14)
    buffer_load_dwordx4 v17, s[16:19], s45 offen nt lds
    buffer_load_dwordx4 v18, s[16:19], s45 offen offset:1024 nt lds
    buffer_load_dwordx4 v19, s[16:19], s45 offen offset:2048 nt lds
    buffer_load_dwordx4 v20, s[16:19], s45 offen offset:3072 nt lds
    s_waitcnt vmcnt(15)
    ds_read_b64_tr_b16 v[96:97], v35 offset:12288
    s_waitcnt vmcnt(14)
    ds_read_b64_tr_b16 v[98:99], v35 offset:13312
    ds_read_b128 v[112:115], v43 offset:24576
    ds_read_b64_tr_b16 v[100:101], v36 offset:12288
    ds_read_b64_tr_b16 v[102:103], v36 offset:13312
    ds_read_b128 v[116:119], v44 offset:24576
    s_waitcnt vmcnt(13)
    ds_read_b64_tr_b16 v[104:105], v35 offset:14336
    s_waitcnt vmcnt(12)
    ds_read_b64_tr_b16 v[106:107], v35 offset:15360
    ds_read_b128 v[120:123], v43 offset:26624
    ds_read_b64_tr_b16 v[108:109], v36 offset:14336
    ds_read_b64_tr_b16 v[110:111], v36 offset:15360
    ds_read_b128 v[124:127], v44 offset:26624
    s_add_u32 m0, s44, 4096
    s_mov_b32 s45, 212992
    s_waitcnt lgkmcnt(14)
    buffer_load_dwordx4 v17, s[16:19], s45 offen nt lds
    buffer_load_dwordx4 v18, s[16:19], s45 offen offset:1024 nt lds
    buffer_load_dwordx4 v19, s[16:19], s45 offen offset:2048 nt lds
    buffer_load_dwordx4 v20, s[16:19], s45 offen offset:3072 nt lds
    s_waitcnt lgkmcnt(9)
    v_mfma_f32_32x32x16_bf16 v[128:143], v[96:99], v[112:115], v[128:143]
    s_waitcnt lgkmcnt(7)
    v_mfma_f32_32x32x16_bf16 v[160:175], v[100:103], v[112:115], v[160:175]
    s_waitcnt vmcnt(15)
    ds_read_b64_tr_b16 v[64:65], v35 offset:16384
    s_waitcnt vmcnt(14)
    ds_read_b64_tr_b16 v[66:67], v35 offset:17408
    s_waitcnt lgkmcnt(8)
    v_mfma_f32_32x32x16_bf16 v[144:159], v[96:99], v[116:119], v[144:159]
    ds_read_b128 v[80:83], v43 offset:40960
    ds_read_b64_tr_b16 v[68:69], v36 offset:16384
    v_mfma_f32_32x32x16_bf16 v[176:191], v[100:103], v[116:119], v[176:191]
    ds_read_b64_tr_b16 v[70:71], v36 offset:17408
    ds_read_b128 v[84:87], v44 offset:40960
    s_waitcnt lgkmcnt(9)
    v_mfma_f32_32x32x16_bf16 v[128:143], v[104:107], v[120:123], v[128:143]
    s_waitcnt vmcnt(13)
    ds_read_b64_tr_b16 v[72:73], v35 offset:18432
    s_waitcnt vmcnt(12)
    ds_read_b64_tr_b16 v[74:75], v35 offset:19456
    s_waitcnt lgkmcnt(9)
    v_mfma_f32_32x32x16_bf16 v[160:175], v[108:111], v[120:123], v[160:175]
    ds_read_b128 v[88:91], v43 offset:43008
    ds_read_b64_tr_b16 v[76:77], v36 offset:18432
    s_waitcnt lgkmcnt(10)
    v_mfma_f32_32x32x16_bf16 v[144:159], v[104:107], v[124:127], v[144:159]
    ds_read_b64_tr_b16 v[78:79], v36 offset:19456
    ds_read_b128 v[92:95], v44 offset:43008
    v_mfma_f32_32x32x16_bf16 v[176:191], v[108:111], v[124:127], v[176:191]
    s_waitcnt lgkmcnt(9)
    v_mfma_f32_32x32x16_bf16 v[128:143], v[64:67], v[80:83], v[128:143]
    s_add_u32 m0, s44, 8192
    s_mov_b32 s45, 229376
    buffer_load_dwordx4 v17, s[16:19], s45 offen nt lds
    s_waitcnt lgkmcnt(7)
    v_mfma_f32_32x32x16_bf16 v[160:175], v[68:71], v[80:83], v[160:175]
    s_waitcnt vmcnt(12)
    ds_read_b64_tr_b16 v[96:97], v35 offset:20480
    s_waitcnt vmcnt(11)
    ds_read_b64_tr_b16 v[98:99], v35 offset:21504
    s_waitcnt lgkmcnt(8)
    v_mfma_f32_32x32x16_bf16 v[144:159], v[64:67], v[84:87], v[144:159]
    buffer_load_dwordx4 v18, s[16:19], s45 offen offset:1024 nt lds
    ds_read_b128 v[112:115], v43 offset:57344
    ds_read_b64_tr_b16 v[100:101], v36 offset:20480
    v_mfma_f32_32x32x16_bf16 v[176:191], v[68:71], v[84:87], v[176:191]
    ds_read_b64_tr_b16 v[102:103], v36 offset:21504
    ds_read_b128 v[116:119], v44 offset:57344
    s_waitcnt lgkmcnt(9)
    v_mfma_f32_32x32x16_bf16 v[128:143], v[72:75], v[88:91], v[128:143]
    buffer_load_dwordx4 v19, s[16:19], s45 offen offset:2048 nt lds
    s_waitcnt vmcnt(12)
    ds_read_b64_tr_b16 v[104:105], v35 offset:22528
    s_waitcnt vmcnt(11)
    ds_read_b64_tr_b16 v[106:107], v35 offset:23552
    s_waitcnt lgkmcnt(9)
    v_mfma_f32_32x32x16_bf16 v[160:175], v[76:79], v[88:91], v[160:175]
    ds_read_b128 v[120:123], v43 offset:59392
    ds_read_b64_tr_b16 v[108:109], v36 offset:22528
    s_waitcnt lgkmcnt(10)
    v_mfma_f32_32x32x16_bf16 v[144:159], v[72:75], v[92:95], v[144:159]
    buffer_load_dwordx4 v20, s[16:19], s45 offen offset:3072 nt lds
    ds_read_b64_tr_b16 v[110:111], v36 offset:23552
    ds_read_b128 v[124:127], v44 offset:59392
    v_mfma_f32_32x32x16_bf16 v[176:191], v[76:79], v[92:95], v[176:191]
    s_waitcnt lgkmcnt(9)
    v_mfma_f32_32x32x16_bf16 v[128:143], v[96:99], v[112:115], v[128:143]
    s_add_u32 m0, s44, 12288
    s_mov_b32 s45, 245760
    buffer_load_dwordx4 v17, s[16:19], s45 offen nt lds
    s_waitcnt lgkmcnt(7)
    v_mfma_f32_32x32x16_bf16 v[160:175], v[100:103], v[112:115], v[160:175]
    s_waitcnt vmcnt(12)
    ds_read_b64_tr_b16 v[64:65], v35 offset:0
    s_waitcnt vmcnt(11)
    ds_read_b64_tr_b16 v[66:67], v35 offset:1024
    s_waitcnt lgkmcnt(8)
    v_mfma_f32_32x32x16_bf16 v[144:159], v[96:99], v[116:119], v[144:159]
    buffer_load_dwordx4 v18, s[16:19], s45 offen offset:1024 nt lds
    ds_read_b128 v[80:83], v43 offset:12288
    ds_read_b64_tr_b16 v[68:69], v36 offset:0
    v_mfma_f32_32x32x16_bf16 v[176:191], v[100:103], v[116:119], v[176:191]
    ds_read_b64_tr_b16 v[70:71], v36 offset:1024
    ds_read_b128 v[84:87], v44 offset:12288
    s_waitcnt lgkmcnt(9)
    v_mfma_f32_32x32x16_bf16 v[128:143], v[104:107], v[120:123], v[128:143]
    buffer_load_dwordx4 v19, s[16:19], s45 offen offset:2048 nt lds
    s_waitcnt vmcnt(12)
    ds_read_b64_tr_b16 v[72:73], v35 offset:2048
    s_waitcnt vmcnt(11)
    ds_read_b64_tr_b16 v[74:75], v35 offset:3072
    s_waitcnt lgkmcnt(9)
    v_mfma_f32_32x32x16_bf16 v[160:175], v[108:111], v[120:123], v[160:175]
    ds_read_b128 v[88:91], v43 offset:14336
    ds_read_b64_tr_b16 v[76:77], v36 offset:2048
    s_waitcnt lgkmcnt(10)
    v_mfma_f32_32x32x16_bf16 v[144:159], v[104:107], v[124:127], v[144:159]
    buffer_load_dwordx4 v20, s[16:19], s45 offen offset:3072 nt lds
    ds_read_b64_tr_b16 v[78:79], v36 offset:3072
    ds_read_b128 v[92:95], v44 offset:14336
    v_mfma_f32_32x32x16_bf16 v[176:191], v[108:111], v[124:127], v[176:191]
    s_waitcnt lgkmcnt(9)
    v_mfma_f32_32x32x16_bf16 v[128:143], v[64:67], v[80:83], v[128:143]
    s_waitcnt lgkmcnt(7)
    v_mfma_f32_32x32x16_bf16 v[160:175], v[68:71], v[80:83], v[160:175]
    s_waitcnt vmcnt(11)
    ds_read_b64_tr_b16 v[96:97], v35 offset:4096
    s_waitcnt vmcnt(10)
    ds_read_b64_tr_b16 v[98:99], v35 offset:5120
    s_waitcnt lgkmcnt(8)
    v_mfma_f32_32x32x16_bf16 v[144:159], v[64:67], v[84:87], v[144:159]
    ds_read_b128 v[112:115], v43 offset:28672
    ds_read_b64_tr_b16 v[100:101], v36 offset:4096
    v_mfma_f32_32x32x16_bf16 v[176:191], v[68:71], v[84:87], v[176:191]
    ds_read_b64_tr_b16 v[102:103], v36 offset:5120
    ds_read_b128 v[116:119], v44 offset:28672
    s_waitcnt lgkmcnt(9)
    v_mfma_f32_32x32x16_bf16 v[128:143], v[72:75], v[88:91], v[128:143]
    s_waitcnt vmcnt(9)
    ds_read_b64_tr_b16 v[104:105], v35 offset:6144
    s_waitcnt vmcnt(8)
    ds_read_b64_tr_b16 v[106:107], v35 offset:7168
    s_waitcnt lgkmcnt(9)
    v_mfma_f32_32x32x16_bf16 v[160:175], v[76:79], v[88:91], v[160:175]
    ds_read_b128 v[120:123], v43 offset:30720
    ds_read_b64_tr_b16 v[108:109], v36 offset:6144
    s_waitcnt lgkmcnt(10)
    v_mfma_f32_32x32x16_bf16 v[144:159], v[72:75], v[92:95], v[144:159]
    ds_read_b64_tr_b16 v[110:111], v36 offset:7168
    ds_read_b128 v[124:127], v44 offset:30720
    v_mfma_f32_32x32x16_bf16 v[176:191], v[76:79], v[92:95], v[176:191]
    s_waitcnt lgkmcnt(9)
    v_mfma_f32_32x32x16_bf16 v[128:143], v[96:99], v[112:115], v[128:143]
    s_add_u32 m0, s44, 16384
    s_xor_b32 s45, s61, 6
    s_mulk_i32 s45, 14336
    buffer_load_dwordx4 v21, s[24:27], s45 offen lds
    s_waitcnt lgkmcnt(7)
    v_mfma_f32_32x32x16_bf16 v[160:175], v[100:103], v[112:115], v[160:175]
    s_waitcnt vmcnt(8)
    ds_read_b64_tr_b16 v[64:65], v35 offset:8192
    s_waitcnt vmcnt(7)
    ds_read_b64_tr_b16 v[66:67], v35 offset:9216
    s_waitcnt lgkmcnt(8)
    v_mfma_f32_32x32x16_bf16 v[144:159], v[96:99], v[116:119], v[144:159]
    buffer_load_dwordx4 v22, s[24:27], s45 offen offset:1024 lds
    ds_read_b128 v[80:83], v43 offset:45056
    ds_read_b64_tr_b16 v[68:69], v36 offset:8192
    v_mfma_f32_32x32x16_bf16 v[176:191], v[100:103], v[116:119], v[176:191]
    ds_read_b64_tr_b16 v[70:71], v36 offset:9216
    ds_read_b128 v[84:87], v44 offset:45056
    s_waitcnt lgkmcnt(9)
    v_mfma_f32_32x32x16_bf16 v[128:143], v[104:107], v[120:123], v[128:143]
    buffer_load_dwordx4 v23, s[24:27], s45 offen offset:2048 lds
    s_waitcnt vmcnt(8)
    ds_read_b64_tr_b16 v[72:73], v35 offset:10240
    s_waitcnt vmcnt(7)
    ds_read_b64_tr_b16 v[74:75], v35 offset:11264
    s_waitcnt lgkmcnt(9)
    v_mfma_f32_32x32x16_bf16 v[160:175], v[108:111], v[120:123], v[160:175]
    ds_read_b128 v[88:91], v43 offset:47104
    ds_read_b64_tr_b16 v[76:77], v36 offset:10240
    s_waitcnt lgkmcnt(10)
    v_mfma_f32_32x32x16_bf16 v[144:159], v[104:107], v[124:127], v[144:159]
    buffer_load_dwordx4 v24, s[24:27], s45 offen offset:3072 lds
    ds_read_b64_tr_b16 v[78:79], v36 offset:11264
    ds_read_b128 v[92:95], v44 offset:47104
    v_mfma_f32_32x32x16_bf16 v[176:191], v[108:111], v[124:127], v[176:191]
    s_waitcnt lgkmcnt(9)
    v_mfma_f32_32x32x16_bf16 v[128:143], v[64:67], v[80:83], v[128:143]
    s_add_u32 m0, s44, 20480
    s_xor_b32 s45, s61, 7
    s_mulk_i32 s45, 14336
    buffer_load_dwordx4 v21, s[24:27], s45 offen lds
    s_waitcnt lgkmcnt(7)
    v_mfma_f32_32x32x16_bf16 v[160:175], v[68:71], v[80:83], v[160:175]
    s_waitcnt vmcnt(8)
    ds_read_b64_tr_b16 v[96:97], v35 offset:12288
    s_waitcnt vmcnt(7)
    ds_read_b64_tr_b16 v[98:99], v35 offset:13312
    s_waitcnt lgkmcnt(8)
    v_mfma_f32_32x32x16_bf16 v[144:159], v[64:67], v[84:87], v[144:159]
    buffer_load_dwordx4 v22, s[24:27], s45 offen offset:1024 lds
    ds_read_b128 v[112:115], v43 offset:61440
    ds_read_b64_tr_b16 v[100:101], v36 offset:12288
    v_mfma_f32_32x32x16_bf16 v[176:191], v[68:71], v[84:87], v[176:191]
    ds_read_b64_tr_b16 v[102:103], v36 offset:13312
    ds_read_b128 v[116:119], v44 offset:61440
    s_waitcnt lgkmcnt(9)
    v_mfma_f32_32x32x16_bf16 v[128:143], v[72:75], v[88:91], v[128:143]
    buffer_load_dwordx4 v23, s[24:27], s45 offen offset:2048 lds
    s_waitcnt vmcnt(8)
    ds_read_b64_tr_b16 v[104:105], v35 offset:14336
    s_waitcnt vmcnt(7)
    ds_read_b64_tr_b16 v[106:107], v35 offset:15360
    s_waitcnt lgkmcnt(9)
    v_mfma_f32_32x32x16_bf16 v[160:175], v[76:79], v[88:91], v[160:175]
    ds_read_b128 v[120:123], v43 offset:63488
    ds_read_b64_tr_b16 v[108:109], v36 offset:14336
    s_waitcnt lgkmcnt(10)
    v_mfma_f32_32x32x16_bf16 v[144:159], v[72:75], v[92:95], v[144:159]
    buffer_load_dwordx4 v24, s[24:27], s45 offen offset:3072 lds
    ds_read_b64_tr_b16 v[110:111], v36 offset:15360
    ds_read_b128 v[124:127], v44 offset:63488
    v_mfma_f32_32x32x16_bf16 v[176:191], v[76:79], v[92:95], v[176:191]
    s_waitcnt lgkmcnt(9)
    v_mfma_f32_32x32x16_bf16 v[128:143], v[96:99], v[112:115], v[128:143]
    s_waitcnt lgkmcnt(3)
    v_mfma_f32_32x32x16_bf16 v[128:143], v[104:107], v[120:123], v[128:143]
    v_mfma_f32_32x32x16_bf16 v[144:159], v[96:99], v[116:119], v[144:159]
    s_waitcnt lgkmcnt(0)
    v_mfma_f32_32x32x16_bf16 v[144:159], v[104:107], v[124:127], v[144:159]
    v_mfma_f32_32x32x16_bf16 v[160:175], v[100:103], v[112:115], v[160:175]
    s_nop 7
    v_cvt_pk_bf16_f32 v64, v128, v129
    v_cvt_pk_bf16_f32 v65, v130, v131
    v_cvt_pk_bf16_f32 v66, v132, v133
    v_cvt_pk_bf16_f32 v67, v134, v135
    ds_write_b128 v16, v[64:67] offset:0
    v_cvt_pk_bf16_f32 v72, v136, v137
    v_cvt_pk_bf16_f32 v73, v138, v139
    v_cvt_pk_bf16_f32 v74, v140, v141
    v_cvt_pk_bf16_f32 v75, v142, v143
    ds_write_b128 v16, v[72:75] offset:2048
    v_mfma_f32_32x32x16_bf16 v[160:175], v[108:111], v[120:123], v[160:175]
    v_mfma_f32_32x32x16_bf16 v[176:191], v[100:103], v[116:119], v[176:191]
    v_cvt_pk_bf16_f32 v68, v144, v145
    v_cvt_pk_bf16_f32 v69, v146, v147
    v_cvt_pk_bf16_f32 v70, v148, v149
    v_cvt_pk_bf16_f32 v71, v150, v151
    ds_write_b128 v12, v[68:71] offset:0
    v_cvt_pk_bf16_f32 v76, v152, v153
    v_cvt_pk_bf16_f32 v77, v154, v155
    v_cvt_pk_bf16_f32 v78, v156, v157
    v_cvt_pk_bf16_f32 v79, v158, v159
    ds_write_b128 v12, v[76:79] offset:2048
    v_mfma_f32_32x32x16_bf16 v[176:191], v[108:111], v[124:127], v[176:191]
    v_cvt_pk_bf16_f32 v80, v160, v161
    v_cvt_pk_bf16_f32 v81, v162, v163
    v_cvt_pk_bf16_f32 v82, v164, v165
    v_cvt_pk_bf16_f32 v83, v166, v167
    ds_write_b128 v16, v[80:83] offset:4096
    v_cvt_pk_bf16_f32 v88, v168, v169
    v_cvt_pk_bf16_f32 v89, v170, v171
    v_cvt_pk_bf16_f32 v90, v172, v173
    v_cvt_pk_bf16_f32 v91, v174, v175
    ds_write_b128 v16, v[88:91] offset:6144
    s_nop 1
    v_cvt_pk_bf16_f32 v84, v176, v177
    v_cvt_pk_bf16_f32 v85, v178, v179
    v_cvt_pk_bf16_f32 v86, v180, v181
    v_cvt_pk_bf16_f32 v87, v182, v183
    ds_write_b128 v12, v[84:87] offset:4096
    v_cvt_pk_bf16_f32 v92, v184, v185
    v_cvt_pk_bf16_f32 v93, v186, v187
    v_cvt_pk_bf16_f32 v94, v188, v189
    v_cvt_pk_bf16_f32 v95, v190, v191
    ds_write_b128 v12, v[92:95] offset:6144
    s_add_u32 m0, s44, 0
    s_xor_b32 s45, s61, 8
    s_mulk_i32 s45, 14336
    buffer_load_dwordx4 v21, s[24:27], s45 offen lds
    buffer_load_dwordx4 v22, s[24:27], s45 offen offset:1024 lds
    buffer_load_dwordx4 v23, s[24:27], s45 offen offset:2048 lds
    buffer_load_dwordx4 v24, s[24:27], s45 offen offset:3072 lds
    s_waitcnt lgkmcnt(0)
    s_barrier
    ds_read_b128 v[240:243], v43 offset:0
    ds_read_b128 v[244:247], v44 offset:0
    s_waitcnt lgkmcnt(1)
    v_mfma_f32_32x32x16_bf16 v[128:143], a[128:131], v[240:243], 0
    s_add_u32 m0, s44, 4096
    s_xor_b32 s45, s61, 9
    s_mulk_i32 s45, 14336
    buffer_load_dwordx4 v21, s[24:27], s45 offen lds
    s_lshl_b32 s51, s47, 1
    s_add_u32 s51, s51, s42
    v_mfma_f32_32x32x16_bf16 v[144:159], a[132:135], v[240:243], 0
    buffer_load_dwordx4 v22, s[24:27], s45 offen offset:1024 lds
    ds_read_b128 v[248:251], v43 offset:2048
    ds_read_b128 v[252:255], v44 offset:2048
    ds_read_b128 v[96:99], v43 offset:36864
    s_and_b32 s51, s51, 15
    v_mfma_f32_32x32x16_bf16 v[160:175], a[136:139], v[240:243], 0
    ds_read_b128 v[100:103], v44 offset:36864
    s_waitcnt vmcnt(11)
    ds_read_b64_tr_b16 a[224:225], v37 offset:16384
    s_lshl_b32 s3, s47, 13
    v_mfma_f32_32x32x16_bf16 v[176:191], a[140:143], v[240:243], 0
    buffer_load_dwordx4 v23, s[24:27], s45 offen offset:2048 lds
    ds_read_b64_tr_b16 a[228:229], v38 offset:16384
    ds_read_b64_tr_b16 a[232:233], v39 offset:16384
    ds_read_b64_tr_b16 a[236:237], v40 offset:16384
    s_add_u32 s3, s3, 65536
    s_waitcnt lgkmcnt(8)
    v_mfma_f32_32x32x16_bf16 v[192:207], a[128:131], v[244:247], 0
    s_waitcnt vmcnt(11)
    ds_read_b64_tr_b16 a[226:227], v37 offset:17408
    ds_read_b64_tr_b16 a[230:231], v38 offset:17408
    s_lshl_b32 s5, s51, 2
    v_mfma_f32_32x32x16_bf16 v[208:223], a[132:135], v[244:247], 0
    buffer_load_dwordx4 v24, s[24:27], s45 offen offset:3072 lds
    ds_read_b64_tr_b16 a[234:235], v39 offset:17408
    ds_read_b64_tr_b16 a[238:239], v40 offset:17408
    s_add_u32 s5, s5, s40
    v_mfma_f32_32x32x16_bf16 v[224:239], a[136:139], v[244:247], 0
    s_lshl_b32 s4, s5, 7
    s_waitcnt lgkmcnt(11)
    v_mfma_f32_32x32x16_bf16 v[128:143], a[144:147], v[248:251], v[128:143]
    s_add_u32 m0, s44, 8192
    s_xor_b32 s45, s61, 10
    s_mulk_i32 s45, 14336
    buffer_load_dwordx4 v21, s[24:27], s45 offen lds
    s_add_u32 s59, s3, s4
    v_mov_b32 v5, 1
    v_mfma_f32_32x32x16_bf16 v[144:159], a[148:151], v[248:251], v[144:159]
    buffer_load_dwordx4 v22, s[24:27], s45 offen offset:1024 lds
    ds_read_b128 v[240:243], v43 offset:4096
    ds_read_b128 v[244:247], v44 offset:4096
    ds_read_b128 v[104:107], v43 offset:38912
    v_mov_b32 v7, 0
    v_mfma_f32_32x32x16_bf16 v[160:175], a[152:155], v[248:251], v[160:175]
    ds_read_b128 v[108:111], v44 offset:38912
    s_waitcnt vmcnt(11)
    ds_read_b64_tr_b16 a[240:241], v37 offset:20480
    v_and_b32 v28, v28, v29
    v_mfma_f32_32x32x16_bf16 v[176:191], a[156:159], v[248:251], v[176:191]
    buffer_load_dwordx4 v23, s[24:27], s45 offen offset:2048 lds
    ds_read_b64_tr_b16 a[244:245], v38 offset:20480
    ds_read_b64_tr_b16 a[248:249], v39 offset:20480
    ds_read_b64_tr_b16 a[252:253], v40 offset:20480
    v_and_b32 v30, v30, v31
    s_waitcnt lgkmcnt(14)
    v_mfma_f32_32x32x16_bf16 v[192:207], a[144:147], v[252:255], v[192:207]
    s_waitcnt vmcnt(11)
    ds_read_b64_tr_b16 a[242:243], v37 offset:21504
    ds_read_b64_tr_b16 a[246:247], v38 offset:21504
    v_and_b32 v28, v28, v30
    v_mfma_f32_32x32x16_bf16 v[208:223], a[148:151], v[252:255], v[208:223]
    buffer_load_dwordx4 v24, s[24:27], s45 offen offset:3072 lds
    ds_read_b64_tr_b16 a[250:251], v39 offset:21504
    ds_read_b64_tr_b16 a[254:255], v40 offset:21504
    s_mul_i32 s6, s47, 917504
    v_mfma_f32_32x32x16_bf16 v[224:239], a[152:155], v[252:255], v[224:239]
    s_lshr_b32 s4, s5, 1
    s_waitcnt lgkmcnt(11)
    v_mfma_f32_32x32x16_bf16 v[128:143], a[160:163], v[240:243], v[128:143]
    s_add_u32 m0, s44, 12288
    s_xor_b32 s45, s61, 11
    s_mulk_i32 s45, 14336
    buffer_load_dwordx4 v21, s[24:27], s45 offen lds
    s_lshl_b32 s4, s4, 15
    s_add_u32 s6, s6, s4
    v_mfma_f32_32x32x16_bf16 v[144:159], a[164:167], v[240:243], v[144:159]
    buffer_load_dwordx4 v22, s[24:27], s45 offen offset:1024 lds
    ds_read_b128 v[248:251], v43 offset:6144
    ds_read_b128 v[252:255], v44 offset:6144
    ds_read_b128 v[112:115], v43 offset:49152
    s_lshl_b32 s4, s50, 10
    v_mfma_f32_32x32x16_bf16 v[160:175], a[168:171], v[240:243], v[160:175]
    ds_read_b128 v[116:119], v44 offset:49152
    s_waitcnt vmcnt(11)
    ds_read_b64_tr_b16 a[0:1], v37 offset:0
    s_add_u32 s6, s6, s4
    v_mfma_f32_32x32x16_bf16 v[176:191], a[172:175], v[240:243], v[176:191]
    buffer_load_dwordx4 v23, s[24:27], s45 offen offset:2048 lds
    ds_read_b64_tr_b16 a[4:5], v38 offset:0
    ds_read_b64_tr_b16 a[8:9], v39 offset:0
    ds_read_b64_tr_b16 a[12:13], v40 offset:0
    s_add_u32 s6, s6, 1048576
    s_waitcnt lgkmcnt(14)
    v_mfma_f32_32x32x16_bf16 v[192:207], a[160:163], v[244:247], v[192:207]
    s_waitcnt vmcnt(11)
    ds_read_b64_tr_b16 a[2:3], v37 offset:1024
    ds_read_b64_tr_b16 a[6:7], v38 offset:1024
    s_lshl_b32 s7, s43, 1
    v_mfma_f32_32x32x16_bf16 v[208:223], a[164:167], v[244:247], v[208:223]
    buffer_load_dwordx4 v24, s[24:27], s45 offen offset:3072 lds
    ds_read_b64_tr_b16 a[10:11], v39 offset:1024
    ds_read_b64_tr_b16 a[14:15], v40 offset:1024
    s_and_b32 s4, s51, 1
    v_mfma_f32_32x32x16_bf16 v[224:239], a[168:171], v[244:247], v[224:239]
    s_add_u32 s7, s7, s4
    s_waitcnt lgkmcnt(11)
    v_mfma_f32_32x32x16_bf16 v[128:143], a[176:179], v[248:251], v[128:143]
    s_add_u32 m0, s44, 16384
    s_xor_b32 s45, s61, 12
    s_mulk_i32 s45, 14336
    buffer_load_dwordx4 v21, s[24:27], s45 offen lds
    s_mul_i32 s7, s7, 57344
    s_mul_i32 s4, s41, 896
    v_mfma_f32_32x32x16_bf16 v[144:159], a[180:183], v[248:251], v[144:159]
    buffer_load_dwordx4 v22, s[24:27], s45 offen offset:1024 lds
    ds_read_b128 v[240:243], v43 offset:16384
    ds_read_b128 v[244:247], v44 offset:16384
    ds_read_b128 v[120:123], v43 offset:51200
    s_add_u32 s7, s7, s4
    v_mfma_f32_32x32x16_bf16 v[160:175], a[184:187], v[248:251], v[160:175]
    ds_read_b128 v[124:127], v44 offset:51200
    s_waitcnt vmcnt(11)
    ds_read_b64_tr_b16 a[16:17], v37 offset:4096
    s_lshr_b32 s4, s51, 1
    v_mfma_f32_32x32x16_bf16 v[176:191], a[188:191], v[248:251], v[176:191]
    buffer_load_dwordx4 v23, s[24:27], s45 offen offset:2048 lds
    ds_read_b64_tr_b16 a[20:21], v38 offset:4096
    ds_read_b64_tr_b16 a[24:25], v39 offset:4096
    ds_read_b64_tr_b16 a[28:29], v40 offset:4096
    s_lshl_b32 s4, s4, 7
    s_waitcnt lgkmcnt(14)
    v_mfma_f32_32x32x16_bf16 v[192:207], a[176:179], v[252:255], v[192:207]
    s_waitcnt vmcnt(11)
    ds_read_b64_tr_b16 a[18:19], v37 offset:5120
    ds_read_b64_tr_b16 a[22:23], v38 offset:5120
    s_add_u32 s7, s7, s4
    v_mfma_f32_32x32x16_bf16 v[208:223], a[180:183], v[252:255], v[208:223]
    buffer_load_dwordx4 v24, s[24:27], s45 offen offset:3072 lds
    ds_read_b64_tr_b16 a[26:27], v39 offset:5120
    ds_read_b64_tr_b16 a[30:31], v40 offset:5120
    s_lshl_b32 s4, s40, 5
    v_mfma_f32_32x32x16_bf16 v[224:239], a[184:187], v[252:255], v[224:239]
    s_add_u32 s7, s7, s4
    s_waitcnt lgkmcnt(11)
    v_mfma_f32_32x32x16_bf16 v[128:143], a[192:195], v[240:243], v[128:143]
    s_add_u32 m0, s44, 20480
    s_xor_b32 s45, s61, 13
    s_mulk_i32 s45, 14336
    buffer_load_dwordx4 v21, s[24:27], s45 offen lds
    v_and_b32 v2, 31, v1
    v_mul_u32_u24 v2, 1792, v2
    v_mfma_f32_32x32x16_bf16 v[144:159], a[196:199], v[240:243], v[144:159]
    buffer_load_dwordx4 v22, s[24:27], s45 offen offset:1024 lds
    ds_read_b128 v[248:251], v43 offset:18432
    ds_read_b128 v[252:255], v44 offset:18432
    ds_read_b128 v[64:67], v43 offset:53248
    v_lshrrev_b32 v3, 5, v1
    v_mfma_f32_32x32x16_bf16 v[160:175], a[200:203], v[240:243], v[160:175]
    ds_read_b128 v[68:71], v44 offset:53248
    s_waitcnt vmcnt(11)
    ds_read_b64_tr_b16 a[32:33], v37 offset:8192
    v_lshl_add_u32 v2, v3, 4, v2
    v_mfma_f32_32x32x16_bf16 v[176:191], a[204:207], v[240:243], v[176:191]
    buffer_load_dwordx4 v23, s[24:27], s45 offen offset:2048 lds
    ds_read_b64_tr_b16 a[36:37], v38 offset:8192
    ds_read_b64_tr_b16 a[40:41], v39 offset:8192
    ds_read_b64_tr_b16 a[44:45], v40 offset:8192
    v_bfe_u32 v9, v1, 2, 1
    s_waitcnt lgkmcnt(14)
    v_mfma_f32_32x32x16_bf16 v[192:207], a[192:195], v[244:247], v[192:207]
    s_waitcnt vmcnt(11)
    ds_read_b64_tr_b16 a[34:35], v37 offset:9216
    ds_read_b64_tr_b16 a[38:39], v38 offset:9216
    v_xor_b32 v9, v9, v3
    v_mfma_f32_32x32x16_bf16 v[208:223], a[196:199], v[244:247], v[208:223]
    buffer_load_dwordx4 v24, s[24:27], s45 offen offset:3072 lds
    ds_read_b64_tr_b16 a[42:43], v39 offset:9216
    ds_read_b64_tr_b16 a[46:47], v40 offset:9216
    v_bfe_u32 v10, v1, 4, 1
    v_mfma_f32_32x32x16_bf16 v[224:239], a[200:203], v[244:247], v[224:239]
    v_or_b32 v9, v9, v10
    s_waitcnt lgkmcnt(11)
    v_mfma_f32_32x32x16_bf16 v[128:143], a[208:211], v[248:251], v[128:143]
    s_add_u32 m0, s44, 0
    s_xor_b32 s45, s61, 14
    s_mulk_i32 s45, 14336
    buffer_load_dwordx4 v21, s[24:27], s45 offen lds
    v_lshlrev_b32 v9, 2, v9
    v_bfe_u32 v10, v1, 3, 1
    v_mfma_f32_32x32x16_bf16 v[144:159], a[212:215], v[248:251], v[144:159]
    buffer_load_dwordx4 v22, s[24:27], s45 offen offset:1024 lds
    ds_read_b128 v[240:243], v43 offset:20480
    ds_read_b128 v[244:247], v44 offset:20480
    ds_read_b128 v[72:75], v43 offset:55296
    v_lshl_add_u32 v9, v10, 1, v9
    v_mfma_f32_32x32x16_bf16 v[160:175], a[216:219], v[248:251], v[160:175]
    ds_read_b128 v[76:79], v44 offset:55296
    s_waitcnt vmcnt(11)
    ds_read_b64_tr_b16 a[48:49], v37 offset:12288
    v_bfe_u32 v10, v1, 1, 1
    v_mfma_f32_32x32x16_bf16 v[176:191], a[220:223], v[248:251], v[176:191]
    buffer_load_dwordx4 v23, s[24:27], s45 offen offset:2048 lds
    ds_read_b64_tr_b16 a[52:53], v38 offset:12288
    ds_read_b64_tr_b16 a[56:57], v39 offset:12288
    ds_read_b64_tr_b16 a[60:61], v40 offset:12288
    v_add_u32 v9, v9, v10
    s_waitcnt lgkmcnt(14)
    v_mfma_f32_32x32x16_bf16 v[192:207], a[208:211], v[252:255], v[192:207]
    s_waitcnt vmcnt(11)
    ds_read_b64_tr_b16 a[50:51], v37 offset:13312
    ds_read_b64_tr_b16 a[54:55], v38 offset:13312
    v_and_b32 v10, 1, v1
    v_mfma_f32_32x32x16_bf16 v[208:223], a[212:215], v[252:255], v[208:223]
    buffer_load_dwordx4 v24, s[24:27], s45 offen offset:3072 lds
    ds_read_b64_tr_b16 a[58:59], v39 offset:13312
    ds_read_b64_tr_b16 a[62:63], v40 offset:13312
    v_lshlrev_b32 v10, 4, v10
    v_mfma_f32_32x32x16_bf16 v[224:239], a[216:219], v[252:255], v[224:239]
    v_mov_b32 v11, 0x3f80
    s_waitcnt lgkmcnt(11)
    v_mfma_f32_32x32x16_bf16 v[128:143], a[224:227], v[240:243], v[128:143]
    s_add_u32 m0, s44, 4096
    s_xor_b32 s45, s61, 15
    s_mulk_i32 s45, 14336
    buffer_load_dwordx4 v21, s[24:27], s45 offen lds
    v_lshlrev_b32 v10, v10, v11
    v_cmp_eq_u32 vcc, 0, v9
    v_mfma_f32_32x32x16_bf16 v[144:159], a[228:231], v[240:243], v[144:159]
    buffer_load_dwordx4 v22, s[24:27], s45 offen offset:1024 lds
    ds_read_b128 v[248:251], v43 offset:22528
    ds_read_b128 v[252:255], v44 offset:22528
    v_cndmask_b32 v16, 0, v10, vcc
    v_mfma_f32_32x32x16_bf16 v[160:175], a[232:235], v[240:243], v[160:175]
    s_waitcnt vmcnt(11)
    ds_read_b64_tr_b16 a[64:65], v37 offset:16384
    ds_read_b64_tr_b16 a[68:69], v38 offset:16384
    v_cmp_eq_u32 vcc, 1, v9
    v_mfma_f32_32x32x16_bf16 v[176:191], a[236:239], v[240:243], v[176:191]
    buffer_load_dwordx4 v23, s[24:27], s45 offen offset:2048 lds
    ds_read_b64_tr_b16 a[72:73], v39 offset:16384
    ds_read_b64_tr_b16 a[76:77], v40 offset:16384
    v_cndmask_b32 v17, 0, v10, vcc
    s_waitcnt lgkmcnt(14)
    v_mfma_f32_32x32x16_bf16 v[192:207], a[224:227], v[244:247], v[192:207]
    s_waitcnt vmcnt(11)
    ds_read_b64_tr_b16 a[66:67], v37 offset:17408
    ds_read_b64_tr_b16 a[70:71], v38 offset:17408
    v_cmp_eq_u32 vcc, 2, v9
    v_mfma_f32_32x32x16_bf16 v[208:223], a[228:231], v[244:247], v[208:223]
    buffer_load_dwordx4 v24, s[24:27], s45 offen offset:3072 lds
    ds_read_b64_tr_b16 a[74:75], v39 offset:17408
    ds_read_b64_tr_b16 a[78:79], v40 offset:17408
    v_cndmask_b32 v18, 0, v10, vcc
    v_mfma_f32_32x32x16_bf16 v[224:239], a[232:235], v[244:247], v[224:239]
    v_cmp_eq_u32 vcc, 3, v9
    s_waitcnt lgkmcnt(9)
    v_mfma_f32_32x32x16_bf16 v[128:143], a[240:243], v[248:251], v[128:143]
    v_cndmask_b32 v19, 0, v10, vcc
    v_mfma_f32_32x32x16_bf16 v[144:159], a[244:247], v[248:251], v[144:159]
    ds_read_b128 v[240:243], v43 offset:32768
    ds_read_b128 v[244:247], v44 offset:32768
    v_mfma_f32_32x32x16_bf16 v[160:175], a[248:251], v[248:251], v[160:175]
    s_waitcnt vmcnt(9)
    ds_read_b64_tr_b16 a[80:81], v37 offset:20480
    ds_read_b64_tr_b16 a[84:85], v38 offset:20480
    v_mfma_f32_32x32x16_bf16 v[176:191], a[252:255], v[248:251], v[176:191]
    ds_read_b64_tr_b16 a[88:89], v39 offset:20480
    ds_read_b64_tr_b16 a[92:93], v40 offset:20480
    s_waitcnt lgkmcnt(14)
    v_mfma_f32_32x32x16_bf16 v[192:207], a[240:243], v[252:255], v[192:207]
    s_waitcnt vmcnt(8)
    ds_read_b64_tr_b16 a[82:83], v37 offset:21504
    ds_read_b64_tr_b16 a[86:87], v38 offset:21504
    v_mfma_f32_32x32x16_bf16 v[208:223], a[244:247], v[252:255], v[208:223]
    ds_read_b64_tr_b16 a[90:91], v39 offset:21504
    ds_read_b64_tr_b16 a[94:95], v40 offset:21504
    v_mfma_f32_32x32x16_bf16 v[224:239], a[248:251], v[252:255], v[224:239]
    s_waitcnt lgkmcnt(9)
    v_mfma_f32_32x32x16_bf16 v[128:143], a[0:3], v[240:243], v[128:143]
    v_mfma_f32_32x32x16_bf16 v[144:159], a[4:7], v[240:243], v[144:159]
    ds_read_b128 v[248:251], v43 offset:34816
    ds_read_b128 v[252:255], v44 offset:34816
    v_mfma_f32_32x32x16_bf16 v[160:175], a[8:11], v[240:243], v[160:175]
    s_waitcnt vmcnt(5)
    ds_read_b64_tr_b16 a[96:97], v37 offset:0
    ds_read_b64_tr_b16 a[100:101], v38 offset:0
    v_mfma_f32_32x32x16_bf16 v[176:191], a[12:15], v[240:243], v[176:191]
    ds_read_b64_tr_b16 a[104:105], v39 offset:0
    ds_read_b64_tr_b16 a[108:109], v40 offset:0
    s_waitcnt lgkmcnt(14)
    v_mfma_f32_32x32x16_bf16 v[192:207], a[0:3], v[244:247], v[192:207]
    s_waitcnt vmcnt(4)
    ds_read_b64_tr_b16 a[98:99], v37 offset:1024
    ds_read_b64_tr_b16 a[102:103], v38 offset:1024
    v_mfma_f32_32x32x16_bf16 v[208:223], a[4:7], v[244:247], v[208:223]
    ds_read_b64_tr_b16 a[106:107], v39 offset:1024
    ds_read_b64_tr_b16 a[110:111], v40 offset:1024
    v_mfma_f32_32x32x16_bf16 v[224:239], a[8:11], v[244:247], v[224:239]
    s_waitcnt lgkmcnt(9)
    v_mfma_f32_32x32x16_bf16 v[128:143], a[16:19], v[248:251], v[128:143]
    v_mfma_f32_32x32x16_bf16 v[144:159], a[20:23], v[248:251], v[144:159]
    s_waitcnt vmcnt(1)
    ds_read_b64_tr_b16 a[112:113], v37 offset:4096
    ds_read_b64_tr_b16 a[116:117], v38 offset:4096
    v_mfma_f32_32x32x16_bf16 v[160:175], a[24:27], v[248:251], v[160:175]
    ds_read_b64_tr_b16 a[120:121], v39 offset:4096
    ds_read_b64_tr_b16 a[124:125], v40 offset:4096
    v_mfma_f32_32x32x16_bf16 v[176:191], a[28:31], v[248:251], v[176:191]
    s_waitcnt vmcnt(0)
    ds_read_b64_tr_b16 a[114:115], v37 offset:5120
    s_waitcnt lgkmcnt(13)
    v_mfma_f32_32x32x16_bf16 v[192:207], a[16:19], v[252:255], v[192:207]
    ds_read_b64_tr_b16 a[118:119], v38 offset:5120
    ds_read_b64_tr_b16 a[122:123], v39 offset:5120
    v_mfma_f32_32x32x16_bf16 v[208:223], a[20:23], v[252:255], v[208:223]
    ds_read_b64_tr_b16 a[126:127], v40 offset:5120
    v_mfma_f32_32x32x16_bf16 v[224:239], a[24:27], v[252:255], v[224:239]
    v_mfma_f32_32x32x16_bf16 v[128:143], a[32:35], v[96:99], v[128:143]
    v_mfma_f32_32x32x16_bf16 v[128:143], a[48:51], v[104:107], v[128:143]
    v_mfma_f32_32x32x16_bf16 v[128:143], a[64:67], v[112:115], v[128:143]
    v_mfma_f32_32x32x16_bf16 v[128:143], a[80:83], v[120:123], v[128:143]
    s_waitcnt lgkmcnt(11)
    v_mfma_f32_32x32x16_bf16 v[128:143], a[96:99], v[64:67], v[128:143]
    s_waitcnt lgkmcnt(3)
    v_mfma_f32_32x32x16_bf16 v[128:143], a[112:115], v[72:75], v[128:143]
    v_mfma_f32_32x32x16_bf16 v[144:159], a[36:39], v[96:99], v[144:159]
    v_mfma_f32_32x32x16_bf16 v[144:159], a[52:55], v[104:107], v[144:159]
    s_nop 9
    v_cvt_pk_bf16_f32 v48, v128, v129
    v_cvt_pk_bf16_f32 v49, v130, v131
    v_mfma_f32_32x32x16_bf16 v[144:159], a[68:71], v[112:115], v[144:159]
    v_cvt_pk_bf16_f32 v50, v132, v133
    v_cvt_pk_bf16_f32 v51, v134, v135
    v_mfma_f32_32x32x16_bf16 v[144:159], a[84:87], v[120:123], v[144:159]
    buffer_store_dwordx4 v[48:51], v41, s[28:31], s52 offen sc0 sc1
    v_cvt_pk_bf16_f32 v52, v136, v137
    v_mfma_f32_32x32x16_bf16 v[144:159], a[100:103], v[64:67], v[144:159]
    v_cvt_pk_bf16_f32 v53, v138, v139
    v_cvt_pk_bf16_f32 v54, v140, v141
    s_waitcnt lgkmcnt(2)
    v_mfma_f32_32x32x16_bf16 v[144:159], a[116:119], v[72:75], v[144:159]
    v_cvt_pk_bf16_f32 v55, v142, v143
    buffer_store_dwordx4 v[52:55], v41, s[28:31], s52 offen offset:1024 sc0 sc1
    v_mfma_f32_32x32x16_bf16 v[160:175], a[40:43], v[96:99], v[160:175]
    v_mfma_f32_32x32x16_bf16 v[160:175], a[56:59], v[104:107], v[160:175]
    s_nop 7
    v_cvt_pk_bf16_f32 v56, v144, v145
    v_cvt_pk_bf16_f32 v57, v146, v147
    v_mfma_f32_32x32x16_bf16 v[160:175], a[72:75], v[112:115], v[160:175]
    v_cvt_pk_bf16_f32 v58, v148, v149
    v_cvt_pk_bf16_f32 v59, v150, v151
    v_mfma_f32_32x32x16_bf16 v[160:175], a[88:91], v[120:123], v[160:175]
    buffer_store_dwordx4 v[56:59], v41, s[28:31], s54 offen sc0 sc1
    v_cvt_pk_bf16_f32 v60, v152, v153
    v_mfma_f32_32x32x16_bf16 v[160:175], a[104:107], v[64:67], v[160:175]
    v_cvt_pk_bf16_f32 v61, v154, v155
    v_cvt_pk_bf16_f32 v62, v156, v157
    s_waitcnt lgkmcnt(1)
    v_mfma_f32_32x32x16_bf16 v[160:175], a[120:123], v[72:75], v[160:175]
    v_cvt_pk_bf16_f32 v63, v158, v159
    buffer_store_dwordx4 v[60:63], v41, s[28:31], s54 offen offset:1024 sc0 sc1
    v_mfma_f32_32x32x16_bf16 v[176:191], a[44:47], v[96:99], v[176:191]
    v_mfma_f32_32x32x16_bf16 v[176:191], a[60:63], v[104:107], v[176:191]
    s_nop 7
    v_cvt_pk_bf16_f32 v32, v160, v161
    v_cvt_pk_bf16_f32 v33, v162, v163
    v_mfma_f32_32x32x16_bf16 v[176:191], a[76:79], v[112:115], v[176:191]
    v_cvt_pk_bf16_f32 v34, v164, v165
    v_cvt_pk_bf16_f32 v35, v166, v167
    v_mfma_f32_32x32x16_bf16 v[176:191], a[92:95], v[120:123], v[176:191]
    buffer_store_dwordx4 v[32:35], v41, s[28:31], s56 offen sc0 sc1
    v_cvt_pk_bf16_f32 v36, v168, v169
    v_mfma_f32_32x32x16_bf16 v[176:191], a[108:111], v[64:67], v[176:191]
    v_cvt_pk_bf16_f32 v37, v170, v171
    v_cvt_pk_bf16_f32 v38, v172, v173
    s_waitcnt lgkmcnt(0)
    v_mfma_f32_32x32x16_bf16 v[176:191], a[124:127], v[72:75], v[176:191]
    v_cvt_pk_bf16_f32 v39, v174, v175
    buffer_store_dwordx4 v[36:39], v41, s[28:31], s56 offen offset:1024 sc0 sc1
    v_mfma_f32_32x32x16_bf16 v[192:207], a[32:35], v[100:103], v[192:207]
    v_mfma_f32_32x32x16_bf16 v[192:207], a[48:51], v[108:111], v[192:207]
    s_nop 7
    v_cvt_pk_bf16_f32 v48, v176, v177
    v_cvt_pk_bf16_f32 v49, v178, v179
    v_mfma_f32_32x32x16_bf16 v[192:207], a[64:67], v[116:119], v[192:207]
    v_cvt_pk_bf16_f32 v50, v180, v181
    v_cvt_pk_bf16_f32 v51, v182, v183
    v_mfma_f32_32x32x16_bf16 v[192:207], a[80:83], v[124:127], v[192:207]
    buffer_store_dwordx4 v[48:51], v41, s[28:31], s58 offen sc0 sc1
    v_cvt_pk_bf16_f32 v52, v184, v185
    v_mfma_f32_32x32x16_bf16 v[192:207], a[96:99], v[68:71], v[192:207]
    v_cvt_pk_bf16_f32 v53, v186, v187
    v_cvt_pk_bf16_f32 v54, v188, v189
    v_mfma_f32_32x32x16_bf16 v[192:207], a[112:115], v[76:79], v[192:207]
    v_cvt_pk_bf16_f32 v55, v190, v191
    buffer_store_dwordx4 v[52:55], v41, s[28:31], s58 offen offset:1024 sc0 sc1
    v_mfma_f32_32x32x16_bf16 v[208:223], a[36:39], v[100:103], v[208:223]
    v_mfma_f32_32x32x16_bf16 v[208:223], a[52:55], v[108:111], v[208:223]
    s_nop 7
    v_cvt_pk_bf16_f32 v56, v192, v193
    v_cvt_pk_bf16_f32 v57, v194, v195
    v_mfma_f32_32x32x16_bf16 v[208:223], a[68:71], v[116:119], v[208:223]
    v_cvt_pk_bf16_f32 v58, v196, v197
    v_cvt_pk_bf16_f32 v59, v198, v199
    v_mfma_f32_32x32x16_bf16 v[208:223], a[84:87], v[124:127], v[208:223]
    buffer_store_dwordx4 v[56:59], v41, s[28:31], s53 offen sc0 sc1
    v_cvt_pk_bf16_f32 v60, v200, v201
    v_mfma_f32_32x32x16_bf16 v[208:223], a[100:103], v[68:71], v[208:223]
    v_cvt_pk_bf16_f32 v61, v202, v203
    v_cvt_pk_bf16_f32 v62, v204, v205
    v_mfma_f32_32x32x16_bf16 v[208:223], a[116:119], v[76:79], v[208:223]
    v_cvt_pk_bf16_f32 v63, v206, v207
    buffer_store_dwordx4 v[60:63], v41, s[28:31], s53 offen offset:1024 sc0 sc1
    v_mfma_f32_32x32x16_bf16 v[224:239], a[40:43], v[100:103], v[224:239]
    v_mfma_f32_32x32x16_bf16 v[224:239], a[56:59], v[108:111], v[224:239]
    s_nop 7
    v_cvt_pk_bf16_f32 v32, v208, v209
    v_cvt_pk_bf16_f32 v33, v210, v211
    v_mfma_f32_32x32x16_bf16 v[224:239], a[72:75], v[116:119], v[224:239]
    v_cvt_pk_bf16_f32 v34, v212, v213
    v_cvt_pk_bf16_f32 v35, v214, v215
    v_mfma_f32_32x32x16_bf16 v[224:239], a[88:91], v[124:127], v[224:239]
    buffer_store_dwordx4 v[32:35], v41, s[28:31], s55 offen sc0 sc1
    v_cvt_pk_bf16_f32 v36, v216, v217
    v_mfma_f32_32x32x16_bf16 v[224:239], a[104:107], v[68:71], v[224:239]
    v_cvt_pk_bf16_f32 v37, v218, v219
    v_cvt_pk_bf16_f32 v38, v220, v221
    v_mfma_f32_32x32x16_bf16 v[224:239], a[120:123], v[76:79], v[224:239]
    v_cvt_pk_bf16_f32 v39, v222, v223
    buffer_store_dwordx4 v[36:39], v41, s[28:31], s55 offen offset:1024 sc0 sc1
    s_nop 9
    v_cvt_pk_bf16_f32 v48, v224, v225
    v_cvt_pk_bf16_f32 v49, v226, v227
    v_cvt_pk_bf16_f32 v50, v228, v229
    v_cvt_pk_bf16_f32 v51, v230, v231
    buffer_store_dwordx4 v[48:51], v41, s[28:31], s57 offen sc0 sc1
    v_cvt_pk_bf16_f32 v52, v232, v233
    v_cvt_pk_bf16_f32 v53, v234, v235
    v_cvt_pk_bf16_f32 v54, v236, v237
    v_cvt_pk_bf16_f32 v55, v238, v239
    buffer_store_dwordx4 v[52:55], v41, s[28:31], s57 offen offset:1024 sc0 sc1
    v_cmp_eq_u32 vcc, 1, v28
    s_mov_b32 s5, 100000
    s_nop 2
    s_cbranch_vccnz L_go1
L_ready1:
    buffer_load_dwordx4 v[28:31], v7, s[36:39], s60 offen sc0 sc1
    s_sub_u32 s5, s5, 1
    s_cmp_eq_u32 s5, 0
    s_waitcnt vmcnt(0)
    s_cbranch_scc1 L_go1
    v_and_b32 v28, v28, v29
    v_and_b32 v30, v30, v31
    v_and_b32 v28, v28, v30
    v_cmp_eq_u32 vcc, 1, v28
    s_nop 3
    s_cbranch_vccz L_ready1
L_go1:
    s_mov_b64 exec, 0x333
    s_waitcnt vmcnt(8)
    buffer_atomic_add v5, v4, s[28:31], s3 offen sc1
    s_mov_b64 exec, 0x300c
    s_waitcnt vmcnt(5)
    buffer_atomic_add v5, v4, s[28:31], s3 offen sc1
    s_mov_b64 exec, 0xcc0
    s_waitcnt vmcnt(2)
    buffer_atomic_add v5, v4, s[28:31], s3 offen sc1
    s_mov_b64 exec, -1
    s_cmp_ge_u32 s51, 14
    s_cbranch_scc1 L_fin1
    s_mov_b32 s5, 100000
    s_mov_b64 exec, 1
L_poll1:
    s_nop 0
    v_mov_b32 v3, 0
    buffer_atomic_add v3, v7, s[28:31], s59 offen sc0 sc1
    s_waitcnt vmcnt(0)
    v_cmp_eq_u32 vcc, 16, v3
    s_nop 3
    s_cbranch_vccnz L_polled1
    s_sub_u32 s5, s5, 1
    s_cmp_lg_u32 s5, 0
    s_cbranch_scc1 L_poll1
L_polled1:
    s_mov_b64 exec, -1
    s_nop 0
    buffer_load_dwordx4 v[64:67], v41, s[28:31], s6 offen sc0 sc1
    buffer_load_dwordx4 v[68:71], v41, s[28:31], s6 offen offset:2048 sc0 sc1
    s_addk_i32 s6, 4096
    buffer_load_dwordx4 v[72:75], v41, s[28:31], s6 offen sc0 sc1
    buffer_load_dwordx4 v[76:79], v41, s[28:31], s6 offen offset:2048 sc0 sc1
    s_addk_i32 s6, 4096
    buffer_load_dwordx4 v[80:83], v41, s[28:31], s6 offen sc0 sc1
    buffer_load_dwordx4 v[84:87], v41, s[28:31], s6 offen offset:2048 sc0 sc1
    s_addk_i32 s6, 4096
    buffer_load_dwordx4 v[88:91], v41, s[28:31], s6 offen sc0 sc1
    buffer_load_dwordx4 v[92:95], v41, s[28:31], s6 offen offset:2048 sc0 sc1
    s_addk_i32 s6, 4096
    buffer_load_dwordx4 v[96:99], v41, s[28:31], s6 offen sc0 sc1
    buffer_load_dwordx4 v[100:103], v41, s[28:31], s6 offen offset:2048 sc0 sc1
    s_addk_i32 s6, 4096
    buffer_load_dwordx4 v[104:107], v41, s[28:31], s6 offen sc0 sc1
    buffer_load_dwordx4 v[108:111], v41, s[28:31], s6 offen offset:2048 sc0 sc1
    s_addk_i32 s6, 4096
    buffer_load_dwordx4 v[112:115], v41, s[28:31], s6 offen sc0 sc1
    buffer_load_dwordx4 v[116:119], v41, s[28:31], s6 offen offset:2048 sc0 sc1
    s_addk_i32 s6, 4096
    buffer_load_dwordx4 v[120:123], v41, s[28:31], s6 offen sc0 sc1
    buffer_load_dwordx4 v[124:127], v41, s[28:31], s6 offen offset:2048 sc0 sc1
    s_waitcnt vmcnt(15)
    v_mfma_f32_32x32x16_bf16 v[128:143], v[16:19], v[64:67], 0
    s_waitcnt vmcnt(14)
    v_mfma_f32_32x32x16_bf16 v[128:143], v[16:19], v[68:71], v[128:143]
    s_waitcnt vmcnt(13)
    v_mfma_f32_32x32x16_bf16 v[128:143], v[16:19], v[72:75], v[128:143]
    s_waitcnt vmcnt(12)
    v_mfma_f32_32x32x16_bf16 v[128:143], v[16:19], v[76:79], v[128:143]
    s_waitcnt vmcnt(11)
    v_mfma_f32_32x32x16_bf16 v[128:143], v[16:19], v[80:83], v[128:143]
    s_waitcnt vmcnt(10)
    v_mfma_f32_32x32x16_bf16 v[128:143], v[16:19], v[84:87], v[128:143]
    s_waitcnt vmcnt(9)
    v_mfma_f32_32x32x16_bf16 v[128:143], v[16:19], v[88:91], v[128:143]
    s_waitcnt vmcnt(8)
    v_mfma_f32_32x32x16_bf16 v[128:143], v[16:19], v[92:95], v[128:143]
    s_waitcnt vmcnt(7)
    v_mfma_f32_32x32x16_bf16 v[128:143], v[16:19], v[96:99], v[128:143]
    s_waitcnt vmcnt(6)
    v_mfma_f32_32x32x16_bf16 v[128:143], v[16:19], v[100:103], v[128:143]
    s_waitcnt vmcnt(5)
    v_mfma_f32_32x32x16_bf16 v[128:143], v[16:19], v[104:107], v[128:143]
    s_waitcnt vmcnt(4)
    v_mfma_f32_32x32x16_bf16 v[128:143], v[16:19], v[108:111], v[128:143]
    s_waitcnt vmcnt(3)
    v_mfma_f32_32x32x16_bf16 v[128:143], v[16:19], v[112:115], v[128:143]
    s_waitcnt vmcnt(2)
    v_mfma_f32_32x32x16_bf16 v[128:143], v[16:19], v[116:119], v[128:143]
    s_waitcnt vmcnt(1)
    v_mfma_f32_32x32x16_bf16 v[128:143], v[16:19], v[120:123], v[128:143]
    s_waitcnt vmcnt(0)
    v_mfma_f32_32x32x16_bf16 v[128:143], v[16:19], v[124:127], v[128:143]
    s_nop 11
    v_cvt_pk_bf16_f32 v56, v128, v129
    v_cvt_pk_bf16_f32 v57, v130, v131
    v_cvt_pk_bf16_f32 v58, v132, v133
    v_cvt_pk_bf16_f32 v59, v134, v135
    buffer_store_dwordx4 v[56:59], v2, s[32:35], s7 offen
L_fin1:
    s_endpgm
.p2align 6
L_class2:
    s_waitcnt vmcnt(8)
    s_barrier
    s_cmp_lg_u32 s42, 15
    s_cbranch_scc1 L_noset2
    s_lshl_b32 s3, s40, 2
    s_add_u32 s3, s3, s60
    v_mov_b32 v2, 0
    v_mov_b32 v3, 1
    s_mov_b64 exec, 1
    s_nop 0
    buffer_store_dword v3, v2, s[36:39], s3 offen sc0 sc1
    s_mov_b64 exec, -1
L_noset2:
    s_add_u32 m0, s44, 8192
    s_xor_b32 s45, s69, 0
    buffer_load_dwordx4 v13, s[12:15], s45 offen nt lds
    buffer_load_dwordx4 v14, s[12:15], s45 offen offset:1024 nt lds
    buffer_load_dwordx4 v15, s[12:15], s45 offen offset:2048 nt lds
    buffer_load_dwordx4 v16, s[12:15], s45 offen offset:3072 nt lds
    s_add_u32 m0, s44, 12288
    s_xor_b32 s45, s69, 128
    buffer_load_dwordx4 v13, s[12:15], s45 offen nt lds
    buffer_load_dwordx4 v14, s[12:15], s45 offen offset:1024 nt lds
    buffer_load_dwordx4 v15, s[12:15], s45 offen offset:2048 nt lds
    buffer_load_dwordx4 v16, s[12:15], s45 offen offset:3072 nt lds
    s_mul_i32 s3, s47, 917504
    s_mul_i32 s4, s42, 2048
    s_add_u32 s3, s3, s4
    s_add_u32 s3, s3, 1048576
    s_lshr_b32 s4, s40, 1
    s_mul_i32 s4, s4, 7
    s_mul_i32 s5, s50, 3
    s_add_u32 s4, s4, s5
    s_waitcnt vmcnt(14)
    ds_read_b64_tr_b16 v[64:65], v29 offset:0
    ds_read_b64_tr_b16 v[66:67], v29 offset:512
    ds_read_b128 v[80:83], v25 offset:0
    ds_read_b64_tr_b16 v[68:69], v30 offset:0
    ds_read_b64_tr_b16 v[70:71], v30 offset:512
    ds_read_b128 v[84:87], v25 offset:4096
    s_waitcnt vmcnt(12)
    ds_read_b64_tr_b16 v[72:73], v29 offset:2048
    ds_read_b64_tr_b16 v[74:75], v29 offset:2560
    ds_read_b128 v[88:91], v26 offset:0
    ds_read_b64_tr_b16 v[76:77], v30 offset:2048
    ds_read_b64_tr_b16 v[78:79], v30 offset:2560
    ds_read_b128 v[92:95], v26 offset:4096
    s_add_u32 m0, s44, 16384
    s_xor_b32 s45, s69, 256
    buffer_load_dwordx4 v13, s[12:15], s45 offen nt lds
    buffer_load_dwordx4 v14, s[12:15], s45 offen offset:1024 nt lds
    buffer_load_dwordx4 v15, s[12:15], s45 offen offset:2048 nt lds
    buffer_load_dwordx4 v16, s[12:15], s45 offen offset:3072 nt lds
    s_waitcnt lgkmcnt(9)
    v_mfma_f32_32x32x16_bf16 v[128:143], v[64:67], v[80:83], 0
    s_lshl_b32 s7, s50, 1
    s_waitcnt lgkmcnt(7)
    v_mfma_f32_32x32x16_bf16 v[160:175], v[68:71], v[80:83], 0
    s_waitcnt vmcnt(14)
    ds_read_b64_tr_b16 v[96:97], v29 offset:4096
    ds_read_b64_tr_b16 v[98:99], v29 offset:4608
    v_mov_b32 v4, 0
    s_waitcnt lgkmcnt(8)
    v_mfma_f32_32x32x16_bf16 v[144:159], v[64:67], v[84:87], 0
    ds_read_b128 v[112:115], v27 offset:0
    ds_read_b64_tr_b16 v[100:101], v30 offset:4096
    s_add_u32 s5, s50, 0
    v_mfma_f32_32x32x16_bf16 v[176:191], v[68:71], v[84:87], 0
    ds_read_b64_tr_b16 v[102:103], v30 offset:4608
    ds_read_b128 v[116:119], v27 offset:4096
    s_and_b32 s5, s5, 3
    s_waitcnt lgkmcnt(9)
    v_mfma_f32_32x32x16_bf16 v[128:143], v[72:75], v[88:91], v[128:143]
    s_waitcnt vmcnt(12)
    ds_read_b64_tr_b16 v[104:105], v29 offset:6144
    ds_read_b64_tr_b16 v[106:107], v29 offset:6656
    s_add_u32 s5, s5, s4
    s_waitcnt lgkmcnt(9)
    v_mfma_f32_32x32x16_bf16 v[160:175], v[76:79], v[88:91], v[160:175]
    ds_read_b128 v[120:123], v28 offset:0
    ds_read_b64_tr_b16 v[108:109], v30 offset:6144
    s_lshr_b32 s6, s5, 1
    s_waitcnt lgkmcnt(10)
    v_mfma_f32_32x32x16_bf16 v[144:159], v[72:75], v[92:95], v[144:159]
    ds_read_b64_tr_b16 v[110:111], v30 offset:6656
    ds_read_b128 v[124:127], v28 offset:4096
    s_lshl_b32 s6, s6, 2
    v_mfma_f32_32x32x16_bf16 v[176:191], v[76:79], v[92:95], v[176:191]
    s_and_b32 s5, s5, 1
    s_waitcnt lgkmcnt(9)
    v_mfma_f32_32x32x16_bf16 v[128:143], v[96:99], v[112:115], v[128:143]
    s_add_u32 m0, s44, 20480
    s_lshl_b32 s45, s63, 12
    buffer_load_dwordx4 v9, s[20:23], s45 offen lds
    s_add_u32 s5, s5, s6
    s_waitcnt lgkmcnt(7)
    v_mfma_f32_32x32x16_bf16 v[160:175], v[100:103], v[112:115], v[160:175]
    s_waitcnt vmcnt(9)
    ds_read_b128 a[128:131], v31 offset:8192
    s_add_u32 s5, s5, s7
    s_waitcnt lgkmcnt(7)
    v_mfma_f32_32x32x16_bf16 v[144:159], v[96:99], v[116:119], v[144:159]
    buffer_load_dwordx4 v10, s[20:23], s45 offen offset:1024 lds
    ds_read_b128 a[132:135], v32 offset:8192
    s_lshl_b32 s6, s5, 15
    v_mfma_f32_32x32x16_bf16 v[176:191], v[100:103], v[116:119], v[176:191]
    s_add_u32 s52, s6, s3
    s_waitcnt lgkmcnt(5)
    v_mfma_f32_32x32x16_bf16 v[128:143], v[104:107], v[120:123], v[128:143]
    buffer_load_dwordx4 v11, s[20:23], s45 offen offset:2048 lds
    ds_read_b128 a[136:139], v33 offset:8192
    s_lshl_b32 s6, s5, 8
    s_waitcnt lgkmcnt(4)
    v_mfma_f32_32x32x16_bf16 v[160:175], v[108:111], v[120:123], v[160:175]
    ds_read_b128 a[140:143], v34 offset:8192
    v_writelane_b32 v4, s6, 0
    s_waitcnt lgkmcnt(4)
    v_mfma_f32_32x32x16_bf16 v[144:159], v[104:107], v[124:127], v[144:159]
    buffer_load_dwordx4 v12, s[20:23], s45 offen offset:3072 lds
    s_add_u32 s6, s6, 128
    v_mfma_f32_32x32x16_bf16 v[176:191], v[108:111], v[124:127], v[176:191]
    v_writelane_b32 v4, s6, 1
    s_xor_b32 s5, s5, 2
    s_lshl_b32 s6, s5, 15
    s_add_u32 s53, s6, s3
    s_lshl_b32 s6, s5, 8
    v_writelane_b32 v4, s6, 2
    s_add_u32 s6, s6, 128
    v_writelane_b32 v4, s6, 3
    s_add_u32 s5, s50, 1
    s_waitcnt vmcnt(8)
    ds_read_b128 a[144:147], v31 offset:12288
    ds_read_b128 a[148:151], v32 offset:12288
    ds_read_b128 a[152:155], v33 offset:12288
    ds_read_b128 a[156:159], v34 offset:12288
    s_add_u32 m0, s44, 0
    s_lshl_b32 s45, s63, 12
    s_bitset1_b32 s45, 18
    buffer_load_dwordx4 v9, s[20:23], s45 offen lds
    buffer_load_dwordx4 v10, s[20:23], s45 offen offset:1024 lds
    buffer_load_dwordx4 v11, s[20:23], s45 offen offset:2048 lds
    buffer_load_dwordx4 v12, s[20:23], s45 offen offset:3072 lds
    s_add_u32 m0, s44, 4096
    s_lshl_b32 s45, s64, 12
    buffer_load_dwordx4 v9, s[20:23], s45 offen lds
    buffer_load_dwordx4 v10, s[20:23], s45 offen offset:1024 lds
    buffer_load_dwordx4 v11, s[20:23], s45 offen offset:2048 lds
    buffer_load_dwordx4 v12, s[20:23], s45 offen offset:3072 lds
    s_and_b32 s5, s5, 3
    s_add_u32 s5, s5, s4
    s_lshr_b32 s6, s5, 1
    s_lshl_b32 s6, s6, 2
    s_and_b32 s5, s5, 1
    s_add_u32 s5, s5, s6
    s_add_u32 s5, s5, s7
    s_lshl_b32 s6, s5, 15
    s_waitcnt vmcnt(12)
    ds_read_b128 a[160:163], v31 offset:16384
    ds_read_b128 a[164:167], v32 offset:16384
    ds_read_b128 a[168:171], v33 offset:16384
    ds_read_b128 a[172:175], v34 offset:16384
    s_add_u32 m0, s44, 8192
    s_lshl_b32 s45, s64, 12
    s_bitset1_b32 s45, 18
    s_waitcnt lgkmcnt(8)
    buffer_load_dwordx4 v9, s[20:23], s45 offen lds
    buffer_load_dwordx4 v10, s[20:23], s45 offen offset:1024 lds
    buffer_load_dwordx4 v11, s[20:23], s45 offen offset:2048 lds
    buffer_load_dwordx4 v12, s[20:23], s45 offen offset:3072 lds
    s_add_u32 s54, s6, s3
    s_lshl_b32 s6, s5, 8
    v_writelane_b32 v4, s6, 4
    s_add_u32 s6, s6, 128
    v_writelane_b32 v4, s6, 5
    s_xor_b32 s5, s5, 2
    s_lshl_b32 s6, s5, 15
    s_add_u32 s55, s6, s3
    s_waitcnt vmcnt(14)
    ds_read_b64_tr_b16 v[64:65], v29 offset:20480
    ds_read_b64_tr_b16 v[66:67], v29 offset:20992
    ds_read_b128 v[80:83], v25 offset:16384
    ds_read_b64_tr_b16 v[68:69], v30 offset:20480
    ds_read_b64_tr_b16 v[70:71], v30 offset:20992
    ds_read_b128 v[84:87], v25 offset:20480
    s_waitcnt vmcnt(12)
    ds_read_b64_tr_b16 v[72:73], v29 offset:22528
    ds_read_b64_tr_b16 v[74:75], v29 offset:23040
    ds_read_b128 v[88:91], v26 offset:16384
    ds_read_b64_tr_b16 v[76:77], v30 offset:22528
    ds_read_b64_tr_b16 v[78:79], v30 offset:23040
    ds_read_b128 v[92:95], v26 offset:20480
    s_add_u32 m0, s44, 12288
    s_lshl_b32 s45, s65, 12
    s_waitcnt lgkmcnt(14)
    buffer_load_dwordx4 v9, s[20:23], s45 offen lds
    buffer_load_dwordx4 v10, s[20:23], s45 offen offset:1024 lds
    buffer_load_dwordx4 v11, s[20:23], s45 offen offset:2048 lds
    buffer_load_dwordx4 v12, s[20:23], s45 offen offset:3072 lds
    s_waitcnt lgkmcnt(9)
    v_mfma_f32_32x32x16_bf16 v[128:143], v[64:67], v[80:83], v[128:143]
    s_lshl_b32 s6, s5, 8
    s_waitcnt lgkmcnt(7)
    v_mfma_f32_32x32x16_bf16 v[160:175], v[68:71], v[80:83], v[160:175]
    s_waitcnt vmcnt(14)
    ds_read_b64_tr_b16 v[96:97], v29 offset:0
    ds_read_b64_tr_b16 v[98:99], v29 offset:512
    v_writelane_b32 v4, s6, 6
    s_waitcnt lgkmcnt(8)
    v_mfma_f32_32x32x16_bf16 v[144:159], v[64:67], v[84:87], v[144:159]
    ds_read_b128 v[112:115], v27 offset:16384
    ds_read_b64_tr_b16 v[100:101], v30 offset:0
    s_add_u32 s6, s6, 128
    v_mfma_f32_32x32x16_bf16 v[176:191], v[68:71], v[84:87], v[176:191]
    ds_read_b64_tr_b16 v[102:103], v30 offset:512
    ds_read_b128 v[116:119], v27 offset:20480
    v_writelane_b32 v4, s6, 7
    s_waitcnt lgkmcnt(9)
    v_mfma_f32_32x32x16_bf16 v[128:143], v[72:75], v[88:91], v[128:143]
    s_waitcnt vmcnt(12)
    ds_read_b64_tr_b16 v[104:105], v29 offset:2048
    ds_read_b64_tr_b16 v[106:107], v29 offset:2560
    s_add_u32 s5, s50, 2
    s_waitcnt lgkmcnt(9)
    v_mfma_f32_32x32x16_bf16 v[160:175], v[76:79], v[88:91], v[160:175]
    ds_read_b128 v[120:123], v28 offset:16384
    ds_read_b64_tr_b16 v[108:109], v30 offset:2048
    s_and_b32 s5, s5, 3
    s_waitcnt lgkmcnt(10)
    v_mfma_f32_32x32x16_bf16 v[144:159], v[72:75], v[92:95], v[144:159]
    ds_read_b64_tr_b16 v[110:111], v30 offset:2560
    ds_read_b128 v[124:127], v28 offset:20480
    s_add_u32 s5, s5, s4
    v_mfma_f32_32x32x16_bf16 v[176:191], v[76:79], v[92:95], v[176:191]
    s_lshr_b32 s6, s5, 1
    s_waitcnt lgkmcnt(9)
    v_mfma_f32_32x32x16_bf16 v[128:143], v[96:99], v[112:115], v[128:143]
    s_add_u32 m0, s44, 16384
    s_lshl_b32 s45, s65, 12
    s_bitset1_b32 s45, 18
    buffer_load_dwordx4 v9, s[20:23], s45 offen lds
    s_lshl_b32 s6, s6, 2
    s_waitcnt lgkmcnt(7)
    v_mfma_f32_32x32x16_bf16 v[160:175], v[100:103], v[112:115], v[160:175]
    s_waitcnt vmcnt(11)
    ds_read_b64_tr_b16 v[64:65], v29 offset:4096
    ds_read_b64_tr_b16 v[66:67], v29 offset:4608
    s_and_b32 s5, s5, 1
    s_waitcnt lgkmcnt(8)
    v_mfma_f32_32x32x16_bf16 v[144:159], v[96:99], v[116:119], v[144:159]
    buffer_load_dwordx4 v10, s[20:23], s45 offen offset:1024 lds
    ds_read_b128 v[80:83], v25 offset:32768
    ds_read_b64_tr_b16 v[68:69], v30 offset:4096
    s_add_u32 s5, s5, s6
    v_mfma_f32_32x32x16_bf16 v[176:191], v[100:103], v[116:119], v[176:191]
    ds_read_b64_tr_b16 v[70:71], v30 offset:4608
    ds_read_b128 v[84:87], v25 offset:36864
    s_add_u32 s5, s5, s7
    s_waitcnt lgkmcnt(9)
    v_mfma_f32_32x32x16_bf16 v[128:143], v[104:107], v[120:123], v[128:143]
    buffer_load_dwordx4 v11, s[20:23], s45 offen offset:2048 lds
    s_waitcnt vmcnt(11)
    ds_read_b64_tr_b16 v[72:73], v29 offset:6144
    ds_read_b64_tr_b16 v[74:75], v29 offset:6656
    s_lshl_b32 s6, s5, 15
    s_waitcnt lgkmcnt(9)
    v_mfma_f32_32x32x16_bf16 v[160:175], v[108:111], v[120:123], v[160:175]
    ds_read_b128 v[88:91], v26 offset:32768
    ds_read_b64_tr_b16 v[76:77], v30 offset:6144
    s_add_u32 s56, s6, s3
    s_waitcnt lgkmcnt(10)
    v_mfma_f32_32x32x16_bf16 v[144:159], v[104:107], v[124:127], v[144:159]
    buffer_load_dwordx4 v12, s[20:23], s45 offen offset:3072 lds
    ds_read_b64_tr_b16 v[78:79], v30 offset:6656
    ds_read_b128 v[92:95], v26 offset:36864
    s_lshl_b32 s6, s5, 8
    v_mfma_f32_32x32x16_bf16 v[176:191], v[108:111], v[124:127], v[176:191]
    v_writelane_b32 v4, s6, 8
    s_waitcnt lgkmcnt(9)
    v_mfma_f32_32x32x16_bf16 v[128:143], v[64:67], v[80:83], v[128:143]
    s_add_u32 m0, s44, 20480
    s_lshl_b32 s45, s66, 12
    buffer_load_dwordx4 v9, s[20:23], s45 offen lds
    s_add_u32 s6, s6, 128
    s_waitcnt lgkmcnt(7)
    v_mfma_f32_32x32x16_bf16 v[160:175], v[68:71], v[80:83], v[160:175]
    s_waitcnt vmcnt(11)
    ds_read_b64_tr_b16 v[96:97], v29 offset:8192
    ds_read_b64_tr_b16 v[98:99], v29 offset:8704
    v_writelane_b32 v4, s6, 9
    s_waitcnt lgkmcnt(8)
    v_mfma_f32_32x32x16_bf16 v[144:159], v[64:67], v[84:87], v[144:159]
    buffer_load_dwordx4 v10, s[20:23], s45 offen offset:1024 lds
    ds_read_b128 v[112:115], v27 offset:32768
    ds_read_b64_tr_b16 v[100:101], v30 offset:8192
    s_xor_b32 s5, s5, 2
    v_mfma_f32_32x32x16_bf16 v[176:191], v[68:71], v[84:87], v[176:191]
    ds_read_b64_tr_b16 v[102:103], v30 offset:8704
    ds_read_b128 v[116:119], v27 offset:36864
    s_lshl_b32 s6, s5, 15
    s_waitcnt lgkmcnt(9)
    v_mfma_f32_32x32x16_bf16 v[128:143], v[72:75], v[88:91], v[128:143]
    buffer_load_dwordx4 v11, s[20:23], s45 offen offset:2048 lds
    s_waitcnt vmcnt(11)
    ds_read_b64_tr_b16 v[104:105], v29 offset:10240
    ds_read_b64_tr_b16 v[106:107], v29 offset:10752
    s_add_u32 s57, s6, s3
    s_waitcnt lgkmcnt(9)
    v_mfma_f32_32x32x16_bf16 v[160:175], v[76:79], v[88:91], v[160:175]
    ds_read_b128 v[120:123], v28 offset:32768
    ds_read_b64_tr_b16 v[108:109], v30 offset:10240
    s_lshl_b32 s6, s5, 8
    s_waitcnt lgkmcnt(10)
    v_mfma_f32_32x32x16_bf16 v[144:159], v[72:75], v[92:95], v[144:159]
    buffer_load_dwordx4 v12, s[20:23], s45 offen offset:3072 lds
    ds_read_b64_tr_b16 v[110:111], v30 offset:10752
    ds_read_b128 v[124:127], v28 offset:36864
    v_writelane_b32 v4, s6, 10
    v_mfma_f32_32x32x16_bf16 v[176:191], v[76:79], v[92:95], v[176:191]
    s_add_u32 s6, s6, 128
    s_waitcnt lgkmcnt(9)
    v_mfma_f32_32x32x16_bf16 v[128:143], v[96:99], v[112:115], v[128:143]
    s_add_u32 m0, s44, 0
    s_lshl_b32 s45, s66, 12
    s_bitset1_b32 s45, 18
    buffer_load_dwordx4 v9, s[20:23], s45 offen lds
    v_writelane_b32 v4, s6, 11
    s_waitcnt lgkmcnt(7)
    v_mfma_f32_32x32x16_bf16 v[160:175], v[100:103], v[112:115], v[160:175]
    s_waitcnt vmcnt(11)
    ds_read_b64_tr_b16 v[64:65], v29 offset:12288
    ds_read_b64_tr_b16 v[66:67], v29 offset:12800
    s_add_u32 s5, s50, 3
    s_waitcnt lgkmcnt(8)
    v_mfma_f32_32x32x16_bf16 v[144:159], v[96:99], v[116:119], v[144:159]
    buffer_load_dwordx4 v10, s[20:23], s45 offen offset:1024 lds
    ds_read_b128 v[80:83], v25 offset:49152
    ds_read_b64_tr_b16 v[68:69], v30 offset:12288
    s_and_b32 s5, s5, 3
    v_mfma_f32_32x32x16_bf16 v[176:191], v[100:103], v[116:119], v[176:191]
    ds_read_b64_tr_b16 v[70:71], v30 offset:12800
    ds_read_b128 v[84:87], v25 offset:53248
    s_add_u32 s5, s5, s4
    s_waitcnt lgkmcnt(9)
    v_mfma_f32_32x32x16_bf16 v[128:143], v[104:107], v[120:123], v[128:143]
    buffer_load_dwordx4 v11, s[20:23], s45 offen offset:2048 lds
    s_waitcnt vmcnt(11)
    ds_read_b64_tr_b16 v[72:73], v29 offset:14336
    ds_read_b64_tr_b16 v[74:75], v29 offset:14848
    s_lshr_b32 s6, s5, 1
    s_waitcnt lgkmcnt(9)
    v_mfma_f32_32x32x16_bf16 v[160:175], v[108:111], v[120:123], v[160:175]
    ds_read_b128 v[88:91], v26 offset:49152
    ds_read_b64_tr_b16 v[76:77], v30 offset:14336
    s_lshl_b32 s6, s6, 2
    s_waitcnt lgkmcnt(10)
    v_mfma_f32_32x32x16_bf16 v[144:159], v[104:107], v[124:127], v[144:159]
    buffer_load_dwordx4 v12, s[20:23], s45 offen offset:3072 lds
    ds_read_b64_tr_b16 v[78:79], v30 offset:14848
    ds_read_b128 v[92:95], v26 offset:53248
    s_and_b32 s5, s5, 1
    v_mfma_f32_32x32x16_bf16 v[176:191], v[108:111], v[124:127], v[176:191]
    s_add_u32 s5, s5, s6
    s_waitcnt lgkmcnt(9)
    v_mfma_f32_32x32x16_bf16 v[128:143], v[64:67], v[80:83], v[128:143]
    s_add_u32 m0, s44, 4096
    s_lshl_b32 s45, s67, 12
    buffer_load_dwordx4 v9, s[20:23], s45 offen lds
    s_add_u32 s5, s5, s7
    s_waitcnt lgkmcnt(7)
    v_mfma_f32_32x32x16_bf16 v[160:175], v[68:71], v[80:83], v[160:175]
    s_waitcnt vmcnt(11)
    ds_read_b64_tr_b16 v[96:97], v29 offset:16384
    ds_read_b64_tr_b16 v[98:99], v29 offset:16896
    s_lshl_b32 s6, s5, 15
    s_waitcnt lgkmcnt(8)
    v_mfma_f32_32x32x16_bf16 v[144:159], v[64:67], v[84:87], v[144:159]
    buffer_load_dwordx4 v10, s[20:23], s45 offen offset:1024 lds
    ds_read_b128 v[112:115], v27 offset:49152
    ds_read_b64_tr_b16 v[100:101], v30 offset:16384
    s_add_u32 s58, s6, s3
    v_mfma_f32_32x32x16_bf16 v[176:191], v[68:71], v[84:87], v[176:191]
    ds_read_b64_tr_b16 v[102:103], v30 offset:16896
    ds_read_b128 v[116:119], v27 offset:53248
    s_lshl_b32 s6, s5, 8
    s_waitcnt lgkmcnt(9)
    v_mfma_f32_32x32x16_bf16 v[128:143], v[72:75], v[88:91], v[128:143]
    buffer_load_dwordx4 v11, s[20:23], s45 offen offset:2048 lds
    s_waitcnt vmcnt(11)
    ds_read_b64_tr_b16 v[104:105], v29 offset:18432
    ds_read_b64_tr_b16 v[106:107], v29 offset:18944
    v_writelane_b32 v4, s6, 12
    s_waitcnt lgkmcnt(9)
    v_mfma_f32_32x32x16_bf16 v[160:175], v[76:79], v[88:91], v[160:175]
    ds_read_b128 v[120:123], v28 offset:49152
    ds_read_b64_tr_b16 v[108:109], v30 offset:18432
    s_add_u32 s6, s6, 128
    s_waitcnt lgkmcnt(10)
    v_mfma_f32_32x32x16_bf16 v[144:159], v[72:75], v[92:95], v[144:159]
    buffer_load_dwordx4 v12, s[20:23], s45 offen offset:3072 lds
    ds_read_b64_tr_b16 v[110:111], v30 offset:18944
    ds_read_b128 v[124:127], v28 offset:53248
    v_writelane_b32 v4, s6, 13
    v_mfma_f32_32x32x16_bf16 v[176:191], v[76:79], v[92:95], v[176:191]
    s_waitcnt lgkmcnt(9)
    v_mfma_f32_32x32x16_bf16 v[128:143], v[96:99], v[112:115], v[128:143]
    s_add_u32 m0, s44, 8192
    s_lshl_b32 s45, s67, 12
    s_bitset1_b32 s45, 18
    buffer_load_dwordx4 v9, s[20:23], s45 offen lds
    s_waitcnt lgkmcnt(7)
    v_mfma_f32_32x32x16_bf16 v[160:175], v[100:103], v[112:115], v[160:175]
    s_waitcnt vmcnt(11)
    ds_read_b64_tr_b16 v[64:65], v29 offset:20480
    ds_read_b64_tr_b16 v[66:67], v29 offset:20992
    s_waitcnt lgkmcnt(8)
    v_mfma_f32_32x32x16_bf16 v[144:159], v[96:99], v[116:119], v[144:159]
    buffer_load_dwordx4 v10, s[20:23], s45 offen offset:1024 lds
    ds_read_b128 v[80:83], v25 offset:8192
    ds_read_b64_tr_b16 v[68:69], v30 offset:20480
    v_mfma_f32_32x32x16_bf16 v[176:191], v[100:103], v[116:119], v[176:191]
    ds_read_b64_tr_b16 v[70:71], v30 offset:20992
    ds_read_b128 v[84:87], v25 offset:12288
    s_waitcnt lgkmcnt(9)
    v_mfma_f32_32x32x16_bf16 v[128:143], v[104:107], v[120:123], v[128:143]
    buffer_load_dwordx4 v11, s[20:23], s45 offen offset:2048 lds
    s_waitcnt vmcnt(11)
    ds_read_b64_tr_b16 v[72:73], v29 offset:22528
    ds_read_b64_tr_b16 v[74:75], v29 offset:23040
    s_waitcnt lgkmcnt(9)
    v_mfma_f32_32x32x16_bf16 v[160:175], v[108:111], v[120:123], v[160:175]
    ds_read_b128 v[88:91], v26 offset:8192
    ds_read_b64_tr_b16 v[76:77], v30 offset:22528
    s_waitcnt lgkmcnt(10)
    v_mfma_f32_32x32x16_bf16 v[144:159], v[104:107], v[124:127], v[144:159]
    buffer_load_dwordx4 v12, s[20:23], s45 offen offset:3072 lds
    ds_read_b64_tr_b16 v[78:79], v30 offset:23040
    ds_read_b128 v[92:95], v26 offset:12288
    v_mfma_f32_32x32x16_bf16 v[176:191], v[108:111], v[124:127], v[176:191]
    s_waitcnt lgkmcnt(9)
    v_mfma_f32_32x32x16_bf16 v[128:143], v[64:67], v[80:83], v[128:143]
    s_add_u32 m0, s44, 12288
    s_lshl_b32 s45, s68, 12
    buffer_load_dwordx4 v9, s[20:23], s45 offen lds
    s_waitcnt lgkmcnt(7)
    v_mfma_f32_32x32x16_bf16 v[160:175], v[68:71], v[80:83], v[160:175]
    s_barrier
    s_waitcnt vmcnt(11)
    ds_read_b64_tr_b16 v[96:97], v29 offset:0
    ds_read_b64_tr_b16 v[98:99], v29 offset:512
    s_waitcnt lgkmcnt(8)
    v_mfma_f32_32x32x16_bf16 v[144:159], v[64:67], v[84:87], v[144:159]
    buffer_load_dwordx4 v10, s[20:23], s45 offen offset:1024 lds
    ds_read_b128 v[112:115], v27 offset:8192
    ds_read_b64_tr_b16 v[100:101], v30 offset:0
    v_mfma_f32_32x32x16_bf16 v[176:191], v[68:71], v[84:87], v[176:191]
    ds_read_b64_tr_b16 v[102:103], v30 offset:512
    ds_read_b128 v[116:119], v27 offset:12288
    s_waitcnt lgkmcnt(9)
    v_mfma_f32_32x32x16_bf16 v[128:143], v[72:75], v[88:91], v[128:143]
    buffer_load_dwordx4 v11, s[20:23], s45 offen offset:2048 lds
    s_waitcnt vmcnt(11)
    ds_read_b64_tr_b16 v[104:105], v29 offset:2048
    ds_read_b64_tr_b16 v[106:107], v29 offset:2560
    s_waitcnt lgkmcnt(9)
    v_mfma_f32_32x32x16_bf16 v[160:175], v[76:79], v[88:91], v[160:175]
    ds_read_b128 v[120:123], v28 offset:8192
    ds_read_b64_tr_b16 v[108:109], v30 offset:2048
    s_waitcnt lgkmcnt(10)
    v_mfma_f32_32x32x16_bf16 v[144:159], v[72:75], v[92:95], v[144:159]
    buffer_load_dwordx4 v12, s[20:23], s45 offen offset:3072 lds
    ds_read_b64_tr_b16 v[110:111], v30 offset:2560
    ds_read_b128 v[124:127], v28 offset:12288
    v_mfma_f32_32x32x16_bf16 v[176:191], v[76:79], v[92:95], v[176:191]
    s_waitcnt lgkmcnt(9)
    v_mfma_f32_32x32x16_bf16 v[128:143], v[96:99], v[112:115], v[128:143]
    s_add_u32 m0, s44, 16384
    s_lshl_b32 s45, s68, 12
    s_bitset1_b32 s45, 18
    buffer_load_dwordx4 v9, s[20:23], s45 offen lds
    s_waitcnt lgkmcnt(7)
    v_mfma_f32_32x32x16_bf16 v[160:175], v[100:103], v[112:115], v[160:175]
    s_waitcnt vmcnt(11)
    ds_read_b64_tr_b16 v[64:65], v29 offset:4096
    ds_read_b64_tr_b16 v[66:67], v29 offset:4608
    s_waitcnt lgkmcnt(8)
    v_mfma_f32_32x32x16_bf16 v[144:159], v[96:99], v[116:119], v[144:159]
    buffer_load_dwordx4 v10, s[20:23], s45 offen offset:1024 lds
    ds_read_b128 v[80:83], v25 offset:24576
    ds_read_b64_tr_b16 v[68:69], v30 offset:4096
    v_mfma_f32_32x32x16_bf16 v[176:191], v[100:103], v[116:119], v[176:191]
    ds_read_b64_tr_b16 v[70:71], v30 offset:4608
    ds_read_b128 v[84:87], v25 offset:28672
    s_waitcnt lgkmcnt(9)
    v_mfma_f32_32x32x16_bf16 v[128:143], v[104:107], v[120:123], v[128:143]
    buffer_load_dwordx4 v11, s[20:23], s45 offen offset:2048 lds
    s_waitcnt vmcnt(11)
    ds_read_b64_tr_b16 v[72:73], v29 offset:6144
    ds_read_b64_tr_b16 v[74:75], v29 offset:6656
    s_waitcnt lgkmcnt(9)
    v_mfma_f32_32x32x16_bf16 v[160:175], v[108:111], v[120:123], v[160:175]
    ds_read_b128 v[88:91], v26 offset:24576
    ds_read_b64_tr_b16 v[76:77], v30 offset:6144
    s_waitcnt lgkmcnt(10)
    v_mfma_f32_32x32x16_bf16 v[144:159], v[104:107], v[124:127], v[144:159]
    buffer_load_dwordx4 v12, s[20:23], s45 offen offset:3072 lds
    ds_read_b64_tr_b16 v[78:79], v30 offset:6656
    ds_read_b128 v[92:95], v26 offset:28672
    v_mfma_f32_32x32x16_bf16 v[176:191], v[108:111], v[124:127], v[176:191]
    s_waitcnt lgkmcnt(9)
    v_mfma_f32_32x32x16_bf16 v[128:143], v[64:67], v[80:83], v[128:143]
    s_add_u32 m0, s44, 20480
    s_xor_b32 s45, s69, 384
    buffer_load_dwordx4 v13, s[12:15], s45 offen nt lds
    s_waitcnt lgkmcnt(7)
    v_mfma_f32_32x32x16_bf16 v[160:175], v[68:71], v[80:83], v[160:175]
    s_waitcnt vmcnt(11)
    ds_read_b64_tr_b16 v[96:97], v29 offset:8192
    ds_read_b64_tr_b16 v[98:99], v29 offset:8704
    s_waitcnt lgkmcnt(8)
    v_mfma_f32_32x32x16_bf16 v[144:159], v[64:67], v[84:87], v[144:159]
    buffer_load_dwordx4 v14, s[12:15], s45 offen offset:1024 nt lds
    ds_read_b128 v[112:115], v27 offset:24576
    ds_read_b64_tr_b16 v[100:101], v30 offset:8192
    v_mfma_f32_32x32x16_bf16 v[176:191], v[68:71], v[84:87], v[176:191]
    ds_read_b64_tr_b16 v[102:103], v30 offset:8704
    ds_read_b128 v[116:119], v27 offset:28672
    s_waitcnt lgkmcnt(9)
    v_mfma_f32_32x32x16_bf16 v[128:143], v[72:75], v[88:91], v[128:143]
    buffer_load_dwordx4 v15, s[12:15], s45 offen offset:2048 nt lds
    s_waitcnt vmcnt(11)
    ds_read_b64_tr_b16 v[104:105], v29 offset:10240
    ds_read_b64_tr_b16 v[106:107], v29 offset:10752
    s_waitcnt lgkmcnt(9)
    v_mfma_f32_32x32x16_bf16 v[160:175], v[76:79], v[88:91], v[160:175]
    ds_read_b128 v[120:123], v28 offset:24576
    ds_read_b64_tr_b16 v[108:109], v30 offset:10240
    s_waitcnt lgkmcnt(10)
    v_mfma_f32_32x32x16_bf16 v[144:159], v[72:75], v[92:95], v[144:159]
    buffer_load_dwordx4 v16, s[12:15], s45 offen offset:3072 nt lds
    ds_read_b64_tr_b16 v[110:111], v30 offset:10752
    ds_read_b128 v[124:127], v28 offset:28672
    v_mfma_f32_32x32x16_bf16 v[176:191], v[76:79], v[92:95], v[176:191]
    s_waitcnt lgkmcnt(9)
    v_mfma_f32_32x32x16_bf16 v[128:143], v[96:99], v[112:115], v[128:143]
    s_add_u32 m0, s44, 0
    s_xor_b32 s45, s69, 65536
    buffer_load_dwordx4 v13, s[12:15], s45 offen nt lds
    s_waitcnt lgkmcnt(7)
    v_mfma_f32_32x32x16_bf16 v[160:175], v[100:103], v[112:115], v[160:175]
    s_waitcnt vmcnt(11)
    ds_read_b64_tr_b16 v[64:65], v29 offset:12288
    ds_read_b64_tr_b16 v[66:67], v29 offset:12800
    s_waitcnt lgkmcnt(8)
    v_mfma_f32_32x32x16_bf16 v[144:159], v[96:99], v[116:119], v[144:159]
    buffer_load_dwordx4 v14, s[12:15], s45 offen offset:1024 nt lds
    ds_read_b128 v[80:83], v25 offset:40960
    ds_read_b64_tr_b16 v[68:69], v30 offset:12288
    v_mfma_f32_32x32x16_bf16 v[176:191], v[100:103], v[116:119], v[176:191]
    ds_read_b64_tr_b16 v[70:71], v30 offset:12800
    ds_read_b128 v[84:87], v25 offset:45056
    s_waitcnt lgkmcnt(9)
    v_mfma_f32_32x32x16_bf16 v[128:143], v[104:107], v[120:123], v[128:143]
    buffer_load_dwordx4 v15, s[12:15], s45 offen offset:2048 nt lds
    s_waitcnt vmcnt(11)
    ds_read_b64_tr_b16 v[72:73], v29 offset:14336
    ds_read_b64_tr_b16 v[74:75], v29 offset:14848
    s_waitcnt lgkmcnt(9)
    v_mfma_f32_32x32x16_bf16 v[160:175], v[108:111], v[120:123], v[160:175]
    ds_read_b128 v[88:91], v26 offset:40960
    ds_read_b64_tr_b16 v[76:77], v30 offset:14336
    s_waitcnt lgkmcnt(10)
    v_mfma_f32_32x32x16_bf16 v[144:159], v[104:107], v[124:127], v[144:159]
    buffer_load_dwordx4 v16, s[12:15], s45 offen offset:3072 nt lds
    ds_read_b64_tr_b16 v[78:79], v30 offset:14848
    ds_read_b128 v[92:95], v26 offset:45056
    v_mfma_f32_32x32x16_bf16 v[176:191], v[108:111], v[124:127], v[176:191]
    s_waitcnt lgkmcnt(9)
    v_mfma_f32_32x32x16_bf16 v[128:143], v[64:67], v[80:83], v[128:143]
    s_add_u32 m0, s44, 4096
    s_xor_b32 s45, s69, 65664
    buffer_load_dwordx4 v13, s[12:15], s45 offen nt lds
    s_waitcnt lgkmcnt(7)
    v_mfma_f32_32x32x16_bf16 v[160:175], v[68:71], v[80:83], v[160:175]
    s_waitcnt vmcnt(11)
    ds_read_b64_tr_b16 v[96:97], v29 offset:16384
    ds_read_b64_tr_b16 v[98:99], v29 offset:16896
    s_waitcnt lgkmcnt(8)
    v_mfma_f32_32x32x16_bf16 v[144:159], v[64:67], v[84:87], v[144:159]
    buffer_load_dwordx4 v14, s[12:15], s45 offen offset:1024 nt lds
    ds_read_b128 v[112:115], v27 offset:40960
    ds_read_b64_tr_b16 v[100:101], v30 offset:16384
    v_mfma_f32_32x32x16_bf16 v[176:191], v[68:71], v[84:87], v[176:191]
    ds_read_b64_tr_b16 v[102:103], v30 offset:16896
    ds_read_b128 v[116:119], v27 offset:45056
    s_waitcnt lgkmcnt(9)
    v_mfma_f32_32x32x16_bf16 v[128:143], v[72:75], v[88:91], v[128:143]
    buffer_load_dwordx4 v15, s[12:15], s45 offen offset:2048 nt lds
    s_waitcnt vmcnt(11)
    ds_read_b64_tr_b16 v[104:105], v29 offset:18432
    ds_read_b64_tr_b16 v[106:107], v29 offset:18944
    s_waitcnt lgkmcnt(9)
    v_mfma_f32_32x32x16_bf16 v[160:175], v[76:79], v[88:91], v[160:175]
    ds_read_b128 v[120:123], v28 offset:40960
    ds_read_b64_tr_b16 v[108:109], v30 offset:18432
    s_waitcnt lgkmcnt(10)
    v_mfma_f32_32x32x16_bf16 v[144:159], v[72:75], v[92:95], v[144:159]
    buffer_load_dwordx4 v16, s[12:15], s45 offen offset:3072 nt lds
    ds_read_b64_tr_b16 v[110:111], v30 offset:18944
    ds_read_b128 v[124:127], v28 offset:45056
    v_mfma_f32_32x32x16_bf16 v[176:191], v[76:79], v[92:95], v[176:191]
    s_waitcnt lgkmcnt(9)
    v_mfma_f32_32x32x16_bf16 v[128:143], v[96:99], v[112:115], v[128:143]
    s_add_u32 m0, s44, 8192
    s_xor_b32 s45, s69, 65792
    buffer_load_dwordx4 v13, s[12:15], s45 offen nt lds
    s_waitcnt lgkmcnt(3)
    v_mfma_f32_32x32x16_bf16 v[128:143], v[104:107], v[120:123], v[128:143]
    buffer_load_dwordx4 v14, s[12:15], s45 offen offset:1024 nt lds
    v_mfma_f32_32x32x16_bf16 v[144:159], v[96:99], v[116:119], v[144:159]
    buffer_load_dwordx4 v15, s[12:15], s45 offen offset:2048 nt lds
    s_waitcnt lgkmcnt(0)
    v_mfma_f32_32x32x16_bf16 v[144:159], v[104:107], v[124:127], v[144:159]
    buffer_load_dwordx4 v16, s[12:15], s45 offen offset:3072 nt lds
    v_mfma_f32_32x32x16_bf16 v[160:175], v[100:103], v[112:115], v[160:175]
    s_nop 4
    v_cvt_pk_bf16_f32 v64, v128, v129
    v_cvt_pk_bf16_f32 v65, v130, v131
    v_cvt_pk_bf16_f32 v66, v132, v133
    v_cvt_pk_bf16_f32 v67, v134, v135
    ds_write_b128 v42, v[64:67] offset:0
    v_cvt_pk_bf16_f32 v72, v136, v137
    v_cvt_pk_bf16_f32 v73, v138, v139
    v_cvt_pk_bf16_f32 v74, v140, v141
    v_cvt_pk_bf16_f32 v75, v142, v143
    ds_write_b128 v42, v[72:75] offset:2048
    v_mfma_f32_32x32x16_bf16 v[160:175], v[108:111], v[120:123], v[160:175]
    v_mfma_f32_32x32x16_bf16 v[176:191], v[100:103], v[116:119], v[176:191]
    v_cvt_pk_bf16_f32 v68, v144, v145
    v_cvt_pk_bf16_f32 v69, v146, v147
    v_cvt_pk_bf16_f32 v70, v148, v149
    v_cvt_pk_bf16_f32 v71, v150, v151
    ds_write_b128 v42, v[68:71] offset:1024
    v_cvt_pk_bf16_f32 v76, v152, v153
    v_cvt_pk_bf16_f32 v77, v154, v155
    v_cvt_pk_bf16_f32 v78, v156, v157
    v_cvt_pk_bf16_f32 v79, v158, v159
    ds_write_b128 v42, v[76:79] offset:3072
    v_mfma_f32_32x32x16_bf16 v[176:191], v[108:111], v[124:127], v[176:191]
    v_cvt_pk_bf16_f32 v80, v160, v161
    v_cvt_pk_bf16_f32 v81, v162, v163
    v_cvt_pk_bf16_f32 v82, v164, v165
    v_cvt_pk_bf16_f32 v83, v166, v167
    ds_write_b128 v42, v[80:83] offset:4096
    v_cvt_pk_bf16_f32 v88, v168, v169
    v_cvt_pk_bf16_f32 v89, v170, v171
    v_cvt_pk_bf16_f32 v90, v172, v173
    v_cvt_pk_bf16_f32 v91, v174, v175
    ds_write_b128 v42, v[88:91] offset:6144
    s_nop 1
    v_cvt_pk_bf16_f32 v84, v176, v177
    v_cvt_pk_bf16_f32 v85, v178, v179
    v_cvt_pk_bf16_f32 v86, v180, v181
    v_cvt_pk_bf16_f32 v87, v182, v183
    ds_write_b128 v42, v[84:87] offset:5120
    v_cvt_pk_bf16_f32 v92, v184, v185
    v_cvt_pk_bf16_f32 v93, v186, v187
    v_cvt_pk_bf16_f32 v94, v188, v189
    v_cvt_pk_bf16_f32 v95, v190, v191
    ds_write_b128 v42, v[92:95] offset:7168
    s_add_u32 m0, s44, 12288
    s_xor_b32 s45, s69, 65920
    buffer_load_dwordx4 v13, s[12:15], s45 offen nt lds
    buffer_load_dwordx4 v14, s[12:15], s45 offen offset:1024 nt lds
    buffer_load_dwordx4 v15, s[12:15], s45 offen offset:2048 nt lds
    buffer_load_dwordx4 v16, s[12:15], s45 offen offset:3072 nt lds
    v_mfma_f32_32x32x16_bf16 v[128:143], a[128:131], v[64:67], 0
    v_mfma_f32_32x32x16_bf16 v[144:159], a[128:131], v[68:71], 0
    s_waitcnt lgkmcnt(0)
    s_barrier
    ds_read_b128 a[96:99], v47 offset:0
    ds_read_b128 a[100:103], v47 offset:1024
    v_mfma_f32_32x32x16_bf16 v[128:143], a[132:135], v[72:75], v[128:143]
    ds_read_b128 a[104:107], v47 offset:2048
    ds_read_b128 a[108:111], v47 offset:3072
    v_mfma_f32_32x32x16_bf16 v[144:159], a[132:135], v[76:79], v[144:159]
    ds_read_b128 a[112:115], v47 offset:4096
    ds_read_b128 a[116:119], v47 offset:5120
    v_mfma_f32_32x32x16_bf16 v[128:143], a[136:139], v[80:83], v[128:143]
    ds_read_b128 a[120:123], v47 offset:6144
    ds_read_b128 a[124:127], v47 offset:7168
    v_mfma_f32_32x32x16_bf16 v[144:159], a[136:139], v[84:87], v[144:159]
    s_waitcnt vmcnt(16)
    ds_read_b128 v[96:99], v31 offset:20480
    ds_read_b128 v[100:103], v32 offset:20480
    v_mfma_f32_32x32x16_bf16 v[128:143], a[140:143], v[88:91], v[128:143]
    ds_read_b128 v[104:107], v33 offset:20480
    ds_read_b128 v[108:111], v34 offset:20480
    v_mfma_f32_32x32x16_bf16 v[144:159], a[140:143], v[92:95], v[144:159]
    s_waitcnt lgkmcnt(3)
    v_mfma_f32_32x32x16_bf16 v[128:143], v[96:99], a[96:99], v[128:143]
    v_mfma_f32_32x32x16_bf16 v[144:159], v[96:99], a[100:103], v[144:159]
    ds_read_b128 a[32:35], v45 offset:0
    ds_read_b128 a[36:39], v45 offset:1024
    s_waitcnt lgkmcnt(4)
    v_mfma_f32_32x32x16_bf16 v[128:143], v[100:103], a[104:107], v[128:143]
    ds_read_b128 a[40:43], v45 offset:2048
    v_mfma_f32_32x32x16_bf16 v[144:159], v[100:103], a[108:111], v[144:159]
    ds_read_b128 a[44:47], v45 offset:3072
    s_waitcnt lgkmcnt(5)
    v_mfma_f32_32x32x16_bf16 v[128:143], v[104:107], a[112:115], v[128:143]
    ds_read_b128 a[48:51], v45 offset:4096
    ds_read_b128 a[52:55], v45 offset:5120
    v_mfma_f32_32x32x16_bf16 v[144:159], v[104:107], a[116:119], v[144:159]
    ds_read_b128 a[56:59], v45 offset:6144
    s_waitcnt lgkmcnt(7)
    v_mfma_f32_32x32x16_bf16 v[128:143], v[108:111], a[120:123], v[128:143]
    ds_read_b128 a[60:63], v45 offset:7168
    v_mfma_f32_32x32x16_bf16 v[144:159], v[108:111], a[124:127], v[144:159]
    s_waitcnt lgkmcnt(7)
    v_mfma_f32_32x32x16_bf16 v[128:143], a[144:147], a[32:35], v[128:143]
    s_waitcnt lgkmcnt(6)
    v_mfma_f32_32x32x16_bf16 v[144:159], a[144:147], a[36:39], v[144:159]
    ds_read_b128 a[64:67], v46 offset:0
    ds_read_b128 a[68:71], v46 offset:1024
    s_waitcnt lgkmcnt(7)
    v_mfma_f32_32x32x16_bf16 v[128:143], a[148:151], a[40:43], v[128:143]
    ds_read_b128 a[72:75], v46 offset:2048
    s_waitcnt lgkmcnt(7)
    v_mfma_f32_32x32x16_bf16 v[144:159], a[148:151], a[44:47], v[144:159]
    ds_read_b128 a[76:79], v46 offset:3072
    s_waitcnt lgkmcnt(7)
    v_mfma_f32_32x32x16_bf16 v[128:143], a[152:155], a[48:51], v[128:143]
    ds_read_b128 a[80:83], v46 offset:4096
    ds_read_b128 a[84:87], v46 offset:5120
    s_waitcnt lgkmcnt(8)
    v_mfma_f32_32x32x16_bf16 v[144:159], a[152:155], a[52:55], v[144:159]
    ds_read_b128 a[88:91], v46 offset:6144
    s_waitcnt lgkmcnt(8)
    v_mfma_f32_32x32x16_bf16 v[128:143], a[156:159], a[56:59], v[128:143]
    ds_read_b128 a[92:95], v46 offset:7168
    s_waitcnt lgkmcnt(8)
    v_mfma_f32_32x32x16_bf16 v[144:159], a[156:159], a[60:63], v[144:159]
    s_waitcnt lgkmcnt(7)
    v_mfma_f32_32x32x16_bf16 v[128:143], a[160:163], a[64:67], v[128:143]
    s_waitcnt lgkmcnt(6)
    v_mfma_f32_32x32x16_bf16 v[144:159], a[160:163], a[68:71], v[144:159]
    s_waitcnt vmcnt(12)
    ds_read_b128 v[112:115], v31 offset:0
    s_waitcnt lgkmcnt(6)
    v_mfma_f32_32x32x16_bf16 v[128:143], a[164:167], a[72:75], v[128:143]
    ds_read_b128 v[116:119], v32 offset:0
    s_waitcnt lgkmcnt(6)
    v_mfma_f32_32x32x16_bf16 v[144:159], a[164:167], a[76:79], v[144:159]
    s_waitcnt lgkmcnt(5)
    v_mfma_f32_32x32x16_bf16 v[128:143], a[168:171], a[80:83], v[128:143]
    ds_read_b128 v[120:123], v33 offset:0
    s_waitcnt lgkmcnt(5)
    v_mfma_f32_32x32x16_bf16 v[144:159], a[168:171], a[84:87], v[144:159]
    ds_read_b128 v[124:127], v34 offset:0
    s_waitcnt lgkmcnt(5)
    v_mfma_f32_32x32x16_bf16 v[128:143], a[172:175], a[88:91], v[128:143]
    s_waitcnt lgkmcnt(4)
    v_mfma_f32_32x32x16_bf16 v[144:159], a[172:175], a[92:95], v[144:159]
    s_waitcnt lgkmcnt(3)
    v_mfma_f32_32x32x16_bf16 v[160:175], v[112:115], v[64:67], 0
    s_add_u32 m0, s44, 16384
    s_xor_b32 s45, s69, 131072
    buffer_load_dwordx4 v13, s[12:15], s45 offen nt lds
    s_nop 4
    v_max3_f32 v48, v128, v129, v130
    v_max3_f32 v48, v48, v131, v132
    v_max3_f32 v48, v48, v133, v134
    v_max3_f32 v48, v48, v135, v136
    v_max3_f32 v48, v48, v137, v138
    v_mfma_f32_32x32x16_bf16 v[176:191], v[112:115], v[68:71], 0
    s_waitcnt vmcnt(9)
    ds_read_b128 v[96:99], v31 offset:4096
    v_max3_f32 v48, v48, v139, v140
    v_max3_f32 v48, v48, v141, v142
    v_max_f32 v48, v48, v143
    v_mul_f32 v48, s46, v48
    v_fma_f32 v128, v128, s46, -v48
    s_waitcnt lgkmcnt(3)
    v_mfma_f32_32x32x16_bf16 v[160:175], v[116:119], v[72:75], v[160:175]
    buffer_load_dwordx4 v14, s[12:15], s45 offen offset:1024 nt lds
    ds_read_b128 v[100:103], v32 offset:4096
    v_fma_f32 v129, v129, s46, -v48
    v_fma_f32 v130, v130, s46, -v48
    v_fma_f32 v131, v131, s46, -v48
    v_fma_f32 v132, v132, s46, -v48
    v_fma_f32 v133, v133, s46, -v48
    v_mfma_f32_32x32x16_bf16 v[176:191], v[116:119], v[76:79], v[176:191]
    v_fma_f32 v134, v134, s46, -v48
    v_fma_f32 v135, v135, s46, -v48
    v_fma_f32 v136, v136, s46, -v48
    v_fma_f32 v137, v137, s46, -v48
    v_fma_f32 v138, v138, s46, -v48
    s_waitcnt lgkmcnt(3)
    v_mfma_f32_32x32x16_bf16 v[160:175], v[120:123], v[80:83], v[160:175]
    buffer_load_dwordx4 v15, s[12:15], s45 offen offset:2048 nt lds
    ds_read_b128 v[104:107], v33 offset:4096
    v_fma_f32 v139, v139, s46, -v48
    v_fma_f32 v140, v140, s46, -v48
    v_fma_f32 v141, v141, s46, -v48
    v_fma_f32 v142, v142, s46, -v48
    v_fma_f32 v143, v143, s46, -v48
    v_mfma_f32_32x32x16_bf16 v[176:191], v[120:123], v[84:87], v[176:191]
    ds_read_b128 v[108:111], v34 offset:4096
    v_exp_f32 v128, v128
    v_exp_f32 v129, v129
    v_exp_f32 v130, v130
    v_add_f32 v56, v128, v129
    v_exp_f32 v131, v131
    s_waitcnt lgkmcnt(4)
    v_mfma_f32_32x32x16_bf16 v[160:175], v[124:127], v[88:91], v[160:175]
    buffer_load_dwordx4 v16, s[12:15], s45 offen offset:3072 nt lds
    v_add_f32 v56, v56, v130
    v_exp_f32 v132, v132
    v_add_f32 v56, v56, v131
    v_exp_f32 v133, v133
    v_add_f32 v56, v56, v132
    v_mfma_f32_32x32x16_bf16 v[176:191], v[124:127], v[92:95], v[176:191]
    v_exp_f32 v134, v134
    v_add_f32 v56, v56, v133
    v_exp_f32 v135, v135
    v_add_f32 v56, v56, v134
    v_exp_f32 v136, v136
    s_waitcnt lgkmcnt(3)
    v_mfma_f32_32x32x16_bf16 v[160:175], v[96:99], a[32:35], v[160:175]
    s_add_u32 m0, s44, 20480
    s_xor_b32 s45, s69, 131200
    buffer_load_dwordx4 v13, s[12:15], s45 offen nt lds
    v_add_f32 v56, v56, v135
    v_exp_f32 v137, v137
    v_add_f32 v56, v56, v136
    v_exp_f32 v138, v138
    v_add_f32 v56, v56, v137
    v_mfma_f32_32x32x16_bf16 v[176:191], v[96:99], a[36:39], v[176:191]
    s_waitcnt vmcnt(9)
    ds_read_b128 v[112:115], v31 offset:8192
    v_exp_f32 v139, v139
    v_add_f32 v56, v56, v138
    v_exp_f32 v140, v140
    v_add_f32 v56, v56, v139
    v_exp_f32 v141, v141
    s_waitcnt lgkmcnt(3)
    v_mfma_f32_32x32x16_bf16 v[160:175], v[100:103], a[40:43], v[160:175]
    buffer_load_dwordx4 v14, s[12:15], s45 offen offset:1024 nt lds
    ds_read_b128 v[116:119], v32 offset:8192
    v_add_f32 v56, v56, v140
    v_exp_f32 v142, v142
    v_add_f32 v56, v56, v141
    v_exp_f32 v143, v143
    v_add_f32 v56, v56, v142
    v_mfma_f32_32x32x16_bf16 v[176:191], v[100:103], a[44:47], v[176:191]
    v_add_f32 v56, v56, v143
    v_max3_f32 v49, v144, v145, v146
    v_max3_f32 v49, v49, v147, v148
    v_max3_f32 v49, v49, v149, v150
    v_max3_f32 v49, v49, v151, v152
    s_waitcnt lgkmcnt(3)
    v_mfma_f32_32x32x16_bf16 v[160:175], v[104:107], a[48:51], v[160:175]
    buffer_load_dwordx4 v15, s[12:15], s45 offen offset:2048 nt lds
    ds_read_b128 v[120:123], v33 offset:8192
    v_max3_f32 v49, v49, v153, v154
    v_max3_f32 v49, v49, v155, v156
    v_max3_f32 v49, v49, v157, v158
    v_max_f32 v49, v49, v159
    v_mul_f32 v49, s46, v49
    v_mfma_f32_32x32x16_bf16 v[176:191], v[104:107], a[52:55], v[176:191]
    ds_read_b128 v[124:127], v34 offset:8192
    v_fma_f32 v144, v144, s46, -v49
    v_fma_f32 v145, v145, s46, -v49
    v_fma_f32 v146, v146, s46, -v49
    v_fma_f32 v147, v147, s46, -v49
    v_fma_f32 v148, v148, s46, -v49
    s_waitcnt lgkmcnt(4)
    v_mfma_f32_32x32x16_bf16 v[160:175], v[108:111], a[56:59], v[160:175]
    buffer_load_dwordx4 v16, s[12:15], s45 offen offset:3072 nt lds
    v_fma_f32 v149, v149, s46, -v49
    v_fma_f32 v150, v150, s46, -v49
    v_fma_f32 v151, v151, s46, -v49
    v_fma_f32 v152, v152, s46, -v49
    v_fma_f32 v153, v153, s46, -v49
    v_mfma_f32_32x32x16_bf16 v[176:191], v[108:111], a[60:63], v[176:191]
    v_fma_f32 v154, v154, s46, -v49
    v_fma_f32 v155, v155, s46, -v49
    v_fma_f32 v156, v156, s46, -v49
    v_fma_f32 v157, v157, s46, -v49
    v_fma_f32 v158, v158, s46, -v49
    s_waitcnt lgkmcnt(3)
    v_mfma_f32_32x32x16_bf16 v[160:175], v[112:115], a[64:67], v[160:175]
    s_add_u32 m0, s44, 0
    s_xor_b32 s45, s69, 131328
    buffer_load_dwordx4 v13, s[12:15], s45 offen nt lds
    v_fma_f32 v159, v159, s46, -v49
    v_exp_f32 v144, v144
    v_exp_f32 v145, v145
    v_exp_f32 v146, v146
    v_mfma_f32_32x32x16_bf16 v[176:191], v[112:115], a[68:71], v[176:191]
    s_waitcnt vmcnt(9)
    ds_read_b128 v[96:99], v31 offset:12288
    v_add_f32 v57, v144, v145
    v_exp_f32 v147, v147
    v_add_f32 v57, v57, v146
    v_exp_f32 v148, v148
    s_waitcnt lgkmcnt(3)
    v_mfma_f32_32x32x16_bf16 v[160:175], v[116:119], a[72:75], v[160:175]
    buffer_load_dwordx4 v14, s[12:15], s45 offen offset:1024 nt lds
    ds_read_b128 v[100:103], v32 offset:12288
    v_add_f32 v57, v57, v147
    v_exp_f32 v149, v149
    v_add_f32 v57, v57, v148
    v_exp_f32 v150, v150
    v_mfma_f32_32x32x16_bf16 v[176:191], v[116:119], a[76:79], v[176:191]
    v_add_f32 v57, v57, v149
    v_exp_f32 v151, v151
    v_add_f32 v57, v57, v150
    v_exp_f32 v152, v152
    s_waitcnt lgkmcnt(3)
    v_mfma_f32_32x32x16_bf16 v[160:175], v[120:123], a[80:83], v[160:175]
    buffer_load_dwordx4 v15, s[12:15], s45 offen offset:2048 nt lds
    ds_read_b128 v[104:107], v33 offset:12288
    v_add_f32 v57, v57, v151
    v_exp_f32 v153, v153
    v_add_f32 v57, v57, v152
    v_exp_f32 v154, v154
    v_mfma_f32_32x32x16_bf16 v[176:191], v[120:123], a[84:87], v[176:191]
    ds_read_b128 v[108:111], v34 offset:12288
    v_add_f32 v57, v57, v153
    v_exp_f32 v155, v155
    v_add_f32 v57, v57, v154
    v_exp_f32 v156, v156
    s_waitcnt lgkmcnt(4)
    v_mfma_f32_32x32x16_bf16 v[160:175], v[124:127], a[88:91], v[160:175]
    buffer_load_dwordx4 v16, s[12:15], s45 offen offset:3072 nt lds
    v_add_f32 v57, v57, v155
    v_exp_f32 v157, v157
    v_add_f32 v57, v57, v156
    v_exp_f32 v158, v158
    v_mfma_f32_32x32x16_bf16 v[176:191], v[124:127], a[92:95], v[176:191]
    v_add_f32 v57, v57, v157
    v_exp_f32 v159, v159
    v_add_f32 v57, v57, v158
    v_add_f32 v57, v57, v159
    s_waitcnt lgkmcnt(3)
    v_mfma_f32_32x32x16_bf16 v[160:175], v[96:99], a[96:99], v[160:175]
    s_add_u32 m0, s44, 4096
    s_xor_b32 s45, s69, 131456
    buffer_load_dwordx4 v13, s[12:15], s45 offen nt lds
    v_mfma_f32_32x32x16_bf16 v[176:191], v[96:99], a[100:103], v[176:191]
    s_waitcnt vmcnt(9)
    ds_read_b128 v[112:115], v31 offset:16384
    s_waitcnt lgkmcnt(3)
    v_mfma_f32_32x32x16_bf16 v[160:175], v[100:103], a[104:107], v[160:175]
    buffer_load_dwordx4 v14, s[12:15], s45 offen offset:1024 nt lds
    ds_read_b128 v[116:119], v32 offset:16384
    v_mfma_f32_32x32x16_bf16 v[176:191], v[100:103], a[108:111], v[176:191]
    s_waitcnt lgkmcnt(3)
    v_mfma_f32_32x32x16_bf16 v[160:175], v[104:107], a[112:115], v[160:175]
    buffer_load_dwordx4 v15, s[12:15], s45 offen offset:2048 nt lds
    ds_read_b128 v[120:123], v33 offset:16384
    v_mfma_f32_32x32x16_bf16 v[176:191], v[104:107], a[116:119], v[176:191]
    ds_read_b128 v[124:127], v34 offset:16384
    s_waitcnt lgkmcnt(4)
    v_mfma_f32_32x32x16_bf16 v[160:175], v[108:111], a[120:123], v[160:175]
    buffer_load_dwordx4 v16, s[12:15], s45 offen offset:3072 nt lds
    v_mfma_f32_32x32x16_bf16 v[176:191], v[108:111], a[124:127], v[176:191]
    s_waitcnt lgkmcnt(3)
    v_mfma_f32_32x32x16_bf16 v[192:207], v[112:115], v[64:67], 0
    s_add_u32 m0, s44, 8192
    s_xor_b32 s45, s69, 196608
    buffer_load_dwordx4 v13, s[12:15], s45 offen nt lds
    s_nop 4
    v_max3_f32 v50, v160, v161, v162
    v_max3_f32 v50, v50, v163, v164
    v_max3_f32 v50, v50, v165, v166
    v_max3_f32 v50, v50, v167, v168
    v_max3_f32 v50, v50, v169, v170
    v_mfma_f32_32x32x16_bf16 v[208:223], v[112:115], v[68:71], 0
    s_waitcnt vmcnt(9)
    ds_read_b128 v[96:99], v31 offset:20480
    v_max3_f32 v50, v50, v171, v172
    v_max3_f32 v50, v50, v173, v174
    v_max_f32 v50, v50, v175
    v_mul_f32 v50, s46, v50
    v_fma_f32 v160, v160, s46, -v50
    s_waitcnt lgkmcnt(3)
    v_mfma_f32_32x32x16_bf16 v[192:207], v[116:119], v[72:75], v[192:207]
    buffer_load_dwordx4 v14, s[12:15], s45 offen offset:1024 nt lds
    ds_read_b128 v[100:103], v32 offset:20480
    v_fma_f32 v161, v161, s46, -v50
    v_fma_f32 v162, v162, s46, -v50
    v_fma_f32 v163, v163, s46, -v50
    v_fma_f32 v164, v164, s46, -v50
    v_fma_f32 v165, v165, s46, -v50
    v_mfma_f32_32x32x16_bf16 v[208:223], v[116:119], v[76:79], v[208:223]
    v_fma_f32 v166, v166, s46, -v50
    v_fma_f32 v167, v167, s46, -v50
    v_fma_f32 v168, v168, s46, -v50
    v_fma_f32 v169, v169, s46, -v50
    v_fma_f32 v170, v170, s46, -v50
    s_waitcnt lgkmcnt(3)
    v_mfma_f32_32x32x16_bf16 v[192:207], v[120:123], v[80:83], v[192:207]
    buffer_load_dwordx4 v15, s[12:15], s45 offen offset:2048 nt lds
    ds_read_b128 v[104:107], v33 offset:20480
    v_fma_f32 v171, v171, s46, -v50
    v_fma_f32 v172, v172, s46, -v50
    v_fma_f32 v173, v173, s46, -v50
    v_fma_f32 v174, v174, s46, -v50
    v_fma_f32 v175, v175, s46, -v50
    v_mfma_f32_32x32x16_bf16 v[208:223], v[120:123], v[84:87], v[208:223]
    ds_read_b128 v[108:111], v34 offset:20480
    v_exp_f32 v160, v160
    v_exp_f32 v161, v161
    v_exp_f32 v162, v162
    v_add_f32 v58, v160, v161
    v_exp_f32 v163, v163
    s_waitcnt lgkmcnt(4)
    v_mfma_f32_32x32x16_bf16 v[192:207], v[124:127], v[88:91], v[192:207]
    buffer_load_dwordx4 v16, s[12:15], s45 offen offset:3072 nt lds
    v_add_f32 v58, v58, v162
    v_exp_f32 v164, v164
    v_add_f32 v58, v58, v163
    v_exp_f32 v165, v165
    v_add_f32 v58, v58, v164
    v_mfma_f32_32x32x16_bf16 v[208:223], v[124:127], v[92:95], v[208:223]
    v_exp_f32 v166, v166
    v_add_f32 v58, v58, v165
    v_exp_f32 v167, v167
    v_add_f32 v58, v58, v166
    v_exp_f32 v168, v168
    s_waitcnt lgkmcnt(3)
    v_mfma_f32_32x32x16_bf16 v[192:207], v[96:99], a[32:35], v[192:207]
    s_add_u32 m0, s44, 12288
    s_xor_b32 s45, s69, 196736
    buffer_load_dwordx4 v13, s[12:15], s45 offen nt lds
    v_add_f32 v58, v58, v167
    v_exp_f32 v169, v169
    v_add_f32 v58, v58, v168
    v_exp_f32 v170, v170
    v_add_f32 v58, v58, v169
    v_mfma_f32_32x32x16_bf16 v[208:223], v[96:99], a[36:39], v[208:223]
    s_waitcnt vmcnt(9)
    ds_read_b128 v[112:115], v31 offset:0
    v_exp_f32 v171, v171
    v_add_f32 v58, v58, v170
    v_exp_f32 v172, v172
    v_add_f32 v58, v58, v171
    v_exp_f32 v173, v173
    s_waitcnt lgkmcnt(3)
    v_mfma_f32_32x32x16_bf16 v[192:207], v[100:103], a[40:43], v[192:207]
    buffer_load_dwordx4 v14, s[12:15], s45 offen offset:1024 nt lds
    ds_read_b128 v[116:119], v32 offset:0
    v_add_f32 v58, v58, v172
    v_exp_f32 v174, v174
    v_add_f32 v58, v58, v173
    v_exp_f32 v175, v175
    v_add_f32 v58, v58, v174
    v_mfma_f32_32x32x16_bf16 v[208:223], v[100:103], a[44:47], v[208:223]
    v_add_f32 v58, v58, v175
    v_max3_f32 v51, v176, v177, v178
    v_max3_f32 v51, v51, v179, v180
    v_max3_f32 v51, v51, v181, v182
    v_max3_f32 v51, v51, v183, v184
    s_waitcnt lgkmcnt(3)
    v_mfma_f32_32x32x16_bf16 v[192:207], v[104:107], a[48:51], v[192:207]
    buffer_load_dwordx4 v15, s[12:15], s45 offen offset:2048 nt lds
    ds_read_b128 v[120:123], v33 offset:0
    v_max3_f32 v51, v51, v185, v186
    v_max3_f32 v51, v51, v187, v188
    v_max3_f32 v51, v51, v189, v190
    v_max_f32 v51, v51, v191
    v_mul_f32 v51, s46, v51
    v_mfma_f32_32x32x16_bf16 v[208:223], v[104:107], a[52:55], v[208:223]
    ds_read_b128 v[124:127], v34 offset:0
    v_fma_f32 v176, v176, s46, -v51
    v_fma_f32 v177, v177, s46, -v51
    v_fma_f32 v178, v178, s46, -v51
    v_fma_f32 v179, v179, s46, -v51
    v_fma_f32 v180, v180, s46, -v51
    s_waitcnt lgkmcnt(4)
    v_mfma_f32_32x32x16_bf16 v[192:207], v[108:111], a[56:59], v[192:207]
    buffer_load_dwordx4 v16, s[12:15], s45 offen offset:3072 nt lds
    v_fma_f32 v181, v181, s46, -v51
    v_fma_f32 v182, v182, s46, -v51
    v_fma_f32 v183, v183, s46, -v51
    v_fma_f32 v184, v184, s46, -v51
    v_fma_f32 v185, v185, s46, -v51
    v_mfma_f32_32x32x16_bf16 v[208:223], v[108:111], a[60:63], v[208:223]
    v_fma_f32 v186, v186, s46, -v51
    v_fma_f32 v187, v187, s46, -v51
    v_fma_f32 v188, v188, s46, -v51
    v_fma_f32 v189, v189, s46, -v51
    v_fma_f32 v190, v190, s46, -v51
    s_waitcnt lgkmcnt(3)
    v_mfma_f32_32x32x16_bf16 v[192:207], v[112:115], a[64:67], v[192:207]
    s_add_u32 m0, s44, 16384
    s_xor_b32 s45, s69, 196864
    buffer_load_dwordx4 v13, s[12:15], s45 offen nt lds
    v_fma_f32 v191, v191, s46, -v51
    v_exp_f32 v176, v176
    v_exp_f32 v177, v177
    v_exp_f32 v178, v178
    v_mfma_f32_32x32x16_bf16 v[208:223], v[112:115], a[68:71], v[208:223]
    s_waitcnt vmcnt(9)
    ds_read_b128 v[96:99], v31 offset:4096
    v_add_f32 v59, v176, v177
    v_exp_f32 v179, v179
    v_add_f32 v59, v59, v178
    v_exp_f32 v180, v180
    s_waitcnt lgkmcnt(3)
    v_mfma_f32_32x32x16_bf16 v[192:207], v[116:119], a[72:75], v[192:207]
    buffer_load_dwordx4 v14, s[12:15], s45 offen offset:1024 nt lds
    ds_read_b128 v[100:103], v32 offset:4096
    v_add_f32 v59, v59, v179
    v_exp_f32 v181, v181
    v_add_f32 v59, v59, v180
    v_exp_f32 v182, v182
    v_mfma_f32_32x32x16_bf16 v[208:223], v[116:119], a[76:79], v[208:223]
    v_add_f32 v59, v59, v181
    v_exp_f32 v183, v183
    v_add_f32 v59, v59, v182
    v_exp_f32 v184, v184
    s_waitcnt lgkmcnt(3)
    v_mfma_f32_32x32x16_bf16 v[192:207], v[120:123], a[80:83], v[192:207]
    buffer_load_dwordx4 v15, s[12:15], s45 offen offset:2048 nt lds
    ds_read_b128 v[104:107], v33 offset:4096
    v_add_f32 v59, v59, v183
    v_exp_f32 v185, v185
    v_add_f32 v59, v59, v184
    v_exp_f32 v186, v186
    v_mfma_f32_32x32x16_bf16 v[208:223], v[120:123], a[84:87], v[208:223]
    ds_read_b128 v[108:111], v34 offset:4096
    v_add_f32 v59, v59, v185
    v_exp_f32 v187, v187
    v_add_f32 v59, v59, v186
    v_exp_f32 v188, v188
    s_waitcnt lgkmcnt(4)
    v_mfma_f32_32x32x16_bf16 v[192:207], v[124:127], a[88:91], v[192:207]
    buffer_load_dwordx4 v16, s[12:15], s45 offen offset:3072 nt lds
    v_add_f32 v59, v59, v187
    v_exp_f32 v189, v189
    v_add_f32 v59, v59, v188
    v_exp_f32 v190, v190
    v_mfma_f32_32x32x16_bf16 v[208:223], v[124:127], a[92:95], v[208:223]
    v_add_f32 v59, v59, v189
    v_exp_f32 v191, v191
    v_add_f32 v59, v59, v190
    v_add_f32 v59, v59, v191
    s_waitcnt lgkmcnt(3)
    v_mfma_f32_32x32x16_bf16 v[192:207], v[96:99], a[96:99], v[192:207]
    s_add_u32 m0, s44, 20480
    s_xor_b32 s45, s69, 196992
    buffer_load_dwordx4 v13, s[12:15], s45 offen nt lds
    v_mfma_f32_32x32x16_bf16 v[208:223], v[96:99], a[100:103], v[208:223]
    s_waitcnt vmcnt(9)
    ds_read_b128 v[112:115], v31 offset:8192
    s_waitcnt lgkmcnt(3)
    v_mfma_f32_32x32x16_bf16 v[192:207], v[100:103], a[104:107], v[192:207]
    buffer_load_dwordx4 v14, s[12:15], s45 offen offset:1024 nt lds
    ds_read_b128 v[116:119], v32 offset:8192
    v_mfma_f32_32x32x16_bf16 v[208:223], v[100:103], a[108:111], v[208:223]
    s_waitcnt lgkmcnt(3)
    v_mfma_f32_32x32x16_bf16 v[192:207], v[104:107], a[112:115], v[192:207]
    buffer_load_dwordx4 v15, s[12:15], s45 offen offset:2048 nt lds
    ds_read_b128 v[120:123], v33 offset:8192
    v_mfma_f32_32x32x16_bf16 v[208:223], v[104:107], a[116:119], v[208:223]
    ds_read_b128 v[124:127], v34 offset:8192
    s_waitcnt lgkmcnt(4)
    v_mfma_f32_32x32x16_bf16 v[192:207], v[108:111], a[120:123], v[192:207]
    buffer_load_dwordx4 v16, s[12:15], s45 offen offset:3072 nt lds
    v_mfma_f32_32x32x16_bf16 v[208:223], v[108:111], a[124:127], v[208:223]
    s_waitcnt lgkmcnt(3)
    v_mfma_f32_32x32x16_bf16 v[224:239], v[112:115], v[64:67], 0
    s_add_u32 m0, s44, 0
    s_xor_b32 s45, s61, 0
    s_mulk_i32 s45, 14336
    buffer_load_dwordx4 v21, s[24:27], s45 offen lds
    s_nop 3
    v_max3_f32 v52, v192, v193, v194
    v_max3_f32 v52, v52, v195, v196
    v_max3_f32 v52, v52, v197, v198
    v_max3_f32 v52, v52, v199, v200
    v_max3_f32 v52, v52, v201, v202
    v_mfma_f32_32x32x16_bf16 v[240:255], v[112:115], v[68:71], 0
    s_waitcnt vmcnt(9)
    ds_read_b128 v[96:99], v31 offset:12288
    v_max3_f32 v52, v52, v203, v204
    v_max3_f32 v52, v52, v205, v206
    v_max_f32 v52, v52, v207
    v_mul_f32 v52, s46, v52
    v_fma_f32 v192, v192, s46, -v52
    s_waitcnt lgkmcnt(3)
    v_mfma_f32_32x32x16_bf16 v[224:239], v[116:119], v[72:75], v[224:239]
    buffer_load_dwordx4 v22, s[24:27], s45 offen offset:1024 lds
    ds_read_b128 v[100:103], v32 offset:12288
    v_fma_f32 v193, v193, s46, -v52
    v_fma_f32 v194, v194, s46, -v52
    v_fma_f32 v195, v195, s46, -v52
    v_fma_f32 v196, v196, s46, -v52
    v_fma_f32 v197, v197, s46, -v52
    v_mfma_f32_32x32x16_bf16 v[240:255], v[116:119], v[76:79], v[240:255]
    v_fma_f32 v198, v198, s46, -v52
    v_fma_f32 v199, v199, s46, -v52
    v_fma_f32 v200, v200, s46, -v52
    v_fma_f32 v201, v201, s46, -v52
    v_fma_f32 v202, v202, s46, -v52
    s_waitcnt lgkmcnt(3)
    v_mfma_f32_32x32x16_bf16 v[224:239], v[120:123], v[80:83], v[224:239]
    buffer_load_dwordx4 v23, s[24:27], s45 offen offset:2048 lds
    ds_read_b128 v[104:107], v33 offset:12288
    v_fma_f32 v203, v203, s46, -v52
    v_fma_f32 v204, v204, s46, -v52
    v_fma_f32 v205, v205, s46, -v52
    v_fma_f32 v206, v206, s46, -v52
    v_fma_f32 v207, v207, s46, -v52
    v_mfma_f32_32x32x16_bf16 v[240:255], v[120:123], v[84:87], v[240:255]
    ds_read_b128 v[108:111], v34 offset:12288
    v_exp_f32 v192, v192
    v_exp_f32 v193, v193
    v_exp_f32 v194, v194
    v_add_f32 v60, v192, v193
    v_exp_f32 v195, v195
    s_waitcnt lgkmcnt(4)
    v_mfma_f32_32x32x16_bf16 v[224:239], v[124:127], v[88:91], v[224:239]
    buffer_load_dwordx4 v24, s[24:27], s45 offen offset:3072 lds
    v_add_f32 v60, v60, v194
    v_exp_f32 v196, v196
    v_add_f32 v60, v60, v195
    v_exp_f32 v197, v197
    v_add_f32 v60, v60, v196
    v_mfma_f32_32x32x16_bf16 v[240:255], v[124:127], v[92:95], v[240:255]
    v_exp_f32 v198, v198
    v_add_f32 v60, v60, v197
    v_exp_f32 v199, v199
    v_add_f32 v60, v60, v198
    v_exp_f32 v200, v200
    s_waitcnt lgkmcnt(3)
    v_mfma_f32_32x32x16_bf16 v[224:239], v[96:99], a[32:35], v[224:239]
    s_add_u32 m0, s44, 4096
    s_xor_b32 s45, s61, 1
    s_mulk_i32 s45, 14336
    buffer_load_dwordx4 v21, s[24:27], s45 offen lds
    v_add_f32 v60, v60, v199
    v_exp_f32 v201, v201
    v_add_f32 v60, v60, v200
    v_exp_f32 v202, v202
    v_add_f32 v60, v60, v201
    v_mfma_f32_32x32x16_bf16 v[240:255], v[96:99], a[36:39], v[240:255]
    s_waitcnt vmcnt(9)
    ds_read_b128 v[112:115], v31 offset:16384
    v_exp_f32 v203, v203
    v_add_f32 v60, v60, v202
    v_exp_f32 v204, v204
    v_add_f32 v60, v60, v203
    v_exp_f32 v205, v205
    s_waitcnt lgkmcnt(3)
    v_mfma_f32_32x32x16_bf16 v[224:239], v[100:103], a[40:43], v[224:239]
    buffer_load_dwordx4 v22, s[24:27], s45 offen offset:1024 lds
    ds_read_b128 v[116:119], v32 offset:16384
    v_add_f32 v60, v60, v204
    v_exp_f32 v206, v206
    v_add_f32 v60, v60, v205
    v_exp_f32 v207, v207
    v_add_f32 v60, v60, v206
    v_mfma_f32_32x32x16_bf16 v[240:255], v[100:103], a[44:47], v[240:255]
    v_add_f32 v60, v60, v207
    v_max3_f32 v53, v208, v209, v210
    v_max3_f32 v53, v53, v211, v212
    v_max3_f32 v53, v53, v213, v214
    v_max3_f32 v53, v53, v215, v216
    s_waitcnt lgkmcnt(3)
    v_mfma_f32_32x32x16_bf16 v[224:239], v[104:107], a[48:51], v[224:239]
    buffer_load_dwordx4 v23, s[24:27], s45 offen offset:2048 lds
    ds_read_b128 v[120:123], v33 offset:16384
    v_max3_f32 v53, v53, v217, v218
    v_max3_f32 v53, v53, v219, v220
    v_max3_f32 v53, v53, v221, v222
    v_max_f32 v53, v53, v223
    v_mul_f32 v53, s46, v53
    v_mfma_f32_32x32x16_bf16 v[240:255], v[104:107], a[52:55], v[240:255]
    ds_read_b128 v[124:127], v34 offset:16384
    v_fma_f32 v208, v208, s46, -v53
    v_fma_f32 v209, v209, s46, -v53
    v_fma_f32 v210, v210, s46, -v53
    v_fma_f32 v211, v211, s46, -v53
    v_fma_f32 v212, v212, s46, -v53
    s_waitcnt lgkmcnt(4)
    v_mfma_f32_32x32x16_bf16 v[224:239], v[108:111], a[56:59], v[224:239]
    buffer_load_dwordx4 v24, s[24:27], s45 offen offset:3072 lds
    v_fma_f32 v213, v213, s46, -v53
    v_fma_f32 v214, v214, s46, -v53
    v_fma_f32 v215, v215, s46, -v53
    v_fma_f32 v216, v216, s46, -v53
    v_fma_f32 v217, v217, s46, -v53
    v_mfma_f32_32x32x16_bf16 v[240:255], v[108:111], a[60:63], v[240:255]
    v_fma_f32 v218, v218, s46, -v53
    v_fma_f32 v219, v219, s46, -v53
    v_fma_f32 v220, v220, s46, -v53
    v_fma_f32 v221, v221, s46, -v53
    v_fma_f32 v222, v222, s46, -v53
    s_waitcnt lgkmcnt(3)
    v_mfma_f32_32x32x16_bf16 v[224:239], v[112:115], a[64:67], v[224:239]
    s_add_u32 m0, s44, 8192
    s_xor_b32 s45, s61, 2
    s_mulk_i32 s45, 14336
    buffer_load_dwordx4 v21, s[24:27], s45 offen lds
    v_fma_f32 v223, v223, s46, -v53
    v_exp_f32 v208, v208
    v_exp_f32 v209, v209
    v_exp_f32 v210, v210
    v_mfma_f32_32x32x16_bf16 v[240:255], v[112:115], a[68:71], v[240:255]
    s_waitcnt vmcnt(9)
    ds_read_b128 v[96:99], v31 offset:20480
    v_add_f32 v61, v208, v209
    v_exp_f32 v211, v211
    v_add_f32 v61, v61, v210
    v_exp_f32 v212, v212
    s_waitcnt lgkmcnt(3)
    v_mfma_f32_32x32x16_bf16 v[224:239], v[116:119], a[72:75], v[224:239]
    buffer_load_dwordx4 v22, s[24:27], s45 offen offset:1024 lds
    ds_read_b128 v[100:103], v32 offset:20480
    v_add_f32 v61, v61, v211
    v_exp_f32 v213, v213
    v_add_f32 v61, v61, v212
    v_exp_f32 v214, v214
    v_mfma_f32_32x32x16_bf16 v[240:255], v[116:119], a[76:79], v[240:255]
    v_add_f32 v61, v61, v213
    v_exp_f32 v215, v215
    v_add_f32 v61, v61, v214
    v_exp_f32 v216, v216
    s_waitcnt lgkmcnt(3)
    v_mfma_f32_32x32x16_bf16 v[224:239], v[120:123], a[80:83], v[224:239]
    buffer_load_dwordx4 v23, s[24:27], s45 offen offset:2048 lds
    ds_read_b128 v[104:107], v33 offset:20480
    v_add_f32 v61, v61, v215
    v_exp_f32 v217, v217
    v_add_f32 v61, v61, v216
    v_exp_f32 v218, v218
    v_mfma_f32_32x32x16_bf16 v[240:255], v[120:123], a[84:87], v[240:255]
    ds_read_b128 v[108:111], v34 offset:20480
    v_add_f32 v61, v61, v217
    v_exp_f32 v219, v219
    v_add_f32 v61, v61, v218
    v_exp_f32 v220, v220
    s_waitcnt lgkmcnt(4)
    v_mfma_f32_32x32x16_bf16 v[224:239], v[124:127], a[88:91], v[224:239]
    buffer_load_dwordx4 v24, s[24:27], s45 offen offset:3072 lds
    v_add_f32 v61, v61, v219
    v_exp_f32 v221, v221
    v_add_f32 v61, v61, v220
    v_exp_f32 v222, v222
    v_mfma_f32_32x32x16_bf16 v[240:255], v[124:127], a[92:95], v[240:255]
    v_add_f32 v61, v61, v221
    v_exp_f32 v223, v223
    v_add_f32 v61, v61, v222
    v_add_f32 v61, v61, v223
    s_waitcnt lgkmcnt(3)
    v_mfma_f32_32x32x16_bf16 v[224:239], v[96:99], a[96:99], v[224:239]
    s_add_u32 m0, s44, 12288
    s_mov_b32 s45, 0
    buffer_load_dwordx4 v17, s[16:19], s45 offen nt lds
    v_mfma_f32_32x32x16_bf16 v[240:255], v[96:99], a[100:103], v[240:255]
    s_waitcnt lgkmcnt(2)
    v_mfma_f32_32x32x16_bf16 v[224:239], v[100:103], a[104:107], v[224:239]
    buffer_load_dwordx4 v18, s[16:19], s45 offen offset:1024 nt lds
    v_mfma_f32_32x32x16_bf16 v[240:255], v[100:103], a[108:111], v[240:255]
    s_waitcnt lgkmcnt(1)
    v_mfma_f32_32x32x16_bf16 v[224:239], v[104:107], a[112:115], v[224:239]
    buffer_load_dwordx4 v19, s[16:19], s45 offen offset:2048 nt lds
    v_mfma_f32_32x32x16_bf16 v[240:255], v[104:107], a[116:119], v[240:255]
    s_waitcnt lgkmcnt(0)
    v_mfma_f32_32x32x16_bf16 v[224:239], v[108:111], a[120:123], v[224:239]
    buffer_load_dwordx4 v20, s[16:19], s45 offen offset:3072 nt lds
    v_mfma_f32_32x32x16_bf16 v[240:255], v[108:111], a[124:127], v[240:255]
    s_nop 9
    v_max3_f32 v54, v224, v225, v226
    v_max3_f32 v54, v54, v227, v228
    v_max3_f32 v54, v54, v229, v230
    v_max3_f32 v54, v54, v231, v232
    v_max3_f32 v54, v54, v233, v234
    v_max3_f32 v54, v54, v235, v236
    v_max3_f32 v54, v54, v237, v238
    v_max_f32 v54, v54, v239
    v_mul_f32 v54, s46, v54
    v_pk_fma_f32 v[224:225], v[224:225], s[46:47], v[54:55] op_sel:[0,0,0] op_sel_hi:[1,0,0] neg_lo:[0,0,1] neg_hi:[0,0,1]
    v_pk_fma_f32 v[226:227], v[226:227], s[46:47], v[54:55] op_sel:[0,0,0] op_sel_hi:[1,0,0] neg_lo:[0,0,1] neg_hi:[0,0,1]
    v_pk_fma_f32 v[228:229], v[228:229], s[46:47], v[54:55] op_sel:[0,0,0] op_sel_hi:[1,0,0] neg_lo:[0,0,1] neg_hi:[0,0,1]
    v_pk_fma_f32 v[230:231], v[230:231], s[46:47], v[54:55] op_sel:[0,0,0] op_sel_hi:[1,0,0] neg_lo:[0,0,1] neg_hi:[0,0,1]
    v_pk_fma_f32 v[232:233], v[232:233], s[46:47], v[54:55] op_sel:[0,0,0] op_sel_hi:[1,0,0] neg_lo:[0,0,1] neg_hi:[0,0,1]
    v_pk_fma_f32 v[234:235], v[234:235], s[46:47], v[54:55] op_sel:[0,0,0] op_sel_hi:[1,0,0] neg_lo:[0,0,1] neg_hi:[0,0,1]
    v_pk_fma_f32 v[236:237], v[236:237], s[46:47], v[54:55] op_sel:[0,0,0] op_sel_hi:[1,0,0] neg_lo:[0,0,1] neg_hi:[0,0,1]
    v_pk_fma_f32 v[238:239], v[238:239], s[46:47], v[54:55] op_sel:[0,0,0] op_sel_hi:[1,0,0] neg_lo:[0,0,1] neg_hi:[0,0,1]
    v_exp_f32 v224, v224
    v_exp_f32 v225, v225
    v_exp_f32 v226, v226
    v_exp_f32 v227, v227
    v_exp_f32 v228, v228
    v_pk_add_f32 v[2:3], v[224:225], v[226:227]
    v_exp_f32 v229, v229
    v_exp_f32 v230, v230
    v_pk_add_f32 v[2:3], v[2:3], v[228:229]
    v_exp_f32 v231, v231
    v_exp_f32 v232, v232
    v_pk_add_f32 v[2:3], v[2:3], v[230:231]
    s_waitcnt vmcnt(13)
    ds_read_b64_tr_b16 a[128:129], v37 offset:0
    ds_read_b64_tr_b16 a[132:133], v38 offset:0
    ds_read_b64_tr_b16 a[136:137], v39 offset:0
    ds_read_b64_tr_b16 a[140:141], v40 offset:0
    s_waitcnt vmcnt(12)
    ds_read_b64_tr_b16 a[130:131], v37 offset:1024
    ds_read_b64_tr_b16 a[134:135], v38 offset:1024
    ds_read_b64_tr_b16 a[138:139], v39 offset:1024
    ds_read_b64_tr_b16 a[142:143], v40 offset:1024
    s_add_u32 m0, s44, 16384
    s_mov_b32 s45, 16384
    buffer_load_dwordx4 v17, s[16:19], s45 offen nt lds
    buffer_load_dwordx4 v18, s[16:19], s45 offen offset:1024 nt lds
    buffer_load_dwordx4 v19, s[16:19], s45 offen offset:2048 nt lds
    buffer_load_dwordx4 v20, s[16:19], s45 offen offset:3072 nt lds
    s_add_u32 m0, s44, 20480
    s_mov_b32 s45, 32768
    buffer_load_dwordx4 v17, s[16:19], s45 offen nt lds
    buffer_load_dwordx4 v18, s[16:19], s45 offen offset:1024 nt lds
    buffer_load_dwordx4 v19, s[16:19], s45 offen offset:2048 nt lds
    buffer_load_dwordx4 v20, s[16:19], s45 offen offset:3072 nt lds
    v_exp_f32 v233, v233
    v_exp_f32 v234, v234
    v_pk_add_f32 v[2:3], v[2:3], v[232:233]
    v_exp_f32 v235, v235
    v_exp_f32 v236, v236
    v_pk_add_f32 v[2:3], v[2:3], v[234:235]
    v_exp_f32 v237, v237
    v_exp_f32 v238, v238
    v_pk_add_f32 v[2:3], v[2:3], v[236:237]
    v_exp_f32 v239, v239
    s_nop 0
    v_pk_add_f32 v[2:3], v[2:3], v[238:239]
    v_add_f32 v62, v2, v3
    v_max3_f32 v55, v240, v241, v242
    v_max3_f32 v55, v55, v243, v244
    v_max3_f32 v55, v55, v245, v246
    v_max3_f32 v55, v55, v247, v248
    v_max3_f32 v55, v55, v249, v250
    v_max3_f32 v55, v55, v251, v252
    v_max3_f32 v55, v55, v253, v254
    v_max_f32 v55, v55, v255
    v_mul_f32 v55, s46, v55
    v_pk_fma_f32 v[240:241], v[240:241], s[46:47], v[54:55] op_sel:[0,0,1] op_sel_hi:[1,0,1] neg_lo:[0,0,1] neg_hi:[0,0,1]
    v_pk_fma_f32 v[242:243], v[242:243], s[46:47], v[54:55] op_sel:[0,0,1] op_sel_hi:[1,0,1] neg_lo:[0,0,1] neg_hi:[0,0,1]
    v_pk_fma_f32 v[244:245], v[244:245], s[46:47], v[54:55] op_sel:[0,0,1] op_sel_hi:[1,0,1] neg_lo:[0,0,1] neg_hi:[0,0,1]
    v_pk_fma_f32 v[246:247], v[246:247], s[46:47], v[54:55] op_sel:[0,0,1] op_sel_hi:[1,0,1] neg_lo:[0,0,1] neg_hi:[0,0,1]
    v_pk_fma_f32 v[248:249], v[248:249], s[46:47], v[54:55] op_sel:[0,0,1] op_sel_hi:[1,0,1] neg_lo:[0,0,1] neg_hi:[0,0,1]
    v_pk_fma_f32 v[250:251], v[250:251], s[46:47], v[54:55] op_sel:[0,0,1] op_sel_hi:[1,0,1] neg_lo:[0,0,1] neg_hi:[0,0,1]
    v_pk_fma_f32 v[252:253], v[252:253], s[46:47], v[54:55] op_sel:[0,0,1] op_sel_hi:[1,0,1] neg_lo:[0,0,1] neg_hi:[0,0,1]
    v_pk_fma_f32 v[254:255], v[254:255], s[46:47], v[54:55] op_sel:[0,0,1] op_sel_hi:[1,0,1] neg_lo:[0,0,1] neg_hi:[0,0,1]
    v_exp_f32 v240, v240
    v_exp_f32 v241, v241
    v_exp_f32 v242, v242
    v_exp_f32 v243, v243
    v_exp_f32 v244, v244
    v_pk_add_f32 v[2:3], v[240:241], v[242:243]
    v_exp_f32 v245, v245
    v_exp_f32 v246, v246
    v_pk_add_f32 v[2:3], v[2:3], v[244:245]
    v_exp_f32 v247, v247
    v_exp_f32 v248, v248
    v_pk_add_f32 v[2:3], v[2:3], v[246:247]
    v_exp_f32 v249, v249
    v_exp_f32 v250, v250
    v_pk_add_f32 v[2:3], v[2:3], v[248:249]
    v_exp_f32 v251, v251
    v_exp_f32 v252, v252
    v_pk_add_f32 v[2:3], v[2:3], v[250:251]
    v_exp_f32 v253, v253
    v_exp_f32 v254, v254
    v_pk_add_f32 v[2:3], v[2:3], v[252:253]
    v_exp_f32 v255, v255
    s_nop 0
    v_pk_add_f32 v[2:3], v[2:3], v[254:255]
    v_add_f32 v63, v2, v3
    v_max3_f32 v64, v48, v50, v52
    v_max_f32 v64, v64, v54
    v_max3_f32 v65, v49, v51, v53
    v_max_f32 v65, v65, v55
    v_sub_f32 v68, v48, v64
    s_waitcnt vmcnt(17)
    ds_read_b64_tr_b16 a[144:145], v37 offset:4096
    ds_read_b64_tr_b16 a[148:149], v38 offset:4096
    ds_read_b64_tr_b16 a[152:153], v39 offset:4096
    ds_read_b64_tr_b16 a[156:157], v40 offset:4096
    s_waitcnt vmcnt(16)
    ds_read_b64_tr_b16 a[146:147], v37 offset:5120
    ds_read_b64_tr_b16 a[150:151], v38 offset:5120
    ds_read_b64_tr_b16 a[154:155], v39 offset:5120
    ds_read_b64_tr_b16 a[158:159], v40 offset:5120
    s_add_u32 m0, s44, 0
    s_mov_b32 s45, 49152
    s_waitcnt lgkmcnt(8)
    buffer_load_dwordx4 v17, s[16:19], s45 offen nt lds
    buffer_load_dwordx4 v18, s[16:19], s45 offen offset:1024 nt lds
    buffer_load_dwordx4 v19, s[16:19], s45 offen offset:2048 nt lds
    buffer_load_dwordx4 v20, s[16:19], s45 offen offset:3072 nt lds
    v_sub_f32 v69, v49, v65
    v_sub_f32 v70, v50, v64
    v_sub_f32 v71, v51, v65
    v_sub_f32 v72, v52, v64
    v_sub_f32 v73, v53, v65
    v_sub_f32 v74, v54, v64
    v_sub_f32 v75, v55, v65
    v_exp_f32 v68, v68
    v_exp_f32 v69, v69
    v_exp_f32 v70, v70
    v_exp_f32 v71, v71
    v_exp_f32 v72, v72
    v_exp_f32 v73, v73
    v_exp_f32 v74, v74
    v_exp_f32 v75, v75
    v_pk_mul_f32 v[66:67], v[56:57], v[68:69]
    v_pk_fma_f32 v[66:67], v[58:59], v[70:71], v[66:67]
    v_pk_fma_f32 v[66:67], v[60:61], v[72:73], v[66:67]
    v_pk_fma_f32 v[66:67], v[62:63], v[74:75], v[66:67]
    v_permlane32_swap_b32 v64, v65
    s_nop 0
    v_permlane32_swap_b32 v66, v67
    v_max_f32 v72, v64, v65
    v_sub_f32 v68, v64, v72
    v_sub_f32 v69, v65, v72
    v_exp_f32 v68, v68
    v_exp_f32 v69, v69
    v_mul_f32 v73, v66, v68
    v_fmac_f32 v73, v67, v69
    ds_write_b64 v6, v[72:73] offset:0
    ds_write_b64 v6, v[72:73] offset:16384
    ds_write_b64 v6, v[72:73] offset:32768
    ds_write_b64 v6, v[72:73] offset:49152
    s_waitcnt lgkmcnt(0)
    s_barrier
    ds_read_b64 v[74:75], v8 offset:0
    ds_read_b64 v[76:77], v8 offset:512
    ds_read_b64 v[78:79], v8 offset:1024
    ds_read_b64 v[80:81], v8 offset:1536
    s_waitcnt lgkmcnt(1)
    v_max3_f32 v64, v74, v76, v78
    s_waitcnt lgkmcnt(0)
    v_max_f32 v64, v64, v80
    v_sub_f32 v68, v74, v64
    v_sub_f32 v69, v76, v64
    v_sub_f32 v70, v78, v64
    v_sub_f32 v71, v80, v64
    v_exp_f32 v68, v68
    v_exp_f32 v69, v69
    v_exp_f32 v70, v70
    v_exp_f32 v71, v71
    v_mul_f32 v65, v75, v68
    v_fmac_f32 v65, v77, v69
    v_fmac_f32 v65, v79, v70
    v_fmac_f32 v65, v81, v71
    v_log_f32 v65, v65
    s_nop 0
    v_add_f32 v64, v64, v65
    v_mov_b32 v65, v64
    s_nop 1
    v_permlane32_swap_b32 v64, v65
    v_sub_f32 v48, v48, v64
    v_sub_f32 v49, v49, v65
    s_waitcnt vmcnt(17)
    ds_read_b64_tr_b16 a[160:161], v37 offset:8192
    ds_read_b64_tr_b16 a[164:165], v38 offset:8192
    ds_read_b64_tr_b16 a[168:169], v39 offset:8192
    ds_read_b64_tr_b16 a[172:173], v40 offset:8192
    s_waitcnt vmcnt(16)
    ds_read_b64_tr_b16 a[162:163], v37 offset:9216
    ds_read_b64_tr_b16 a[166:167], v38 offset:9216
    ds_read_b64_tr_b16 a[170:171], v39 offset:9216
    ds_read_b64_tr_b16 a[174:175], v40 offset:9216
    s_add_u32 m0, s44, 4096
    s_mov_b32 s45, 65536
    buffer_load_dwordx4 v17, s[16:19], s45 offen nt lds
    buffer_load_dwordx4 v18, s[16:19], s45 offen offset:1024 nt lds
    buffer_load_dwordx4 v19, s[16:19], s45 offen offset:2048 nt lds
    buffer_load_dwordx4 v20, s[16:19], s45 offen offset:3072 nt lds
    v_sub_f32 v50, v50, v64
    v_sub_f32 v51, v51, v65
    v_sub_f32 v52, v52, v64
    v_sub_f32 v53, v53, v65
    v_sub_f32 v54, v54, v64
    v_sub_f32 v55, v55, v65
    v_exp_f32 v48, v48
    v_exp_f32 v49, v49
    v_exp_f32 v50, v50
    v_exp_f32 v51, v51
    v_exp_f32 v52, v52
    v_exp_f32 v53, v53
    v_exp_f32 v54, v54
    v_exp_f32 v55, v55
    v_pk_mul_f32 v[128:129], v[128:129], v[48:49] op_sel:[0,0] op_sel_hi:[1,0]
    v_pk_mul_f32 v[130:131], v[130:131], v[48:49] op_sel:[0,0] op_sel_hi:[1,0]
    v_pk_mul_f32 v[132:133], v[132:133], v[48:49] op_sel:[0,0] op_sel_hi:[1,0]
    v_pk_mul_f32 v[134:135], v[134:135], v[48:49] op_sel:[0,0] op_sel_hi:[1,0]
    v_cvt_pk_bf16_f32 v128, v128, v129
    v_cvt_pk_bf16_f32 v129, v130, v131
    v_cvt_pk_bf16_f32 v130, v132, v133
    v_cvt_pk_bf16_f32 v131, v134, v135
    ds_write_b128 v42, v[128:131] offset:0
    v_pk_mul_f32 v[136:137], v[136:137], v[48:49] op_sel:[0,0] op_sel_hi:[1,0]
    v_pk_mul_f32 v[138:139], v[138:139], v[48:49] op_sel:[0,0] op_sel_hi:[1,0]
    v_pk_mul_f32 v[140:141], v[140:141], v[48:49] op_sel:[0,0] op_sel_hi:[1,0]
    v_pk_mul_f32 v[142:143], v[142:143], v[48:49] op_sel:[0,0] op_sel_hi:[1,0]
    v_cvt_pk_bf16_f32 v136, v136, v137
    v_cvt_pk_bf16_f32 v137, v138, v139
    v_cvt_pk_bf16_f32 v138, v140, v141
    v_cvt_pk_bf16_f32 v139, v142, v143
    ds_write_b128 v42, v[136:139] offset:2048
    v_pk_mul_f32 v[144:145], v[144:145], v[48:49] op_sel:[0,1] op_sel_hi:[1,1]
    v_pk_mul_f32 v[146:147], v[146:147], v[48:49] op_sel:[0,1] op_sel_hi:[1,1]
    v_pk_mul_f32 v[148:149], v[148:149], v[48:49] op_sel:[0,1] op_sel_hi:[1,1]
    v_pk_mul_f32 v[150:151], v[150:151], v[48:49] op_sel:[0,1] op_sel_hi:[1,1]
    v_cvt_pk_bf16_f32 v144, v144, v145
    v_cvt_pk_bf16_f32 v145, v146, v147
    v_cvt_pk_bf16_f32 v146, v148, v149
    v_cvt_pk_bf16_f32 v147, v150, v151
    ds_write_b128 v42, v[144:147] offset:1024
    v_pk_mul_f32 v[152:153], v[152:153], v[48:49] op_sel:[0,1] op_sel_hi:[1,1]
    v_pk_mul_f32 v[154:155], v[154:155], v[48:49] op_sel:[0,1] op_sel_hi:[1,1]
    v_pk_mul_f32 v[156:157], v[156:157], v[48:49] op_sel:[0,1] op_sel_hi:[1,1]
    v_pk_mul_f32 v[158:159], v[158:159], v[48:49] op_sel:[0,1] op_sel_hi:[1,1]
    v_cvt_pk_bf16_f32 v152, v152, v153
    v_cvt_pk_bf16_f32 v153, v154, v155
    v_cvt_pk_bf16_f32 v154, v156, v157
    v_cvt_pk_bf16_f32 v155, v158, v159
    ds_write_b128 v42, v[152:155] offset:3072
    v_pk_mul_f32 v[160:161], v[160:161], v[50:51] op_sel:[0,0] op_sel_hi:[1,0]
    v_pk_mul_f32 v[162:163], v[162:163], v[50:51] op_sel:[0,0] op_sel_hi:[1,0]
    v_pk_mul_f32 v[164:165], v[164:165], v[50:51] op_sel:[0,0] op_sel_hi:[1,0]
    v_pk_mul_f32 v[166:167], v[166:167], v[50:51] op_sel:[0,0] op_sel_hi:[1,0]
    v_cvt_pk_bf16_f32 v160, v160, v161
    v_cvt_pk_bf16_f32 v161, v162, v163
    v_cvt_pk_bf16_f32 v162, v164, v165
    v_cvt_pk_bf16_f32 v163, v166, v167
    s_add_u32 m0, s44, 8192
    s_mov_b32 s45, 81920
    s_waitcnt lgkmcnt(4)
    buffer_load_dwordx4 v17, s[16:19], s45 offen nt lds
    buffer_load_dwordx4 v18, s[16:19], s45 offen offset:1024 nt lds
    buffer_load_dwordx4 v19, s[16:19], s45 offen offset:2048 nt lds
    buffer_load_dwordx4 v20, s[16:19], s45 offen offset:3072 nt lds
    ds_write_b128 v42, v[160:163] offset:4096
    v_pk_mul_f32 v[168:169], v[168:169], v[50:51] op_sel:[0,0] op_sel_hi:[1,0]
    v_pk_mul_f32 v[170:171], v[170:171], v[50:51] op_sel:[0,0] op_sel_hi:[1,0]
    v_pk_mul_f32 v[172:173], v[172:173], v[50:51] op_sel:[0,0] op_sel_hi:[1,0]
    v_pk_mul_f32 v[174:175], v[174:175], v[50:51] op_sel:[0,0] op_sel_hi:[1,0]
    v_cvt_pk_bf16_f32 v168, v168, v169
    v_cvt_pk_bf16_f32 v169, v170, v171
    v_cvt_pk_bf16_f32 v170, v172, v173
    v_cvt_pk_bf16_f32 v171, v174, v175
    ds_write_b128 v42, v[168:171] offset:6144
    v_pk_mul_f32 v[176:177], v[176:177], v[50:51] op_sel:[0,1] op_sel_hi:[1,1]
    v_pk_mul_f32 v[178:179], v[178:179], v[50:51] op_sel:[0,1] op_sel_hi:[1,1]
    v_pk_mul_f32 v[180:181], v[180:181], v[50:51] op_sel:[0,1] op_sel_hi:[1,1]
    v_pk_mul_f32 v[182:183], v[182:183], v[50:51] op_sel:[0,1] op_sel_hi:[1,1]
    v_cvt_pk_bf16_f32 v176, v176, v177
    v_cvt_pk_bf16_f32 v177, v178, v179
    v_cvt_pk_bf16_f32 v178, v180, v181
    v_cvt_pk_bf16_f32 v179, v182, v183
    ds_write_b128 v42, v[176:179] offset:5120
    v_pk_mul_f32 v[184:185], v[184:185], v[50:51] op_sel:[0,1] op_sel_hi:[1,1]
    v_pk_mul_f32 v[186:187], v[186:187], v[50:51] op_sel:[0,1] op_sel_hi:[1,1]
    v_pk_mul_f32 v[188:189], v[188:189], v[50:51] op_sel:[0,1] op_sel_hi:[1,1]
    v_pk_mul_f32 v[190:191], v[190:191], v[50:51] op_sel:[0,1] op_sel_hi:[1,1]
    v_cvt_pk_bf16_f32 v184, v184, v185
    v_cvt_pk_bf16_f32 v185, v186, v187
    v_cvt_pk_bf16_f32 v186, v188, v189
    v_cvt_pk_bf16_f32 v187, v190, v191
    ds_write_b128 v42, v[184:187] offset:7168
    s_waitcnt lgkmcnt(0)
    s_barrier
    v_mul_f32 v192, v192, v52
    v_mul_f32 v193, v193, v52
    v_mul_f32 v194, v194, v52
    v_mul_f32 v195, v195, v52
    v_mul_f32 v196, v196, v52
    v_mul_f32 v197, v197, v52
    v_mul_f32 v198, v198, v52
    v_mul_f32 v199, v199, v52
    v_cvt_pk_bf16_f32 v192, v192, v193
    v_cvt_pk_bf16_f32 v193, v194, v195
    v_cvt_pk_bf16_f32 v194, v196, v197
    v_cvt_pk_bf16_f32 v195, v198, v199
    ds_write_b128 v42, v[192:195] offset:8192
    v_mul_f32 v200, v200, v52
    s_waitcnt vmcnt(23)
    ds_read_b64_tr_b16 v[64:65], v35 offset:12288
    s_waitcnt vmcnt(22)
    ds_read_b64_tr_b16 v[66:67], v35 offset:13312
    ds_read_b128 v[80:83], v43 offset:0
    ds_read_b64_tr_b16 v[68:69], v36 offset:12288
    ds_read_b64_tr_b16 v[70:71], v36 offset:13312
    ds_read_b128 v[84:87], v44 offset:0
    s_waitcnt vmcnt(21)
    ds_read_b64_tr_b16 v[72:73], v35 offset:14336
    s_waitcnt vmcnt(20)
    ds_read_b64_tr_b16 v[74:75], v35 offset:15360
    ds_read_b128 v[88:91], v43 offset:2048
    ds_read_b64_tr_b16 v[76:77], v36 offset:14336
    ds_read_b64_tr_b16 v[78:79], v36 offset:15360
    ds_read_b128 v[92:95], v44 offset:2048
    s_waitcnt lgkmcnt(9)
    v_mfma_f32_32x32x16_bf16 v[128:143], v[64:67], v[80:83], 0
    v_mul_f32 v201, v201, v52
    v_mul_f32 v202, v202, v52
    s_waitcnt lgkmcnt(7)
    v_mfma_f32_32x32x16_bf16 v[160:175], v[68:71], v[80:83], 0
    s_waitcnt vmcnt(19)
    ds_read_b64_tr_b16 v[96:97], v35 offset:16384
    s_waitcnt vmcnt(18)
    ds_read_b64_tr_b16 v[98:99], v35 offset:17408
    v_mul_f32 v203, v203, v52
    v_mul_f32 v204, v204, v52
    s_waitcnt lgkmcnt(8)
    v_mfma_f32_32x32x16_bf16 v[144:159], v[64:67], v[84:87], 0
    ds_read_b128 v[112:115], v43 offset:16384
    ds_read_b64_tr_b16 v[100:101], v36 offset:16384
    v_mul_f32 v205, v205, v52
    v_mul_f32 v206, v206, v52
    v_mfma_f32_32x32x16_bf16 v[176:191], v[68:71], v[84:87], 0
    ds_read_b64_tr_b16 v[102:103], v36 offset:17408
    ds_read_b128 v[116:119], v44 offset:16384
    v_mul_f32 v207, v207, v52
    s_waitcnt lgkmcnt(9)
    v_mfma_f32_32x32x16_bf16 v[128:143], v[72:75], v[88:91], v[128:143]
    s_waitcnt vmcnt(17)
    ds_read_b64_tr_b16 v[104:105], v35 offset:18432
    s_waitcnt vmcnt(16)
    ds_read_b64_tr_b16 v[106:107], v35 offset:19456
    v_cvt_pk_bf16_f32 v200, v200, v201
    v_cvt_pk_bf16_f32 v201, v202, v203
    s_waitcnt lgkmcnt(9)
    v_mfma_f32_32x32x16_bf16 v[160:175], v[76:79], v[88:91], v[160:175]
    ds_read_b128 v[120:123], v43 offset:18432
    ds_read_b64_tr_b16 v[108:109], v36 offset:18432
    v_cvt_pk_bf16_f32 v202, v204, v205
    v_cvt_pk_bf16_f32 v203, v206, v207
    s_waitcnt lgkmcnt(10)
    v_mfma_f32_32x32x16_bf16 v[144:159], v[72:75], v[92:95], v[144:159]
    ds_read_b64_tr_b16 v[110:111], v36 offset:19456
    ds_read_b128 v[124:127], v44 offset:18432
    ds_write_b128 v42, v[200:203] offset:10240
    v_mul_f32 v208, v208, v53
    v_mfma_f32_32x32x16_bf16 v[176:191], v[76:79], v[92:95], v[176:191]
    v_mul_f32 v209, v209, v53
    s_waitcnt lgkmcnt(10)
    v_mfma_f32_32x32x16_bf16 v[128:143], v[96:99], v[112:115], v[128:143]
    v_mul_f32 v210, v210, v53
    v_mul_f32 v211, v211, v53
    s_waitcnt lgkmcnt(8)
    v_mfma_f32_32x32x16_bf16 v[160:175], v[100:103], v[112:115], v[160:175]
    s_waitcnt vmcnt(15)
    ds_read_b64_tr_b16 v[64:65], v35 offset:20480
    s_waitcnt vmcnt(14)
    ds_read_b64_tr_b16 v[66:67], v35 offset:21504
    v_mul_f32 v212, v212, v53
    v_mul_f32 v213, v213, v53
    s_waitcnt lgkmcnt(9)
    v_mfma_f32_32x32x16_bf16 v[144:159], v[96:99], v[116:119], v[144:159]
    ds_read_b128 v[80:83], v43 offset:32768
    ds_read_b64_tr_b16 v[68:69], v36 offset:20480
    v_mul_f32 v214, v214, v53
    v_mul_f32 v215, v215, v53
    v_mfma_f32_32x32x16_bf16 v[176:191], v[100:103], v[116:119], v[176:191]
    ds_read_b64_tr_b16 v[70:71], v36 offset:21504
    ds_read_b128 v[84:87], v44 offset:32768
    v_cvt_pk_bf16_f32 v208, v208, v209
    s_waitcnt lgkmcnt(10)
    v_mfma_f32_32x32x16_bf16 v[128:143], v[104:107], v[120:123], v[128:143]
    s_waitcnt vmcnt(13)
    ds_read_b64_tr_b16 v[72:73], v35 offset:22528
    s_waitcnt vmcnt(12)
    ds_read_b64_tr_b16 v[74:75], v35 offset:23552
    v_cvt_pk_bf16_f32 v209, v210, v211
    v_cvt_pk_bf16_f32 v210, v212, v213
    s_waitcnt lgkmcnt(10)
    v_mfma_f32_32x32x16_bf16 v[160:175], v[108:111], v[120:123], v[160:175]
    ds_read_b128 v[88:91], v43 offset:34816
    ds_read_b64_tr_b16 v[76:77], v36 offset:22528
    v_cvt_pk_bf16_f32 v211, v214, v215
    ds_write_b128 v42, v[208:211] offset:9216
    s_waitcnt lgkmcnt(12)
    v_mfma_f32_32x32x16_bf16 v[144:159], v[104:107], v[124:127], v[144:159]
    ds_read_b64_tr_b16 v[78:79], v36 offset:23552
    ds_read_b128 v[92:95], v44 offset:34816
    v_mul_f32 v216, v216, v53
    v_mul_f32 v217, v217, v53
    v_mfma_f32_32x32x16_bf16 v[176:191], v[108:111], v[124:127], v[176:191]
    v_mul_f32 v218, v218, v53
    s_waitcnt lgkmcnt(10)
    v_mfma_f32_32x32x16_bf16 v[128:143], v[64:67], v[80:83], v[128:143]
    s_add_u32 m0, s44, 12288
    s_mov_b32 s45, 98304
    buffer_load_dwordx4 v17, s[16:19], s45 offen nt lds
    v_mul_f32 v219, v219, v53
    v_mul_f32 v220, v220, v53
    s_waitcnt lgkmcnt(8)
    v_mfma_f32_32x32x16_bf16 v[160:175], v[68:71], v[80:83], v[160:175]
    s_waitcnt vmcnt(12)
    ds_read_b64_tr_b16 v[96:97], v35 offset:0
    s_waitcnt vmcnt(11)
    ds_read_b64_tr_b16 v[98:99], v35 offset:1024
    v_mul_f32 v221, v221, v53
    v_mul_f32 v222, v222, v53
    s_waitcnt lgkmcnt(9)
    v_mfma_f32_32x32x16_bf16 v[144:159], v[64:67], v[84:87], v[144:159]
    buffer_load_dwordx4 v18, s[16:19], s45 offen offset:1024 nt lds
    ds_read_b128 v[112:115], v43 offset:49152
    ds_read_b64_tr_b16 v[100:101], v36 offset:0
    v_mul_f32 v223, v223, v53
    v_cvt_pk_bf16_f32 v216, v216, v217
    v_mfma_f32_32x32x16_bf16 v[176:191], v[68:71], v[84:87], v[176:191]
    ds_read_b64_tr_b16 v[102:103], v36 offset:1024
    ds_read_b128 v[116:119], v44 offset:49152
    v_cvt_pk_bf16_f32 v217, v218, v219
    s_waitcnt lgkmcnt(10)
    v_mfma_f32_32x32x16_bf16 v[128:143], v[72:75], v[88:91], v[128:143]
    buffer_load_dwordx4 v19, s[16:19], s45 offen offset:2048 nt lds
    s_waitcnt vmcnt(12)
    ds_read_b64_tr_b16 v[104:105], v35 offset:2048
    s_waitcnt vmcnt(11)
    ds_read_b64_tr_b16 v[106:107], v35 offset:3072
    v_cvt_pk_bf16_f32 v218, v220, v221
    v_cvt_pk_bf16_f32 v219, v222, v223
    s_waitcnt lgkmcnt(9)
    v_mfma_f32_32x32x16_bf16 v[160:175], v[76:79], v[88:91], v[160:175]
    ds_read_b128 v[120:123], v43 offset:51200
    ds_read_b64_tr_b16 v[108:109], v36 offset:2048
    ds_write_b128 v42, v[216:219] offset:11264
    v_mul_f32 v224, v224, v54
    s_waitcnt lgkmcnt(11)
    v_mfma_f32_32x32x16_bf16 v[144:159], v[72:75], v[92:95], v[144:159]
    buffer_load_dwordx4 v20, s[16:19], s45 offen offset:3072 nt lds
    ds_read_b64_tr_b16 v[110:111], v36 offset:3072
    ds_read_b128 v[124:127], v44 offset:51200
    v_mul_f32 v225, v225, v54
    v_mul_f32 v226, v226, v54
    v_mfma_f32_32x32x16_bf16 v[176:191], v[76:79], v[92:95], v[176:191]
    v_mul_f32 v227, v227, v54
    s_waitcnt lgkmcnt(10)
    v_mfma_f32_32x32x16_bf16 v[128:143], v[96:99], v[112:115], v[128:143]
    s_add_u32 m0, s44, 16384
    s_mov_b32 s45, 114688
    buffer_load_dwordx4 v17, s[16:19], s45 offen nt lds
    v_mul_f32 v228, v228, v54
    v_mul_f32 v229, v229, v54
    s_waitcnt lgkmcnt(8)
    v_mfma_f32_32x32x16_bf16 v[160:175], v[100:103], v[112:115], v[160:175]
    s_waitcnt vmcnt(12)
    ds_read_b64_tr_b16 v[64:65], v35 offset:4096
    s_waitcnt vmcnt(11)
    ds_read_b64_tr_b16 v[66:67], v35 offset:5120
    v_mul_f32 v230, v230, v54
    v_mul_f32 v231, v231, v54
    s_waitcnt lgkmcnt(9)
    v_mfma_f32_32x32x16_bf16 v[144:159], v[96:99], v[116:119], v[144:159]
    buffer_load_dwordx4 v18, s[16:19], s45 offen offset:1024 nt lds
    ds_read_b128 v[80:83], v43 offset:4096
    ds_read_b64_tr_b16 v[68:69], v36 offset:4096
    v_cvt_pk_bf16_f32 v224, v224, v225
    v_cvt_pk_bf16_f32 v225, v226, v227
    v_mfma_f32_32x32x16_bf16 v[176:191], v[100:103], v[116:119], v[176:191]
    ds_read_b64_tr_b16 v[70:71], v36 offset:5120
    ds_read_b128 v[84:87], v44 offset:4096
    v_cvt_pk_bf16_f32 v226, v228, v229
    s_waitcnt lgkmcnt(10)
    v_mfma_f32_32x32x16_bf16 v[128:143], v[104:107], v[120:123], v[128:143]
    buffer_load_dwordx4 v19, s[16:19], s45 offen offset:2048 nt lds
    s_waitcnt vmcnt(12)
    ds_read_b64_tr_b16 v[72:73], v35 offset:6144
    s_waitcnt vmcnt(11)
    ds_read_b64_tr_b16 v[74:75], v35 offset:7168
    v_cvt_pk_bf16_f32 v227, v230, v231
    ds_write_b128 v42, v[224:227] offset:12288
    s_waitcnt lgkmcnt(10)
    v_mfma_f32_32x32x16_bf16 v[160:175], v[108:111], v[120:123], v[160:175]
    ds_read_b128 v[88:91], v43 offset:6144
    ds_read_b64_tr_b16 v[76:77], v36 offset:6144
    v_mul_f32 v232, v232, v54
    v_mul_f32 v233, v233, v54
    s_waitcnt lgkmcnt(11)
    v_mfma_f32_32x32x16_bf16 v[144:159], v[104:107], v[124:127], v[144:159]
    buffer_load_dwordx4 v20, s[16:19], s45 offen offset:3072 nt lds
    ds_read_b64_tr_b16 v[78:79], v36 offset:7168
    ds_read_b128 v[92:95], v44 offset:6144
    v_mul_f32 v234, v234, v54
    v_mul_f32 v235, v235, v54
    v_mfma_f32_32x32x16_bf16 v[176:191], v[108:111], v[124:127], v[176:191]
    v_mul_f32 v236, v236, v54
    s_waitcnt lgkmcnt(10)
    v_mfma_f32_32x32x16_bf16 v[128:143], v[64:67], v[80:83], v[128:143]
    s_add_u32 m0, s44, 20480
    s_mov_b32 s45, 131072
    buffer_load_dwordx4 v17, s[16:19], s45 offen nt lds
    v_mul_f32 v237, v237, v54
    v_mul_f32 v238, v238, v54
    s_waitcnt lgkmcnt(8)
    v_mfma_f32_32x32x16_bf16 v[160:175], v[68:71], v[80:83], v[160:175]
    s_waitcnt vmcnt(12)
    ds_read_b64_tr_b16 v[96:97], v35 offset:8192
    s_waitcnt vmcnt(11)
    ds_read_b64_tr_b16 v[98:99], v35 offset:9216
    v_mul_f32 v239, v239, v54
    v_cvt_pk_bf16_f32 v232, v232, v233
    s_waitcnt lgkmcnt(9)
    v_mfma_f32_32x32x16_bf16 v[144:159], v[64:67], v[84:87], v[144:159]
    buffer_load_dwordx4 v18, s[16:19], s45 offen offset:1024 nt lds
    ds_read_b128 v[112:115], v43 offset:20480
    ds_read_b64_tr_b16 v[100:101], v36 offset:8192
    v_cvt_pk_bf16_f32 v233, v234, v235
    v_cvt_pk_bf16_f32 v234, v236, v237
    v_mfma_f32_32x32x16_bf16 v[176:191], v[68:71], v[84:87], v[176:191]
    ds_read_b64_tr_b16 v[102:103], v36 offset:9216
    ds_read_b128 v[116:119], v44 offset:20480
    v_cvt_pk_bf16_f32 v235, v238, v239
    s_waitcnt lgkmcnt(9)
    v_mfma_f32_32x32x16_bf16 v[128:143], v[72:75], v[88:91], v[128:143]
    buffer_load_dwordx4 v19, s[16:19], s45 offen offset:2048 nt lds
    s_waitcnt vmcnt(12)
    ds_read_b64_tr_b16 v[104:105], v35 offset:10240
    s_waitcnt vmcnt(11)
    ds_read_b64_tr_b16 v[106:107], v35 offset:11264
    ds_write_b128 v42, v[232:235] offset:14336
    v_mul_f32 v240, v240, v55
    s_waitcnt lgkmcnt(10)
    v_mfma_f32_32x32x16_bf16 v[160:175], v[76:79], v[88:91], v[160:175]
    ds_read_b128 v[120:123], v43 offset:22528
    ds_read_b64_tr_b16 v[108:109], v36 offset:10240
    v_mul_f32 v241, v241, v55
    v_mul_f32 v242, v242, v55
    s_waitcnt lgkmcnt(11)
    v_mfma_f32_32x32x16_bf16 v[144:159], v[72:75], v[92:95], v[144:159]
    buffer_load_dwordx4 v20, s[16:19], s45 offen offset:3072 nt lds
    ds_read_b64_tr_b16 v[110:111], v36 offset:11264
    ds_read_b128 v[124:127], v44 offset:22528
    v_mul_f32 v243, v243, v55
    v_mul_f32 v244, v244, v55
    v_mfma_f32_32x32x16_bf16 v[176:191], v[76:79], v[92:95], v[176:191]
    v_mul_f32 v245, v245, v55
    s_waitcnt lgkmcnt(10)
    v_mfma_f32_32x32x16_bf16 v[128:143], v[96:99], v[112:115], v[128:143]
    s_add_u32 m0, s44, 0
    s_mov_b32 s45, 147456
    buffer_load_dwordx4 v17, s[16:19], s45 offen nt lds
    v_mul_f32 v246, v246, v55
    v_mul_f32 v247, v247, v55
    s_waitcnt lgkmcnt(8)
    v_mfma_f32_32x32x16_bf16 v[160:175], v[100:103], v[112:115], v[160:175]
    s_waitcnt vmcnt(12)
    ds_read_b64_tr_b16 v[64:65], v35 offset:12288
    s_waitcnt vmcnt(11)
    ds_read_b64_tr_b16 v[66:67], v35 offset:13312
    v_cvt_pk_bf16_f32 v240, v240, v241
    v_cvt_pk_bf16_f32 v241, v242, v243
    s_waitcnt lgkmcnt(9)
    v_mfma_f32_32x32x16_bf16 v[144:159], v[96:99], v[116:119], v[144:159]
    buffer_load_dwordx4 v18, s[16:19], s45 offen offset:1024 nt lds
    ds_read_b128 v[80:83], v43 offset:36864
    ds_read_b64_tr_b16 v[68:69], v36 offset:12288
    v_cvt_pk_bf16_f32 v242, v244, v245
    v_cvt_pk_bf16_f32 v243, v246, v247
    v_mfma_f32_32x32x16_bf16 v[176:191], v[100:103], v[116:119], v[176:191]
    ds_read_b64_tr_b16 v[70:71], v36 offset:13312
    ds_read_b128 v[84:87], v44 offset:36864
    ds_write_b128 v42, v[240:243] offset:13312
    s_waitcnt lgkmcnt(10)
    v_mfma_f32_32x32x16_bf16 v[128:143], v[104:107], v[120:123], v[128:143]
    buffer_load_dwordx4 v19, s[16:19], s45 offen offset:2048 nt lds
    s_waitcnt vmcnt(12)
    ds_read_b64_tr_b16 v[72:73], v35 offset:14336
    s_waitcnt vmcnt(11)
    ds_read_b64_tr_b16 v[74:75], v35 offset:15360
    v_mul_f32 v248, v248, v55
    v_mul_f32 v249, v249, v55
    s_waitcnt lgkmcnt(10)
    v_mfma_f32_32x32x16_bf16 v[160:175], v[108:111], v[120:123], v[160:175]
    ds_read_b128 v[88:91], v43 offset:38912
    ds_read_b64_tr_b16 v[76:77], v36 offset:14336
    v_mul_f32 v250, v250, v55
    v_mul_f32 v251, v251, v55
    s_waitcnt lgkmcnt(11)
    v_mfma_f32_32x32x16_bf16 v[144:159], v[104:107], v[124:127], v[144:159]
    buffer_load_dwordx4 v20, s[16:19], s45 offen offset:3072 nt lds
    ds_read_b64_tr_b16 v[78:79], v36 offset:15360
    ds_read_b128 v[92:95], v44 offset:38912
    v_mul_f32 v252, v252, v55
    v_mul_f32 v253, v253, v55
    v_mfma_f32_32x32x16_bf16 v[176:191], v[108:111], v[124:127], v[176:191]
    v_mul_f32 v254, v254, v55
    s_waitcnt lgkmcnt(10)
    v_mfma_f32_32x32x16_bf16 v[128:143], v[64:67], v[80:83], v[128:143]
    s_add_u32 m0, s44, 4096
    s_mov_b32 s45, 163840
    buffer_load_dwordx4 v17, s[16:19], s45 offen nt lds
    v_mul_f32 v255, v255, v55
    v_cvt_pk_bf16_f32 v248, v248, v249
    s_waitcnt lgkmcnt(8)
    v_mfma_f32_32x32x16_bf16 v[160:175], v[68:71], v[80:83], v[160:175]
    s_waitcnt vmcnt(12)
    ds_read_b64_tr_b16 v[96:97], v35 offset:16384
    s_waitcnt vmcnt(11)
    ds_read_b64_tr_b16 v[98:99], v35 offset:17408
    v_cvt_pk_bf16_f32 v249, v250, v251
    s_waitcnt lgkmcnt(9)
    v_mfma_f32_32x32x16_bf16 v[144:159], v[64:67], v[84:87], v[144:159]
    buffer_load_dwordx4 v18, s[16:19], s45 offen offset:1024 nt lds
    ds_read_b128 v[112:115], v43 offset:53248
    ds_read_b64_tr_b16 v[100:101], v36 offset:16384
    v_cvt_pk_bf16_f32 v250, v252, v253
    v_cvt_pk_bf16_f32 v251, v254, v255
    v_mfma_f32_32x32x16_bf16 v[176:191], v[68:71], v[84:87], v[176:191]
    ds_read_b64_tr_b16 v[102:103], v36 offset:17408
    ds_read_b128 v[116:119], v44 offset:53248
    ds_write_b128 v42, v[248:251] offset:15360
    s_waitcnt lgkmcnt(10)
    v_mfma_f32_32x32x16_bf16 v[128:143], v[72:75], v[88:91], v[128:143]
    buffer_load_dwordx4 v19, s[16:19], s45 offen offset:2048 nt lds
    s_waitcnt vmcnt(12)
    ds_read_b64_tr_b16 v[104:105], v35 offset:18432
    s_waitcnt vmcnt(11)
    ds_read_b64_tr_b16 v[106:107], v35 offset:19456
    v_mov_b32 v2, 0
    s_waitcnt lgkmcnt(10)
    v_mfma_f32_32x32x16_bf16 v[160:175], v[76:79], v[88:91], v[160:175]
    ds_read_b128 v[120:123], v43 offset:55296
    ds_read_b64_tr_b16 v[108:109], v36 offset:18432
    buffer_load_dwordx4 v[28:31], v2, s[36:39], s60 offen sc1
    s_lshl_b32 s3, s50, 10
    s_waitcnt lgkmcnt(11)
    v_mfma_f32_32x32x16_bf16 v[144:159], v[72:75], v[92:95], v[144:159]
    buffer_load_dwordx4 v20, s[16:19], s45 offen offset:3072 nt lds
    ds_read_b64_tr_b16 v[110:111], v36 offset:19456
    ds_read_b128 v[124:127], v44 offset:55296
    v_add_u32 v16, s3, v42
    v_mfma_f32_32x32x16_bf16 v[176:191], v[76:79], v[92:95], v[176:191]
    v_xor_b32 v12, 0x400, v16
    s_waitcnt lgkmcnt(10)
    v_mfma_f32_32x32x16_bf16 v[128:143], v[96:99], v[112:115], v[128:143]
    s_add_u32 m0, s44, 8192
    s_mov_b32 s45, 180224
    buffer_load_dwordx4 v17, s[16:19], s45 offen nt lds
    s_waitcnt lgkmcnt(8)
    v_mfma_f32_32x32x16_bf16 v[160:175], v[100:103], v[112:115], v[160:175]
    s_waitcnt lgkmcnt(0)
    s_barrier
    s_waitcnt vmcnt(13)
    ds_read_b64_tr_b16 v[64:65], v35 offset:20480
    s_waitcnt vmcnt(12)
    ds_read_b64_tr_b16 v[66:67], v35 offset:21504
    v_mfma_f32_32x32x16_bf16 v[144:159], v[96:99], v[116:119], v[144:159]
    buffer_load_dwordx4 v18, s[16:19], s45 offen offset:1024 nt lds
    ds_read_b128 v[80:83], v43 offset:8192
    ds_read_b64_tr_b16 v[68:69], v36 offset:20480
    v_mfma_f32_32x32x16_bf16 v[176:191], v[100:103], v[116:119], v[176:191]
    ds_read_b64_tr_b16 v[70:71], v36 offset:21504
    ds_read_b128 v[84:87], v44 offset:8192
    v_mfma_f32_32x32x16_bf16 v[128:143], v[104:107], v[120:123], v[128:143]
    buffer_load_dwordx4 v19, s[16:19], s45 offen offset:2048 nt lds
    s_waitcnt vmcnt(13)
    ds_read_b64_tr_b16 v[72:73], v35 offset:22528
    s_waitcnt vmcnt(12)
    ds_read_b64_tr_b16 v[74:75], v35 offset:23552
    v_mfma_f32_32x32x16_bf16 v[160:175], v[108:111], v[120:123], v[160:175]
    ds_read_b128 v[88:91], v43 offset:10240
    ds_read_b64_tr_b16 v[76:77], v36 offset:22528
    v_mfma_f32_32x32x16_bf16 v[144:159], v[104:107], v[124:127], v[144:159]
    buffer_load_dwordx4 v20, s[16:19], s45 offen offset:3072 nt lds
    ds_read_b64_tr_b16 v[78:79], v36 offset:23552
    ds_read_b128 v[92:95], v44 offset:10240
    v_mfma_f32_32x32x16_bf16 v[176:191], v[108:111], v[124:127], v[176:191]
    s_waitcnt lgkmcnt(9)
    v_mfma_f32_32x32x16_bf16 v[128:143], v[64:67], v[80:83], v[128:143]
    s_add_u32 m0, s44, 12288
    s_mov_b32 s45, 196608
    buffer_load_dwordx4 v17, s[16:19], s45 offen nt lds
    s_waitcnt lgkmcnt(7)
    v_mfma_f32_32x32x16_bf16 v[160:175], v[68:71], v[80:83], v[160:175]
    s_waitcnt vmcnt(13)
    ds_read_b64_tr_b16 v[96:97], v35 offset:0
    s_waitcnt vmcnt(12)
    ds_read_b64_tr_b16 v[98:99], v35 offset:1024
    s_waitcnt lgkmcnt(8)
    v_mfma_f32_32x32x16_bf16 v[144:159], v[64:67], v[84:87], v[144:159]
    buffer_load_dwordx4 v18, s[16:19], s45 offen offset:1024 nt lds
    ds_read_b128 v[112:115], v43 offset:24576
    ds_read_b64_tr_b16 v[100:101], v36 offset:0
    v_mfma_f32_32x32x16_bf16 v[176:191], v[68:71], v[84:87], v[176:191]
    ds_read_b64_tr_b16 v[102:103], v36 offset:1024
    ds_read_b128 v[116:119], v44 offset:24576
    s_waitcnt lgkmcnt(9)
    v_mfma_f32_32x32x16_bf16 v[128:143], v[72:75], v[88:91], v[128:143]
    buffer_load_dwordx4 v19, s[16:19], s45 offen offset:2048 nt lds
    s_waitcnt vmcnt(13)
    ds_read_b64_tr_b16 v[104:105], v35 offset:2048
    s_waitcnt vmcnt(12)
    ds_read_b64_tr_b16 v[106:107], v35 offset:3072
    s_waitcnt lgkmcnt(9)
    v_mfma_f32_32x32x16_bf16 v[160:175], v[76:79], v[88:91], v[160:175]
    ds_read_b128 v[120:123], v43 offset:26624
    ds_read_b64_tr_b16 v[108:109], v36 offset:2048
    s_waitcnt lgkmcnt(10)
    v_mfma_f32_32x32x16_bf16 v[144:159], v[72:75], v[92:95], v[144:159]
    buffer_load_dwordx4 v20, s[16:19], s45 offen offset:3072 nt lds
    ds_read_b64_tr_b16 v[110:111], v36 offset:3072
    ds_read_b128 v[124:127], v44 offset:26624
    v_mfma_f32_32x32x16_bf16 v[176:191], v[76:79], v[92:95], v[176:191]
    s_waitcnt lgkmcnt(9)
    v_mfma_f32_32x32x16_bf16 v[128:143], v[96:99], v[112:115], v[128:143]
    s_add_u32 m0, s44, 16384
    s_mov_b32 s45, 212992
    buffer_load_dwordx4 v17, s[16:19], s45 offen nt lds
    s_waitcnt lgkmcnt(7)
    v_mfma_f32_32x32x16_bf16 v[160:175], v[100:103], v[112:115], v[160:175]
    s_waitcnt vmcnt(13)
    ds_read_b64_tr_b16 v[64:65], v35 offset:4096
    s_waitcnt vmcnt(12)
    ds_read_b64_tr_b16 v[66:67], v35 offset:5120
    s_waitcnt lgkmcnt(8)
    v_mfma_f32_32x32x16_bf16 v[144:159], v[96:99], v[116:119], v[144:159]
    buffer_load_dwordx4 v18, s[16:19], s45 offen offset:1024 nt lds
    ds_read_b128 v[80:83], v43 offset:40960
    ds_read_b64_tr_b16 v[68:69], v36 offset:4096
    v_mfma_f32_32x32x16_bf16 v[176:191], v[100:103], v[116:119], v[176:191]
    ds_read_b64_tr_b16 v[70:71], v36 offset:5120
    ds_read_b128 v[84:87], v44 offset:40960
    s_waitcnt lgkmcnt(9)
    v_mfma_f32_32x32x16_bf16 v[128:143], v[104:107], v[120:123], v[128:143]
    buffer_load_dwordx4 v19, s[16:19], s45 offen offset:2048 nt lds
    s_waitcnt vmcnt(13)
    ds_read_b64_tr_b16 v[72:73], v35 offset:6144
    s_waitcnt vmcnt(11)
    ds_read_b64_tr_b16 v[74:75], v35 offset:7168
    s_waitcnt lgkmcnt(9)
    v_mfma_f32_32x32x16_bf16 v[160:175], v[108:111], v[120:123], v[160:175]
    ds_read_b128 v[88:91], v43 offset:43008
    ds_read_b64_tr_b16 v[76:77], v36 offset:6144
    s_waitcnt lgkmcnt(10)
    v_mfma_f32_32x32x16_bf16 v[144:159], v[104:107], v[124:127], v[144:159]
    buffer_load_dwordx4 v20, s[16:19], s45 offen offset:3072 nt lds
    ds_read_b64_tr_b16 v[78:79], v36 offset:7168
    ds_read_b128 v[92:95], v44 offset:43008
    v_mfma_f32_32x32x16_bf16 v[176:191], v[108:111], v[124:127], v[176:191]
    s_waitcnt lgkmcnt(9)
    v_mfma_f32_32x32x16_bf16 v[128:143], v[64:67], v[80:83], v[128:143]
    s_add_u32 m0, s44, 20480
    s_mov_b32 s45, 229376
    buffer_load_dwordx4 v17, s[16:19], s45 offen nt lds
    s_waitcnt lgkmcnt(7)
    v_mfma_f32_32x32x16_bf16 v[160:175], v[68:71], v[80:83], v[160:175]
    s_waitcnt vmcnt(12)
    ds_read_b64_tr_b16 v[96:97], v35 offset:8192
    s_waitcnt vmcnt(11)
    ds_read_b64_tr_b16 v[98:99], v35 offset:9216
    s_waitcnt lgkmcnt(8)
    v_mfma_f32_32x32x16_bf16 v[144:159], v[64:67], v[84:87], v[144:159]
    buffer_load_dwordx4 v18, s[16:19], s45 offen offset:1024 nt lds
    ds_read_b128 v[112:115], v43 offset:57344
    ds_read_b64_tr_b16 v[100:101], v36 offset:8192
    v_mfma_f32_32x32x16_bf16 v[176:191], v[68:71], v[84:87], v[176:191]
    ds_read_b64_tr_b16 v[102:103], v36 offset:9216
    ds_read_b128 v[116:119], v44 offset:57344
    s_waitcnt lgkmcnt(9)
    v_mfma_f32_32x32x16_bf16 v[128:143], v[72:75], v[88:91], v[128:143]
    buffer_load_dwordx4 v19, s[16:19], s45 offen offset:2048 nt lds
    s_waitcnt vmcnt(12)
    ds_read_b64_tr_b16 v[104:105], v35 offset:10240
    s_waitcnt vmcnt(11)
    ds_read_b64_tr_b16 v[106:107], v35 offset:11264
    s_waitcnt lgkmcnt(9)
    v_mfma_f32_32x32x16_bf16 v[160:175], v[76:79], v[88:91], v[160:175]
    ds_read_b128 v[120:123], v43 offset:59392
    ds_read_b64_tr_b16 v[108:109], v36 offset:10240
    s_waitcnt lgkmcnt(10)
    v_mfma_f32_32x32x16_bf16 v[144:159], v[72:75], v[92:95], v[144:159]
    buffer_load_dwordx4 v20, s[16:19], s45 offen offset:3072 nt lds
    ds_read_b64_tr_b16 v[110:111], v36 offset:11264
    ds_read_b128 v[124:127], v44 offset:59392
    v_mfma_f32_32x32x16_bf16 v[176:191], v[76:79], v[92:95], v[176:191]
    s_waitcnt lgkmcnt(9)
    v_mfma_f32_32x32x16_bf16 v[128:143], v[96:99], v[112:115], v[128:143]
    s_add_u32 m0, s44, 0
    s_mov_b32 s45, 245760
    buffer_load_dwordx4 v17, s[16:19], s45 offen nt lds
    s_waitcnt lgkmcnt(7)
    v_mfma_f32_32x32x16_bf16 v[160:175], v[100:103], v[112:115], v[160:175]
    s_waitcnt vmcnt(12)
    ds_read_b64_tr_b16 v[64:65], v35 offset:12288
    s_waitcnt vmcnt(11)
    ds_read_b64_tr_b16 v[66:67], v35 offset:13312
    s_waitcnt lgkmcnt(8)
    v_mfma_f32_32x32x16_bf16 v[144:159], v[96:99], v[116:119], v[144:159]
    buffer_load_dwordx4 v18, s[16:19], s45 offen offset:1024 nt lds
    ds_read_b128 v[80:83], v43 offset:12288
    ds_read_b64_tr_b16 v[68:69], v36 offset:12288
    v_mfma_f32_32x32x16_bf16 v[176:191], v[100:103], v[116:119], v[176:191]
    ds_read_b64_tr_b16 v[70:71], v36 offset:13312
    ds_read_b128 v[84:87], v44 offset:12288
    s_waitcnt lgkmcnt(9)
    v_mfma_f32_32x32x16_bf16 v[128:143], v[104:107], v[120:123], v[128:143]
    buffer_load_dwordx4 v19, s[16:19], s45 offen offset:2048 nt lds
    s_waitcnt vmcnt(12)
    ds_read_b64_tr_b16 v[72:73], v35 offset:14336
    s_waitcnt vmcnt(11)
    ds_read_b64_tr_b16 v[74:75], v35 offset:15360
    s_waitcnt lgkmcnt(9)
    v_mfma_f32_32x32x16_bf16 v[160:175], v[108:111], v[120:123], v[160:175]
    ds_read_b128 v[88:91], v43 offset:14336
    ds_read_b64_tr_b16 v[76:77], v36 offset:14336
    s_waitcnt lgkmcnt(10)
    v_mfma_f32_32x32x16_bf16 v[144:159], v[104:107], v[124:127], v[144:159]
    buffer_load_dwordx4 v20, s[16:19], s45 offen offset:3072 nt lds
    ds_read_b64_tr_b16 v[78:79], v36 offset:15360
    ds_read_b128 v[92:95], v44 offset:14336
    v_mfma_f32_32x32x16_bf16 v[176:191], v[108:111], v[124:127], v[176:191]
    s_waitcnt lgkmcnt(9)
    v_mfma_f32_32x32x16_bf16 v[128:143], v[64:67], v[80:83], v[128:143]
    s_waitcnt lgkmcnt(7)
    v_mfma_f32_32x32x16_bf16 v[160:175], v[68:71], v[80:83], v[160:175]
    s_waitcnt vmcnt(11)
    ds_read_b64_tr_b16 v[96:97], v35 offset:16384
    s_waitcnt vmcnt(10)
    ds_read_b64_tr_b16 v[98:99], v35 offset:17408
    s_waitcnt lgkmcnt(8)
    v_mfma_f32_32x32x16_bf16 v[144:159], v[64:67], v[84:87], v[144:159]
    ds_read_b128 v[112:115], v43 offset:28672
    ds_read_b64_tr_b16 v[100:101], v36 offset:16384
    v_mfma_f32_32x32x16_bf16 v[176:191], v[68:71], v[84:87], v[176:191]
    ds_read_b64_tr_b16 v[102:103], v36 offset:17408
    ds_read_b128 v[116:119], v44 offset:28672
    s_waitcnt lgkmcnt(9)
    v_mfma_f32_32x32x16_bf16 v[128:143], v[72:75], v[88:91], v[128:143]
    s_waitcnt vmcnt(9)
    ds_read_b64_tr_b16 v[104:105], v35 offset:18432
    s_waitcnt vmcnt(8)
    ds_read_b64_tr_b16 v[106:107], v35 offset:19456
    s_waitcnt lgkmcnt(9)
    v_mfma_f32_32x32x16_bf16 v[160:175], v[76:79], v[88:91], v[160:175]
    ds_read_b128 v[120:123], v43 offset:30720
    ds_read_b64_tr_b16 v[108:109], v36 offset:18432
    s_waitcnt lgkmcnt(10)
    v_mfma_f32_32x32x16_bf16 v[144:159], v[72:75], v[92:95], v[144:159]
    ds_read_b64_tr_b16 v[110:111], v36 offset:19456
    ds_read_b128 v[124:127], v44 offset:30720
    v_mfma_f32_32x32x16_bf16 v[176:191], v[76:79], v[92:95], v[176:191]
    s_waitcnt lgkmcnt(9)
    v_mfma_f32_32x32x16_bf16 v[128:143], v[96:99], v[112:115], v[128:143]
    s_add_u32 m0, s44, 4096
    s_xor_b32 s45, s61, 3
    s_mulk_i32 s45, 14336
    buffer_load_dwordx4 v21, s[24:27], s45 offen lds
    s_waitcnt lgkmcnt(7)
    v_mfma_f32_32x32x16_bf16 v[160:175], v[100:103], v[112:115], v[160:175]
    s_waitcnt vmcnt(8)
    ds_read_b64_tr_b16 v[64:65], v35 offset:20480
    s_waitcnt vmcnt(7)
    ds_read_b64_tr_b16 v[66:67], v35 offset:21504
    s_waitcnt lgkmcnt(8)
    v_mfma_f32_32x32x16_bf16 v[144:159], v[96:99], v[116:119], v[144:159]
    buffer_load_dwordx4 v22, s[24:27], s45 offen offset:1024 lds
    ds_read_b128 v[80:83], v43 offset:45056
    ds_read_b64_tr_b16 v[68:69], v36 offset:20480
    v_mfma_f32_32x32x16_bf16 v[176:191], v[100:103], v[116:119], v[176:191]
    ds_read_b64_tr_b16 v[70:71], v36 offset:21504
    ds_read_b128 v[84:87], v44 offset:45056
    s_waitcnt lgkmcnt(9)
    v_mfma_f32_32x32x16_bf16 v[128:143], v[104:107], v[120:123], v[128:143]
    buffer_load_dwordx4 v23, s[24:27], s45 offen offset:2048 lds
    s_waitcnt vmcnt(8)
    ds_read_b64_tr_b16 v[72:73], v35 offset:22528
    s_waitcnt vmcnt(7)
    ds_read_b64_tr_b16 v[74:75], v35 offset:23552
    s_waitcnt lgkmcnt(9)
    v_mfma_f32_32x32x16_bf16 v[160:175], v[108:111], v[120:123], v[160:175]
    ds_read_b128 v[88:91], v43 offset:47104
    ds_read_b64_tr_b16 v[76:77], v36 offset:22528
    s_waitcnt lgkmcnt(10)
    v_mfma_f32_32x32x16_bf16 v[144:159], v[104:107], v[124:127], v[144:159]
    buffer_load_dwordx4 v24, s[24:27], s45 offen offset:3072 lds
    ds_read_b64_tr_b16 v[78:79], v36 offset:23552
    ds_read_b128 v[92:95], v44 offset:47104
    v_mfma_f32_32x32x16_bf16 v[176:191], v[108:111], v[124:127], v[176:191]
    s_waitcnt lgkmcnt(9)
    v_mfma_f32_32x32x16_bf16 v[128:143], v[64:67], v[80:83], v[128:143]
    s_add_u32 m0, s44, 8192
    s_xor_b32 s45, s61, 4
    s_mulk_i32 s45, 14336
    buffer_load_dwordx4 v21, s[24:27], s45 offen lds
    s_waitcnt lgkmcnt(7)
    v_mfma_f32_32x32x16_bf16 v[160:175], v[68:71], v[80:83], v[160:175]
    s_waitcnt vmcnt(8)
    ds_read_b64_tr_b16 v[96:97], v35 offset:0
    s_waitcnt vmcnt(7)
    ds_read_b64_tr_b16 v[98:99], v35 offset:1024
    s_waitcnt lgkmcnt(8)
    v_mfma_f32_32x32x16_bf16 v[144:159], v[64:67], v[84:87], v[144:159]
    buffer_load_dwordx4 v22, s[24:27], s45 offen offset:1024 lds
    ds_read_b128 v[112:115], v43 offset:61440
    ds_read_b64_tr_b16 v[100:101], v36 offset:0
    v_mfma_f32_32x32x16_bf16 v[176:191], v[68:71], v[84:87], v[176:191]
    ds_read_b64_tr_b16 v[102:103], v36 offset:1024
    ds_read_b128 v[116:119], v44 offset:61440
    s_waitcnt lgkmcnt(9)
    v_mfma_f32_32x32x16_bf16 v[128:143], v[72:75], v[88:91], v[128:143]
    buffer_load_dwordx4 v23, s[24:27], s45 offen offset:2048 lds
    s_waitcnt vmcnt(8)
    ds_read_b64_tr_b16 v[104:105], v35 offset:2048
    s_waitcnt vmcnt(7)
    ds_read_b64_tr_b16 v[106:107], v35 offset:3072
    s_waitcnt lgkmcnt(9)
    v_mfma_f32_32x32x16_bf16 v[160:175], v[76:79], v[88:91], v[160:175]
    ds_read_b128 v[120:123], v43 offset:63488
    ds_read_b64_tr_b16 v[108:109], v36 offset:2048
    s_waitcnt lgkmcnt(10)
    v_mfma_f32_32x32x16_bf16 v[144:159], v[72:75], v[92:95], v[144:159]
    buffer_load_dwordx4 v24, s[24:27], s45 offen offset:3072 lds
    ds_read_b64_tr_b16 v[110:111], v36 offset:3072
    ds_read_b128 v[124:127], v44 offset:63488
    v_mfma_f32_32x32x16_bf16 v[176:191], v[76:79], v[92:95], v[176:191]
    s_waitcnt lgkmcnt(9)
    v_mfma_f32_32x32x16_bf16 v[128:143], v[96:99], v[112:115], v[128:143]
    s_waitcnt lgkmcnt(3)
    v_mfma_f32_32x32x16_bf16 v[128:143], v[104:107], v[120:123], v[128:143]
    v_mfma_f32_32x32x16_bf16 v[144:159], v[96:99], v[116:119], v[144:159]
    s_waitcnt lgkmcnt(0)
    v_mfma_f32_32x32x16_bf16 v[144:159], v[104:107], v[124:127], v[144:159]
    v_mfma_f32_32x32x16_bf16 v[160:175], v[100:103], v[112:115], v[160:175]
    s_nop 7
    v_cvt_pk_bf16_f32 v64, v128, v129
    v_cvt_pk_bf16_f32 v65, v130, v131
    v_cvt_pk_bf16_f32 v66, v132, v133
    v_cvt_pk_bf16_f32 v67, v134, v135
    ds_write_b128 v16, v[64:67] offset:0
    v_cvt_pk_bf16_f32 v72, v136, v137
    v_cvt_pk_bf16_f32 v73, v138, v139
    v_cvt_pk_bf16_f32 v74, v140, v141
    v_cvt_pk_bf16_f32 v75, v142, v143
    ds_write_b128 v16, v[72:75] offset:2048
    v_mfma_f32_32x32x16_bf16 v[160:175], v[108:111], v[120:123], v[160:175]
    v_mfma_f32_32x32x16_bf16 v[176:191], v[100:103], v[116:119], v[176:191]
    v_cvt_pk_bf16_f32 v68, v144, v145
    v_cvt_pk_bf16_f32 v69, v146, v147
    v_cvt_pk_bf16_f32 v70, v148, v149
    v_cvt_pk_bf16_f32 v71, v150, v151
    ds_write_b128 v12, v[68:71] offset:0
    v_cvt_pk_bf16_f32 v76, v152, v153
    v_cvt_pk_bf16_f32 v77, v154, v155
    v_cvt_pk_bf16_f32 v78, v156, v157
    v_cvt_pk_bf16_f32 v79, v158, v159
    ds_write_b128 v12, v[76:79] offset:2048
    v_mfma_f32_32x32x16_bf16 v[176:191], v[108:111], v[124:127], v[176:191]
    v_cvt_pk_bf16_f32 v80, v160, v161
    v_cvt_pk_bf16_f32 v81, v162, v163
    v_cvt_pk_bf16_f32 v82, v164, v165
    v_cvt_pk_bf16_f32 v83, v166, v167
    ds_write_b128 v16, v[80:83] offset:4096
    v_cvt_pk_bf16_f32 v88, v168, v169
    v_cvt_pk_bf16_f32 v89, v170, v171
    v_cvt_pk_bf16_f32 v90, v172, v173
    v_cvt_pk_bf16_f32 v91, v174, v175
    ds_write_b128 v16, v[88:91] offset:6144
    s_nop 1
    v_cvt_pk_bf16_f32 v84, v176, v177
    v_cvt_pk_bf16_f32 v85, v178, v179
    v_cvt_pk_bf16_f32 v86, v180, v181
    v_cvt_pk_bf16_f32 v87, v182, v183
    ds_write_b128 v12, v[84:87] offset:4096
    v_cvt_pk_bf16_f32 v92, v184, v185
    v_cvt_pk_bf16_f32 v93, v186, v187
    v_cvt_pk_bf16_f32 v94, v188, v189
    v_cvt_pk_bf16_f32 v95, v190, v191
    ds_write_b128 v12, v[92:95] offset:6144
    s_add_u32 m0, s44, 12288
    s_xor_b32 s45, s61, 5
    s_mulk_i32 s45, 14336
    buffer_load_dwordx4 v21, s[24:27], s45 offen lds
    buffer_load_dwordx4 v22, s[24:27], s45 offen offset:1024 lds
    buffer_load_dwordx4 v23, s[24:27], s45 offen offset:2048 lds
    buffer_load_dwordx4 v24, s[24:27], s45 offen offset:3072 lds
    s_waitcnt lgkmcnt(0)
    s_barrier
    ds_read_b128 v[240:243], v43 offset:0
    ds_read_b128 v[244:247], v44 offset:0
    s_waitcnt lgkmcnt(1)
    v_mfma_f32_32x32x16_bf16 v[128:143], a[128:131], v[240:243], 0
    s_add_u32 m0, s44, 16384
    s_xor_b32 s45, s61, 6
    s_mulk_i32 s45, 14336
    buffer_load_dwordx4 v21, s[24:27], s45 offen lds
    s_lshl_b32 s51, s47, 1
    s_add_u32 s51, s51, s42
    v_mfma_f32_32x32x16_bf16 v[144:159], a[132:135], v[240:243], 0
    buffer_load_dwordx4 v22, s[24:27], s45 offen offset:1024 lds
    ds_read_b128 v[248:251], v43 offset:2048
    ds_read_b128 v[252:255], v44 offset:2048
    ds_read_b128 v[96:99], v43 offset:51200
    s_and_b32 s51, s51, 15
    v_mfma_f32_32x32x16_bf16 v[160:175], a[136:139], v[240:243], 0
    ds_read_b128 v[100:103], v44 offset:51200
    s_waitcnt vmcnt(11)
    ds_read_b64_tr_b16 a[176:177], v37 offset:4096
    s_lshl_b32 s3, s47, 13
    v_mfma_f32_32x32x16_bf16 v[176:191], a[140:143], v[240:243], 0
    buffer_load_dwordx4 v23, s[24:27], s45 offen offset:2048 lds
    ds_read_b64_tr_b16 a[180:181], v38 offset:4096
    ds_read_b64_tr_b16 a[184:185], v39 offset:4096
    ds_read_b64_tr_b16 a[188:189], v40 offset:4096
    s_add_u32 s3, s3, 65536
    s_waitcnt lgkmcnt(8)
    v_mfma_f32_32x32x16_bf16 v[192:207], a[128:131], v[244:247], 0
    s_waitcnt vmcnt(11)
    ds_read_b64_tr_b16 a[178:179], v37 offset:5120
    ds_read_b64_tr_b16 a[182:183], v38 offset:5120
    s_lshl_b32 s5, s51, 2
    v_mfma_f32_32x32x16_bf16 v[208:223], a[132:135], v[244:247], 0
    buffer_load_dwordx4 v24, s[24:27], s45 offen offset:3072 lds
    ds_read_b64_tr_b16 a[186:187], v39 offset:5120
    ds_read_b64_tr_b16 a[190:191], v40 offset:5120
    s_add_u32 s5, s5, s40
    v_mfma_f32_32x32x16_bf16 v[224:239], a[136:139], v[244:247], 0
    s_lshl_b32 s4, s5, 7
    s_waitcnt lgkmcnt(11)
    v_mfma_f32_32x32x16_bf16 v[128:143], a[144:147], v[248:251], v[128:143]
    s_add_u32 m0, s44, 20480
    s_xor_b32 s45, s61, 7
    s_mulk_i32 s45, 14336
    buffer_load_dwordx4 v21, s[24:27], s45 offen lds
    s_add_u32 s59, s3, s4
    v_mov_b32 v5, 1
    v_mfma_f32_32x32x16_bf16 v[144:159], a[148:151], v[248:251], v[144:159]
    buffer_load_dwordx4 v22, s[24:27], s45 offen offset:1024 lds
    ds_read_b128 v[240:243], v43 offset:4096
    ds_read_b128 v[244:247], v44 offset:4096
    ds_read_b128 v[104:107], v43 offset:53248
    v_mov_b32 v7, 0
    v_mfma_f32_32x32x16_bf16 v[160:175], a[152:155], v[248:251], v[160:175]
    ds_read_b128 v[108:111], v44 offset:53248
    s_waitcnt vmcnt(11)
    ds_read_b64_tr_b16 a[192:193], v37 offset:8192
    v_and_b32 v28, v28, v29
    v_mfma_f32_32x32x16_bf16 v[176:191], a[156:159], v[248:251], v[176:191]
    buffer_load_dwordx4 v23, s[24:27], s45 offen offset:2048 lds
    ds_read_b64_tr_b16 a[196:197], v38 offset:8192
    ds_read_b64_tr_b16 a[200:201], v39 offset:8192
    ds_read_b64_tr_b16 a[204:205], v40 offset:8192
    v_and_b32 v30, v30, v31
    s_waitcnt lgkmcnt(14)
    v_mfma_f32_32x32x16_bf16 v[192:207], a[144:147], v[252:255], v[192:207]
    s_waitcnt vmcnt(11)
    ds_read_b64_tr_b16 a[194:195], v37 offset:9216
    ds_read_b64_tr_b16 a[198:199], v38 offset:9216
    v_and_b32 v28, v28, v30
    v_mfma_f32_32x32x16_bf16 v[208:223], a[148:151], v[252:255], v[208:223]
    buffer_load_dwordx4 v24, s[24:27], s45 offen offset:3072 lds
    ds_read_b64_tr_b16 a[202:203], v39 offset:9216
    ds_read_b64_tr_b16 a[206:207], v40 offset:9216
    s_mul_i32 s6, s47, 917504
    v_mfma_f32_32x32x16_bf16 v[224:239], a[152:155], v[252:255], v[224:239]
    s_lshr_b32 s4, s5, 1
    s_waitcnt lgkmcnt(11)
    v_mfma_f32_32x32x16_bf16 v[128:143], a[160:163], v[240:243], v[128:143]
    s_add_u32 m0, s44, 0
    s_xor_b32 s45, s61, 8
    s_mulk_i32 s45, 14336
    buffer_load_dwordx4 v21, s[24:27], s45 offen lds
    s_lshl_b32 s4, s4, 15
    s_add_u32 s6, s6, s4
    v_mfma_f32_32x32x16_bf16 v[144:159], a[164:167], v[240:243], v[144:159]
    buffer_load_dwordx4 v22, s[24:27], s45 offen offset:1024 lds
    ds_read_b128 v[248:251], v43 offset:6144
    ds_read_b128 v[252:255], v44 offset:6144
    ds_read_b128 v[112:115], v43 offset:55296
    s_lshl_b32 s4, s50, 10
    v_mfma_f32_32x32x16_bf16 v[160:175], a[168:171], v[240:243], v[160:175]
    ds_read_b128 v[116:119], v44 offset:55296
    s_waitcnt vmcnt(11)
    ds_read_b64_tr_b16 a[208:209], v37 offset:12288
    s_add_u32 s6, s6, s4
    v_mfma_f32_32x32x16_bf16 v[176:191], a[172:175], v[240:243], v[176:191]
    buffer_load_dwordx4 v23, s[24:27], s45 offen offset:2048 lds
    ds_read_b64_tr_b16 a[212:213], v38 offset:12288
    ds_read_b64_tr_b16 a[216:217], v39 offset:12288
    ds_read_b64_tr_b16 a[220:221], v40 offset:12288
    s_add_u32 s6, s6, 1048576
    s_waitcnt lgkmcnt(14)
    v_mfma_f32_32x32x16_bf16 v[192:207], a[160:163], v[244:247], v[192:207]
    s_waitcnt vmcnt(11)
    ds_read_b64_tr_b16 a[210:211], v37 offset:13312
    ds_read_b64_tr_b16 a[214:215], v38 offset:13312
    s_lshl_b32 s7, s43, 1
    v_mfma_f32_32x32x16_bf16 v[208:223], a[164:167], v[244:247], v[208:223]
    buffer_load_dwordx4 v24, s[24:27], s45 offen offset:3072 lds
    ds_read_b64_tr_b16 a[218:219], v39 offset:13312
    ds_read_b64_tr_b16 a[222:223], v40 offset:13312
    s_and_b32 s4, s51, 1
    v_mfma_f32_32x32x16_bf16 v[224:239], a[168:171], v[244:247], v[224:239]
    s_add_u32 s7, s7, s4
    s_waitcnt lgkmcnt(11)
    v_mfma_f32_32x32x16_bf16 v[128:143], a[176:179], v[248:251], v[128:143]
    s_add_u32 m0, s44, 4096
    s_xor_b32 s45, s61, 9
    s_mulk_i32 s45, 14336
    buffer_load_dwordx4 v21, s[24:27], s45 offen lds
    s_mul_i32 s7, s7, 57344
    s_mul_i32 s4, s41, 896
    v_mfma_f32_32x32x16_bf16 v[144:159], a[180:183], v[248:251], v[144:159]
    buffer_load_dwordx4 v22, s[24:27], s45 offen offset:1024 lds
    ds_read_b128 v[240:243], v43 offset:16384
    ds_read_b128 v[244:247], v44 offset:16384
    s_add_u32 s7, s7, s4
    v_mfma_f32_32x32x16_bf16 v[160:175], a[184:187], v[248:251], v[160:175]
    s_waitcnt vmcnt(11)
    ds_read_b64_tr_b16 a[224:225], v37 offset:16384
    ds_read_b64_tr_b16 a[228:229], v38 offset:16384
    s_lshr_b32 s4, s51, 1
    v_mfma_f32_32x32x16_bf16 v[176:191], a[188:191], v[248:251], v[176:191]
    buffer_load_dwordx4 v23, s[24:27], s45 offen offset:2048 lds
    ds_read_b64_tr_b16 a[232:233], v39 offset:16384
    ds_read_b64_tr_b16 a[236:237], v40 offset:16384
    s_lshl_b32 s4, s4, 7
    s_waitcnt lgkmcnt(14)
    v_mfma_f32_32x32x16_bf16 v[192:207], a[176:179], v[252:255], v[192:207]
    s_waitcnt vmcnt(11)
    ds_read_b64_tr_b16 a[226:227], v37 offset:17408
    ds_read_b64_tr_b16 a[230:231], v38 offset:17408
    s_add_u32 s7, s7, s4
    v_mfma_f32_32x32x16_bf16 v[208:223], a[180:183], v[252:255], v[208:223]
    buffer_load_dwordx4 v24, s[24:27], s45 offen offset:3072 lds
    ds_read_b64_tr_b16 a[234:235], v39 offset:17408
    ds_read_b64_tr_b16 a[238:239], v40 offset:17408
    s_lshl_b32 s4, s40, 5
    v_mfma_f32_32x32x16_bf16 v[224:239], a[184:187], v[252:255], v[224:239]
    s_add_u32 s7, s7, s4
    s_waitcnt lgkmcnt(9)
    v_mfma_f32_32x32x16_bf16 v[128:143], a[192:195], v[240:243], v[128:143]
    s_add_u32 m0, s44, 8192
    s_xor_b32 s45, s61, 10
    s_mulk_i32 s45, 14336
    buffer_load_dwordx4 v21, s[24:27], s45 offen lds
    v_and_b32 v2, 31, v1
    v_mul_u32_u24 v2, 1792, v2
    v_mfma_f32_32x32x16_bf16 v[144:159], a[196:199], v[240:243], v[144:159]
    buffer_load_dwordx4 v22, s[24:27], s45 offen offset:1024 lds
    ds_read_b128 v[248:251], v43 offset:18432
    ds_read_b128 v[252:255], v44 offset:18432
    v_lshrrev_b32 v3, 5, v1
    v_mfma_f32_32x32x16_bf16 v[160:175], a[200:203], v[240:243], v[160:175]
    s_waitcnt vmcnt(11)
    ds_read_b64_tr_b16 a[240:241], v37 offset:20480
    ds_read_b64_tr_b16 a[244:245], v38 offset:20480
    v_lshl_add_u32 v2, v3, 4, v2
    v_mfma_f32_32x32x16_bf16 v[176:191], a[204:207], v[240:243], v[176:191]
    buffer_load_dwordx4 v23, s[24:27], s45 offen offset:2048 lds
    ds_read_b64_tr_b16 a[248:249], v39 offset:20480
    ds_read_b64_tr_b16 a[252:253], v40 offset:20480
    v_bfe_u32 v9, v1, 2, 1
    s_waitcnt lgkmcnt(14)
    v_mfma_f32_32x32x16_bf16 v[192:207], a[192:195], v[244:247], v[192:207]
    s_waitcnt vmcnt(11)
    ds_read_b64_tr_b16 a[242:243], v37 offset:21504
    ds_read_b64_tr_b16 a[246:247], v38 offset:21504
    v_xor_b32 v9, v9, v3
    v_mfma_f32_32x32x16_bf16 v[208:223], a[196:199], v[244:247], v[208:223]
    buffer_load_dwordx4 v24, s[24:27], s45 offen offset:3072 lds
    ds_read_b64_tr_b16 a[250:251], v39 offset:21504
    ds_read_b64_tr_b16 a[254:255], v40 offset:21504
    v_bfe_u32 v10, v1, 4, 1
    v_mfma_f32_32x32x16_bf16 v[224:239], a[200:203], v[244:247], v[224:239]
    v_or_b32 v9, v9, v10
    s_waitcnt lgkmcnt(9)
    v_mfma_f32_32x32x16_bf16 v[128:143], a[208:211], v[248:251], v[128:143]
    s_add_u32 m0, s44, 12288
    s_xor_b32 s45, s61, 11
    s_mulk_i32 s45, 14336
    buffer_load_dwordx4 v21, s[24:27], s45 offen lds
    v_lshlrev_b32 v9, 2, v9
    v_bfe_u32 v10, v1, 3, 1
    v_mfma_f32_32x32x16_bf16 v[144:159], a[212:215], v[248:251], v[144:159]
    buffer_load_dwordx4 v22, s[24:27], s45 offen offset:1024 lds
    ds_read_b128 v[240:243], v43 offset:20480
    ds_read_b128 v[244:247], v44 offset:20480
    v_lshl_add_u32 v9, v10, 1, v9
    v_mfma_f32_32x32x16_bf16 v[160:175], a[216:219], v[248:251], v[160:175]
    s_waitcnt vmcnt(11)
    ds_read_b64_tr_b16 a[0:1], v37 offset:0
    ds_read_b64_tr_b16 a[4:5], v38 offset:0
    v_bfe_u32 v10, v1, 1, 1
    v_mfma_f32_32x32x16_bf16 v[176:191], a[220:223], v[248:251], v[176:191]
    buffer_load_dwordx4 v23, s[24:27], s45 offen offset:2048 lds
    ds_read_b64_tr_b16 a[8:9], v39 offset:0
    ds_read_b64_tr_b16 a[12:13], v40 offset:0
    v_add_u32 v9, v9, v10
    s_waitcnt lgkmcnt(14)
    v_mfma_f32_32x32x16_bf16 v[192:207], a[208:211], v[252:255], v[192:207]
    s_waitcnt vmcnt(11)
    ds_read_b64_tr_b16 a[2:3], v37 offset:1024
    ds_read_b64_tr_b16 a[6:7], v38 offset:1024
    v_and_b32 v10, 1, v1
    v_mfma_f32_32x32x16_bf16 v[208:223], a[212:215], v[252:255], v[208:223]
    buffer_load_dwordx4 v24, s[24:27], s45 offen offset:3072 lds
    ds_read_b64_tr_b16 a[10:11], v39 offset:1024
    ds_read_b64_tr_b16 a[14:15], v40 offset:1024
    v_lshlrev_b32 v10, 4, v10
    v_mfma_f32_32x32x16_bf16 v[224:239], a[216:219], v[252:255], v[224:239]
    v_mov_b32 v11, 0x3f80
    s_waitcnt lgkmcnt(9)
    v_mfma_f32_32x32x16_bf16 v[128:143], a[224:227], v[240:243], v[128:143]
    s_add_u32 m0, s44, 16384
    s_xor_b32 s45, s61, 12
    s_mulk_i32 s45, 14336
    buffer_load_dwordx4 v21, s[24:27], s45 offen lds
    v_lshlrev_b32 v10, v10, v11
    v_cmp_eq_u32 vcc, 0, v9
    v_mfma_f32_32x32x16_bf16 v[144:159], a[228:231], v[240:243], v[144:159]
    buffer_load_dwordx4 v22, s[24:27], s45 offen offset:1024 lds
    ds_read_b128 v[248:251], v43 offset:22528
    ds_read_b128 v[252:255], v44 offset:22528
    v_cndmask_b32 v16, 0, v10, vcc
    v_mfma_f32_32x32x16_bf16 v[160:175], a[232:235], v[240:243], v[160:175]
    s_waitcnt vmcnt(11)
    ds_read_b64_tr_b16 a[16:17], v37 offset:4096
    ds_read_b64_tr_b16 a[20:21], v38 offset:4096
    v_cmp_eq_u32 vcc, 1, v9
    v_mfma_f32_32x32x16_bf16 v[176:191], a[236:239], v[240:243], v[176:191]
    buffer_load_dwordx4 v23, s[24:27], s45 offen offset:2048 lds
    ds_read_b64_tr_b16 a[24:25], v39 offset:4096
    ds_read_b64_tr_b16 a[28:29], v40 offset:4096
    v_cndmask_b32 v17, 0, v10, vcc
    s_waitcnt lgkmcnt(14)
    v_mfma_f32_32x32x16_bf16 v[192:207], a[224:227], v[244:247], v[192:207]
    s_waitcnt vmcnt(11)
    ds_read_b64_tr_b16 a[18:19], v37 offset:5120
    ds_read_b64_tr_b16 a[22:23], v38 offset:5120
    v_cmp_eq_u32 vcc, 2, v9
    v_mfma_f32_32x32x16_bf16 v[208:223], a[228:231], v[244:247], v[208:223]
    buffer_load_dwordx4 v24, s[24:27], s45 offen offset:3072 lds
    ds_read_b64_tr_b16 a[26:27], v39 offset:5120
    ds_read_b64_tr_b16 a[30:31], v40 offset:5120
    v_cndmask_b32 v18, 0, v10, vcc
    v_mfma_f32_32x32x16_bf16 v[224:239], a[232:235], v[244:247], v[224:239]
    v_cmp_eq_u32 vcc, 3, v9
    s_waitcnt lgkmcnt(9)
    v_mfma_f32_32x32x16_bf16 v[128:143], a[240:243], v[248:251], v[128:143]
    s_add_u32 m0, s44, 20480
    s_xor_b32 s45, s61, 13
    s_mulk_i32 s45, 14336
    buffer_load_dwordx4 v21, s[24:27], s45 offen lds
    v_cndmask_b32 v19, 0, v10, vcc
    v_mfma_f32_32x32x16_bf16 v[144:159], a[244:247], v[248:251], v[144:159]
    buffer_load_dwordx4 v22, s[24:27], s45 offen offset:1024 lds
    ds_read_b128 v[240:243], v43 offset:32768
    ds_read_b128 v[244:247], v44 offset:32768
    v_mfma_f32_32x32x16_bf16 v[160:175], a[248:251], v[248:251], v[160:175]
    s_waitcnt vmcnt(11)
    ds_read_b64_tr_b16 a[32:33], v37 offset:8192
    ds_read_b64_tr_b16 a[36:37], v38 offset:8192
    v_mfma_f32_32x32x16_bf16 v[176:191], a[252:255], v[248:251], v[176:191]
    buffer_load_dwordx4 v23, s[24:27], s45 offen offset:2048 lds
    ds_read_b64_tr_b16 a[40:41], v39 offset:8192
    ds_read_b64_tr_b16 a[44:45], v40 offset:8192
    s_waitcnt lgkmcnt(14)
    v_mfma_f32_32x32x16_bf16 v[192:207], a[240:243], v[252:255], v[192:207]
    s_waitcnt vmcnt(11)
    ds_read_b64_tr_b16 a[34:35], v37 offset:9216
    ds_read_b64_tr_b16 a[38:39], v38 offset:9216
    v_mfma_f32_32x32x16_bf16 v[208:223], a[244:247], v[252:255], v[208:223]
    buffer_load_dwordx4 v24, s[24:27], s45 offen offset:3072 lds
    ds_read_b64_tr_b16 a[42:43], v39 offset:9216
    ds_read_b64_tr_b16 a[46:47], v40 offset:9216
    v_mfma_f32_32x32x16_bf16 v[224:239], a[248:251], v[252:255], v[224:239]
    s_waitcnt lgkmcnt(9)
    v_mfma_f32_32x32x16_bf16 v[128:143], a[0:3], v[240:243], v[128:143]
    s_add_u32 m0, s44, 0
    s_xor_b32 s45, s61, 14
    s_mulk_i32 s45, 14336
    buffer_load_dwordx4 v21, s[24:27], s45 offen lds
    v_mfma_f32_32x32x16_bf16 v[144:159], a[4:7], v[240:243], v[144:159]
    buffer_load_dwordx4 v22, s[24:27], s45 offen offset:1024 lds
    ds_read_b128 v[248:251], v43 offset:34816
    ds_read_b128 v[252:255], v44 offset:34816
    v_mfma_f32_32x32x16_bf16 v[160:175], a[8:11], v[240:243], v[160:175]
    s_waitcnt vmcnt(11)
    ds_read_b64_tr_b16 a[48:49], v37 offset:12288
    ds_read_b64_tr_b16 a[52:53], v38 offset:12288
    v_mfma_f32_32x32x16_bf16 v[176:191], a[12:15], v[240:243], v[176:191]
    buffer_load_dwordx4 v23, s[24:27], s45 offen offset:2048 lds
    ds_read_b64_tr_b16 a[56:57], v39 offset:12288
    ds_read_b64_tr_b16 a[60:61], v40 offset:12288
    s_waitcnt lgkmcnt(14)
    v_mfma_f32_32x32x16_bf16 v[192:207], a[0:3], v[244:247], v[192:207]
    s_waitcnt vmcnt(11)
    ds_read_b64_tr_b16 a[50:51], v37 offset:13312
    ds_read_b64_tr_b16 a[54:55], v38 offset:13312
    v_mfma_f32_32x32x16_bf16 v[208:223], a[4:7], v[244:247], v[208:223]
    buffer_load_dwordx4 v24, s[24:27], s45 offen offset:3072 lds
    ds_read_b64_tr_b16 a[58:59], v39 offset:13312
    ds_read_b64_tr_b16 a[62:63], v40 offset:13312
    v_mfma_f32_32x32x16_bf16 v[224:239], a[8:11], v[244:247], v[224:239]
    s_waitcnt lgkmcnt(9)
    v_mfma_f32_32x32x16_bf16 v[128:143], a[16:19], v[248:251], v[128:143]
    s_add_u32 m0, s44, 4096
    s_xor_b32 s45, s61, 15
    s_mulk_i32 s45, 14336
    buffer_load_dwordx4 v21, s[24:27], s45 offen lds
    v_mfma_f32_32x32x16_bf16 v[144:159], a[20:23], v[248:251], v[144:159]
    buffer_load_dwordx4 v22, s[24:27], s45 offen offset:1024 lds
    ds_read_b128 v[240:243], v43 offset:36864
    ds_read_b128 v[244:247], v44 offset:36864
    v_mfma_f32_32x32x16_bf16 v[160:175], a[24:27], v[248:251], v[160:175]
    s_waitcnt vmcnt(11)
    ds_read_b64_tr_b16 a[64:65], v37 offset:16384
    ds_read_b64_tr_b16 a[68:69], v38 offset:16384
    v_mfma_f32_32x32x16_bf16 v[176:191], a[28:31], v[248:251], v[176:191]
    buffer_load_dwordx4 v23, s[24:27], s45 offen offset:2048 lds
    ds_read_b64_tr_b16 a[72:73], v39 offset:16384
    ds_read_b64_tr_b16 a[76:77], v40 offset:16384
    s_waitcnt lgkmcnt(14)
    v_mfma_f32_32x32x16_bf16 v[192:207], a[16:19], v[252:255], v[192:207]
    s_waitcnt vmcnt(11)
    ds_read_b64_tr_b16 a[66:67], v37 offset:17408
    ds_read_b64_tr_b16 a[70:71], v38 offset:17408
    v_mfma_f32_32x32x16_bf16 v[208:223], a[20:23], v[252:255], v[208:223]
    buffer_load_dwordx4 v24, s[24:27], s45 offen offset:3072 lds
    ds_read_b64_tr_b16 a[74:75], v39 offset:17408
    ds_read_b64_tr_b16 a[78:79], v40 offset:17408
    v_mfma_f32_32x32x16_bf16 v[224:239], a[24:27], v[252:255], v[224:239]
    s_waitcnt lgkmcnt(9)
    v_mfma_f32_32x32x16_bf16 v[128:143], a[32:35], v[240:243], v[128:143]
    v_mfma_f32_32x32x16_bf16 v[144:159], a[36:39], v[240:243], v[144:159]
    ds_read_b128 v[248:251], v43 offset:38912
    ds_read_b128 v[252:255], v44 offset:38912
    v_mfma_f32_32x32x16_bf16 v[160:175], a[40:43], v[240:243], v[160:175]
    s_waitcnt vmcnt(9)
    ds_read_b64_tr_b16 a[80:81], v37 offset:20480
    ds_read_b64_tr_b16 a[84:85], v38 offset:20480
    v_mfma_f32_32x32x16_bf16 v[176:191], a[44:47], v[240:243], v[176:191]
    ds_read_b64_tr_b16 a[88:89], v39 offset:20480
    ds_read_b64_tr_b16 a[92:93], v40 offset:20480
    s_waitcnt lgkmcnt(14)
    v_mfma_f32_32x32x16_bf16 v[192:207], a[32:35], v[244:247], v[192:207]
    s_waitcnt vmcnt(8)
    ds_read_b64_tr_b16 a[82:83], v37 offset:21504
    ds_read_b64_tr_b16 a[86:87], v38 offset:21504
    v_mfma_f32_32x32x16_bf16 v[208:223], a[36:39], v[244:247], v[208:223]
    ds_read_b64_tr_b16 a[90:91], v39 offset:21504
    ds_read_b64_tr_b16 a[94:95], v40 offset:21504
    v_mfma_f32_32x32x16_bf16 v[224:239], a[40:43], v[244:247], v[224:239]
    s_waitcnt lgkmcnt(9)
    v_mfma_f32_32x32x16_bf16 v[128:143], a[48:51], v[248:251], v[128:143]
    v_mfma_f32_32x32x16_bf16 v[144:159], a[52:55], v[248:251], v[144:159]
    ds_read_b128 v[240:243], v43 offset:49152
    ds_read_b128 v[244:247], v44 offset:49152
    v_mfma_f32_32x32x16_bf16 v[160:175], a[56:59], v[248:251], v[160:175]
    s_waitcnt vmcnt(5)
    ds_read_b64_tr_b16 a[96:97], v37 offset:0
    ds_read_b64_tr_b16 a[100:101], v38 offset:0
    v_mfma_f32_32x32x16_bf16 v[176:191], a[60:63], v[248:251], v[176:191]
    ds_read_b64_tr_b16 a[104:105], v39 offset:0
    ds_read_b64_tr_b16 a[108:109], v40 offset:0
    s_waitcnt lgkmcnt(14)
    v_mfma_f32_32x32x16_bf16 v[192:207], a[48:51], v[252:255], v[192:207]
    s_waitcnt vmcnt(4)
    ds_read_b64_tr_b16 a[98:99], v37 offset:1024
    ds_read_b64_tr_b16 a[102:103], v38 offset:1024
    v_mfma_f32_32x32x16_bf16 v[208:223], a[52:55], v[252:255], v[208:223]
    ds_read_b64_tr_b16 a[106:107], v39 offset:1024
    ds_read_b64_tr_b16 a[110:111], v40 offset:1024
    v_mfma_f32_32x32x16_bf16 v[224:239], a[56:59], v[252:255], v[224:239]
    s_waitcnt lgkmcnt(9)
    v_mfma_f32_32x32x16_bf16 v[128:143], a[64:67], v[240:243], v[128:143]
    v_mfma_f32_32x32x16_bf16 v[144:159], a[68:71], v[240:243], v[144:159]
    s_waitcnt vmcnt(1)
    ds_read_b64_tr_b16 a[112:113], v37 offset:4096
    ds_read_b64_tr_b16 a[116:117], v38 offset:4096
    v_mfma_f32_32x32x16_bf16 v[160:175], a[72:75], v[240:243], v[160:175]
    ds_read_b64_tr_b16 a[120:121], v39 offset:4096
    ds_read_b64_tr_b16 a[124:125], v40 offset:4096
    v_mfma_f32_32x32x16_bf16 v[176:191], a[76:79], v[240:243], v[176:191]
    s_waitcnt vmcnt(0)
    ds_read_b64_tr_b16 a[114:115], v37 offset:5120
    s_waitcnt lgkmcnt(13)
    v_mfma_f32_32x32x16_bf16 v[192:207], a[64:67], v[244:247], v[192:207]
    ds_read_b64_tr_b16 a[118:119], v38 offset:5120
    ds_read_b64_tr_b16 a[122:123], v39 offset:5120
    v_mfma_f32_32x32x16_bf16 v[208:223], a[68:71], v[244:247], v[208:223]
    ds_read_b64_tr_b16 a[126:127], v40 offset:5120
    v_mfma_f32_32x32x16_bf16 v[224:239], a[72:75], v[244:247], v[224:239]
    v_mfma_f32_32x32x16_bf16 v[128:143], a[80:83], v[96:99], v[128:143]
    s_waitcnt lgkmcnt(11)
    v_mfma_f32_32x32x16_bf16 v[128:143], a[96:99], v[104:107], v[128:143]
    s_waitcnt lgkmcnt(3)
    v_mfma_f32_32x32x16_bf16 v[128:143], a[112:115], v[112:115], v[128:143]
    v_mfma_f32_32x32x16_bf16 v[144:159], a[84:87], v[96:99], v[144:159]
    v_mfma_f32_32x32x16_bf16 v[144:159], a[100:103], v[104:107], v[144:159]
    s_nop 9
    v_cvt_pk_bf16_f32 v48, v128, v129
    v_cvt_pk_bf16_f32 v49, v130, v131
    v_cvt_pk_bf16_f32 v50, v132, v133
    v_cvt_pk_bf16_f32 v51, v134, v135
    buffer_store_dwordx4 v[48:51], v41, s[28:31], s52 offen sc0 sc1
    s_waitcnt lgkmcnt(2)
    v_mfma_f32_32x32x16_bf16 v[144:159], a[116:119], v[112:115], v[144:159]
    v_cvt_pk_bf16_f32 v52, v136, v137
    v_cvt_pk_bf16_f32 v53, v138, v139
    v_cvt_pk_bf16_f32 v54, v140, v141
    v_cvt_pk_bf16_f32 v55, v142, v143
    buffer_store_dwordx4 v[52:55], v41, s[28:31], s52 offen offset:1024 sc0 sc1
    v_mfma_f32_32x32x16_bf16 v[160:175], a[88:91], v[96:99], v[160:175]
    v_mfma_f32_32x32x16_bf16 v[160:175], a[104:107], v[104:107], v[160:175]
    s_nop 4
    v_cvt_pk_bf16_f32 v56, v144, v145
    v_cvt_pk_bf16_f32 v57, v146, v147
    v_cvt_pk_bf16_f32 v58, v148, v149
    v_cvt_pk_bf16_f32 v59, v150, v151
    buffer_store_dwordx4 v[56:59], v41, s[28:31], s54 offen sc0 sc1
    s_waitcnt lgkmcnt(1)
    v_mfma_f32_32x32x16_bf16 v[160:175], a[120:123], v[112:115], v[160:175]
    v_cvt_pk_bf16_f32 v60, v152, v153
    v_cvt_pk_bf16_f32 v61, v154, v155
    v_cvt_pk_bf16_f32 v62, v156, v157
    v_cvt_pk_bf16_f32 v63, v158, v159
    buffer_store_dwordx4 v[60:63], v41, s[28:31], s54 offen offset:1024 sc0 sc1
    v_mfma_f32_32x32x16_bf16 v[176:191], a[92:95], v[96:99], v[176:191]
    v_mfma_f32_32x32x16_bf16 v[176:191], a[108:111], v[104:107], v[176:191]
    s_nop 4
    v_cvt_pk_bf16_f32 v32, v160, v161
    v_cvt_pk_bf16_f32 v33, v162, v163
    v_cvt_pk_bf16_f32 v34, v164, v165
    v_cvt_pk_bf16_f32 v35, v166, v167
    buffer_store_dwordx4 v[32:35], v41, s[28:31], s56 offen sc0 sc1
    s_waitcnt lgkmcnt(0)
    v_mfma_f32_32x32x16_bf16 v[176:191], a[124:127], v[112:115], v[176:191]
    v_cvt_pk_bf16_f32 v36, v168, v169
    v_cvt_pk_bf16_f32 v37, v170, v171
    v_cvt_pk_bf16_f32 v38, v172, v173
    v_cvt_pk_bf16_f32 v39, v174, v175
    buffer_store_dwordx4 v[36:39], v41, s[28:31], s56 offen offset:1024 sc0 sc1
    v_mfma_f32_32x32x16_bf16 v[192:207], a[80:83], v[100:103], v[192:207]
    v_mfma_f32_32x32x16_bf16 v[192:207], a[96:99], v[108:111], v[192:207]
    s_nop 4
    v_cvt_pk_bf16_f32 v48, v176, v177
    v_cvt_pk_bf16_f32 v49, v178, v179
    v_cvt_pk_bf16_f32 v50, v180, v181
    v_cvt_pk_bf16_f32 v51, v182, v183
    buffer_store_dwordx4 v[48:51], v41, s[28:31], s58 offen sc0 sc1
    v_mfma_f32_32x32x16_bf16 v[192:207], a[112:115], v[116:119], v[192:207]
    v_cvt_pk_bf16_f32 v52, v184, v185
    v_cvt_pk_bf16_f32 v53, v186, v187
    v_cvt_pk_bf16_f32 v54, v188, v189
    v_cvt_pk_bf16_f32 v55, v190, v191
    buffer_store_dwordx4 v[52:55], v41, s[28:31], s58 offen offset:1024 sc0 sc1
    v_mfma_f32_32x32x16_bf16 v[208:223], a[84:87], v[100:103], v[208:223]
    v_mfma_f32_32x32x16_bf16 v[208:223], a[100:103], v[108:111], v[208:223]
    s_nop 4
    v_cvt_pk_bf16_f32 v56, v192, v193
    v_cvt_pk_bf16_f32 v57, v194, v195
    v_cvt_pk_bf16_f32 v58, v196, v197
    v_cvt_pk_bf16_f32 v59, v198, v199
    buffer_store_dwordx4 v[56:59], v41, s[28:31], s53 offen sc0 sc1
    v_mfma_f32_32x32x16_bf16 v[208:223], a[116:119], v[116:119], v[208:223]
    v_cvt_pk_bf16_f32 v60, v200, v201
    v_cvt_pk_bf16_f32 v61, v202, v203
    v_cvt_pk_bf16_f32 v62, v204, v205
    v_cvt_pk_bf16_f32 v63, v206, v207
    buffer_store_dwordx4 v[60:63], v41, s[28:31], s53 offen offset:1024 sc0 sc1
    v_mfma_f32_32x32x16_bf16 v[224:239], a[88:91], v[100:103], v[224:239]
    v_mfma_f32_32x32x16_bf16 v[224:239], a[104:107], v[108:111], v[224:239]
    s_nop 4
    v_cvt_pk_bf16_f32 v32, v208, v209
    v_cvt_pk_bf16_f32 v33, v210, v211
    v_cvt_pk_bf16_f32 v34, v212, v213
    v_cvt_pk_bf16_f32 v35, v214, v215
    buffer_store_dwordx4 v[32:35], v41, s[28:31], s55 offen sc0 sc1
    v_mfma_f32_32x32x16_bf16 v[224:239], a[120:123], v[116:119], v[224:239]
    v_cvt_pk_bf16_f32 v36, v216, v217
    v_cvt_pk_bf16_f32 v37, v218, v219
    v_cvt_pk_bf16_f32 v38, v220, v221
    v_cvt_pk_bf16_f32 v39, v222, v223
    buffer_store_dwordx4 v[36:39], v41, s[28:31], s55 offen offset:1024 sc0 sc1
    s_nop 6
    v_cvt_pk_bf16_f32 v48, v224, v225
    v_cvt_pk_bf16_f32 v49, v226, v227
    v_cvt_pk_bf16_f32 v50, v228, v229
    v_cvt_pk_bf16_f32 v51, v230, v231
    buffer_store_dwordx4 v[48:51], v41, s[28:31], s57 offen sc0 sc1
    v_cvt_pk_bf16_f32 v52, v232, v233
    v_cvt_pk_bf16_f32 v53, v234, v235
    v_cvt_pk_bf16_f32 v54, v236, v237
    v_cvt_pk_bf16_f32 v55, v238, v239
    buffer_store_dwordx4 v[52:55], v41, s[28:31], s57 offen offset:1024 sc0 sc1
    v_cmp_eq_u32 vcc, 1, v28
    s_mov_b32 s5, 100000
    s_nop 2
    s_cbranch_vccnz L_go2
L_ready2:
    buffer_load_dwordx4 v[28:31], v7, s[36:39], s60 offen sc0 sc1
    s_sub_u32 s5, s5, 1
    s_cmp_eq_u32 s5, 0
    s_waitcnt vmcnt(0)
    s_cbranch_scc1 L_go2
    v_and_b32 v28, v28, v29
    v_and_b32 v30, v30, v31
    v_and_b32 v28, v28, v30
    v_cmp_eq_u32 vcc, 1, v28
    s_nop 3
    s_cbranch_vccz L_ready2
L_go2:
    s_mov_b64 exec, 0x333
    s_waitcnt vmcnt(8)
    buffer_atomic_add v5, v4, s[28:31], s3 offen sc1
    s_mov_b64 exec, 0x300c
    s_waitcnt vmcnt(5)
    buffer_atomic_add v5, v4, s[28:31], s3 offen sc1
    s_mov_b64 exec, 0xcc0
    s_waitcnt vmcnt(2)
    buffer_atomic_add v5, v4, s[28:31], s3 offen sc1
    s_mov_b64 exec, -1
    s_cmp_ge_u32 s51, 14
    s_cbranch_scc1 L_fin2
    s_mov_b32 s5, 100000
    s_mov_b64 exec, 1
L_poll2:
    s_nop 0
    v_mov_b32 v3, 0
    buffer_atomic_add v3, v7, s[28:31], s59 offen sc0 sc1
    s_waitcnt vmcnt(0)
    v_cmp_eq_u32 vcc, 16, v3
    s_nop 3
    s_cbranch_vccnz L_polled2
    s_sub_u32 s5, s5, 1
    s_cmp_lg_u32 s5, 0
    s_cbranch_scc1 L_poll2
L_polled2:
    s_mov_b64 exec, -1
    s_nop 0
    buffer_load_dwordx4 v[64:67], v41, s[28:31], s6 offen sc0 sc1
    buffer_load_dwordx4 v[68:71], v41, s[28:31], s6 offen offset:2048 sc0 sc1
    s_addk_i32 s6, 4096
    buffer_load_dwordx4 v[72:75], v41, s[28:31], s6 offen sc0 sc1
    buffer_load_dwordx4 v[76:79], v41, s[28:31], s6 offen offset:2048 sc0 sc1
    s_addk_i32 s6, 4096
    buffer_load_dwordx4 v[80:83], v41, s[28:31], s6 offen sc0 sc1
    buffer_load_dwordx4 v[84:87], v41, s[28:31], s6 offen offset:2048 sc0 sc1
    s_addk_i32 s6, 4096
    buffer_load_dwordx4 v[88:91], v41, s[28:31], s6 offen sc0 sc1
    buffer_load_dwordx4 v[92:95], v41, s[28:31], s6 offen offset:2048 sc0 sc1
    s_addk_i32 s6, 4096
    buffer_load_dwordx4 v[96:99], v41, s[28:31], s6 offen sc0 sc1
    buffer_load_dwordx4 v[100:103], v41, s[28:31], s6 offen offset:2048 sc0 sc1
    s_addk_i32 s6, 4096
    buffer_load_dwordx4 v[104:107], v41, s[28:31], s6 offen sc0 sc1
    buffer_load_dwordx4 v[108:111], v41, s[28:31], s6 offen offset:2048 sc0 sc1
    s_addk_i32 s6, 4096
    buffer_load_dwordx4 v[112:115], v41, s[28:31], s6 offen sc0 sc1
    buffer_load_dwordx4 v[116:119], v41, s[28:31], s6 offen offset:2048 sc0 sc1
    s_addk_i32 s6, 4096
    buffer_load_dwordx4 v[120:123], v41, s[28:31], s6 offen sc0 sc1
    buffer_load_dwordx4 v[124:127], v41, s[28:31], s6 offen offset:2048 sc0 sc1
    s_waitcnt vmcnt(15)
    v_mfma_f32_32x32x16_bf16 v[128:143], v[16:19], v[64:67], 0
    s_waitcnt vmcnt(14)
    v_mfma_f32_32x32x16_bf16 v[128:143], v[16:19], v[68:71], v[128:143]
    s_waitcnt vmcnt(13)
    v_mfma_f32_32x32x16_bf16 v[128:143], v[16:19], v[72:75], v[128:143]
    s_waitcnt vmcnt(12)
    v_mfma_f32_32x32x16_bf16 v[128:143], v[16:19], v[76:79], v[128:143]
    s_waitcnt vmcnt(11)
    v_mfma_f32_32x32x16_bf16 v[128:143], v[16:19], v[80:83], v[128:143]
    s_waitcnt vmcnt(10)
    v_mfma_f32_32x32x16_bf16 v[128:143], v[16:19], v[84:87], v[128:143]
    s_waitcnt vmcnt(9)
    v_mfma_f32_32x32x16_bf16 v[128:143], v[16:19], v[88:91], v[128:143]
    s_waitcnt vmcnt(8)
    v_mfma_f32_32x32x16_bf16 v[128:143], v[16:19], v[92:95], v[128:143]
    s_waitcnt vmcnt(7)
    v_mfma_f32_32x32x16_bf16 v[128:143], v[16:19], v[96:99], v[128:143]
    s_waitcnt vmcnt(6)
    v_mfma_f32_32x32x16_bf16 v[128:143], v[16:19], v[100:103], v[128:143]
    s_waitcnt vmcnt(5)
    v_mfma_f32_32x32x16_bf16 v[128:143], v[16:19], v[104:107], v[128:143]
    s_waitcnt vmcnt(4)
    v_mfma_f32_32x32x16_bf16 v[128:143], v[16:19], v[108:111], v[128:143]
    s_waitcnt vmcnt(3)
    v_mfma_f32_32x32x16_bf16 v[128:143], v[16:19], v[112:115], v[128:143]
    s_waitcnt vmcnt(2)
    v_mfma_f32_32x32x16_bf16 v[128:143], v[16:19], v[116:119], v[128:143]
    s_waitcnt vmcnt(1)
    v_mfma_f32_32x32x16_bf16 v[128:143], v[16:19], v[120:123], v[128:143]
    s_waitcnt vmcnt(0)
    v_mfma_f32_32x32x16_bf16 v[128:143], v[16:19], v[124:127], v[128:143]
    s_nop 11
    v_cvt_pk_bf16_f32 v56, v128, v129
    v_cvt_pk_bf16_f32 v57, v130, v131
    v_cvt_pk_bf16_f32 v58, v132, v133
    v_cvt_pk_bf16_f32 v59, v134, v135
    buffer_store_dwordx4 v[56:59], v2, s[32:35], s7 offen
L_fin2:
    s_endpgm
.p2align 6
L_class3:
    s_waitcnt vmcnt(8)
    s_barrier
    s_cmp_lg_u32 s42, 15
    s_cbranch_scc1 L_noset3
    s_lshl_b32 s3, s40, 2
    s_add_u32 s3, s3, s60
    v_mov_b32 v2, 0
    v_mov_b32 v3, 1
    s_mov_b64 exec, 1
    s_nop 0
    buffer_store_dword v3, v2, s[36:39], s3 offen sc0 sc1
    s_mov_b64 exec, -1
L_noset3:
    s_add_u32 m0, s44, 8192
    s_xor_b32 s45, s69, 0
    buffer_load_dwordx4 v13, s[12:15], s45 offen nt lds
    buffer_load_dwordx4 v14, s[12:15], s45 offen offset:1024 nt lds
    buffer_load_dwordx4 v15, s[12:15], s45 offen offset:2048 nt lds
    buffer_load_dwordx4 v16, s[12:15], s45 offen offset:3072 nt lds
    s_add_u32 m0, s44, 12288
    s_xor_b32 s45, s69, 128
    buffer_load_dwordx4 v13, s[12:15], s45 offen nt lds
    buffer_load_dwordx4 v14, s[12:15], s45 offen offset:1024 nt lds
    buffer_load_dwordx4 v15, s[12:15], s45 offen offset:2048 nt lds
    buffer_load_dwordx4 v16, s[12:15], s45 offen offset:3072 nt lds
    s_mul_i32 s3, s47, 917504
    s_mul_i32 s4, s42, 2048
    s_add_u32 s3, s3, s4
    s_add_u32 s3, s3, 1048576
    s_lshr_b32 s4, s40, 1
    s_mul_i32 s4, s4, 7
    s_mul_i32 s5, s50, 3
    s_add_u32 s4, s4, s5
    s_waitcnt vmcnt(14)
    ds_read_b64_tr_b16 v[64:65], v29 offset:0
    ds_read_b64_tr_b16 v[66:67], v29 offset:512
    ds_read_b128 v[80:83], v25 offset:0
    ds_read_b64_tr_b16 v[68:69], v30 offset:0
    ds_read_b64_tr_b16 v[70:71], v30 offset:512
    ds_read_b128 v[84:87], v25 offset:4096
    s_waitcnt vmcnt(12)
    ds_read_b64_tr_b16 v[72:73], v29 offset:2048
    ds_read_b64_tr_b16 v[74:75], v29 offset:2560
    ds_read_b128 v[88:91], v26 offset:0
    ds_read_b64_tr_b16 v[76:77], v30 offset:2048
    ds_read_b64_tr_b16 v[78:79], v30 offset:2560
    ds_read_b128 v[92:95], v26 offset:4096
    s_add_u32 m0, s44, 16384
    s_xor_b32 s45, s69, 256
    buffer_load_dwordx4 v13, s[12:15], s45 offen nt lds
    buffer_load_dwordx4 v14, s[12:15], s45 offen offset:1024 nt lds
    buffer_load_dwordx4 v15, s[12:15], s45 offen offset:2048 nt lds
    buffer_load_dwordx4 v16, s[12:15], s45 offen offset:3072 nt lds
    s_waitcnt lgkmcnt(9)
    v_mfma_f32_32x32x16_bf16 v[128:143], v[64:67], v[80:83], 0
    s_lshl_b32 s7, s50, 1
    s_waitcnt lgkmcnt(7)
    v_mfma_f32_32x32x16_bf16 v[160:175], v[68:71], v[80:83], 0
    s_waitcnt vmcnt(14)
    ds_read_b64_tr_b16 v[96:97], v29 offset:4096
    ds_read_b64_tr_b16 v[98:99], v29 offset:4608
    v_mov_b32 v4, 0
    s_waitcnt lgkmcnt(8)
    v_mfma_f32_32x32x16_bf16 v[144:159], v[64:67], v[84:87], 0
    ds_read_b128 v[112:115], v27 offset:0
    ds_read_b64_tr_b16 v[100:101], v30 offset:4096
    s_add_u32 s5, s50, 0
    v_mfma_f32_32x32x16_bf16 v[176:191], v[68:71], v[84:87], 0
    ds_read_b64_tr_b16 v[102:103], v30 offset:4608
    ds_read_b128 v[116:119], v27 offset:4096
    s_and_b32 s5, s5, 3
    s_waitcnt lgkmcnt(9)
    v_mfma_f32_32x32x16_bf16 v[128:143], v[72:75], v[88:91], v[128:143]
    s_waitcnt vmcnt(12)
    ds_read_b64_tr_b16 v[104:105], v29 offset:6144
    ds_read_b64_tr_b16 v[106:107], v29 offset:6656
    s_add_u32 s5, s5, s4
    s_waitcnt lgkmcnt(9)
    v_mfma_f32_32x32x16_bf16 v[160:175], v[76:79], v[88:91], v[160:175]
    ds_read_b128 v[120:123], v28 offset:0
    ds_read_b64_tr_b16 v[108:109], v30 offset:6144
    s_lshr_b32 s6, s5, 1
    s_waitcnt lgkmcnt(10)
    v_mfma_f32_32x32x16_bf16 v[144:159], v[72:75], v[92:95], v[144:159]
    ds_read_b64_tr_b16 v[110:111], v30 offset:6656
    ds_read_b128 v[124:127], v28 offset:4096
    s_lshl_b32 s6, s6, 2
    v_mfma_f32_32x32x16_bf16 v[176:191], v[76:79], v[92:95], v[176:191]
    s_and_b32 s5, s5, 1
    s_waitcnt lgkmcnt(9)
    v_mfma_f32_32x32x16_bf16 v[128:143], v[96:99], v[112:115], v[128:143]
    s_add_u32 m0, s44, 20480
    s_xor_b32 s45, s69, 384
    buffer_load_dwordx4 v13, s[12:15], s45 offen nt lds
    s_add_u32 s5, s5, s6
    s_waitcnt lgkmcnt(7)
    v_mfma_f32_32x32x16_bf16 v[160:175], v[100:103], v[112:115], v[160:175]
    s_waitcnt vmcnt(9)
    ds_read_b128 v[192:195], v31 offset:8192
    s_add_u32 s5, s5, s7
    s_waitcnt lgkmcnt(7)
    v_mfma_f32_32x32x16_bf16 v[144:159], v[96:99], v[116:119], v[144:159]
    buffer_load_dwordx4 v14, s[12:15], s45 offen offset:1024 nt lds
    ds_read_b128 v[196:199], v32 offset:8192
    s_lshl_b32 s6, s5, 15
    v_mfma_f32_32x32x16_bf16 v[176:191], v[100:103], v[116:119], v[176:191]
    s_add_u32 s52, s6, s3
    s_waitcnt lgkmcnt(5)
    v_mfma_f32_32x32x16_bf16 v[128:143], v[104:107], v[120:123], v[128:143]
    buffer_load_dwordx4 v15, s[12:15], s45 offen offset:2048 nt lds
    ds_read_b128 v[200:203], v33 offset:8192
    s_lshl_b32 s6, s5, 8
    s_waitcnt lgkmcnt(4)
    v_mfma_f32_32x32x16_bf16 v[160:175], v[108:111], v[120:123], v[160:175]
    ds_read_b128 v[204:207], v34 offset:8192
    v_writelane_b32 v4, s6, 0
    s_waitcnt lgkmcnt(4)
    v_mfma_f32_32x32x16_bf16 v[144:159], v[104:107], v[124:127], v[144:159]
    buffer_load_dwordx4 v16, s[12:15], s45 offen offset:3072 nt lds
    s_add_u32 s6, s6, 128
    v_mfma_f32_32x32x16_bf16 v[176:191], v[108:111], v[124:127], v[176:191]
    v_writelane_b32 v4, s6, 1
    s_xor_b32 s5, s5, 2
    s_lshl_b32 s6, s5, 15
    s_add_u32 s53, s6, s3
    s_lshl_b32 s6, s5, 8
    v_writelane_b32 v4, s6, 2
    s_add_u32 s6, s6, 128
    v_writelane_b32 v4, s6, 3
    s_add_u32 s5, s50, 1
    s_waitcnt vmcnt(8)
    ds_read_b128 v[208:211], v31 offset:12288
    ds_read_b128 v[212:215], v32 offset:12288
    ds_read_b128 v[216:219], v33 offset:12288
    ds_read_b128 v[220:223], v34 offset:12288
    s_add_u32 m0, s44, 0
    s_xor_b32 s45, s69, 65536
    buffer_load_dwordx4 v13, s[12:15], s45 offen nt lds
    buffer_load_dwordx4 v14, s[12:15], s45 offen offset:1024 nt lds
    buffer_load_dwordx4 v15, s[12:15], s45 offen offset:2048 nt lds
    buffer_load_dwordx4 v16, s[12:15], s45 offen offset:3072 nt lds
    s_add_u32 m0, s44, 4096
    s_xor_b32 s45, s69, 65664
    buffer_load_dwordx4 v13, s[12:15], s45 offen nt lds
    buffer_load_dwordx4 v14, s[12:15], s45 offen offset:1024 nt lds
    buffer_load_dwordx4 v15, s[12:15], s45 offen offset:2048 nt lds
    buffer_load_dwordx4 v16, s[12:15], s45 offen offset:3072 nt lds
    s_and_b32 s5, s5, 3
    s_add_u32 s5, s5, s4
    s_lshr_b32 s6, s5, 1
    s_lshl_b32 s6, s6, 2
    s_and_b32 s5, s5, 1
    s_add_u32 s5, s5, s6
    s_add_u32 s5, s5, s7
    s_lshl_b32 s6, s5, 15
    s_waitcnt vmcnt(12)
    ds_read_b128 v[224:227], v31 offset:16384
    ds_read_b128 v[228:231], v32 offset:16384
    ds_read_b128 v[232:235], v33 offset:16384
    ds_read_b128 v[236:239], v34 offset:16384
    s_add_u32 m0, s44, 8192
    s_xor_b32 s45, s69, 65792
    s_waitcnt lgkmcnt(8)
    buffer_load_dwordx4 v13, s[12:15], s45 offen nt lds
    buffer_load_dwordx4 v14, s[12:15], s45 offen offset:1024 nt lds
    buffer_load_dwordx4 v15, s[12:15], s45 offen offset:2048 nt lds
    buffer_load_dwordx4 v16, s[12:15], s45 offen offset:3072 nt lds
    s_add_u32 s54, s6, s3
    s_lshl_b32 s6, s5, 8
    v_writelane_b32 v4, s6, 4
    s_add_u32 s6, s6, 128
    v_writelane_b32 v4, s6, 5
    s_xor_b32 s5, s5, 2
    s_lshl_b32 s6, s5, 15
    s_add_u32 s55, s6, s3
    s_waitcnt vmcnt(12)
    ds_read_b128 v[240:243], v31 offset:20480
    ds_read_b128 v[244:247], v32 offset:20480
    ds_read_b128 v[248:251], v33 offset:20480
    ds_read_b128 v[252:255], v34 offset:20480
    s_add_u32 m0, s44, 12288
    s_xor_b32 s45, s69, 65920
    s_waitcnt lgkmcnt(8)
    buffer_load_dwordx4 v13, s[12:15], s45 offen nt lds
    buffer_load_dwordx4 v14, s[12:15], s45 offen offset:1024 nt lds
    buffer_load_dwordx4 v15, s[12:15], s45 offen offset:2048 nt lds
    buffer_load_dwordx4 v16, s[12:15], s45 offen offset:3072 nt lds
    s_lshl_b32 s6, s5, 8
    v_writelane_b32 v4, s6, 6
    s_add_u32 s6, s6, 128
    v_writelane_b32 v4, s6, 7
    s_add_u32 s5, s50, 2
    s_and_b32 s5, s5, 3
    s_add_u32 s5, s5, s4
    s_lshr_b32 s6, s5, 1
    s_waitcnt vmcnt(12)
    ds_read_b128 a[128:131], v31 offset:0
    ds_read_b128 a[132:135], v32 offset:0
    ds_read_b128 a[136:139], v33 offset:0
    ds_read_b128 a[140:143], v34 offset:0
    s_add_u32 m0, s44, 16384
    s_xor_b32 s45, s69, 131072
    s_waitcnt lgkmcnt(8)
    buffer_load_dwordx4 v13, s[12:15], s45 offen nt lds
    buffer_load_dwordx4 v14, s[12:15], s45 offen offset:1024 nt lds
    buffer_load_dwordx4 v15, s[12:15], s45 offen offset:2048 nt lds
    buffer_load_dwordx4 v16, s[12:15], s45 offen offset:3072 nt lds
    s_lshl_b32 s6, s6, 2
    s_and_b32 s5, s5, 1
    s_add_u32 s5, s5, s6
    s_add_u32 s5, s5, s7
    s_lshl_b32 s6, s5, 15
    s_add_u32 s56, s6, s3
    s_lshl_b32 s6, s5, 8
    v_writelane_b32 v4, s6, 8
    s_waitcnt vmcnt(12)
    ds_read_b128 a[144:147], v31 offset:4096
    ds_read_b128 a[148:151], v32 offset:4096
    ds_read_b128 a[152:155], v33 offset:4096
    ds_read_b128 a[156:159], v34 offset:4096
    s_add_u32 m0, s44, 20480
    s_xor_b32 s45, s69, 131200
    s_waitcnt lgkmcnt(8)
    buffer_load_dwordx4 v13, s[12:15], s45 offen nt lds
    buffer_load_dwordx4 v14, s[12:15], s45 offen offset:1024 nt lds
    buffer_load_dwordx4 v15, s[12:15], s45 offen offset:2048 nt lds
    buffer_load_dwordx4 v16, s[12:15], s45 offen offset:3072 nt lds
    s_add_u32 s6, s6, 128
    v_writelane_b32 v4, s6, 9
    s_xor_b32 s5, s5, 2
    s_lshl_b32 s6, s5, 15
    s_add_u32 s57, s6, s3
    s_lshl_b32 s6, s5, 8
    v_writelane_b32 v4, s6, 10
    s_add_u32 s6, s6, 128
    s_waitcnt vmcnt(12)
    ds_read_b128 a[160:163], v31 offset:8192
    ds_read_b128 a[164:167], v32 offset:8192
    ds_read_b128 a[168:171], v33 offset:8192
    ds_read_b128 a[172:175], v34 offset:8192
    s_add_u32 m0, s44, 0
    s_xor_b32 s45, s69, 131328
    s_waitcnt lgkmcnt(8)
    buffer_load_dwordx4 v13, s[12:15], s45 offen nt lds
    buffer_load_dwordx4 v14, s[12:15], s45 offen offset:1024 nt lds
    buffer_load_dwordx4 v15, s[12:15], s45 offen offset:2048 nt lds
    buffer_load_dwordx4 v16, s[12:15], s45 offen offset:3072 nt lds
    v_writelane_b32 v4, s6, 11
    s_add_u32 s5, s50, 3
    s_and_b32 s5, s5, 3
    s_add_u32 s5, s5, s4
    s_lshr_b32 s6, s5, 1
    s_lshl_b32 s6, s6, 2
    s_and_b32 s5, s5, 1
    s_add_u32 s5, s5, s6
    s_waitcnt vmcnt(12)
    ds_read_b128 a[176:179], v31 offset:12288
    ds_read_b128 a[180:183], v32 offset:12288
    ds_read_b128 a[184:187], v33 offset:12288
    ds_read_b128 a[188:191], v34 offset:12288
    s_add_u32 m0, s44, 4096
    s_lshl_b32 s45, s63, 12
    s_waitcnt lgkmcnt(8)
    buffer_load_dwordx4 v9, s[20:23], s45 offen lds
    buffer_load_dwordx4 v10, s[20:23], s45 offen offset:1024 lds
    buffer_load_dwordx4 v11, s[20:23], s45 offen offset:2048 lds
    buffer_load_dwordx4 v12, s[20:23], s45 offen offset:3072 lds
    s_add_u32 s5, s5, s7
    s_lshl_b32 s6, s5, 15
    s_add_u32 s58, s6, s3
    s_lshl_b32 s6, s5, 8
    v_writelane_b32 v4, s6, 12
    s_add_u32 s6, s6, 128
    v_writelane_b32 v4, s6, 13
    s_waitcnt vmcnt(12)
    ds_read_b128 a[192:195], v31 offset:16384
    ds_read_b128 a[196:199], v32 offset:16384
    ds_read_b128 a[200:203], v33 offset:16384
    ds_read_b128 a[204:207], v34 offset:16384
    s_add_u32 m0, s44, 8192
    s_lshl_b32 s45, s63, 12
    s_bitset1_b32 s45, 18
    s_waitcnt lgkmcnt(8)
    buffer_load_dwordx4 v9, s[20:23], s45 offen lds
    buffer_load_dwordx4 v10, s[20:23], s45 offen offset:1024 lds
    buffer_load_dwordx4 v11, s[20:23], s45 offen offset:2048 lds
    buffer_load_dwordx4 v12, s[20:23], s45 offen offset:3072 lds
    s_waitcnt vmcnt(12)
    ds_read_b128 a[208:211], v31 offset:20480
    ds_read_b128 a[212:215], v32 offset:20480
    ds_read_b128 a[216:219], v33 offset:20480
    ds_read_b128 a[220:223], v34 offset:20480
    s_add_u32 m0, s44, 12288
    s_lshl_b32 s45, s64, 12
    s_waitcnt lgkmcnt(8)
    buffer_load_dwordx4 v9, s[20:23], s45 offen lds
    buffer_load_dwordx4 v10, s[20:23], s45 offen offset:1024 lds
    buffer_load_dwordx4 v11, s[20:23], s45 offen offset:2048 lds
    buffer_load_dwordx4 v12, s[20:23], s45 offen offset:3072 lds
    s_waitcnt vmcnt(12)
    ds_read_b128 a[224:227], v31 offset:0
    ds_read_b128 a[228:231], v32 offset:0
    ds_read_b128 a[232:235], v33 offset:0
    ds_read_b128 a[236:239], v34 offset:0
    s_add_u32 m0, s44, 16384
    s_lshl_b32 s45, s64, 12
    s_bitset1_b32 s45, 18
    s_waitcnt lgkmcnt(8)
    buffer_load_dwordx4 v9, s[20:23], s45 offen lds
    buffer_load_dwordx4 v10, s[20:23], s45 offen offset:1024 lds
    buffer_load_dwordx4 v11, s[20:23], s45 offen offset:2048 lds
    buffer_load_dwordx4 v12, s[20:23], s45 offen offset:3072 lds
    s_waitcnt vmcnt(14)
    ds_read_b64_tr_b16 v[64:65], v29 offset:4096
    ds_read_b64_tr_b16 v[66:67], v29 offset:4608
    ds_read_b128 v[80:83], v25 offset:16384
    ds_read_b64_tr_b16 v[68:69], v30 offset:4096
    ds_read_b64_tr_b16 v[70:71], v30 offset:4608
    ds_read_b128 v[84:87], v25 offset:20480
    s_waitcnt vmcnt(12)
    ds_read_b64_tr_b16 v[72:73], v29 offset:6144
    ds_read_b64_tr_b16 v[74:75], v29 offset:6656
    ds_read_b128 v[88:91], v26 offset:16384
    ds_read_b64_tr_b16 v[76:77], v30 offset:6144
    ds_read_b64_tr_b16 v[78:79], v30 offset:6656
    ds_read_b128 v[92:95], v26 offset:20480
    s_add_u32 m0, s44, 20480
    s_lshl_b32 s45, s65, 12
    s_waitcnt lgkmcnt(14)
    buffer_load_dwordx4 v9, s[20:23], s45 offen lds
    buffer_load_dwordx4 v10, s[20:23], s45 offen offset:1024 lds
    buffer_load_dwordx4 v11, s[20:23], s45 offen offset:2048 lds
    buffer_load_dwordx4 v12, s[20:23], s45 offen offset:3072 lds
    s_waitcnt lgkmcnt(9)
    v_mfma_f32_32x32x16_bf16 v[128:143], v[64:67], v[80:83], v[128:143]
    s_waitcnt lgkmcnt(7)
    v_mfma_f32_32x32x16_bf16 v[160:175], v[68:71], v[80:83], v[160:175]
    s_waitcnt vmcnt(14)
    ds_read_b64_tr_b16 v[96:97], v29 offset:8192
    ds_read_b64_tr_b16 v[98:99], v29 offset:8704
    s_waitcnt lgkmcnt(8)
    v_mfma_f32_32x32x16_bf16 v[144:159], v[64:67], v[84:87], v[144:159]
    ds_read_b128 v[112:115], v27 offset:16384
    ds_read_b64_tr_b16 v[100:101], v30 offset:8192
    v_mfma_f32_32x32x16_bf16 v[176:191], v[68:71], v[84:87], v[176:191]
    ds_read_b64_tr_b16 v[102:103], v30 offset:8704
    ds_read_b128 v[116:119], v27 offset:20480
    s_waitcnt lgkmcnt(9)
    v_mfma_f32_32x32x16_bf16 v[128:143], v[72:75], v[88:91], v[128:143]
    s_waitcnt vmcnt(12)
    ds_read_b64_tr_b16 v[104:105], v29 offset:10240
    ds_read_b64_tr_b16 v[106:107], v29 offset:10752
    s_waitcnt lgkmcnt(9)
    v_mfma_f32_32x32x16_bf16 v[160:175], v[76:79], v[88:91], v[160:175]
    ds_read_b128 v[120:123], v28 offset:16384
    ds_read_b64_tr_b16 v[108:109], v30 offset:10240
    s_waitcnt lgkmcnt(10)
    v_mfma_f32_32x32x16_bf16 v[144:159], v[72:75], v[92:95], v[144:159]
    ds_read_b64_tr_b16 v[110:111], v30 offset:10752
    ds_read_b128 v[124:127], v28 offset:20480
    v_mfma_f32_32x32x16_bf16 v[176:191], v[76:79], v[92:95], v[176:191]
    s_waitcnt lgkmcnt(9)
    v_mfma_f32_32x32x16_bf16 v[128:143], v[96:99], v[112:115], v[128:143]
    s_add_u32 m0, s44, 0
    s_lshl_b32 s45, s65, 12
    s_bitset1_b32 s45, 18
    buffer_load_dwordx4 v9, s[20:23], s45 offen lds
    s_waitcnt lgkmcnt(7)
    v_mfma_f32_32x32x16_bf16 v[160:175], v[100:103], v[112:115], v[160:175]
    s_waitcnt vmcnt(11)
    ds_read_b64_tr_b16 v[64:65], v29 offset:12288
    ds_read_b64_tr_b16 v[66:67], v29 offset:12800
    s_waitcnt lgkmcnt(8)
    v_mfma_f32_32x32x16_bf16 v[144:159], v[96:99], v[116:119], v[144:159]
    buffer_load_dwordx4 v10, s[20:23], s45 offen offset:1024 lds
    ds_read_b128 v[80:83], v25 offset:32768
    ds_read_b64_tr_b16 v[68:69], v30 offset:12288
    v_mfma_f32_32x32x16_bf16 v[176:191], v[100:103], v[116:119], v[176:191]
    ds_read_b64_tr_b16 v[70:71], v30 offset:12800
    ds_read_b128 v[84:87], v25 offset:36864
    s_waitcnt lgkmcnt(9)
    v_mfma_f32_32x32x16_bf16 v[128:143], v[104:107], v[120:123], v[128:143]
    buffer_load_dwordx4 v11, s[20:23], s45 offen offset:2048 lds
    s_waitcnt vmcnt(11)
    ds_read_b64_tr_b16 v[72:73], v29 offset:14336
    ds_read_b64_tr_b16 v[74:75], v29 offset:14848
    s_waitcnt lgkmcnt(9)
    v_mfma_f32_32x32x16_bf16 v[160:175], v[108:111], v[120:123], v[160:175]
    ds_read_b128 v[88:91], v26 offset:32768
    ds_read_b64_tr_b16 v[76:77], v30 offset:14336
    s_waitcnt lgkmcnt(10)
    v_mfma_f32_32x32x16_bf16 v[144:159], v[104:107], v[124:127], v[144:159]
    buffer_load_dwordx4 v12, s[20:23], s45 offen offset:3072 lds
    ds_read_b64_tr_b16 v[78:79], v30 offset:14848
    ds_read_b128 v[92:95], v26 offset:36864
    v_mfma_f32_32x32x16_bf16 v[176:191], v[108:111], v[124:127], v[176:191]
    s_waitcnt lgkmcnt(9)
    v_mfma_f32_32x32x16_bf16 v[128:143], v[64:67], v[80:83], v[128:143]
    s_add_u32 m0, s44, 4096
    s_lshl_b32 s45, s66, 12
    buffer_load_dwordx4 v9, s[20:23], s45 offen lds
    s_waitcnt lgkmcnt(7)
    v_mfma_f32_32x32x16_bf16 v[160:175], v[68:71], v[80:83], v[160:175]
    s_waitcnt vmcnt(11)
    ds_read_b64_tr_b16 v[96:97], v29 offset:16384
    ds_read_b64_tr_b16 v[98:99], v29 offset:16896
    s_waitcnt lgkmcnt(8)
    v_mfma_f32_32x32x16_bf16 v[144:159], v[64:67], v[84:87], v[144:159]
    buffer_load_dwordx4 v10, s[20:23], s45 offen offset:1024 lds
    ds_read_b128 v[112:115], v27 offset:32768
    ds_read_b64_tr_b16 v[100:101], v30 offset:16384
    v_mfma_f32_32x32x16_bf16 v[176:191], v[68:71], v[84:87], v[176:191]
    ds_read_b64_tr_b16 v[102:103], v30 offset:16896
    ds_read_b128 v[116:119], v27 offset:36864
    s_waitcnt lgkmcnt(9)
    v_mfma_f32_32x32x16_bf16 v[128:143], v[72:75], v[88:91], v[128:143]
    buffer_load_dwordx4 v11, s[20:23], s45 offen offset:2048 lds
    s_waitcnt vmcnt(11)
    ds_read_b64_tr_b16 v[104:105], v29 offset:18432
    ds_read_b64_tr_b16 v[106:107], v29 offset:18944
    s_waitcnt lgkmcnt(9)
    v_mfma_f32_32x32x16_bf16 v[160:175], v[76:79], v[88:91], v[160:175]
    ds_read_b128 v[120:123], v28 offset:32768
    ds_read_b64_tr_b16 v[108:109], v30 offset:18432
    s_waitcnt lgkmcnt(10)
    v_mfma_f32_32x32x16_bf16 v[144:159], v[72:75], v[92:95], v[144:159]
    buffer_load_dwordx4 v12, s[20:23], s45 offen offset:3072 lds
    ds_read_b64_tr_b16 v[110:111], v30 offset:18944
    ds_read_b128 v[124:127], v28 offset:36864
    v_mfma_f32_32x32x16_bf16 v[176:191], v[76:79], v[92:95], v[176:191]
    s_waitcnt lgkmcnt(9)
    v_mfma_f32_32x32x16_bf16 v[128:143], v[96:99], v[112:115], v[128:143]
    s_add_u32 m0, s44, 8192
    s_lshl_b32 s45, s66, 12
    s_bitset1_b32 s45, 18
    buffer_load_dwordx4 v9, s[20:23], s45 offen lds
    s_waitcnt lgkmcnt(7)
    v_mfma_f32_32x32x16_bf16 v[160:175], v[100:103], v[112:115], v[160:175]
    s_waitcnt vmcnt(11)
    ds_read_b64_tr_b16 v[64:65], v29 offset:20480
    ds_read_b64_tr_b16 v[66:67], v29 offset:20992
    s_waitcnt lgkmcnt(8)
    v_mfma_f32_32x32x16_bf16 v[144:159], v[96:99], v[116:119], v[144:159]
    buffer_load_dwordx4 v10, s[20:23], s45 offen offset:1024 lds
    ds_read_b128 v[80:83], v25 offset:49152
    ds_read_b64_tr_b16 v[68:69], v30 offset:20480
    v_mfma_f32_32x32x16_bf16 v[176:191], v[100:103], v[116:119], v[176:191]
    ds_read_b64_tr_b16 v[70:71], v30 offset:20992
    ds_read_b128 v[84:87], v25 offset:53248
    s_waitcnt lgkmcnt(9)
    v_mfma_f32_32x32x16_bf16 v[128:143], v[104:107], v[120:123], v[128:143]
    buffer_load_dwordx4 v11, s[20:23], s45 offen offset:2048 lds
    s_waitcnt vmcnt(11)
    ds_read_b64_tr_b16 v[72:73], v29 offset:22528
    ds_read_b64_tr_b16 v[74:75], v29 offset:23040
    s_waitcnt lgkmcnt(9)
    v_mfma_f32_32x32x16_bf16 v[160:175], v[108:111], v[120:123], v[160:175]
    ds_read_b128 v[88:91], v26 offset:49152
    ds_read_b64_tr_b16 v[76:77], v30 offset:22528
    s_waitcnt lgkmcnt(10)
    v_mfma_f32_32x32x16_bf16 v[144:159], v[104:107], v[124:127], v[144:159]
    buffer_load_dwordx4 v12, s[20:23], s45 offen offset:3072 lds
    ds_read_b64_tr_b16 v[78:79], v30 offset:23040
    ds_read_b128 v[92:95], v26 offset:53248
    v_mfma_f32_32x32x16_bf16 v[176:191], v[108:111], v[124:127], v[176:191]
    s_waitcnt lgkmcnt(9)
    v_mfma_f32_32x32x16_bf16 v[128:143], v[64:67], v[80:83], v[128:143]
    s_add_u32 m0, s44, 12288
    s_lshl_b32 s45, s67, 12
    buffer_load_dwordx4 v9, s[20:23], s45 offen lds
    s_waitcnt lgkmcnt(7)
    v_mfma_f32_32x32x16_bf16 v[160:175], v[68:71], v[80:83], v[160:175]
    s_waitcnt vmcnt(11)
    ds_read_b64_tr_b16 v[96:97], v29 offset:0
    ds_read_b64_tr_b16 v[98:99], v29 offset:512
    s_waitcnt lgkmcnt(8)
    v_mfma_f32_32x32x16_bf16 v[144:159], v[64:67], v[84:87], v[144:159]
    buffer_load_dwordx4 v10, s[20:23], s45 offen offset:1024 lds
    ds_read_b128 v[112:115], v27 offset:49152
    ds_read_b64_tr_b16 v[100:101], v30 offset:0
    v_mfma_f32_32x32x16_bf16 v[176:191], v[68:71], v[84:87], v[176:191]
    ds_read_b64_tr_b16 v[102:103], v30 offset:512
    ds_read_b128 v[116:119], v27 offset:53248
    s_waitcnt lgkmcnt(9)
    v_mfma_f32_32x32x16_bf16 v[128:143], v[72:75], v[88:91], v[128:143]
    buffer_load_dwordx4 v11, s[20:23], s45 offen offset:2048 lds
    s_waitcnt vmcnt(11)
    ds_read_b64_tr_b16 v[104:105], v29 offset:2048
    ds_read_b64_tr_b16 v[106:107], v29 offset:2560
    s_waitcnt lgkmcnt(9)
    v_mfma_f32_32x32x16_bf16 v[160:175], v[76:79], v[88:91], v[160:175]
    ds_read_b128 v[120:123], v28 offset:49152
    ds_read_b64_tr_b16 v[108:109], v30 offset:2048
    s_waitcnt lgkmcnt(10)
    v_mfma_f32_32x32x16_bf16 v[144:159], v[72:75], v[92:95], v[144:159]
    buffer_load_dwordx4 v12, s[20:23], s45 offen offset:3072 lds
    ds_read_b64_tr_b16 v[110:111], v30 offset:2560
    ds_read_b128 v[124:127], v28 offset:53248
    v_mfma_f32_32x32x16_bf16 v[176:191], v[76:79], v[92:95], v[176:191]
    s_waitcnt lgkmcnt(9)
    v_mfma_f32_32x32x16_bf16 v[128:143], v[96:99], v[112:115], v[128:143]
    s_add_u32 m0, s44, 16384
    s_lshl_b32 s45, s67, 12
    s_bitset1_b32 s45, 18
    buffer_load_dwordx4 v9, s[20:23], s45 offen lds
    s_waitcnt lgkmcnt(7)
    v_mfma_f32_32x32x16_bf16 v[160:175], v[100:103], v[112:115], v[160:175]
    s_waitcnt vmcnt(11)
    ds_read_b64_tr_b16 v[64:65], v29 offset:4096
    ds_read_b64_tr_b16 v[66:67], v29 offset:4608
    s_waitcnt lgkmcnt(8)
    v_mfma_f32_32x32x16_bf16 v[144:159], v[96:99], v[116:119], v[144:159]
    buffer_load_dwordx4 v10, s[20:23], s45 offen offset:1024 lds
    ds_read_b128 v[80:83], v25 offset:8192
    ds_read_b64_tr_b16 v[68:69], v30 offset:4096
    v_mfma_f32_32x32x16_bf16 v[176:191], v[100:103], v[116:119], v[176:191]
    ds_read_b64_tr_b16 v[70:71], v30 offset:4608
    ds_read_b128 v[84:87], v25 offset:12288
    s_waitcnt lgkmcnt(9)
    v_mfma_f32_32x32x16_bf16 v[128:143], v[104:107], v[120:123], v[128:143]
    buffer_load_dwordx4 v11, s[20:23], s45 offen offset:2048 lds
    s_waitcnt vmcnt(11)
    ds_read_b64_tr_b16 v[72:73], v29 offset:6144
    ds_read_b64_tr_b16 v[74:75], v29 offset:6656
    s_waitcnt lgkmcnt(9)
    v_mfma_f32_32x32x16_bf16 v[160:175], v[108:111], v[120:123], v[160:175]
    ds_read_b128 v[88:91], v26 offset:8192
    ds_read_b64_tr_b16 v[76:77], v30 offset:6144
    s_waitcnt lgkmcnt(10)
    v_mfma_f32_32x32x16_bf16 v[144:159], v[104:107], v[124:127], v[144:159]
    buffer_load_dwordx4 v12, s[20:23], s45 offen offset:3072 lds
    ds_read_b64_tr_b16 v[78:79], v30 offset:6656
    ds_read_b128 v[92:95], v26 offset:12288
    v_mfma_f32_32x32x16_bf16 v[176:191], v[108:111], v[124:127], v[176:191]
    s_waitcnt lgkmcnt(9)
    v_mfma_f32_32x32x16_bf16 v[128:143], v[64:67], v[80:83], v[128:143]
    s_add_u32 m0, s44, 20480
    s_lshl_b32 s45, s68, 12
    buffer_load_dwordx4 v9, s[20:23], s45 offen lds
    s_waitcnt lgkmcnt(7)
    v_mfma_f32_32x32x16_bf16 v[160:175], v[68:71], v[80:83], v[160:175]
    s_barrier
    s_waitcnt vmcnt(11)
    ds_read_b64_tr_b16 v[96:97], v29 offset:8192
    ds_read_b64_tr_b16 v[98:99], v29 offset:8704
    s_waitcnt lgkmcnt(8)
    v_mfma_f32_32x32x16_bf16 v[144:159], v[64:67], v[84:87], v[144:159]
    buffer_load_dwordx4 v10, s[20:23], s45 offen offset:1024 lds
    ds_read_b128 v[112:115], v27 offset:8192
    ds_read_b64_tr_b16 v[100:101], v30 offset:8192
    v_mfma_f32_32x32x16_bf16 v[176:191], v[68:71], v[84:87], v[176:191]
    ds_read_b64_tr_b16 v[102:103], v30 offset:8704
    ds_read_b128 v[116:119], v27 offset:12288
    s_waitcnt lgkmcnt(9)
    v_mfma_f32_32x32x16_bf16 v[128:143], v[72:75], v[88:91], v[128:143]
    buffer_load_dwordx4 v11, s[20:23], s45 offen offset:2048 lds
    s_waitcnt vmcnt(11)
    ds_read_b64_tr_b16 v[104:105], v29 offset:10240
    ds_read_b64_tr_b16 v[106:107], v29 offset:10752
    s_waitcnt lgkmcnt(9)
    v_mfma_f32_32x32x16_bf16 v[160:175], v[76:79], v[88:91], v[160:175]
    ds_read_b128 v[120:123], v28 offset:8192
    ds_read_b64_tr_b16 v[108:109], v30 offset:10240
    s_waitcnt lgkmcnt(10)
    v_mfma_f32_32x32x16_bf16 v[144:159], v[72:75], v[92:95], v[144:159]
    buffer_load_dwordx4 v12, s[20:23], s45 offen offset:3072 lds
    ds_read_b64_tr_b16 v[110:111], v30 offset:10752
    ds_read_b128 v[124:127], v28 offset:12288
    v_mfma_f32_32x32x16_bf16 v[176:191], v[76:79], v[92:95], v[176:191]
    s_waitcnt lgkmcnt(9)
    v_mfma_f32_32x32x16_bf16 v[128:143], v[96:99], v[112:115], v[128:143]
    s_add_u32 m0, s44, 0
    s_lshl_b32 s45, s68, 12
    s_bitset1_b32 s45, 18
    buffer_load_dwordx4 v9, s[20:23], s45 offen lds
    s_waitcnt lgkmcnt(7)
    v_mfma_f32_32x32x16_bf16 v[160:175], v[100:103], v[112:115], v[160:175]
    s_waitcnt vmcnt(11)
    ds_read_b64_tr_b16 v[64:65], v29 offset:12288
    ds_read_b64_tr_b16 v[66:67], v29 offset:12800
    s_waitcnt lgkmcnt(8)
    v_mfma_f32_32x32x16_bf16 v[144:159], v[96:99], v[116:119], v[144:159]
    buffer_load_dwordx4 v10, s[20:23], s45 offen offset:1024 lds
    ds_read_b128 v[80:83], v25 offset:24576
    ds_read_b64_tr_b16 v[68:69], v30 offset:12288
    v_mfma_f32_32x32x16_bf16 v[176:191], v[100:103], v[116:119], v[176:191]
    ds_read_b64_tr_b16 v[70:71], v30 offset:12800
    ds_read_b128 v[84:87], v25 offset:28672
    s_waitcnt lgkmcnt(9)
    v_mfma_f32_32x32x16_bf16 v[128:143], v[104:107], v[120:123], v[128:143]
    buffer_load_dwordx4 v11, s[20:23], s45 offen offset:2048 lds
    s_waitcnt vmcnt(11)
    ds_read_b64_tr_b16 v[72:73], v29 offset:14336
    ds_read_b64_tr_b16 v[74:75], v29 offset:14848
    s_waitcnt lgkmcnt(9)
    v_mfma_f32_32x32x16_bf16 v[160:175], v[108:111], v[120:123], v[160:175]
    ds_read_b128 v[88:91], v26 offset:24576
    ds_read_b64_tr_b16 v[76:77], v30 offset:14336
    s_waitcnt lgkmcnt(10)
    v_mfma_f32_32x32x16_bf16 v[144:159], v[104:107], v[124:127], v[144:159]
    buffer_load_dwordx4 v12, s[20:23], s45 offen offset:3072 lds
    ds_read_b64_tr_b16 v[78:79], v30 offset:14848
    ds_read_b128 v[92:95], v26 offset:28672
    v_mfma_f32_32x32x16_bf16 v[176:191], v[108:111], v[124:127], v[176:191]
    s_waitcnt lgkmcnt(9)
    v_mfma_f32_32x32x16_bf16 v[128:143], v[64:67], v[80:83], v[128:143]
    s_add_u32 m0, s44, 4096
    s_xor_b32 s45, s69, 131456
    buffer_load_dwordx4 v13, s[12:15], s45 offen nt lds
    s_waitcnt lgkmcnt(7)
    v_mfma_f32_32x32x16_bf16 v[160:175], v[68:71], v[80:83], v[160:175]
    s_waitcnt vmcnt(11)
    ds_read_b64_tr_b16 v[96:97], v29 offset:16384
    ds_read_b64_tr_b16 v[98:99], v29 offset:16896
    s_waitcnt lgkmcnt(8)
    v_mfma_f32_32x32x16_bf16 v[144:159], v[64:67], v[84:87], v[144:159]
    buffer_load_dwordx4 v14, s[12:15], s45 offen offset:1024 nt lds
    ds_read_b128 v[112:115], v27 offset:24576
    ds_read_b64_tr_b16 v[100:101], v30 offset:16384
    v_mfma_f32_32x32x16_bf16 v[176:191], v[68:71], v[84:87], v[176:191]
    ds_read_b64_tr_b16 v[102:103], v30 offset:16896
    ds_read_b128 v[116:119], v27 offset:28672
    s_waitcnt lgkmcnt(9)
    v_mfma_f32_32x32x16_bf16 v[128:143], v[72:75], v[88:91], v[128:143]
    buffer_load_dwordx4 v15, s[12:15], s45 offen offset:2048 nt lds
    s_waitcnt vmcnt(11)
    ds_read_b64_tr_b16 v[104:105], v29 offset:18432
    ds_read_b64_tr_b16 v[106:107], v29 offset:18944
    s_waitcnt lgkmcnt(9)
    v_mfma_f32_32x32x16_bf16 v[160:175], v[76:79], v[88:91], v[160:175]
    ds_read_b128 v[120:123], v28 offset:24576
    ds_read_b64_tr_b16 v[108:109], v30 offset:18432
    s_waitcnt lgkmcnt(10)
    v_mfma_f32_32x32x16_bf16 v[144:159], v[72:75], v[92:95], v[144:159]
    buffer_load_dwordx4 v16, s[12:15], s45 offen offset:3072 nt lds
    ds_read_b64_tr_b16 v[110:111], v30 offset:18944
    ds_read_b128 v[124:127], v28 offset:28672
    v_mfma_f32_32x32x16_bf16 v[176:191], v[76:79], v[92:95], v[176:191]
    s_waitcnt lgkmcnt(9)
    v_mfma_f32_32x32x16_bf16 v[128:143], v[96:99], v[112:115], v[128:143]
    s_add_u32 m0, s44, 8192
    s_xor_b32 s45, s69, 196608
    buffer_load_dwordx4 v13, s[12:15], s45 offen nt lds
    s_waitcnt lgkmcnt(7)
    v_mfma_f32_32x32x16_bf16 v[160:175], v[100:103], v[112:115], v[160:175]
    s_waitcnt vmcnt(11)
    ds_read_b64_tr_b16 v[64:65], v29 offset:20480
    ds_read_b64_tr_b16 v[66:67], v29 offset:20992
    s_waitcnt lgkmcnt(8)
    v_mfma_f32_32x32x16_bf16 v[144:159], v[96:99], v[116:119], v[144:159]
    buffer_load_dwordx4 v14, s[12:15], s45 offen offset:1024 nt lds
    ds_read_b128 v[80:83], v25 offset:40960
    ds_read_b64_tr_b16 v[68:69], v30 offset:20480
    v_mfma_f32_32x32x16_bf16 v[176:191], v[100:103], v[116:119], v[176:191]
    ds_read_b64_tr_b16 v[70:71], v30 offset:20992
    ds_read_b128 v[84:87], v25 offset:45056
    s_waitcnt lgkmcnt(9)
    v_mfma_f32_32x32x16_bf16 v[128:143], v[104:107], v[120:123], v[128:143]
    buffer_load_dwordx4 v15, s[12:15], s45 offen offset:2048 nt lds
    s_waitcnt vmcnt(11)
    ds_read_b64_tr_b16 v[72:73], v29 offset:22528
    ds_read_b64_tr_b16 v[74:75], v29 offset:23040
    s_waitcnt lgkmcnt(9)
    v_mfma_f32_32x32x16_bf16 v[160:175], v[108:111], v[120:123], v[160:175]
    ds_read_b128 v[88:91], v26 offset:40960
    ds_read_b64_tr_b16 v[76:77], v30 offset:22528
    s_waitcnt lgkmcnt(10)
    v_mfma_f32_32x32x16_bf16 v[144:159], v[104:107], v[124:127], v[144:159]
    buffer_load_dwordx4 v16, s[12:15], s45 offen offset:3072 nt lds
    ds_read_b64_tr_b16 v[78:79], v30 offset:23040
    ds_read_b128 v[92:95], v26 offset:45056
    v_mfma_f32_32x32x16_bf16 v[176:191], v[108:111], v[124:127], v[176:191]
    s_waitcnt lgkmcnt(9)
    v_mfma_f32_32x32x16_bf16 v[128:143], v[64:67], v[80:83], v[128:143]
    s_add_u32 m0, s44, 12288
    s_xor_b32 s45, s69, 196736
    buffer_load_dwordx4 v13, s[12:15], s45 offen nt lds
    s_waitcnt lgkmcnt(7)
    v_mfma_f32_32x32x16_bf16 v[160:175], v[68:71], v[80:83], v[160:175]
    s_waitcnt vmcnt(11)
    ds_read_b64_tr_b16 v[96:97], v29 offset:0
    ds_read_b64_tr_b16 v[98:99], v29 offset:512
    s_waitcnt lgkmcnt(8)
    v_mfma_f32_32x32x16_bf16 v[144:159], v[64:67], v[84:87], v[144:159]
    buffer_load_dwordx4 v14, s[12:15], s45 offen offset:1024 nt lds
    ds_read_b128 v[112:115], v27 offset:40960
    ds_read_b64_tr_b16 v[100:101], v30 offset:0
    v_mfma_f32_32x32x16_bf16 v[176:191], v[68:71], v[84:87], v[176:191]
    ds_read_b64_tr_b16 v[102:103], v30 offset:512
    ds_read_b128 v[116:119], v27 offset:45056
    s_waitcnt lgkmcnt(9)
    v_mfma_f32_32x32x16_bf16 v[128:143], v[72:75], v[88:91], v[128:143]
    buffer_load_dwordx4 v15, s[12:15], s45 offen offset:2048 nt lds
    s_waitcnt vmcnt(11)
    ds_read_b64_tr_b16 v[104:105], v29 offset:2048
    ds_read_b64_tr_b16 v[106:107], v29 offset:2560
    s_waitcnt lgkmcnt(9)
    v_mfma_f32_32x32x16_bf16 v[160:175], v[76:79], v[88:91], v[160:175]
    ds_read_b128 v[120:123], v28 offset:40960
    ds_read_b64_tr_b16 v[108:109], v30 offset:2048
    s_waitcnt lgkmcnt(10)
    v_mfma_f32_32x32x16_bf16 v[144:159], v[72:75], v[92:95], v[144:159]
    buffer_load_dwordx4 v16, s[12:15], s45 offen offset:3072 nt lds
    ds_read_b64_tr_b16 v[110:111], v30 offset:2560
    ds_read_b128 v[124:127], v28 offset:45056
    v_mfma_f32_32x32x16_bf16 v[176:191], v[76:79], v[92:95], v[176:191]
    s_waitcnt lgkmcnt(9)
    v_mfma_f32_32x32x16_bf16 v[128:143], v[96:99], v[112:115], v[128:143]
    s_add_u32 m0, s44, 16384
    s_xor_b32 s45, s69, 196864
    buffer_load_dwordx4 v13, s[12:15], s45 offen nt lds
    s_waitcnt lgkmcnt(3)
    v_mfma_f32_32x32x16_bf16 v[128:143], v[104:107], v[120:123], v[128:143]
    buffer_load_dwordx4 v14, s[12:15], s45 offen offset:1024 nt lds
    v_mfma_f32_32x32x16_bf16 v[144:159], v[96:99], v[116:119], v[144:159]
    buffer_load_dwordx4 v15, s[12:15], s45 offen offset:2048 nt lds
    s_waitcnt lgkmcnt(0)
    v_mfma_f32_32x32x16_bf16 v[144:159], v[104:107], v[124:127], v[144:159]
    buffer_load_dwordx4 v16, s[12:15], s45 offen offset:3072 nt lds
    v_mfma_f32_32x32x16_bf16 v[160:175], v[100:103], v[112:115], v[160:175]
    s_nop 4
    v_cvt_pk_bf16_f32 v64, v128, v129
    v_cvt_pk_bf16_f32 v65, v130, v131
    v_cvt_pk_bf16_f32 v66, v132, v133
    v_cvt_pk_bf16_f32 v67, v134, v135
    ds_write_b128 v42, v[64:67] offset:0
    v_cvt_pk_bf16_f32 v72, v136, v137
    v_cvt_pk_bf16_f32 v73, v138, v139
    v_cvt_pk_bf16_f32 v74, v140, v141
    v_cvt_pk_bf16_f32 v75, v142, v143
    ds_write_b128 v42, v[72:75] offset:2048
    v_mfma_f32_32x32x16_bf16 v[160:175], v[108:111], v[120:123], v[160:175]
    v_mfma_f32_32x32x16_bf16 v[176:191], v[100:103], v[116:119], v[176:191]
    v_cvt_pk_bf16_f32 v68, v144, v145
    v_cvt_pk_bf16_f32 v69, v146, v147
    v_cvt_pk_bf16_f32 v70, v148, v149
    v_cvt_pk_bf16_f32 v71, v150, v151
    ds_write_b128 v42, v[68:71] offset:1024
    v_cvt_pk_bf16_f32 v76, v152, v153
    v_cvt_pk_bf16_f32 v77, v154, v155
    v_cvt_pk_bf16_f32 v78, v156, v157
    v_cvt_pk_bf16_f32 v79, v158, v159
    ds_write_b128 v42, v[76:79] offset:3072
    v_mfma_f32_32x32x16_bf16 v[176:191], v[108:111], v[124:127], v[176:191]
    v_cvt_pk_bf16_f32 v80, v160, v161
    v_cvt_pk_bf16_f32 v81, v162, v163
    v_cvt_pk_bf16_f32 v82, v164, v165
    v_cvt_pk_bf16_f32 v83, v166, v167
    ds_write_b128 v42, v[80:83] offset:4096
    v_cvt_pk_bf16_f32 v88, v168, v169
    v_cvt_pk_bf16_f32 v89, v170, v171
    v_cvt_pk_bf16_f32 v90, v172, v173
    v_cvt_pk_bf16_f32 v91, v174, v175
    ds_write_b128 v42, v[88:91] offset:6144
    s_nop 1
    v_cvt_pk_bf16_f32 v84, v176, v177
    v_cvt_pk_bf16_f32 v85, v178, v179
    v_cvt_pk_bf16_f32 v86, v180, v181
    v_cvt_pk_bf16_f32 v87, v182, v183
    ds_write_b128 v42, v[84:87] offset:5120
    v_cvt_pk_bf16_f32 v92, v184, v185
    v_cvt_pk_bf16_f32 v93, v186, v187
    v_cvt_pk_bf16_f32 v94, v188, v189
    v_cvt_pk_bf16_f32 v95, v190, v191
    ds_write_b128 v42, v[92:95] offset:7168
    s_add_u32 m0, s44, 20480
    s_xor_b32 s45, s69, 196992
    buffer_load_dwordx4 v13, s[12:15], s45 offen nt lds
    buffer_load_dwordx4 v14, s[12:15], s45 offen offset:1024 nt lds
    buffer_load_dwordx4 v15, s[12:15], s45 offen offset:2048 nt lds
    buffer_load_dwordx4 v16, s[12:15], s45 offen offset:3072 nt lds
    v_mfma_f32_32x32x16_bf16 v[128:143], v[192:195], v[64:67], 0
    v_mfma_f32_32x32x16_bf16 v[144:159], v[192:195], v[68:71], 0
    v_mfma_f32_32x32x16_bf16 v[128:143], v[196:199], v[72:75], v[128:143]
    v_mfma_f32_32x32x16_bf16 v[144:159], v[196:199], v[76:79], v[144:159]
    v_mfma_f32_32x32x16_bf16 v[128:143], v[200:203], v[80:83], v[128:143]
    v_mfma_f32_32x32x16_bf16 v[144:159], v[200:203], v[84:87], v[144:159]
    v_mfma_f32_32x32x16_bf16 v[128:143], v[204:207], v[88:91], v[128:143]
    v_mfma_f32_32x32x16_bf16 v[144:159], v[204:207], v[92:95], v[144:159]
    v_mfma_f32_32x32x16_bf16 v[160:175], a[128:131], v[64:67], 0
    v_mfma_f32_32x32x16_bf16 v[176:191], a[128:131], v[68:71], 0
    s_waitcnt lgkmcnt(0)
    s_barrier
    ds_read_b128 a[32:35], v45 offset:0
    v_mfma_f32_32x32x16_bf16 v[160:175], a[132:135], v[72:75], v[160:175]
    ds_read_b128 a[36:39], v45 offset:1024
    v_mfma_f32_32x32x16_bf16 v[176:191], a[132:135], v[76:79], v[176:191]
    ds_read_b128 a[40:43], v45 offset:2048
    ds_read_b128 a[44:47], v45 offset:3072
    v_mfma_f32_32x32x16_bf16 v[160:175], a[136:139], v[80:83], v[160:175]
    ds_read_b128 a[48:51], v45 offset:4096
    v_mfma_f32_32x32x16_bf16 v[176:191], a[136:139], v[84:87], v[176:191]
    ds_read_b128 a[52:55], v45 offset:5120
    ds_read_b128 a[56:59], v45 offset:6144
    v_mfma_f32_32x32x16_bf16 v[160:175], a[140:143], v[88:91], v[160:175]
    ds_read_b128 a[60:63], v45 offset:7168
    v_mfma_f32_32x32x16_bf16 v[176:191], a[140:143], v[92:95], v[176:191]
    s_waitcnt lgkmcnt(7)
    v_mfma_f32_32x32x16_bf16 v[128:143], v[208:211], a[32:35], v[128:143]
    s_waitcnt lgkmcnt(6)
    v_mfma_f32_32x32x16_bf16 v[144:159], v[208:211], a[36:39], v[144:159]
    ds_read_b128 a[64:67], v46 offset:0
    ds_read_b128 a[68:71], v46 offset:1024
    s_waitcnt lgkmcnt(7)
    v_mfma_f32_32x32x16_bf16 v[128:143], v[212:215], a[40:43], v[128:143]
    ds_read_b128 a[72:75], v46 offset:2048
    s_waitcnt lgkmcnt(7)
    v_mfma_f32_32x32x16_bf16 v[144:159], v[212:215], a[44:47], v[144:159]
    ds_read_b128 a[76:79], v46 offset:3072
    s_waitcnt lgkmcnt(7)
    v_mfma_f32_32x32x16_bf16 v[128:143], v[216:219], a[48:51], v[128:143]
    ds_read_b128 a[80:83], v46 offset:4096
    ds_read_b128 a[84:87], v46 offset:5120
    s_waitcnt lgkmcnt(8)
    v_mfma_f32_32x32x16_bf16 v[144:159], v[216:219], a[52:55], v[144:159]
    ds_read_b128 a[88:91], v46 offset:6144
    s_waitcnt lgkmcnt(8)
    v_mfma_f32_32x32x16_bf16 v[128:143], v[220:223], a[56:59], v[128:143]
    ds_read_b128 a[92:95], v46 offset:7168
    s_waitcnt lgkmcnt(8)
    v_mfma_f32_32x32x16_bf16 v[144:159], v[220:223], a[60:63], v[144:159]
    s_waitcnt lgkmcnt(7)
    v_mfma_f32_32x32x16_bf16 v[128:143], v[224:227], a[64:67], v[128:143]
    s_waitcnt lgkmcnt(6)
    v_mfma_f32_32x32x16_bf16 v[144:159], v[224:227], a[68:71], v[144:159]
    ds_read_b128 a[96:99], v47 offset:0
    ds_read_b128 a[100:103], v47 offset:1024
    s_waitcnt lgkmcnt(7)
    v_mfma_f32_32x32x16_bf16 v[128:143], v[228:231], a[72:75], v[128:143]
    ds_read_b128 a[104:107], v47 offset:2048
    s_waitcnt lgkmcnt(7)
    v_mfma_f32_32x32x16_bf16 v[144:159], v[228:231], a[76:79], v[144:159]
    ds_read_b128 a[108:111], v47 offset:3072
    s_waitcnt lgkmcnt(7)
    v_mfma_f32_32x32x16_bf16 v[128:143], v[232:235], a[80:83], v[128:143]
    ds_read_b128 a[112:115], v47 offset:4096
    ds_read_b128 a[116:119], v47 offset:5120
    s_waitcnt lgkmcnt(8)
    v_mfma_f32_32x32x16_bf16 v[144:159], v[232:235], a[84:87], v[144:159]
    ds_read_b128 a[120:123], v47 offset:6144
    s_waitcnt lgkmcnt(8)
    v_mfma_f32_32x32x16_bf16 v[128:143], v[236:239], a[88:91], v[128:143]
    ds_read_b128 a[124:127], v47 offset:7168
    s_waitcnt lgkmcnt(8)
    v_mfma_f32_32x32x16_bf16 v[144:159], v[236:239], a[92:95], v[144:159]
    s_waitcnt lgkmcnt(7)
    v_mfma_f32_32x32x16_bf16 v[128:143], v[240:243], a[96:99], v[128:143]
    s_waitcnt lgkmcnt(6)
    v_mfma_f32_32x32x16_bf16 v[144:159], v[240:243], a[100:103], v[144:159]
    s_waitcnt vmcnt(16)
    ds_read_b128 v[96:99], v31 offset:4096
    s_waitcnt lgkmcnt(6)
    v_mfma_f32_32x32x16_bf16 v[128:143], v[244:247], a[104:107], v[128:143]
    ds_read_b128 v[100:103], v32 offset:4096
    s_waitcnt lgkmcnt(6)
    v_mfma_f32_32x32x16_bf16 v[144:159], v[244:247], a[108:111], v[144:159]
    s_waitcnt lgkmcnt(5)
    v_mfma_f32_32x32x16_bf16 v[128:143], v[248:251], a[112:115], v[128:143]
    ds_read_b128 v[104:107], v33 offset:4096
    s_waitcnt lgkmcnt(5)
    v_mfma_f32_32x32x16_bf16 v[144:159], v[248:251], a[116:119], v[144:159]
    ds_read_b128 v[108:111], v34 offset:4096
    s_waitcnt lgkmcnt(5)
    v_mfma_f32_32x32x16_bf16 v[128:143], v[252:255], a[120:123], v[128:143]
    s_waitcnt lgkmcnt(4)
    v_mfma_f32_32x32x16_bf16 v[144:159], v[252:255], a[124:127], v[144:159]
    s_waitcnt lgkmcnt(3)
    v_mfma_f32_32x32x16_bf16 v[192:207], v[96:99], a[96:99], 0
    s_nop 7
    v_max3_f32 v48, v128, v129, v130
    v_max3_f32 v48, v48, v131, v132
    v_max3_f32 v48, v48, v133, v134
    v_max3_f32 v48, v48, v135, v136
    v_max3_f32 v48, v48, v137, v138
    v_mfma_f32_32x32x16_bf16 v[208:223], v[96:99], a[100:103], 0
    v_max3_f32 v48, v48, v139, v140
    v_max3_f32 v48, v48, v141, v142
    v_max_f32 v48, v48, v143
    v_mul_f32 v48, s46, v48
    v_fma_f32 v128, v128, s46, -v48
    s_waitcnt lgkmcnt(2)
    v_mfma_f32_32x32x16_bf16 v[192:207], v[100:103], a[104:107], v[192:207]
    v_fma_f32 v129, v129, s46, -v48
    v_fma_f32 v130, v130, s46, -v48
    v_fma_f32 v131, v131, s46, -v48
    v_fma_f32 v132, v132, s46, -v48
    v_fma_f32 v133, v133, s46, -v48
    v_mfma_f32_32x32x16_bf16 v[208:223], v[100:103], a[108:111], v[208:223]
    v_fma_f32 v134, v134, s46, -v48
    v_fma_f32 v135, v135, s46, -v48
    v_fma_f32 v136, v136, s46, -v48
    v_fma_f32 v137, v137, s46, -v48
    v_fma_f32 v138, v138, s46, -v48
    s_waitcnt lgkmcnt(1)
    v_mfma_f32_32x32x16_bf16 v[192:207], v[104:107], a[112:115], v[192:207]
    v_fma_f32 v139, v139, s46, -v48
    v_fma_f32 v140, v140, s46, -v48
    v_fma_f32 v141, v141, s46, -v48
    v_fma_f32 v142, v142, s46, -v48
    v_fma_f32 v143, v143, s46, -v48
    v_mfma_f32_32x32x16_bf16 v[208:223], v[104:107], a[116:119], v[208:223]
    v_exp_f32 v128, v128
    v_exp_f32 v129, v129
    v_exp_f32 v130, v130
    v_add_f32 v56, v128, v129
    v_exp_f32 v131, v131
    s_waitcnt lgkmcnt(0)
    v_mfma_f32_32x32x16_bf16 v[192:207], v[108:111], a[120:123], v[192:207]
    v_add_f32 v56, v56, v130
    v_exp_f32 v132, v132
    v_add_f32 v56, v56, v131
    v_exp_f32 v133, v133
    v_add_f32 v56, v56, v132
    v_mfma_f32_32x32x16_bf16 v[208:223], v[108:111], a[124:127], v[208:223]
    v_exp_f32 v134, v134
    v_add_f32 v56, v56, v133
    v_exp_f32 v135, v135
    v_add_f32 v56, v56, v134
    v_exp_f32 v136, v136
    v_mfma_f32_32x32x16_bf16 v[160:175], a[144:147], a[32:35], v[160:175]
    v_add_f32 v56, v56, v135
    v_exp_f32 v137, v137
    v_add_f32 v56, v56, v136
    v_exp_f32 v138, v138
    v_add_f32 v56, v56, v137
    v_mfma_f32_32x32x16_bf16 v[176:191], a[144:147], a[36:39], v[176:191]
    v_exp_f32 v139, v139
    v_add_f32 v56, v56, v138
    v_exp_f32 v140, v140
    v_add_f32 v56, v56, v139
    v_exp_f32 v141, v141
    v_mfma_f32_32x32x16_bf16 v[160:175], a[148:151], a[40:43], v[160:175]
    v_add_f32 v56, v56, v140
    v_exp_f32 v142, v142
    v_add_f32 v56, v56, v141
    v_exp_f32 v143, v143
    v_add_f32 v56, v56, v142
    v_mfma_f32_32x32x16_bf16 v[176:191], a[148:151], a[44:47], v[176:191]
    v_add_f32 v56, v56, v143
    v_max3_f32 v49, v144, v145, v146
    v_max3_f32 v49, v49, v147, v148
    v_max3_f32 v49, v49, v149, v150
    v_max3_f32 v49, v49, v151, v152
    v_mfma_f32_32x32x16_bf16 v[160:175], a[152:155], a[48:51], v[160:175]
    v_max3_f32 v49, v49, v153, v154
    v_max3_f32 v49, v49, v155, v156
    v_max3_f32 v49, v49, v157, v158
    v_max_f32 v49, v49, v159
    v_mul_f32 v49, s46, v49
    v_mfma_f32_32x32x16_bf16 v[176:191], a[152:155], a[52:55], v[176:191]
    v_fma_f32 v144, v144, s46, -v49
    v_fma_f32 v145, v145, s46, -v49
    v_fma_f32 v146, v146, s46, -v49
    v_fma_f32 v147, v147, s46, -v49
    v_fma_f32 v148, v148, s46, -v49
    v_mfma_f32_32x32x16_bf16 v[160:175], a[156:159], a[56:59], v[160:175]
    v_fma_f32 v149, v149, s46, -v49
    v_fma_f32 v150, v150, s46, -v49
    v_fma_f32 v151, v151, s46, -v49
    v_fma_f32 v152, v152, s46, -v49
    v_fma_f32 v153, v153, s46, -v49
    v_mfma_f32_32x32x16_bf16 v[176:191], a[156:159], a[60:63], v[176:191]
    v_fma_f32 v154, v154, s46, -v49
    v_fma_f32 v155, v155, s46, -v49
    v_fma_f32 v156, v156, s46, -v49
    v_fma_f32 v157, v157, s46, -v49
    v_fma_f32 v158, v158, s46, -v49
    v_mfma_f32_32x32x16_bf16 v[160:175], a[160:163], a[64:67], v[160:175]
    v_fma_f32 v159, v159, s46, -v49
    v_exp_f32 v144, v144
    v_exp_f32 v145, v145
    v_exp_f32 v146, v146
    v_mfma_f32_32x32x16_bf16 v[176:191], a[160:163], a[68:71], v[176:191]
    s_waitcnt vmcnt(12)
    ds_read_b128 v[112:115], v31 offset:8192
    v_add_f32 v57, v144, v145
    v_exp_f32 v147, v147
    v_add_f32 v57, v57, v146
    v_exp_f32 v148, v148
    v_mfma_f32_32x32x16_bf16 v[160:175], a[164:167], a[72:75], v[160:175]
    ds_read_b128 v[116:119], v32 offset:8192
    v_add_f32 v57, v57, v147
    v_exp_f32 v149, v149
    v_add_f32 v57, v57, v148
    v_exp_f32 v150, v150
    v_mfma_f32_32x32x16_bf16 v[176:191], a[164:167], a[76:79], v[176:191]
    v_add_f32 v57, v57, v149
    v_exp_f32 v151, v151
    v_add_f32 v57, v57, v150
    v_exp_f32 v152, v152
    v_mfma_f32_32x32x16_bf16 v[160:175], a[168:171], a[80:83], v[160:175]
    ds_read_b128 v[120:123], v33 offset:8192
    v_add_f32 v57, v57, v151
    v_exp_f32 v153, v153
    v_add_f32 v57, v57, v152
    v_exp_f32 v154, v154
    v_mfma_f32_32x32x16_bf16 v[176:191], a[168:171], a[84:87], v[176:191]
    ds_read_b128 v[124:127], v34 offset:8192
    v_add_f32 v57, v57, v153
    v_exp_f32 v155, v155
    v_add_f32 v57, v57, v154
    v_exp_f32 v156, v156
    v_mfma_f32_32x32x16_bf16 v[160:175], a[172:175], a[88:91], v[160:175]
    v_add_f32 v57, v57, v155
    v_exp_f32 v157, v157
    v_add_f32 v57, v57, v156
    v_exp_f32 v158, v158
    v_mfma_f32_32x32x16_bf16 v[176:191], a[172:175], a[92:95], v[176:191]
    v_add_f32 v57, v57, v157
    v_exp_f32 v159, v159
    v_add_f32 v57, v57, v158
    v_add_f32 v57, v57, v159
    s_waitcnt lgkmcnt(3)
    v_mfma_f32_32x32x16_bf16 v[224:239], v[112:115], v[64:67], 0
    s_add_u32 m0, s44, 0
    s_xor_b32 s45, s61, 0
    s_mulk_i32 s45, 14336
    buffer_load_dwordx4 v21, s[24:27], s45 offen lds
    v_mfma_f32_32x32x16_bf16 v[240:255], v[112:115], v[68:71], 0
    s_waitcnt lgkmcnt(2)
    v_mfma_f32_32x32x16_bf16 v[224:239], v[116:119], v[72:75], v[224:239]
    buffer_load_dwordx4 v22, s[24:27], s45 offen offset:1024 lds
    v_mfma_f32_32x32x16_bf16 v[240:255], v[116:119], v[76:79], v[240:255]
    s_waitcnt lgkmcnt(1)
    v_mfma_f32_32x32x16_bf16 v[224:239], v[120:123], v[80:83], v[224:239]
    buffer_load_dwordx4 v23, s[24:27], s45 offen offset:2048 lds
    v_mfma_f32_32x32x16_bf16 v[240:255], v[120:123], v[84:87], v[240:255]
    s_waitcnt lgkmcnt(0)
    v_mfma_f32_32x32x16_bf16 v[224:239], v[124:127], v[88:91], v[224:239]
    buffer_load_dwordx4 v24, s[24:27], s45 offen offset:3072 lds
    v_mfma_f32_32x32x16_bf16 v[240:255], v[124:127], v[92:95], v[240:255]
    v_mfma_f32_32x32x16_bf16 v[160:175], a[176:179], a[96:99], v[160:175]
    v_mfma_f32_32x32x16_bf16 v[176:191], a[176:179], a[100:103], v[176:191]
    v_mfma_f32_32x32x16_bf16 v[160:175], a[180:183], a[104:107], v[160:175]
    v_mfma_f32_32x32x16_bf16 v[176:191], a[180:183], a[108:111], v[176:191]
    v_mfma_f32_32x32x16_bf16 v[160:175], a[184:187], a[112:115], v[160:175]
    v_mfma_f32_32x32x16_bf16 v[176:191], a[184:187], a[116:119], v[176:191]
    v_mfma_f32_32x32x16_bf16 v[160:175], a[188:191], a[120:123], v[160:175]
    v_mfma_f32_32x32x16_bf16 v[176:191], a[188:191], a[124:127], v[176:191]
    v_mfma_f32_32x32x16_bf16 v[192:207], a[192:195], v[64:67], v[192:207]
    s_nop 9
    v_max3_f32 v50, v160, v161, v162
    v_max3_f32 v50, v50, v163, v164
    v_max3_f32 v50, v50, v165, v166
    v_max3_f32 v50, v50, v167, v168
    v_max3_f32 v50, v50, v169, v170
    v_mfma_f32_32x32x16_bf16 v[208:223], a[192:195], v[68:71], v[208:223]
    s_waitcnt vmcnt(12)
    ds_read_b128 v[96:99], v31 offset:12288
    v_max3_f32 v50, v50, v171, v172
    v_max3_f32 v50, v50, v173, v174
    v_max_f32 v50, v50, v175
    v_mul_f32 v50, s46, v50
    v_fma_f32 v160, v160, s46, -v50
    v_mfma_f32_32x32x16_bf16 v[192:207], a[196:199], v[72:75], v[192:207]
    ds_read_b128 v[100:103], v32 offset:12288
    v_fma_f32 v161, v161, s46, -v50
    v_fma_f32 v162, v162, s46, -v50
    v_fma_f32 v163, v163, s46, -v50
    v_fma_f32 v164, v164, s46, -v50
    v_fma_f32 v165, v165, s46, -v50
    v_mfma_f32_32x32x16_bf16 v[208:223], a[196:199], v[76:79], v[208:223]
    v_fma_f32 v166, v166, s46, -v50
    v_fma_f32 v167, v167, s46, -v50
    v_fma_f32 v168, v168, s46, -v50
    v_fma_f32 v169, v169, s46, -v50
    v_fma_f32 v170, v170, s46, -v50
    v_mfma_f32_32x32x16_bf16 v[192:207], a[200:203], v[80:83], v[192:207]
    ds_read_b128 v[104:107], v33 offset:12288
    v_fma_f32 v171, v171, s46, -v50
    v_fma_f32 v172, v172, s46, -v50
    v_fma_f32 v173, v173, s46, -v50
    v_fma_f32 v174, v174, s46, -v50
    v_fma_f32 v175, v175, s46, -v50
    v_mfma_f32_32x32x16_bf16 v[208:223], a[200:203], v[84:87], v[208:223]
    ds_read_b128 v[108:111], v34 offset:12288
    v_exp_f32 v160, v160
    v_exp_f32 v161, v161
    v_exp_f32 v162, v162
    v_add_f32 v58, v160, v161
    v_exp_f32 v163, v163
    v_mfma_f32_32x32x16_bf16 v[192:207], a[204:207], v[88:91], v[192:207]
    v_add_f32 v58, v58, v162
    v_exp_f32 v164, v164
    v_add_f32 v58, v58, v163
    v_exp_f32 v165, v165
    v_add_f32 v58, v58, v164
    v_mfma_f32_32x32x16_bf16 v[208:223], a[204:207], v[92:95], v[208:223]
    v_exp_f32 v166, v166
    v_add_f32 v58, v58, v165
    v_exp_f32 v167, v167
    v_add_f32 v58, v58, v166
    v_exp_f32 v168, v168
    s_waitcnt lgkmcnt(3)
    v_mfma_f32_32x32x16_bf16 v[224:239], v[96:99], a[32:35], v[224:239]
    s_add_u32 m0, s44, 4096
    s_xor_b32 s45, s61, 1
    s_mulk_i32 s45, 14336
    buffer_load_dwordx4 v21, s[24:27], s45 offen lds
    v_add_f32 v58, v58, v167
    v_exp_f32 v169, v169
    v_add_f32 v58, v58, v168
    v_exp_f32 v170, v170
    v_add_f32 v58, v58, v169
    v_mfma_f32_32x32x16_bf16 v[240:255], v[96:99], a[36:39], v[240:255]
    v_exp_f32 v171, v171
    v_add_f32 v58, v58, v170
    v_exp_f32 v172, v172
    v_add_f32 v58, v58, v171
    v_exp_f32 v173, v173
    s_waitcnt lgkmcnt(2)
    v_mfma_f32_32x32x16_bf16 v[224:239], v[100:103], a[40:43], v[224:239]
    buffer_load_dwordx4 v22, s[24:27], s45 offen offset:1024 lds
    v_add_f32 v58, v58, v172
    v_exp_f32 v174, v174
    v_add_f32 v58, v58, v173
    v_exp_f32 v175, v175
    v_add_f32 v58, v58, v174
    v_mfma_f32_32x32x16_bf16 v[240:255], v[100:103], a[44:47], v[240:255]
    v_add_f32 v58, v58, v175
    v_max3_f32 v51, v176, v177, v178
    v_max3_f32 v51, v51, v179, v180
    v_max3_f32 v51, v51, v181, v182
    v_max3_f32 v51, v51, v183, v184
    s_waitcnt lgkmcnt(1)
    v_mfma_f32_32x32x16_bf16 v[224:239], v[104:107], a[48:51], v[224:239]
    buffer_load_dwordx4 v23, s[24:27], s45 offen offset:2048 lds
    v_max3_f32 v51, v51, v185, v186
    v_max3_f32 v51, v51, v187, v188
    v_max3_f32 v51, v51, v189, v190
    v_max_f32 v51, v51, v191
    v_mul_f32 v51, s46, v51
    v_mfma_f32_32x32x16_bf16 v[240:255], v[104:107], a[52:55], v[240:255]
    v_fma_f32 v176, v176, s46, -v51
    v_fma_f32 v177, v177, s46, -v51
    v_fma_f32 v178, v178, s46, -v51
    v_fma_f32 v179, v179, s46, -v51
    v_fma_f32 v180, v180, s46, -v51
    s_waitcnt lgkmcnt(0)
    v_mfma_f32_32x32x16_bf16 v[224:239], v[108:111], a[56:59], v[224:239]
    buffer_load_dwordx4 v24, s[24:27], s45 offen offset:3072 lds
    v_fma_f32 v181, v181, s46, -v51
    v_fma_f32 v182, v182, s46, -v51
    v_fma_f32 v183, v183, s46, -v51
    v_fma_f32 v184, v184, s46, -v51
    v_fma_f32 v185, v185, s46, -v51
    v_mfma_f32_32x32x16_bf16 v[240:255], v[108:111], a[60:63], v[240:255]
    v_fma_f32 v186, v186, s46, -v51
    v_fma_f32 v187, v187, s46, -v51
    v_fma_f32 v188, v188, s46, -v51
    v_fma_f32 v189, v189, s46, -v51
    v_fma_f32 v190, v190, s46, -v51
    v_mfma_f32_32x32x16_bf16 v[192:207], a[208:211], a[32:35], v[192:207]
    v_fma_f32 v191, v191, s46, -v51
    v_exp_f32 v176, v176
    v_exp_f32 v177, v177
    v_exp_f32 v178, v178
    v_mfma_f32_32x32x16_bf16 v[208:223], a[208:211], a[36:39], v[208:223]
    v_add_f32 v59, v176, v177
    v_exp_f32 v179, v179
    v_add_f32 v59, v59, v178
    v_exp_f32 v180, v180
    v_mfma_f32_32x32x16_bf16 v[192:207], a[212:215], a[40:43], v[192:207]
    v_add_f32 v59, v59, v179
    v_exp_f32 v181, v181
    v_add_f32 v59, v59, v180
    v_exp_f32 v182, v182
    v_mfma_f32_32x32x16_bf16 v[208:223], a[212:215], a[44:47], v[208:223]
    v_add_f32 v59, v59, v181
    v_exp_f32 v183, v183
    v_add_f32 v59, v59, v182
    v_exp_f32 v184, v184
    v_mfma_f32_32x32x16_bf16 v[192:207], a[216:219], a[48:51], v[192:207]
    v_add_f32 v59, v59, v183
    v_exp_f32 v185, v185
    v_add_f32 v59, v59, v184
    v_exp_f32 v186, v186
    v_mfma_f32_32x32x16_bf16 v[208:223], a[216:219], a[52:55], v[208:223]
    v_add_f32 v59, v59, v185
    v_exp_f32 v187, v187
    v_add_f32 v59, v59, v186
    v_exp_f32 v188, v188
    v_mfma_f32_32x32x16_bf16 v[192:207], a[220:223], a[56:59], v[192:207]
    v_add_f32 v59, v59, v187
    v_exp_f32 v189, v189
    v_add_f32 v59, v59, v188
    v_exp_f32 v190, v190
    v_mfma_f32_32x32x16_bf16 v[208:223], a[220:223], a[60:63], v[208:223]
    v_add_f32 v59, v59, v189
    v_exp_f32 v191, v191
    v_add_f32 v59, v59, v190
    v_add_f32 v59, v59, v191
    v_mfma_f32_32x32x16_bf16 v[192:207], a[224:227], a[64:67], v[192:207]
    v_mfma_f32_32x32x16_bf16 v[208:223], a[224:227], a[68:71], v[208:223]
    s_waitcnt vmcnt(12)
    ds_read_b128 v[112:115], v31 offset:16384
    v_mfma_f32_32x32x16_bf16 v[192:207], a[228:231], a[72:75], v[192:207]
    ds_read_b128 v[116:119], v32 offset:16384
    v_mfma_f32_32x32x16_bf16 v[208:223], a[228:231], a[76:79], v[208:223]
    v_mfma_f32_32x32x16_bf16 v[192:207], a[232:235], a[80:83], v[192:207]
    ds_read_b128 v[120:123], v33 offset:16384
    v_mfma_f32_32x32x16_bf16 v[208:223], a[232:235], a[84:87], v[208:223]
    ds_read_b128 v[124:127], v34 offset:16384
    v_mfma_f32_32x32x16_bf16 v[192:207], a[236:239], a[88:91], v[192:207]
    v_mfma_f32_32x32x16_bf16 v[208:223], a[236:239], a[92:95], v[208:223]
    s_waitcnt lgkmcnt(3)
    v_mfma_f32_32x32x16_bf16 v[224:239], v[112:115], a[64:67], v[224:239]
    s_add_u32 m0, s44, 8192
    s_xor_b32 s45, s61, 2
    s_mulk_i32 s45, 14336
    buffer_load_dwordx4 v21, s[24:27], s45 offen lds
    s_nop 4
    v_max3_f32 v52, v192, v193, v194
    v_max3_f32 v52, v52, v195, v196
    v_max3_f32 v52, v52, v197, v198
    v_max3_f32 v52, v52, v199, v200
    v_max3_f32 v52, v52, v201, v202
    v_mfma_f32_32x32x16_bf16 v[240:255], v[112:115], a[68:71], v[240:255]
    s_waitcnt vmcnt(9)
    ds_read_b128 v[96:99], v31 offset:20480
    v_max3_f32 v52, v52, v203, v204
    v_max3_f32 v52, v52, v205, v206
    v_max_f32 v52, v52, v207
    v_mul_f32 v52, s46, v52
    v_fma_f32 v192, v192, s46, -v52
    s_waitcnt lgkmcnt(3)
    v_mfma_f32_32x32x16_bf16 v[224:239], v[116:119], a[72:75], v[224:239]
    buffer_load_dwordx4 v22, s[24:27], s45 offen offset:1024 lds
    ds_read_b128 v[100:103], v32 offset:20480
    v_fma_f32 v193, v193, s46, -v52
    v_fma_f32 v194, v194, s46, -v52
    v_fma_f32 v195, v195, s46, -v52
    v_fma_f32 v196, v196, s46, -v52
    v_fma_f32 v197, v197, s46, -v52
    v_mfma_f32_32x32x16_bf16 v[240:255], v[116:119], a[76:79], v[240:255]
    v_fma_f32 v198, v198, s46, -v52
    v_fma_f32 v199, v199, s46, -v52
    v_fma_f32 v200, v200, s46, -v52
    v_fma_f32 v201, v201, s46, -v52
    v_fma_f32 v202, v202, s46, -v52
    s_waitcnt lgkmcnt(3)
    v_mfma_f32_32x32x16_bf16 v[224:239], v[120:123], a[80:83], v[224:239]
    buffer_load_dwordx4 v23, s[24:27], s45 offen offset:2048 lds
    ds_read_b128 v[104:107], v33 offset:20480
    v_fma_f32 v203, v203, s46, -v52
    v_fma_f32 v204, v204, s46, -v52
    v_fma_f32 v205, v205, s46, -v52
    v_fma_f32 v206, v206, s46, -v52
    v_fma_f32 v207, v207, s46, -v52
    v_mfma_f32_32x32x16_bf16 v[240:255], v[120:123], a[84:87], v[240:255]
    ds_read_b128 v[108:111], v34 offset:20480
    v_exp_f32 v192, v192
    v_exp_f32 v193, v193
    v_exp_f32 v194, v194
    v_add_f32 v60, v192, v193
    v_exp_f32 v195, v195
    s_waitcnt lgkmcnt(4)
    v_mfma_f32_32x32x16_bf16 v[224:239], v[124:127], a[88:91], v[224:239]
    buffer_load_dwordx4 v24, s[24:27], s45 offen offset:3072 lds
    v_add_f32 v60, v60, v194
    v_exp_f32 v196, v196
    v_add_f32 v60, v60, v195
    v_exp_f32 v197, v197
    v_add_f32 v60, v60, v196
    v_mfma_f32_32x32x16_bf16 v[240:255], v[124:127], a[92:95], v[240:255]
    v_exp_f32 v198, v198
    v_add_f32 v60, v60, v197
    v_exp_f32 v199, v199
    v_add_f32 v60, v60, v198
    v_exp_f32 v200, v200
    s_waitcnt lgkmcnt(3)
    v_mfma_f32_32x32x16_bf16 v[224:239], v[96:99], a[96:99], v[224:239]
    s_add_u32 m0, s44, 12288
    s_xor_b32 s45, s61, 3
    s_mulk_i32 s45, 14336
    buffer_load_dwordx4 v21, s[24:27], s45 offen lds
    v_add_f32 v60, v60, v199
    v_exp_f32 v201, v201
    v_add_f32 v60, v60, v200
    v_exp_f32 v202, v202
    v_add_f32 v60, v60, v201
    v_mfma_f32_32x32x16_bf16 v[240:255], v[96:99], a[100:103], v[240:255]
    v_exp_f32 v203, v203
    v_add_f32 v60, v60, v202
    v_exp_f32 v204, v204
    v_add_f32 v60, v60, v203
    v_exp_f32 v205, v205
    s_waitcnt lgkmcnt(2)
    v_mfma_f32_32x32x16_bf16 v[224:239], v[100:103], a[104:107], v[224:239]
    buffer_load_dwordx4 v22, s[24:27], s45 offen offset:1024 lds
    v_add_f32 v60, v60, v204
    v_exp_f32 v206, v206
    v_add_f32 v60, v60, v205
    v_exp_f32 v207, v207
    v_add_f32 v60, v60, v206
    v_mfma_f32_32x32x16_bf16 v[240:255], v[100:103], a[108:111], v[240:255]
    v_add_f32 v60, v60, v207
    v_max3_f32 v53, v208, v209, v210
    v_max3_f32 v53, v53, v211, v212
    v_max3_f32 v53, v53, v213, v214
    v_max3_f32 v53, v53, v215, v216
    s_waitcnt lgkmcnt(1)
    v_mfma_f32_32x32x16_bf16 v[224:239], v[104:107], a[112:115], v[224:239]
    buffer_load_dwordx4 v23, s[24:27], s45 offen offset:2048 lds
    v_max3_f32 v53, v53, v217, v218
    v_max3_f32 v53, v53, v219, v220
    v_max3_f32 v53, v53, v221, v222
    v_max_f32 v53, v53, v223
    v_mul_f32 v53, s46, v53
    v_mfma_f32_32x32x16_bf16 v[240:255], v[104:107], a[116:119], v[240:255]
    v_fma_f32 v208, v208, s46, -v53
    v_fma_f32 v209, v209, s46, -v53
    v_fma_f32 v210, v210, s46, -v53
    v_fma_f32 v211, v211, s46, -v53
    v_fma_f32 v212, v212, s46, -v53
    s_waitcnt lgkmcnt(0)
    v_mfma_f32_32x32x16_bf16 v[224:239], v[108:111], a[120:123], v[224:239]
    buffer_load_dwordx4 v24, s[24:27], s45 offen offset:3072 lds
    v_fma_f32 v213, v213, s46, -v53
    v_fma_f32 v214, v214, s46, -v53
    v_fma_f32 v215, v215, s46, -v53
    v_fma_f32 v216, v216, s46, -v53
    v_fma_f32 v217, v217, s46, -v53
    v_mfma_f32_32x32x16_bf16 v[240:255], v[108:111], a[124:127], v[240:255]
    v_fma_f32 v218, v218, s46, -v53
    v_fma_f32 v219, v219, s46, -v53
    v_fma_f32 v220, v220, s46, -v53
    v_fma_f32 v221, v221, s46, -v53
    v_fma_f32 v222, v222, s46, -v53
    v_fma_f32 v223, v223, s46, -v53
    v_exp_f32 v208, v208
    v_exp_f32 v209, v209
    v_exp_f32 v210, v210
    v_add_f32 v61, v208, v209
    v_exp_f32 v211, v211
    v_add_f32 v61, v61, v210
    v_exp_f32 v212, v212
    v_add_f32 v61, v61, v211
    v_exp_f32 v213, v213
    v_add_f32 v61, v61, v212
    v_exp_f32 v214, v214
    v_add_f32 v61, v61, v213
    v_exp_f32 v215, v215
    v_add_f32 v61, v61, v214
    v_exp_f32 v216, v216
    v_add_f32 v61, v61, v215
    v_exp_f32 v217, v217
    v_add_f32 v61, v61, v216
    s_waitcnt vmcnt(13)
    ds_read_b64_tr_b16 a[128:129], v37 offset:0
    ds_read_b64_tr_b16 a[132:133], v38 offset:0
    ds_read_b64_tr_b16 a[136:137], v39 offset:0
    ds_read_b64_tr_b16 a[140:141], v40 offset:0
    s_waitcnt vmcnt(12)
    ds_read_b64_tr_b16 a[130:131], v37 offset:1024
    ds_read_b64_tr_b16 a[134:135], v38 offset:1024
    ds_read_b64_tr_b16 a[138:139], v39 offset:1024
    ds_read_b64_tr_b16 a[142:143], v40 offset:1024
    s_add_u32 m0, s44, 16384
    s_xor_b32 s45, s61, 4
    s_mulk_i32 s45, 14336
    buffer_load_dwordx4 v21, s[24:27], s45 offen lds
    buffer_load_dwordx4 v22, s[24:27], s45 offen offset:1024 lds
    buffer_load_dwordx4 v23, s[24:27], s45 offen offset:2048 lds
    buffer_load_dwordx4 v24, s[24:27], s45 offen offset:3072 lds
    v_exp_f32 v218, v218
    v_add_f32 v61, v61, v217
    v_exp_f32 v219, v219
    v_add_f32 v61, v61, v218
    v_exp_f32 v220, v220
    v_add_f32 v61, v61, v219
    v_exp_f32 v221, v221
    v_add_f32 v61, v61, v220
    v_exp_f32 v222, v222
    v_add_f32 v61, v61, v221
    v_exp_f32 v223, v223
    v_add_f32 v61, v61, v222
    v_add_f32 v61, v61, v223
    v_max3_f32 v54, v224, v225, v226
    v_max3_f32 v54, v54, v227, v228
    v_max3_f32 v54, v54, v229, v230
    v_max3_f32 v54, v54, v231, v232
    v_max3_f32 v54, v54, v233, v234
    v_max3_f32 v54, v54, v235, v236
    v_max3_f32 v54, v54, v237, v238
    v_max_f32 v54, v54, v239
    v_mul_f32 v54, s46, v54
    v_pk_fma_f32 v[224:225], v[224:225], s[46:47], v[54:55] op_sel:[0,0,0] op_sel_hi:[1,0,0] neg_lo:[0,0,1] neg_hi:[0,0,1]
    v_pk_fma_f32 v[226:227], v[226:227], s[46:47], v[54:55] op_sel:[0,0,0] op_sel_hi:[1,0,0] neg_lo:[0,0,1] neg_hi:[0,0,1]
    v_pk_fma_f32 v[228:229], v[228:229], s[46:47], v[54:55] op_sel:[0,0,0] op_sel_hi:[1,0,0] neg_lo:[0,0,1] neg_hi:[0,0,1]
    v_pk_fma_f32 v[230:231], v[230:231], s[46:47], v[54:55] op_sel:[0,0,0] op_sel_hi:[1,0,0] neg_lo:[0,0,1] neg_hi:[0,0,1]
    v_pk_fma_f32 v[232:233], v[232:233], s[46:47], v[54:55] op_sel:[0,0,0] op_sel_hi:[1,0,0] neg_lo:[0,0,1] neg_hi:[0,0,1]
    v_pk_fma_f32 v[234:235], v[234:235], s[46:47], v[54:55] op_sel:[0,0,0] op_sel_hi:[1,0,0] neg_lo:[0,0,1] neg_hi:[0,0,1]
    v_pk_fma_f32 v[236:237], v[236:237], s[46:47], v[54:55] op_sel:[0,0,0] op_sel_hi:[1,0,0] neg_lo:[0,0,1] neg_hi:[0,0,1]
    v_pk_fma_f32 v[238:239], v[238:239], s[46:47], v[54:55] op_sel:[0,0,0] op_sel_hi:[1,0,0] neg_lo:[0,0,1] neg_hi:[0,0,1]
    v_exp_f32 v224, v224
    v_exp_f32 v225, v225
    v_exp_f32 v226, v226
    v_exp_f32 v227, v227
    v_exp_f32 v228, v228
    v_pk_add_f32 v[2:3], v[224:225], v[226:227]
    v_exp_f32 v229, v229
    v_exp_f32 v230, v230
    s_waitcnt vmcnt(13)
    ds_read_b64_tr_b16 a[144:145], v37 offset:4096
    ds_read_b64_tr_b16 a[148:149], v38 offset:4096
    ds_read_b64_tr_b16 a[152:153], v39 offset:4096
    ds_read_b64_tr_b16 a[156:157], v40 offset:4096
    s_waitcnt vmcnt(12)
    ds_read_b64_tr_b16 a[146:147], v37 offset:5120
    ds_read_b64_tr_b16 a[150:151], v38 offset:5120
    ds_read_b64_tr_b16 a[154:155], v39 offset:5120
    ds_read_b64_tr_b16 a[158:159], v40 offset:5120
    s_add_u32 m0, s44, 20480
    s_xor_b32 s45, s61, 5
    s_mulk_i32 s45, 14336
    buffer_load_dwordx4 v21, s[24:27], s45 offen lds
    buffer_load_dwordx4 v22, s[24:27], s45 offen offset:1024 lds
    buffer_load_dwordx4 v23, s[24:27], s45 offen offset:2048 lds
    buffer_load_dwordx4 v24, s[24:27], s45 offen offset:3072 lds
    v_pk_add_f32 v[2:3], v[2:3], v[228:229]
    v_exp_f32 v231, v231
    v_exp_f32 v232, v232
    v_pk_add_f32 v[2:3], v[2:3], v[230:231]
    v_exp_f32 v233, v233
    v_exp_f32 v234, v234
    v_pk_add_f32 v[2:3], v[2:3], v[232:233]
    v_exp_f32 v235, v235
    v_exp_f32 v236, v236
    v_pk_add_f32 v[2:3], v[2:3], v[234:235]
    v_exp_f32 v237, v237
    v_exp_f32 v238, v238
    v_pk_add_f32 v[2:3], v[2:3], v[236:237]
    v_exp_f32 v239, v239
    s_nop 0
    v_pk_add_f32 v[2:3], v[2:3], v[238:239]
    v_add_f32 v62, v2, v3
    v_max3_f32 v55, v240, v241, v242
    v_max3_f32 v55, v55, v243, v244
    v_max3_f32 v55, v55, v245, v246
    v_max3_f32 v55, v55, v247, v248
    v_max3_f32 v55, v55, v249, v250
    v_max3_f32 v55, v55, v251, v252
    v_max3_f32 v55, v55, v253, v254
    v_max_f32 v55, v55, v255
    v_mul_f32 v55, s46, v55
    v_pk_fma_f32 v[240:241], v[240:241], s[46:47], v[54:55] op_sel:[0,0,1] op_sel_hi:[1,0,1] neg_lo:[0,0,1] neg_hi:[0,0,1]
    v_pk_fma_f32 v[242:243], v[242:243], s[46:47], v[54:55] op_sel:[0,0,1] op_sel_hi:[1,0,1] neg_lo:[0,0,1] neg_hi:[0,0,1]
    v_pk_fma_f32 v[244:245], v[244:245], s[46:47], v[54:55] op_sel:[0,0,1] op_sel_hi:[1,0,1] neg_lo:[0,0,1] neg_hi:[0,0,1]
    v_pk_fma_f32 v[246:247], v[246:247], s[46:47], v[54:55] op_sel:[0,0,1] op_sel_hi:[1,0,1] neg_lo:[0,0,1] neg_hi:[0,0,1]
    v_pk_fma_f32 v[248:249], v[248:249], s[46:47], v[54:55] op_sel:[0,0,1] op_sel_hi:[1,0,1] neg_lo:[0,0,1] neg_hi:[0,0,1]
    v_pk_fma_f32 v[250:251], v[250:251], s[46:47], v[54:55] op_sel:[0,0,1] op_sel_hi:[1,0,1] neg_lo:[0,0,1] neg_hi:[0,0,1]
    v_pk_fma_f32 v[252:253], v[252:253], s[46:47], v[54:55] op_sel:[0,0,1] op_sel_hi:[1,0,1] neg_lo:[0,0,1] neg_hi:[0,0,1]
    v_pk_fma_f32 v[254:255], v[254:255], s[46:47], v[54:55] op_sel:[0,0,1] op_sel_hi:[1,0,1] neg_lo:[0,0,1] neg_hi:[0,0,1]
    v_exp_f32 v240, v240
    v_exp_f32 v241, v241
    v_exp_f32 v242, v242
    v_exp_f32 v243, v243
    s_waitcnt vmcnt(13)
    ds_read_b64_tr_b16 a[160:161], v37 offset:8192
    ds_read_b64_tr_b16 a[164:165], v38 offset:8192
    ds_read_b64_tr_b16 a[168:169], v39 offset:8192
    ds_read_b64_tr_b16 a[172:173], v40 offset:8192
    s_waitcnt vmcnt(12)
    ds_read_b64_tr_b16 a[162:163], v37 offset:9216
    ds_read_b64_tr_b16 a[166:167], v38 offset:9216
    ds_read_b64_tr_b16 a[170:171], v39 offset:9216
    ds_read_b64_tr_b16 a[174:175], v40 offset:9216
    s_add_u32 m0, s44, 0
    s_mov_b32 s45, 0
    s_waitcnt lgkmcnt(14)
    buffer_load_dwordx4 v17, s[16:19], s45 offen nt lds
    buffer_load_dwordx4 v18, s[16:19], s45 offen offset:1024 nt lds
    buffer_load_dwordx4 v19, s[16:19], s45 offen offset:2048 nt lds
    buffer_load_dwordx4 v20, s[16:19], s45 offen offset:3072 nt lds
    v_exp_f32 v244, v244
    v_pk_add_f32 v[2:3], v[240:241], v[242:243]
    v_exp_f32 v245, v245
    v_exp_f32 v246, v246
    v_pk_add_f32 v[2:3], v[2:3], v[244:245]
    v_exp_f32 v247, v247
    v_exp_f32 v248, v248
    v_pk_add_f32 v[2:3], v[2:3], v[246:247]
    v_exp_f32 v249, v249
    v_exp_f32 v250, v250
    v_pk_add_f32 v[2:3], v[2:3], v[248:249]
    v_exp_f32 v251, v251
    v_exp_f32 v252, v252
    v_pk_add_f32 v[2:3], v[2:3], v[250:251]
    v_exp_f32 v253, v253
    v_exp_f32 v254, v254
    v_pk_add_f32 v[2:3], v[2:3], v[252:253]
    v_exp_f32 v255, v255
    s_nop 0
    v_pk_add_f32 v[2:3], v[2:3], v[254:255]
    v_add_f32 v63, v2, v3
    v_max3_f32 v64, v48, v50, v52
    v_max_f32 v64, v64, v54
    v_max3_f32 v65, v49, v51, v53
    v_max_f32 v65, v65, v55
    v_sub_f32 v68, v48, v64
    v_sub_f32 v69, v49, v65
    v_sub_f32 v70, v50, v64
    v_sub_f32 v71, v51, v65
    v_sub_f32 v72, v52, v64
    v_sub_f32 v73, v53, v65
    v_sub_f32 v74, v54, v64
    v_sub_f32 v75, v55, v65
    v_exp_f32 v68, v68
    v_exp_f32 v69, v69
    v_exp_f32 v70, v70
    v_exp_f32 v71, v71
    v_exp_f32 v72, v72
    s_waitcnt vmcnt(13)
    ds_read_b64_tr_b16 a[176:177], v37 offset:12288
    ds_read_b64_tr_b16 a[180:181], v38 offset:12288
    ds_read_b64_tr_b16 a[184:185], v39 offset:12288
    ds_read_b64_tr_b16 a[188:189], v40 offset:12288
    s_waitcnt vmcnt(12)
    ds_read_b64_tr_b16 a[178:179], v37 offset:13312
    ds_read_b64_tr_b16 a[182:183], v38 offset:13312
    ds_read_b64_tr_b16 a[186:187], v39 offset:13312
    ds_read_b64_tr_b16 a[190:191], v40 offset:13312
    s_add_u32 m0, s44, 4096
    s_mov_b32 s45, 16384
    s_waitcnt lgkmcnt(14)
    buffer_load_dwordx4 v17, s[16:19], s45 offen nt lds
    buffer_load_dwordx4 v18, s[16:19], s45 offen offset:1024 nt lds
    buffer_load_dwordx4 v19, s[16:19], s45 offen offset:2048 nt lds
    buffer_load_dwordx4 v20, s[16:19], s45 offen offset:3072 nt lds
    s_add_u32 m0, s44, 8192
    s_mov_b32 s45, 32768
    s_waitcnt lgkmcnt(8)
    buffer_load_dwordx4 v17, s[16:19], s45 offen nt lds
    buffer_load_dwordx4 v18, s[16:19], s45 offen offset:1024 nt lds
    buffer_load_dwordx4 v19, s[16:19], s45 offen offset:2048 nt lds
    buffer_load_dwordx4 v20, s[16:19], s45 offen offset:3072 nt lds
    v_exp_f32 v73, v73
    v_exp_f32 v74, v74
    v_exp_f32 v75, v75
    v_pk_mul_f32 v[66:67], v[56:57], v[68:69]
    v_pk_fma_f32 v[66:67], v[58:59], v[70:71], v[66:67]
    v_pk_fma_f32 v[66:67], v[60:61], v[72:73], v[66:67]
    v_pk_fma_f32 v[66:67], v[62:63], v[74:75], v[66:67]
    v_permlane32_swap_b32 v64, v65
    s_nop 0
    v_permlane32_swap_b32 v66, v67
    v_max_f32 v72, v64, v65
    v_sub_f32 v68, v64, v72
    v_sub_f32 v69, v65, v72
    v_exp_f32 v68, v68
    v_exp_f32 v69, v69
    v_mul_f32 v73, v66, v68
    v_fmac_f32 v73, v67, v69
    ds_write_b64 v6, v[72:73] offset:0
    ds_write_b64 v6, v[72:73] offset:16384
    ds_write_b64 v6, v[72:73] offset:32768
    ds_write_b64 v6, v[72:73] offset:49152
    s_waitcnt lgkmcnt(0)
    s_barrier
    ds_read_b64 v[74:75], v8 offset:0
    ds_read_b64 v[76:77], v8 offset:512
    ds_read_b64 v[78:79], v8 offset:1024
    ds_read_b64 v[80:81], v8 offset:1536
    s_waitcnt lgkmcnt(1)
    v_max3_f32 v64, v74, v76, v78
    s_waitcnt lgkmcnt(0)
    v_max_f32 v64, v64, v80
    v_sub_f32 v68, v74, v64
    v_sub_f32 v69, v76, v64
    v_sub_f32 v70, v78, v64
    v_sub_f32 v71, v80, v64
    v_exp_f32 v68, v68
    v_exp_f32 v69, v69
    v_exp_f32 v70, v70
    v_exp_f32 v71, v71
    v_mul_f32 v65, v75, v68
    v_fmac_f32 v65, v77, v69
    v_fmac_f32 v65, v79, v70
    s_waitcnt vmcnt(17)
    ds_read_b64_tr_b16 a[192:193], v37 offset:16384
    ds_read_b64_tr_b16 a[196:197], v38 offset:16384
    ds_read_b64_tr_b16 a[200:201], v39 offset:16384
    ds_read_b64_tr_b16 a[204:205], v40 offset:16384
    s_waitcnt vmcnt(16)
    ds_read_b64_tr_b16 a[194:195], v37 offset:17408
    ds_read_b64_tr_b16 a[198:199], v38 offset:17408
    ds_read_b64_tr_b16 a[202:203], v39 offset:17408
    ds_read_b64_tr_b16 a[206:207], v40 offset:17408
    s_add_u32 m0, s44, 12288
    s_mov_b32 s45, 49152
    buffer_load_dwordx4 v17, s[16:19], s45 offen nt lds
    buffer_load_dwordx4 v18, s[16:19], s45 offen offset:1024 nt lds
    buffer_load_dwordx4 v19, s[16:19], s45 offen offset:2048 nt lds
    buffer_load_dwordx4 v20, s[16:19], s45 offen offset:3072 nt lds
    v_fmac_f32 v65, v81, v71
    v_log_f32 v65, v65
    s_nop 0
    v_add_f32 v64, v64, v65
    v_mov_b32 v65, v64
    s_nop 1
    v_permlane32_swap_b32 v64, v65
    v_sub_f32 v48, v48, v64
    v_sub_f32 v49, v49, v65
    v_sub_f32 v50, v50, v64
    v_sub_f32 v51, v51, v65
    v_sub_f32 v52, v52, v64
    v_sub_f32 v53, v53, v65
    v_sub_f32 v54, v54, v64
    v_sub_f32 v55, v55, v65
    v_exp_f32 v48, v48
    v_exp_f32 v49, v49
    v_exp_f32 v50, v50
    v_exp_f32 v51, v51
    v_exp_f32 v52, v52
    v_exp_f32 v53, v53
    v_exp_f32 v54, v54
    v_exp_f32 v55, v55
    v_pk_mul_f32 v[128:129], v[128:129], v[48:49] op_sel:[0,0] op_sel_hi:[1,0]
    v_pk_mul_f32 v[130:131], v[130:131], v[48:49] op_sel:[0,0] op_sel_hi:[1,0]
    v_pk_mul_f32 v[132:133], v[132:133], v[48:49] op_sel:[0,0] op_sel_hi:[1,0]
    v_pk_mul_f32 v[134:135], v[134:135], v[48:49] op_sel:[0,0] op_sel_hi:[1,0]
    v_cvt_pk_bf16_f32 v128, v128, v129
    v_cvt_pk_bf16_f32 v129, v130, v131
    v_cvt_pk_bf16_f32 v130, v132, v133
    v_cvt_pk_bf16_f32 v131, v134, v135
    ds_write_b128 v42, v[128:131] offset:0
    v_pk_mul_f32 v[136:137], v[136:137], v[48:49] op_sel:[0,0] op_sel_hi:[1,0]
    v_pk_mul_f32 v[138:139], v[138:139], v[48:49] op_sel:[0,0] op_sel_hi:[1,0]
    v_pk_mul_f32 v[140:141], v[140:141], v[48:49] op_sel:[0,0] op_sel_hi:[1,0]
    v_pk_mul_f32 v[142:143], v[142:143], v[48:49] op_sel:[0,0] op_sel_hi:[1,0]
    v_cvt_pk_bf16_f32 v136, v136, v137
    v_cvt_pk_bf16_f32 v137, v138, v139
    v_cvt_pk_bf16_f32 v138, v140, v141
    s_waitcnt vmcnt(17)
    ds_read_b64_tr_b16 a[208:209], v37 offset:20480
    ds_read_b64_tr_b16 a[212:213], v38 offset:20480
    ds_read_b64_tr_b16 a[216:217], v39 offset:20480
    ds_read_b64_tr_b16 a[220:221], v40 offset:20480
    s_waitcnt vmcnt(16)
    ds_read_b64_tr_b16 a[210:211], v37 offset:21504
    ds_read_b64_tr_b16 a[214:215], v38 offset:21504
    ds_read_b64_tr_b16 a[218:219], v39 offset:21504
    ds_read_b64_tr_b16 a[222:223], v40 offset:21504
    s_add_u32 m0, s44, 16384
    s_mov_b32 s45, 65536
    s_waitcnt lgkmcnt(9)
    buffer_load_dwordx4 v17, s[16:19], s45 offen nt lds
    buffer_load_dwordx4 v18, s[16:19], s45 offen offset:1024 nt lds
    buffer_load_dwordx4 v19, s[16:19], s45 offen offset:2048 nt lds
    buffer_load_dwordx4 v20, s[16:19], s45 offen offset:3072 nt lds
    v_cvt_pk_bf16_f32 v139, v142, v143
    ds_write_b128 v42, v[136:139] offset:2048
    v_pk_mul_f32 v[144:145], v[144:145], v[48:49] op_sel:[0,1] op_sel_hi:[1,1]
    v_pk_mul_f32 v[146:147], v[146:147], v[48:49] op_sel:[0,1] op_sel_hi:[1,1]
    v_pk_mul_f32 v[148:149], v[148:149], v[48:49] op_sel:[0,1] op_sel_hi:[1,1]
    v_pk_mul_f32 v[150:151], v[150:151], v[48:49] op_sel:[0,1] op_sel_hi:[1,1]
    v_cvt_pk_bf16_f32 v144, v144, v145
    v_cvt_pk_bf16_f32 v145, v146, v147
    v_cvt_pk_bf16_f32 v146, v148, v149
    v_cvt_pk_bf16_f32 v147, v150, v151
    ds_write_b128 v42, v[144:147] offset:1024
    v_pk_mul_f32 v[152:153], v[152:153], v[48:49] op_sel:[0,1] op_sel_hi:[1,1]
    v_pk_mul_f32 v[154:155], v[154:155], v[48:49] op_sel:[0,1] op_sel_hi:[1,1]
    v_pk_mul_f32 v[156:157], v[156:157], v[48:49] op_sel:[0,1] op_sel_hi:[1,1]
    v_pk_mul_f32 v[158:159], v[158:159], v[48:49] op_sel:[0,1] op_sel_hi:[1,1]
    v_cvt_pk_bf16_f32 v152, v152, v153
    v_cvt_pk_bf16_f32 v153, v154, v155
    v_cvt_pk_bf16_f32 v154, v156, v157
    v_cvt_pk_bf16_f32 v155, v158, v159
    ds_write_b128 v42, v[152:155] offset:3072
    v_pk_mul_f32 v[160:161], v[160:161], v[50:51] op_sel:[0,0] op_sel_hi:[1,0]
    v_pk_mul_f32 v[162:163], v[162:163], v[50:51] op_sel:[0,0] op_sel_hi:[1,0]
    v_pk_mul_f32 v[164:165], v[164:165], v[50:51] op_sel:[0,0] op_sel_hi:[1,0]
    v_pk_mul_f32 v[166:167], v[166:167], v[50:51] op_sel:[0,0] op_sel_hi:[1,0]
    v_cvt_pk_bf16_f32 v160, v160, v161
    v_cvt_pk_bf16_f32 v161, v162, v163
    v_cvt_pk_bf16_f32 v162, v164, v165
    v_cvt_pk_bf16_f32 v163, v166, v167
    ds_write_b128 v42, v[160:163] offset:4096
    v_pk_mul_f32 v[168:169], v[168:169], v[50:51] op_sel:[0,0] op_sel_hi:[1,0]
    v_pk_mul_f32 v[170:171], v[170:171], v[50:51] op_sel:[0,0] op_sel_hi:[1,0]
    v_pk_mul_f32 v[172:173], v[172:173], v[50:51] op_sel:[0,0] op_sel_hi:[1,0]
    v_pk_mul_f32 v[174:175], v[174:175], v[50:51] op_sel:[0,0] op_sel_hi:[1,0]
    v_cvt_pk_bf16_f32 v168, v168, v169
    v_cvt_pk_bf16_f32 v169, v170, v171
    v_cvt_pk_bf16_f32 v170, v172, v173
    v_cvt_pk_bf16_f32 v171, v174, v175
    ds_write_b128 v42, v[168:171] offset:6144
    s_add_u32 m0, s44, 20480
    s_mov_b32 s45, 81920
    s_waitcnt lgkmcnt(5)
    buffer_load_dwordx4 v17, s[16:19], s45 offen nt lds
    buffer_load_dwordx4 v18, s[16:19], s45 offen offset:1024 nt lds
    buffer_load_dwordx4 v19, s[16:19], s45 offen offset:2048 nt lds
    buffer_load_dwordx4 v20, s[16:19], s45 offen offset:3072 nt lds
    v_pk_mul_f32 v[176:177], v[176:177], v[50:51] op_sel:[0,1] op_sel_hi:[1,1]
    v_pk_mul_f32 v[178:179], v[178:179], v[50:51] op_sel:[0,1] op_sel_hi:[1,1]
    v_pk_mul_f32 v[180:181], v[180:181], v[50:51] op_sel:[0,1] op_sel_hi:[1,1]
    v_pk_mul_f32 v[182:183], v[182:183], v[50:51] op_sel:[0,1] op_sel_hi:[1,1]
    v_cvt_pk_bf16_f32 v176, v176, v177
    v_cvt_pk_bf16_f32 v177, v178, v179
    v_cvt_pk_bf16_f32 v178, v180, v181
    v_cvt_pk_bf16_f32 v179, v182, v183
    ds_write_b128 v42, v[176:179] offset:5120
    v_pk_mul_f32 v[184:185], v[184:185], v[50:51] op_sel:[0,1] op_sel_hi:[1,1]
    v_pk_mul_f32 v[186:187], v[186:187], v[50:51] op_sel:[0,1] op_sel_hi:[1,1]
    v_pk_mul_f32 v[188:189], v[188:189], v[50:51] op_sel:[0,1] op_sel_hi:[1,1]
    v_pk_mul_f32 v[190:191], v[190:191], v[50:51] op_sel:[0,1] op_sel_hi:[1,1]
    v_cvt_pk_bf16_f32 v184, v184, v185
    v_cvt_pk_bf16_f32 v185, v186, v187
    v_cvt_pk_bf16_f32 v186, v188, v189
    v_cvt_pk_bf16_f32 v187, v190, v191
    ds_write_b128 v42, v[184:187] offset:7168
    s_waitcnt lgkmcnt(0)
    s_barrier
    v_mul_f32 v192, v192, v52
    v_mul_f32 v193, v193, v52
    v_mul_f32 v194, v194, v52
    v_mul_f32 v195, v195, v52
    v_mul_f32 v196, v196, v52
    v_mul_f32 v197, v197, v52
    v_mul_f32 v198, v198, v52
    v_mul_f32 v199, v199, v52
    v_cvt_pk_bf16_f32 v192, v192, v193
    v_cvt_pk_bf16_f32 v193, v194, v195
    v_cvt_pk_bf16_f32 v194, v196, v197
    v_cvt_pk_bf16_f32 v195, v198, v199
    ds_write_b128 v42, v[192:195] offset:8192
    v_mul_f32 v200, v200, v52
    s_waitcnt vmcnt(23)
    ds_read_b64_tr_b16 v[64:65], v35 offset:0
    s_waitcnt vmcnt(22)
    ds_read_b64_tr_b16 v[66:67], v35 offset:1024
    ds_read_b128 v[80:83], v43 offset:0
    ds_read_b64_tr_b16 v[68:69], v36 offset:0
    ds_read_b64_tr_b16 v[70:71], v36 offset:1024
    ds_read_b128 v[84:87], v44 offset:0
    s_waitcnt vmcnt(21)
    ds_read_b64_tr_b16 v[72:73], v35 offset:2048
    s_waitcnt vmcnt(20)
    ds_read_b64_tr_b16 v[74:75], v35 offset:3072
    ds_read_b128 v[88:91], v43 offset:2048
    ds_read_b64_tr_b16 v[76:77], v36 offset:2048
    ds_read_b64_tr_b16 v[78:79], v36 offset:3072
    ds_read_b128 v[92:95], v44 offset:2048
    s_waitcnt lgkmcnt(9)
    v_mfma_f32_32x32x16_bf16 v[128:143], v[64:67], v[80:83], 0
    v_mul_f32 v201, v201, v52
    v_mul_f32 v202, v202, v52
    s_waitcnt lgkmcnt(7)
    v_mfma_f32_32x32x16_bf16 v[160:175], v[68:71], v[80:83], 0
    s_waitcnt vmcnt(19)
    ds_read_b64_tr_b16 v[96:97], v35 offset:4096
    s_waitcnt vmcnt(18)
    ds_read_b64_tr_b16 v[98:99], v35 offset:5120
    v_mul_f32 v203, v203, v52
    v_mul_f32 v204, v204, v52
    s_waitcnt lgkmcnt(8)
    v_mfma_f32_32x32x16_bf16 v[144:159], v[64:67], v[84:87], 0
    ds_read_b128 v[112:115], v43 offset:16384
    ds_read_b64_tr_b16 v[100:101], v36 offset:4096
    v_mul_f32 v205, v205, v52
    v_mul_f32 v206, v206, v52
    v_mfma_f32_32x32x16_bf16 v[176:191], v[68:71], v[84:87], 0
    ds_read_b64_tr_b16 v[102:103], v36 offset:5120
    ds_read_b128 v[116:119], v44 offset:16384
    v_mul_f32 v207, v207, v52
    s_waitcnt lgkmcnt(9)
    v_mfma_f32_32x32x16_bf16 v[128:143], v[72:75], v[88:91], v[128:143]
    s_waitcnt vmcnt(17)
    ds_read_b64_tr_b16 v[104:105], v35 offset:6144
    s_waitcnt vmcnt(16)
    ds_read_b64_tr_b16 v[106:107], v35 offset:7168
    v_cvt_pk_bf16_f32 v200, v200, v201
    v_cvt_pk_bf16_f32 v201, v202, v203
    s_waitcnt lgkmcnt(9)
    v_mfma_f32_32x32x16_bf16 v[160:175], v[76:79], v[88:91], v[160:175]
    ds_read_b128 v[120:123], v43 offset:18432
    ds_read_b64_tr_b16 v[108:109], v36 offset:6144
    v_cvt_pk_bf16_f32 v202, v204, v205
    v_cvt_pk_bf16_f32 v203, v206, v207
    s_waitcnt lgkmcnt(10)
    v_mfma_f32_32x32x16_bf16 v[144:159], v[72:75], v[92:95], v[144:159]
    ds_read_b64_tr_b16 v[110:111], v36 offset:7168
    ds_read_b128 v[124:127], v44 offset:18432
    ds_write_b128 v42, v[200:203] offset:10240
    v_mul_f32 v208, v208, v53
    v_mfma_f32_32x32x16_bf16 v[176:191], v[76:79], v[92:95], v[176:191]
    v_mul_f32 v209, v209, v53
    s_waitcnt lgkmcnt(10)
    v_mfma_f32_32x32x16_bf16 v[128:143], v[96:99], v[112:115], v[128:143]
    v_mul_f32 v210, v210, v53
    v_mul_f32 v211, v211, v53
    s_waitcnt lgkmcnt(8)
    v_mfma_f32_32x32x16_bf16 v[160:175], v[100:103], v[112:115], v[160:175]
    s_waitcnt vmcnt(15)
    ds_read_b64_tr_b16 v[64:65], v35 offset:8192
    s_waitcnt vmcnt(14)
    ds_read_b64_tr_b16 v[66:67], v35 offset:9216
    v_mul_f32 v212, v212, v53
    v_mul_f32 v213, v213, v53
    s_waitcnt lgkmcnt(9)
    v_mfma_f32_32x32x16_bf16 v[144:159], v[96:99], v[116:119], v[144:159]
    ds_read_b128 v[80:83], v43 offset:32768
    ds_read_b64_tr_b16 v[68:69], v36 offset:8192
    v_mul_f32 v214, v214, v53
    v_mul_f32 v215, v215, v53
    v_mfma_f32_32x32x16_bf16 v[176:191], v[100:103], v[116:119], v[176:191]
    ds_read_b64_tr_b16 v[70:71], v36 offset:9216
    ds_read_b128 v[84:87], v44 offset:32768
    v_cvt_pk_bf16_f32 v208, v208, v209
    s_waitcnt lgkmcnt(10)
    v_mfma_f32_32x32x16_bf16 v[128:143], v[104:107], v[120:123], v[128:143]
    s_waitcnt vmcnt(13)
    ds_read_b64_tr_b16 v[72:73], v35 offset:10240
    s_waitcnt vmcnt(12)
    ds_read_b64_tr_b16 v[74:75], v35 offset:11264
    v_cvt_pk_bf16_f32 v209, v210, v211
    v_cvt_pk_bf16_f32 v210, v212, v213
    s_waitcnt lgkmcnt(10)
    v_mfma_f32_32x32x16_bf16 v[160:175], v[108:111], v[120:123], v[160:175]
    ds_read_b128 v[88:91], v43 offset:34816
    ds_read_b64_tr_b16 v[76:77], v36 offset:10240
    v_cvt_pk_bf16_f32 v211, v214, v215
    ds_write_b128 v42, v[208:211] offset:9216
    s_waitcnt lgkmcnt(12)
    v_mfma_f32_32x32x16_bf16 v[144:159], v[104:107], v[124:127], v[144:159]
    ds_read_b64_tr_b16 v[78:79], v36 offset:11264
    ds_read_b128 v[92:95], v44 offset:34816
    v_mul_f32 v216, v216, v53
    v_mul_f32 v217, v217, v53
    v_mfma_f32_32x32x16_bf16 v[176:191], v[108:111], v[124:127], v[176:191]
    v_mul_f32 v218, v218, v53
    s_waitcnt lgkmcnt(10)
    v_mfma_f32_32x32x16_bf16 v[128:143], v[64:67], v[80:83], v[128:143]
    s_add_u32 m0, s44, 0
    s_mov_b32 s45, 98304
    buffer_load_dwordx4 v17, s[16:19], s45 offen nt lds
    v_mul_f32 v219, v219, v53
    v_mul_f32 v220, v220, v53
    s_waitcnt lgkmcnt(8)
    v_mfma_f32_32x32x16_bf16 v[160:175], v[68:71], v[80:83], v[160:175]
    s_waitcnt vmcnt(12)
    ds_read_b64_tr_b16 v[96:97], v35 offset:12288
    s_waitcnt vmcnt(11)
    ds_read_b64_tr_b16 v[98:99], v35 offset:13312
    v_mul_f32 v221, v221, v53
    v_mul_f32 v222, v222, v53
    s_waitcnt lgkmcnt(9)
    v_mfma_f32_32x32x16_bf16 v[144:159], v[64:67], v[84:87], v[144:159]
    buffer_load_dwordx4 v18, s[16:19], s45 offen offset:1024 nt lds
    ds_read_b128 v[112:115], v43 offset:49152
    ds_read_b64_tr_b16 v[100:101], v36 offset:12288
    v_mul_f32 v223, v223, v53
    v_cvt_pk_bf16_f32 v216, v216, v217
    v_mfma_f32_32x32x16_bf16 v[176:191], v[68:71], v[84:87], v[176:191]
    ds_read_b64_tr_b16 v[102:103], v36 offset:13312
    ds_read_b128 v[116:119], v44 offset:49152
    v_cvt_pk_bf16_f32 v217, v218, v219
    s_waitcnt lgkmcnt(10)
    v_mfma_f32_32x32x16_bf16 v[128:143], v[72:75], v[88:91], v[128:143]
    buffer_load_dwordx4 v19, s[16:19], s45 offen offset:2048 nt lds
    s_waitcnt vmcnt(12)
    ds_read_b64_tr_b16 v[104:105], v35 offset:14336
    s_waitcnt vmcnt(11)
    ds_read_b64_tr_b16 v[106:107], v35 offset:15360
    v_cvt_pk_bf16_f32 v218, v220, v221
    v_cvt_pk_bf16_f32 v219, v222, v223
    s_waitcnt lgkmcnt(9)
    v_mfma_f32_32x32x16_bf16 v[160:175], v[76:79], v[88:91], v[160:175]
    ds_read_b128 v[120:123], v43 offset:51200
    ds_read_b64_tr_b16 v[108:109], v36 offset:14336
    ds_write_b128 v42, v[216:219] offset:11264
    v_mul_f32 v224, v224, v54
    s_waitcnt lgkmcnt(11)
    v_mfma_f32_32x32x16_bf16 v[144:159], v[72:75], v[92:95], v[144:159]
    buffer_load_dwordx4 v20, s[16:19], s45 offen offset:3072 nt lds
    ds_read_b64_tr_b16 v[110:111], v36 offset:15360
    ds_read_b128 v[124:127], v44 offset:51200
    v_mul_f32 v225, v225, v54
    v_mul_f32 v226, v226, v54
    v_mfma_f32_32x32x16_bf16 v[176:191], v[76:79], v[92:95], v[176:191]
    v_mul_f32 v227, v227, v54
    s_waitcnt lgkmcnt(10)
    v_mfma_f32_32x32x16_bf16 v[128:143], v[96:99], v[112:115], v[128:143]
    s_add_u32 m0, s44, 4096
    s_mov_b32 s45, 114688
    buffer_load_dwordx4 v17, s[16:19], s45 offen nt lds
    v_mul_f32 v228, v228, v54
    v_mul_f32 v229, v229, v54
    s_waitcnt lgkmcnt(8)
    v_mfma_f32_32x32x16_bf16 v[160:175], v[100:103], v[112:115], v[160:175]
    s_waitcnt vmcnt(12)
    ds_read_b64_tr_b16 v[64:65], v35 offset:16384
    s_waitcnt vmcnt(11)
    ds_read_b64_tr_b16 v[66:67], v35 offset:17408
    v_mul_f32 v230, v230, v54
    v_mul_f32 v231, v231, v54
    s_waitcnt lgkmcnt(9)
    v_mfma_f32_32x32x16_bf16 v[144:159], v[96:99], v[116:119], v[144:159]
    buffer_load_dwordx4 v18, s[16:19], s45 offen offset:1024 nt lds
    ds_read_b128 v[80:83], v43 offset:4096
    ds_read_b64_tr_b16 v[68:69], v36 offset:16384
    v_cvt_pk_bf16_f32 v224, v224, v225
    v_cvt_pk_bf16_f32 v225, v226, v227
    v_mfma_f32_32x32x16_bf16 v[176:191], v[100:103], v[116:119], v[176:191]
    ds_read_b64_tr_b16 v[70:71], v36 offset:17408
    ds_read_b128 v[84:87], v44 offset:4096
    v_cvt_pk_bf16_f32 v226, v228, v229
    s_waitcnt lgkmcnt(10)
    v_mfma_f32_32x32x16_bf16 v[128:143], v[104:107], v[120:123], v[128:143]
    buffer_load_dwordx4 v19, s[16:19], s45 offen offset:2048 nt lds
    s_waitcnt vmcnt(12)
    ds_read_b64_tr_b16 v[72:73], v35 offset:18432
    s_waitcnt vmcnt(11)
    ds_read_b64_tr_b16 v[74:75], v35 offset:19456
    v_cvt_pk_bf16_f32 v227, v230, v231
    ds_write_b128 v42, v[224:227] offset:12288
    s_waitcnt lgkmcnt(10)
    v_mfma_f32_32x32x16_bf16 v[160:175], v[108:111], v[120:123], v[160:175]
    ds_read_b128 v[88:91], v43 offset:6144
    ds_read_b64_tr_b16 v[76:77], v36 offset:18432
    v_mul_f32 v232, v232, v54
    v_mul_f32 v233, v233, v54
    s_waitcnt lgkmcnt(11)
    v_mfma_f32_32x32x16_bf16 v[144:159], v[104:107], v[124:127], v[144:159]
    buffer_load_dwordx4 v20, s[16:19], s45 offen offset:3072 nt lds
    ds_read_b64_tr_b16 v[78:79], v36 offset:19456
    ds_read_b128 v[92:95], v44 offset:6144
    v_mul_f32 v234, v234, v54
    v_mul_f32 v235, v235, v54
    v_mfma_f32_32x32x16_bf16 v[176:191], v[108:111], v[124:127], v[176:191]
    v_mul_f32 v236, v236, v54
    s_waitcnt lgkmcnt(10)
    v_mfma_f32_32x32x16_bf16 v[128:143], v[64:67], v[80:83], v[128:143]
    s_add_u32 m0, s44, 8192
    s_mov_b32 s45, 131072
    buffer_load_dwordx4 v17, s[16:19], s45 offen nt lds
    v_mul_f32 v237, v237, v54
    v_mul_f32 v238, v238, v54
    s_waitcnt lgkmcnt(8)
    v_mfma_f32_32x32x16_bf16 v[160:175], v[68:71], v[80:83], v[160:175]
    s_waitcnt vmcnt(12)
    ds_read_b64_tr_b16 v[96:97], v35 offset:20480
    s_waitcnt vmcnt(11)
    ds_read_b64_tr_b16 v[98:99], v35 offset:21504
    v_mul_f32 v239, v239, v54
    v_cvt_pk_bf16_f32 v232, v232, v233
    s_waitcnt lgkmcnt(9)
    v_mfma_f32_32x32x16_bf16 v[144:159], v[64:67], v[84:87], v[144:159]
    buffer_load_dwordx4 v18, s[16:19], s45 offen offset:1024 nt lds
    ds_read_b128 v[112:115], v43 offset:20480
    ds_read_b64_tr_b16 v[100:101], v36 offset:20480
    v_cvt_pk_bf16_f32 v233, v234, v235
    v_cvt_pk_bf16_f32 v234, v236, v237
    v_mfma_f32_32x32x16_bf16 v[176:191], v[68:71], v[84:87], v[176:191]
    ds_read_b64_tr_b16 v[102:103], v36 offset:21504
    ds_read_b128 v[116:119], v44 offset:20480
    v_cvt_pk_bf16_f32 v235, v238, v239
    s_waitcnt lgkmcnt(9)
    v_mfma_f32_32x32x16_bf16 v[128:143], v[72:75], v[88:91], v[128:143]
    buffer_load_dwordx4 v19, s[16:19], s45 offen offset:2048 nt lds
    s_waitcnt vmcnt(12)
    ds_read_b64_tr_b16 v[104:105], v35 offset:22528
    s_waitcnt vmcnt(11)
    ds_read_b64_tr_b16 v[106:107], v35 offset:23552
    ds_write_b128 v42, v[232:235] offset:14336
    v_mul_f32 v240, v240, v55
    s_waitcnt lgkmcnt(10)
    v_mfma_f32_32x32x16_bf16 v[160:175], v[76:79], v[88:91], v[160:175]
    ds_read_b128 v[120:123], v43 offset:22528
    ds_read_b64_tr_b16 v[108:109], v36 offset:22528
    v_mul_f32 v241, v241, v55
    v_mul_f32 v242, v242, v55
    s_waitcnt lgkmcnt(11)
    v_mfma_f32_32x32x16_bf16 v[144:159], v[72:75], v[92:95], v[144:159]
    buffer_load_dwordx4 v20, s[16:19], s45 offen offset:3072 nt lds
    ds_read_b64_tr_b16 v[110:111], v36 offset:23552
    ds_read_b128 v[124:127], v44 offset:22528
    v_mul_f32 v243, v243, v55
    v_mul_f32 v244, v244, v55
    v_mfma_f32_32x32x16_bf16 v[176:191], v[76:79], v[92:95], v[176:191]
    v_mul_f32 v245, v245, v55
    s_waitcnt lgkmcnt(10)
    v_mfma_f32_32x32x16_bf16 v[128:143], v[96:99], v[112:115], v[128:143]
    s_add_u32 m0, s44, 12288
    s_mov_b32 s45, 147456
    buffer_load_dwordx4 v17, s[16:19], s45 offen nt lds
    v_mul_f32 v246, v246, v55
    v_mul_f32 v247, v247, v55
    s_waitcnt lgkmcnt(8)
    v_mfma_f32_32x32x16_bf16 v[160:175], v[100:103], v[112:115], v[160:175]
    s_waitcnt vmcnt(12)
    ds_read_b64_tr_b16 v[64:65], v35 offset:0
    s_waitcnt vmcnt(11)
    ds_read_b64_tr_b16 v[66:67], v35 offset:1024
    v_cvt_pk_bf16_f32 v240, v240, v241
    v_cvt_pk_bf16_f32 v241, v242, v243
    s_waitcnt lgkmcnt(9)
    v_mfma_f32_32x32x16_bf16 v[144:159], v[96:99], v[116:119], v[144:159]
    buffer_load_dwordx4 v18, s[16:19], s45 offen offset:1024 nt lds
    ds_read_b128 v[80:83], v43 offset:36864
    ds_read_b64_tr_b16 v[68:69], v36 offset:0
    v_cvt_pk_bf16_f32 v242, v244, v245
    v_cvt_pk_bf16_f32 v243, v246, v247
    v_mfma_f32_32x32x16_bf16 v[176:191], v[100:103], v[116:119], v[176:191]
    ds_read_b64_tr_b16 v[70:71], v36 offset:1024
    ds_read_b128 v[84:87], v44 offset:36864
    ds_write_b128 v42, v[240:243] offset:13312
    s_waitcnt lgkmcnt(10)
    v_mfma_f32_32x32x16_bf16 v[128:143], v[104:107], v[120:123], v[128:143]
    buffer_load_dwordx4 v19, s[16:19], s45 offen offset:2048 nt lds
    s_waitcnt vmcnt(12)
    ds_read_b64_tr_b16 v[72:73], v35 offset:2048
    s_waitcnt vmcnt(11)
    ds_read_b64_tr_b16 v[74:75], v35 offset:3072
    v_mul_f32 v248, v248, v55
    v_mul_f32 v249, v249, v55
    s_waitcnt lgkmcnt(10)
    v_mfma_f32_32x32x16_bf16 v[160:175], v[108:111], v[120:123], v[160:175]
    ds_read_b128 v[88:91], v43 offset:38912
    ds_read_b64_tr_b16 v[76:77], v36 offset:2048
    v_mul_f32 v250, v250, v55
    v_mul_f32 v251, v251, v55
    s_waitcnt lgkmcnt(11)
    v_mfma_f32_32x32x16_bf16 v[144:159], v[104:107], v[124:127], v[144:159]
    buffer_load_dwordx4 v20, s[16:19], s45 offen offset:3072 nt lds
    ds_read_b64_tr_b16 v[78:79], v36 offset:3072
    ds_read_b128 v[92:95], v44 offset:38912
    v_mul_f32 v252, v252, v55
    v_mul_f32 v253, v253, v55
    v_mfma_f32_32x32x16_bf16 v[176:191], v[108:111], v[124:127], v[176:191]
    v_mul_f32 v254, v254, v55
    s_waitcnt lgkmcnt(10)
    v_mfma_f32_32x32x16_bf16 v[128:143], v[64:67], v[80:83], v[128:143]
    s_add_u32 m0, s44, 16384
    s_mov_b32 s45, 163840
    buffer_load_dwordx4 v17, s[16:19], s45 offen nt lds
    v_mul_f32 v255, v255, v55
    v_cvt_pk_bf16_f32 v248, v248, v249
    s_waitcnt lgkmcnt(8)
    v_mfma_f32_32x32x16_bf16 v[160:175], v[68:71], v[80:83], v[160:175]
    s_waitcnt vmcnt(12)
    ds_read_b64_tr_b16 v[96:97], v35 offset:4096
    s_waitcnt vmcnt(11)
    ds_read_b64_tr_b16 v[98:99], v35 offset:5120
    v_cvt_pk_bf16_f32 v249, v250, v251
    s_waitcnt lgkmcnt(9)
    v_mfma_f32_32x32x16_bf16 v[144:159], v[64:67], v[84:87], v[144:159]
    buffer_load_dwordx4 v18, s[16:19], s45 offen offset:1024 nt lds
    ds_read_b128 v[112:115], v43 offset:53248
    ds_read_b64_tr_b16 v[100:101], v36 offset:4096
    v_cvt_pk_bf16_f32 v250, v252, v253
    v_cvt_pk_bf16_f32 v251, v254, v255
    v_mfma_f32_32x32x16_bf16 v[176:191], v[68:71], v[84:87], v[176:191]
    ds_read_b64_tr_b16 v[102:103], v36 offset:5120
    ds_read_b128 v[116:119], v44 offset:53248
    ds_write_b128 v42, v[248:251] offset:15360
    s_waitcnt lgkmcnt(10)
    v_mfma_f32_32x32x16_bf16 v[128:143], v[72:75], v[88:91], v[128:143]
    buffer_load_dwordx4 v19, s[16:19], s45 offen offset:2048 nt lds
    s_waitcnt vmcnt(12)
    ds_read_b64_tr_b16 v[104:105], v35 offset:6144
    s_waitcnt vmcnt(11)
    ds_read_b64_tr_b16 v[106:107], v35 offset:7168
    v_mov_b32 v2, 0
    s_waitcnt lgkmcnt(10)
    v_mfma_f32_32x32x16_bf16 v[160:175], v[76:79], v[88:91], v[160:175]
    ds_read_b128 v[120:123], v43 offset:55296
    ds_read_b64_tr_b16 v[108:109], v36 offset:6144
    buffer_load_dwordx4 v[28:31], v2, s[36:39], s60 offen sc1
    s_lshl_b32 s3, s50, 10
    s_waitcnt lgkmcnt(11)
    v_mfma_f32_32x32x16_bf16 v[144:159], v[72:75], v[92:95], v[144:159]
    buffer_load_dwordx4 v20, s[16:19], s45 offen offset:3072 nt lds
    ds_read_b64_tr_b16 v[110:111], v36 offset:7168
    ds_read_b128 v[124:127], v44 offset:55296
    v_add_u32 v16, s3, v42
    v_mfma_f32_32x32x16_bf16 v[176:191], v[76:79], v[92:95], v[176:191]
    v_xor_b32 v12, 0x400, v16
    s_waitcnt lgkmcnt(10)
    v_mfma_f32_32x32x16_bf16 v[128:143], v[96:99], v[112:115], v[128:143]
    s_add_u32 m0, s44, 20480
    s_mov_b32 s45, 180224
    buffer_load_dwordx4 v17, s[16:19], s45 offen nt lds
    s_waitcnt lgkmcnt(8)
    v_mfma_f32_32x32x16_bf16 v[160:175], v[100:103], v[112:115], v[160:175]
    s_waitcnt lgkmcnt(0)
    s_barrier
    s_waitcnt vmcnt(13)
    ds_read_b64_tr_b16 v[64:65], v35 offset:8192
    s_waitcnt vmcnt(12)
    ds_read_b64_tr_b16 v[66:67], v35 offset:9216
    v_mfma_f32_32x32x16_bf16 v[144:159], v[96:99], v[116:119], v[144:159]
    buffer_load_dwordx4 v18, s[16:19], s45 offen offset:1024 nt lds
    ds_read_b128 v[80:83], v43 offset:8192
    ds_read_b64_tr_b16 v[68:69], v36 offset:8192
    v_mfma_f32_32x32x16_bf16 v[176:191], v[100:103], v[116:119], v[176:191]
    ds_read_b64_tr_b16 v[70:71], v36 offset:9216
    ds_read_b128 v[84:87], v44 offset:8192
    v_mfma_f32_32x32x16_bf16 v[128:143], v[104:107], v[120:123], v[128:143]
    buffer_load_dwordx4 v19, s[16:19], s45 offen offset:2048 nt lds
    s_waitcnt vmcnt(13)
    ds_read_b64_tr_b16 v[72:73], v35 offset:10240
    s_waitcnt vmcnt(12)
    ds_read_b64_tr_b16 v[74:75], v35 offset:11264
    v_mfma_f32_32x32x16_bf16 v[160:175], v[108:111], v[120:123], v[160:175]
    ds_read_b128 v[88:91], v43 offset:10240
    ds_read_b64_tr_b16 v[76:77], v36 offset:10240
    v_mfma_f32_32x32x16_bf16 v[144:159], v[104:107], v[124:127], v[144:159]
    buffer_load_dwordx4 v20, s[16:19], s45 offen offset:3072 nt lds
    ds_read_b64_tr_b16 v[78:79], v36 offset:11264
    ds_read_b128 v[92:95], v44 offset:10240
    v_mfma_f32_32x32x16_bf16 v[176:191], v[108:111], v[124:127], v[176:191]
    s_waitcnt lgkmcnt(9)
    v_mfma_f32_32x32x16_bf16 v[128:143], v[64:67], v[80:83], v[128:143]
    s_add_u32 m0, s44, 0
    s_mov_b32 s45, 196608
    buffer_load_dwordx4 v17, s[16:19], s45 offen nt lds
    s_waitcnt lgkmcnt(7)
    v_mfma_f32_32x32x16_bf16 v[160:175], v[68:71], v[80:83], v[160:175]
    s_waitcnt vmcnt(13)
    ds_read_b64_tr_b16 v[96:97], v35 offset:12288
    s_waitcnt vmcnt(12)
    ds_read_b64_tr_b16 v[98:99], v35 offset:13312
    s_waitcnt lgkmcnt(8)
    v_mfma_f32_32x32x16_bf16 v[144:159], v[64:67], v[84:87], v[144:159]
    buffer_load_dwordx4 v18, s[16:19], s45 offen offset:1024 nt lds
    ds_read_b128 v[112:115], v43 offset:24576
    ds_read_b64_tr_b16 v[100:101], v36 offset:12288
    v_mfma_f32_32x32x16_bf16 v[176:191], v[68:71], v[84:87], v[176:191]
    ds_read_b64_tr_b16 v[102:103], v36 offset:13312
    ds_read_b128 v[116:119], v44 offset:24576
    s_waitcnt lgkmcnt(9)
    v_mfma_f32_32x32x16_bf16 v[128:143], v[72:75], v[88:91], v[128:143]
    buffer_load_dwordx4 v19, s[16:19], s45 offen offset:2048 nt lds
    s_waitcnt vmcnt(13)
    ds_read_b64_tr_b16 v[104:105], v35 offset:14336
    s_waitcnt vmcnt(12)
    ds_read_b64_tr_b16 v[106:107], v35 offset:15360
    s_waitcnt lgkmcnt(9)
    v_mfma_f32_32x32x16_bf16 v[160:175], v[76:79], v[88:91], v[160:175]
    ds_read_b128 v[120:123], v43 offset:26624
    ds_read_b64_tr_b16 v[108:109], v36 offset:14336
    s_waitcnt lgkmcnt(10)
    v_mfma_f32_32x32x16_bf16 v[144:159], v[72:75], v[92:95], v[144:159]
    buffer_load_dwordx4 v20, s[16:19], s45 offen offset:3072 nt lds
    ds_read_b64_tr_b16 v[110:111], v36 offset:15360
    ds_read_b128 v[124:127], v44 offset:26624
    v_mfma_f32_32x32x16_bf16 v[176:191], v[76:79], v[92:95], v[176:191]
    s_waitcnt lgkmcnt(9)
    v_mfma_f32_32x32x16_bf16 v[128:143], v[96:99], v[112:115], v[128:143]
    s_add_u32 m0, s44, 4096
    s_mov_b32 s45, 212992
    buffer_load_dwordx4 v17, s[16:19], s45 offen nt lds
    s_waitcnt lgkmcnt(7)
    v_mfma_f32_32x32x16_bf16 v[160:175], v[100:103], v[112:115], v[160:175]
    s_waitcnt vmcnt(13)
    ds_read_b64_tr_b16 v[64:65], v35 offset:16384
    s_waitcnt vmcnt(12)
    ds_read_b64_tr_b16 v[66:67], v35 offset:17408
    s_waitcnt lgkmcnt(8)
    v_mfma_f32_32x32x16_bf16 v[144:159], v[96:99], v[116:119], v[144:159]
    buffer_load_dwordx4 v18, s[16:19], s45 offen offset:1024 nt lds
    ds_read_b128 v[80:83], v43 offset:40960
    ds_read_b64_tr_b16 v[68:69], v36 offset:16384
    v_mfma_f32_32x32x16_bf16 v[176:191], v[100:103], v[116:119], v[176:191]
    ds_read_b64_tr_b16 v[70:71], v36 offset:17408
    ds_read_b128 v[84:87], v44 offset:40960
    s_waitcnt lgkmcnt(9)
    v_mfma_f32_32x32x16_bf16 v[128:143], v[104:107], v[120:123], v[128:143]
    buffer_load_dwordx4 v19, s[16:19], s45 offen offset:2048 nt lds
    s_waitcnt vmcnt(13)
    ds_read_b64_tr_b16 v[72:73], v35 offset:18432
    s_waitcnt vmcnt(11)
    ds_read_b64_tr_b16 v[74:75], v35 offset:19456
    s_waitcnt lgkmcnt(9)
    v_mfma_f32_32x32x16_bf16 v[160:175], v[108:111], v[120:123], v[160:175]
    ds_read_b128 v[88:91], v43 offset:43008
    ds_read_b64_tr_b16 v[76:77], v36 offset:18432
    s_waitcnt lgkmcnt(10)
    v_mfma_f32_32x32x16_bf16 v[144:159], v[104:107], v[124:127], v[144:159]
    buffer_load_dwordx4 v20, s[16:19], s45 offen offset:3072 nt lds
    ds_read_b64_tr_b16 v[78:79], v36 offset:19456
    ds_read_b128 v[92:95], v44 offset:43008
    v_mfma_f32_32x32x16_bf16 v[176:191], v[108:111], v[124:127], v[176:191]
    s_waitcnt lgkmcnt(9)
    v_mfma_f32_32x32x16_bf16 v[128:143], v[64:67], v[80:83], v[128:143]
    s_add_u32 m0, s44, 8192
    s_mov_b32 s45, 229376
    buffer_load_dwordx4 v17, s[16:19], s45 offen nt lds
    s_waitcnt lgkmcnt(7)
    v_mfma_f32_32x32x16_bf16 v[160:175], v[68:71], v[80:83], v[160:175]
    s_waitcnt vmcnt(12)
    ds_read_b64_tr_b16 v[96:97], v35 offset:20480
    s_waitcnt vmcnt(11)
    ds_read_b64_tr_b16 v[98:99], v35 offset:21504
    s_waitcnt lgkmcnt(8)
    v_mfma_f32_32x32x16_bf16 v[144:159], v[64:67], v[84:87], v[144:159]
    buffer_load_dwordx4 v18, s[16:19], s45 offen offset:1024 nt lds
    ds_read_b128 v[112:115], v43 offset:57344
    ds_read_b64_tr_b16 v[100:101], v36 offset:20480
    v_mfma_f32_32x32x16_bf16 v[176:191], v[68:71], v[84:87], v[176:191]
    ds_read_b64_tr_b16 v[102:103], v36 offset:21504
    ds_read_b128 v[116:119], v44 offset:57344
    s_waitcnt lgkmcnt(9)
    v_mfma_f32_32x32x16_bf16 v[128:143], v[72:75], v[88:91], v[128:143]
    buffer_load_dwordx4 v19, s[16:19], s45 offen offset:2048 nt lds
    s_waitcnt vmcnt(12)
    ds_read_b64_tr_b16 v[104:105], v35 offset:22528
    s_waitcnt vmcnt(11)
    ds_read_b64_tr_b16 v[106:107], v35 offset:23552
    s_waitcnt lgkmcnt(9)
    v_mfma_f32_32x32x16_bf16 v[160:175], v[76:79], v[88:91], v[160:175]
    ds_read_b128 v[120:123], v43 offset:59392
    ds_read_b64_tr_b16 v[108:109], v36 offset:22528
    s_waitcnt lgkmcnt(10)
    v_mfma_f32_32x32x16_bf16 v[144:159], v[72:75], v[92:95], v[144:159]
    buffer_load_dwordx4 v20, s[16:19], s45 offen offset:3072 nt lds
    ds_read_b64_tr_b16 v[110:111], v36 offset:23552
    ds_read_b128 v[124:127], v44 offset:59392
    v_mfma_f32_32x32x16_bf16 v[176:191], v[76:79], v[92:95], v[176:191]
    s_waitcnt lgkmcnt(9)
    v_mfma_f32_32x32x16_bf16 v[128:143], v[96:99], v[112:115], v[128:143]
    s_add_u32 m0, s44, 12288
    s_mov_b32 s45, 245760
    buffer_load_dwordx4 v17, s[16:19], s45 offen nt lds
    s_waitcnt lgkmcnt(7)
    v_mfma_f32_32x32x16_bf16 v[160:175], v[100:103], v[112:115], v[160:175]
    s_waitcnt vmcnt(12)
    ds_read_b64_tr_b16 v[64:65], v35 offset:0
    s_waitcnt vmcnt(11)
    ds_read_b64_tr_b16 v[66:67], v35 offset:1024
    s_waitcnt lgkmcnt(8)
    v_mfma_f32_32x32x16_bf16 v[144:159], v[96:99], v[116:119], v[144:159]
    buffer_load_dwordx4 v18, s[16:19], s45 offen offset:1024 nt lds
    ds_read_b128 v[80:83], v43 offset:12288
    ds_read_b64_tr_b16 v[68:69], v36 offset:0
    v_mfma_f32_32x32x16_bf16 v[176:191], v[100:103], v[116:119], v[176:191]
    ds_read_b64_tr_b16 v[70:71], v36 offset:1024
    ds_read_b128 v[84:87], v44 offset:12288
    s_waitcnt lgkmcnt(9)
    v_mfma_f32_32x32x16_bf16 v[128:143], v[104:107], v[120:123], v[128:143]
    buffer_load_dwordx4 v19, s[16:19], s45 offen offset:2048 nt lds
    s_waitcnt vmcnt(12)
    ds_read_b64_tr_b16 v[72:73], v35 offset:2048
    s_waitcnt vmcnt(11)
    ds_read_b64_tr_b16 v[74:75], v35 offset:3072
    s_waitcnt lgkmcnt(9)
    v_mfma_f32_32x32x16_bf16 v[160:175], v[108:111], v[120:123], v[160:175]
    ds_read_b128 v[88:91], v43 offset:14336
    ds_read_b64_tr_b16 v[76:77], v36 offset:2048
    s_waitcnt lgkmcnt(10)
    v_mfma_f32_32x32x16_bf16 v[144:159], v[104:107], v[124:127], v[144:159]
    buffer_load_dwordx4 v20, s[16:19], s45 offen offset:3072 nt lds
    ds_read_b64_tr_b16 v[78:79], v36 offset:3072
    ds_read_b128 v[92:95], v44 offset:14336
    v_mfma_f32_32x32x16_bf16 v[176:191], v[108:111], v[124:127], v[176:191]
    s_waitcnt lgkmcnt(9)
    v_mfma_f32_32x32x16_bf16 v[128:143], v[64:67], v[80:83], v[128:143]
    s_waitcnt lgkmcnt(7)
    v_mfma_f32_32x32x16_bf16 v[160:175], v[68:71], v[80:83], v[160:175]
    s_waitcnt vmcnt(11)
    ds_read_b64_tr_b16 v[96:97], v35 offset:4096
    s_waitcnt vmcnt(10)
    ds_read_b64_tr_b16 v[98:99], v35 offset:5120
    s_waitcnt lgkmcnt(8)
    v_mfma_f32_32x32x16_bf16 v[144:159], v[64:67], v[84:87], v[144:159]
    ds_read_b128 v[112:115], v43 offset:28672
    ds_read_b64_tr_b16 v[100:101], v36 offset:4096
    v_mfma_f32_32x32x16_bf16 v[176:191], v[68:71], v[84:87], v[176:191]
    ds_read_b64_tr_b16 v[102:103], v36 offset:5120
    ds_read_b128 v[116:119], v44 offset:28672
    s_waitcnt lgkmcnt(9)
    v_mfma_f32_32x32x16_bf16 v[128:143], v[72:75], v[88:91], v[128:143]
    s_waitcnt vmcnt(9)
    ds_read_b64_tr_b16 v[104:105], v35 offset:6144
    s_waitcnt vmcnt(8)
    ds_read_b64_tr_b16 v[106:107], v35 offset:7168
    s_waitcnt lgkmcnt(9)
    v_mfma_f32_32x32x16_bf16 v[160:175], v[76:79], v[88:91], v[160:175]
    ds_read_b128 v[120:123], v43 offset:30720
    ds_read_b64_tr_b16 v[108:109], v36 offset:6144
    s_waitcnt lgkmcnt(10)
    v_mfma_f32_32x32x16_bf16 v[144:159], v[72:75], v[92:95], v[144:159]
    ds_read_b64_tr_b16 v[110:111], v36 offset:7168
    ds_read_b128 v[124:127], v44 offset:30720
    v_mfma_f32_32x32x16_bf16 v[176:191], v[76:79], v[92:95], v[176:191]
    s_waitcnt lgkmcnt(9)
    v_mfma_f32_32x32x16_bf16 v[128:143], v[96:99], v[112:115], v[128:143]
    s_add_u32 m0, s44, 16384
    s_xor_b32 s45, s61, 6
    s_mulk_i32 s45, 14336
    buffer_load_dwordx4 v21, s[24:27], s45 offen lds
    s_waitcnt lgkmcnt(7)
    v_mfma_f32_32x32x16_bf16 v[160:175], v[100:103], v[112:115], v[160:175]
    s_waitcnt vmcnt(8)
    ds_read_b64_tr_b16 v[64:65], v35 offset:8192
    s_waitcnt vmcnt(7)
    ds_read_b64_tr_b16 v[66:67], v35 offset:9216
    s_waitcnt lgkmcnt(8)
    v_mfma_f32_32x32x16_bf16 v[144:159], v[96:99], v[116:119], v[144:159]
    buffer_load_dwordx4 v22, s[24:27], s45 offen offset:1024 lds
    ds_read_b128 v[80:83], v43 offset:45056
    ds_read_b64_tr_b16 v[68:69], v36 offset:8192
    v_mfma_f32_32x32x16_bf16 v[176:191], v[100:103], v[116:119], v[176:191]
    ds_read_b64_tr_b16 v[70:71], v36 offset:9216
    ds_read_b128 v[84:87], v44 offset:45056
    s_waitcnt lgkmcnt(9)
    v_mfma_f32_32x32x16_bf16 v[128:143], v[104:107], v[120:123], v[128:143]
    buffer_load_dwordx4 v23, s[24:27], s45 offen offset:2048 lds
    s_waitcnt vmcnt(8)
    ds_read_b64_tr_b16 v[72:73], v35 offset:10240
    s_waitcnt vmcnt(7)
    ds_read_b64_tr_b16 v[74:75], v35 offset:11264
    s_waitcnt lgkmcnt(9)
    v_mfma_f32_32x32x16_bf16 v[160:175], v[108:111], v[120:123], v[160:175]
    ds_read_b128 v[88:91], v43 offset:47104
    ds_read_b64_tr_b16 v[76:77], v36 offset:10240
    s_waitcnt lgkmcnt(10)
    v_mfma_f32_32x32x16_bf16 v[144:159], v[104:107], v[124:127], v[144:159]
    buffer_load_dwordx4 v24, s[24:27], s45 offen offset:3072 lds
    ds_read_b64_tr_b16 v[78:79], v36 offset:11264
    ds_read_b128 v[92:95], v44 offset:47104
    v_mfma_f32_32x32x16_bf16 v[176:191], v[108:111], v[124:127], v[176:191]
    s_waitcnt lgkmcnt(9)
    v_mfma_f32_32x32x16_bf16 v[128:143], v[64:67], v[80:83], v[128:143]
    s_add_u32 m0, s44, 20480
    s_xor_b32 s45, s61, 7
    s_mulk_i32 s45, 14336
    buffer_load_dwordx4 v21, s[24:27], s45 offen lds
    s_waitcnt lgkmcnt(7)
    v_mfma_f32_32x32x16_bf16 v[160:175], v[68:71], v[80:83], v[160:175]
    s_waitcnt vmcnt(8)
    ds_read_b64_tr_b16 v[96:97], v35 offset:12288
    s_waitcnt vmcnt(7)
    ds_read_b64_tr_b16 v[98:99], v35 offset:13312
    s_waitcnt lgkmcnt(8)
    v_mfma_f32_32x32x16_bf16 v[144:159], v[64:67], v[84:87], v[144:159]
    buffer_load_dwordx4 v22, s[24:27], s45 offen offset:1024 lds
    ds_read_b128 v[112:115], v43 offset:61440
    ds_read_b64_tr_b16 v[100:101], v36 offset:12288
    v_mfma_f32_32x32x16_bf16 v[176:191], v[68:71], v[84:87], v[176:191]
    ds_read_b64_tr_b16 v[102:103], v36 offset:13312
    ds_read_b128 v[116:119], v44 offset:61440
    s_waitcnt lgkmcnt(9)
    v_mfma_f32_32x32x16_bf16 v[128:143], v[72:75], v[88:91], v[128:143]
    buffer_load_dwordx4 v23, s[24:27], s45 offen offset:2048 lds
    s_waitcnt vmcnt(8)
    ds_read_b64_tr_b16 v[104:105], v35 offset:14336
    s_waitcnt vmcnt(7)
    ds_read_b64_tr_b16 v[106:107], v35 offset:15360
    s_waitcnt lgkmcnt(9)
    v_mfma_f32_32x32x16_bf16 v[160:175], v[76:79], v[88:91], v[160:175]
    ds_read_b128 v[120:123], v43 offset:63488
    ds_read_b64_tr_b16 v[108:109], v36 offset:14336
    s_waitcnt lgkmcnt(10)
    v_mfma_f32_32x32x16_bf16 v[144:159], v[72:75], v[92:95], v[144:159]
    buffer_load_dwordx4 v24, s[24:27], s45 offen offset:3072 lds
    ds_read_b64_tr_b16 v[110:111], v36 offset:15360
    ds_read_b128 v[124:127], v44 offset:63488
    v_mfma_f32_32x32x16_bf16 v[176:191], v[76:79], v[92:95], v[176:191]
    s_waitcnt lgkmcnt(9)
    v_mfma_f32_32x32x16_bf16 v[128:143], v[96:99], v[112:115], v[128:143]
    s_waitcnt lgkmcnt(3)
    v_mfma_f32_32x32x16_bf16 v[128:143], v[104:107], v[120:123], v[128:143]
    v_mfma_f32_32x32x16_bf16 v[144:159], v[96:99], v[116:119], v[144:159]
    s_waitcnt lgkmcnt(0)
    v_mfma_f32_32x32x16_bf16 v[144:159], v[104:107], v[124:127], v[144:159]
    v_mfma_f32_32x32x16_bf16 v[160:175], v[100:103], v[112:115], v[160:175]
    s_nop 7
    v_cvt_pk_bf16_f32 v64, v128, v129
    v_cvt_pk_bf16_f32 v65, v130, v131
    v_cvt_pk_bf16_f32 v66, v132, v133
    v_cvt_pk_bf16_f32 v67, v134, v135
    ds_write_b128 v16, v[64:67] offset:0
    v_cvt_pk_bf16_f32 v72, v136, v137
    v_cvt_pk_bf16_f32 v73, v138, v139
    v_cvt_pk_bf16_f32 v74, v140, v141
    v_cvt_pk_bf16_f32 v75, v142, v143
    ds_write_b128 v16, v[72:75] offset:2048
    v_mfma_f32_32x32x16_bf16 v[160:175], v[108:111], v[120:123], v[160:175]
    v_mfma_f32_32x32x16_bf16 v[176:191], v[100:103], v[116:119], v[176:191]
    v_cvt_pk_bf16_f32 v68, v144, v145
    v_cvt_pk_bf16_f32 v69, v146, v147
    v_cvt_pk_bf16_f32 v70, v148, v149
    v_cvt_pk_bf16_f32 v71, v150, v151
    ds_write_b128 v12, v[68:71] offset:0
    v_cvt_pk_bf16_f32 v76, v152, v153
    v_cvt_pk_bf16_f32 v77, v154, v155
    v_cvt_pk_bf16_f32 v78, v156, v157
    v_cvt_pk_bf16_f32 v79, v158, v159
    ds_write_b128 v12, v[76:79] offset:2048
    v_mfma_f32_32x32x16_bf16 v[176:191], v[108:111], v[124:127], v[176:191]
    v_cvt_pk_bf16_f32 v80, v160, v161
    v_cvt_pk_bf16_f32 v81, v162, v163
    v_cvt_pk_bf16_f32 v82, v164, v165
    v_cvt_pk_bf16_f32 v83, v166, v167
    ds_write_b128 v16, v[80:83] offset:4096
    v_cvt_pk_bf16_f32 v88, v168, v169
    v_cvt_pk_bf16_f32 v89, v170, v171
    v_cvt_pk_bf16_f32 v90, v172, v173
    v_cvt_pk_bf16_f32 v91, v174, v175
    ds_write_b128 v16, v[88:91] offset:6144
    s_nop 1
    v_cvt_pk_bf16_f32 v84, v176, v177
    v_cvt_pk_bf16_f32 v85, v178, v179
    v_cvt_pk_bf16_f32 v86, v180, v181
    v_cvt_pk_bf16_f32 v87, v182, v183
    ds_write_b128 v12, v[84:87] offset:4096
    v_cvt_pk_bf16_f32 v92, v184, v185
    v_cvt_pk_bf16_f32 v93, v186, v187
    v_cvt_pk_bf16_f32 v94, v188, v189
    v_cvt_pk_bf16_f32 v95, v190, v191
    ds_write_b128 v12, v[92:95] offset:6144
    s_add_u32 m0, s44, 0
    s_xor_b32 s45, s61, 8
    s_mulk_i32 s45, 14336
    buffer_load_dwordx4 v21, s[24:27], s45 offen lds
    buffer_load_dwordx4 v22, s[24:27], s45 offen offset:1024 lds
    buffer_load_dwordx4 v23, s[24:27], s45 offen offset:2048 lds
    buffer_load_dwordx4 v24, s[24:27], s45 offen offset:3072 lds
    s_waitcnt lgkmcnt(0)
    s_barrier
    ds_read_b128 v[240:243], v43 offset:0
    ds_read_b128 v[244:247], v44 offset:0
    s_waitcnt lgkmcnt(1)
    v_mfma_f32_32x32x16_bf16 v[128:143], a[128:131], v[240:243], 0
    s_add_u32 m0, s44, 4096
    s_xor_b32 s45, s61, 9
    s_mulk_i32 s45, 14336
    buffer_load_dwordx4 v21, s[24:27], s45 offen lds
    s_lshl_b32 s51, s47, 1
    s_add_u32 s51, s51, s42
    v_mfma_f32_32x32x16_bf16 v[144:159], a[132:135], v[240:243], 0
    buffer_load_dwordx4 v22, s[24:27], s45 offen offset:1024 lds
    ds_read_b128 v[248:251], v43 offset:2048
    ds_read_b128 v[252:255], v44 offset:2048
    ds_read_b128 v[96:99], v43 offset:36864
    s_and_b32 s51, s51, 15
    v_mfma_f32_32x32x16_bf16 v[160:175], a[136:139], v[240:243], 0
    ds_read_b128 v[100:103], v44 offset:36864
    s_waitcnt vmcnt(11)
    ds_read_b64_tr_b16 a[224:225], v37 offset:16384
    s_lshl_b32 s3, s47, 13
    v_mfma_f32_32x32x16_bf16 v[176:191], a[140:143], v[240:243], 0
    buffer_load_dwordx4 v23, s[24:27], s45 offen offset:2048 lds
    ds_read_b64_tr_b16 a[228:229], v38 offset:16384
    ds_read_b64_tr_b16 a[232:233], v39 offset:16384
    ds_read_b64_tr_b16 a[236:237], v40 offset:16384
    s_add_u32 s3, s3, 65536
    s_waitcnt lgkmcnt(8)
    v_mfma_f32_32x32x16_bf16 v[192:207], a[128:131], v[244:247], 0
    s_waitcnt vmcnt(11)
    ds_read_b64_tr_b16 a[226:227], v37 offset:17408
    ds_read_b64_tr_b16 a[230:231], v38 offset:17408
    s_lshl_b32 s5, s51, 2
    v_mfma_f32_32x32x16_bf16 v[208:223], a[132:135], v[244:247], 0
    buffer_load_dwordx4 v24, s[24:27], s45 offen offset:3072 lds
    ds_read_b64_tr_b16 a[234:235], v39 offset:17408
    ds_read_b64_tr_b16 a[238:239], v40 offset:17408
    s_add_u32 s5, s5, s40
    v_mfma_f32_32x32x16_bf16 v[224:239], a[136:139], v[244:247], 0
    s_lshl_b32 s4, s5, 7
    s_waitcnt lgkmcnt(11)
    v_mfma_f32_32x32x16_bf16 v[128:143], a[144:147], v[248:251], v[128:143]
    s_add_u32 m0, s44, 8192
    s_xor_b32 s45, s61, 10
    s_mulk_i32 s45, 14336
    buffer_load_dwordx4 v21, s[24:27], s45 offen lds
    s_add_u32 s59, s3, s4
    v_mov_b32 v5, 1
    v_mfma_f32_32x32x16_bf16 v[144:159], a[148:151], v[248:251], v[144:159]
    buffer_load_dwordx4 v22, s[24:27], s45 offen offset:1024 lds
    ds_read_b128 v[240:243], v43 offset:4096
    ds_read_b128 v[244:247], v44 offset:4096
    ds_read_b128 v[104:107], v43 offset:38912
    v_mov_b32 v7, 0
    v_mfma_f32_32x32x16_bf16 v[160:175], a[152:155], v[248:251], v[160:175]
    ds_read_b128 v[108:111], v44 offset:38912
    s_waitcnt vmcnt(11)
    ds_read_b64_tr_b16 a[240:241], v37 offset:20480
    v_and_b32 v28, v28, v29
    v_mfma_f32_32x32x16_bf16 v[176:191], a[156:159], v[248:251], v[176:191]
    buffer_load_dwordx4 v23, s[24:27], s45 offen offset:2048 lds
    ds_read_b64_tr_b16 a[244:245], v38 offset:20480
    ds_read_b64_tr_b16 a[248:249], v39 offset:20480
    ds_read_b64_tr_b16 a[252:253], v40 offset:20480
    v_and_b32 v30, v30, v31
    s_waitcnt lgkmcnt(14)
    v_mfma_f32_32x32x16_bf16 v[192:207], a[144:147], v[252:255], v[192:207]
    s_waitcnt vmcnt(11)
    ds_read_b64_tr_b16 a[242:243], v37 offset:21504
    ds_read_b64_tr_b16 a[246:247], v38 offset:21504
    v_and_b32 v28, v28, v30
    v_mfma_f32_32x32x16_bf16 v[208:223], a[148:151], v[252:255], v[208:223]
    buffer_load_dwordx4 v24, s[24:27], s45 offen offset:3072 lds
    ds_read_b64_tr_b16 a[250:251], v39 offset:21504
    ds_read_b64_tr_b16 a[254:255], v40 offset:21504
    s_mul_i32 s6, s47, 917504
    v_mfma_f32_32x32x16_bf16 v[224:239], a[152:155], v[252:255], v[224:239]
    s_lshr_b32 s4, s5, 1
    s_waitcnt lgkmcnt(11)
    v_mfma_f32_32x32x16_bf16 v[128:143], a[160:163], v[240:243], v[128:143]
    s_add_u32 m0, s44, 12288
    s_xor_b32 s45, s61, 11
    s_mulk_i32 s45, 14336
    buffer_load_dwordx4 v21, s[24:27], s45 offen lds
    s_lshl_b32 s4, s4, 15
    s_add_u32 s6, s6, s4
    v_mfma_f32_32x32x16_bf16 v[144:159], a[164:167], v[240:243], v[144:159]
    buffer_load_dwordx4 v22, s[24:27], s45 offen offset:1024 lds
    ds_read_b128 v[248:251], v43 offset:6144
    ds_read_b128 v[252:255], v44 offset:6144
    ds_read_b128 v[112:115], v43 offset:49152
    s_lshl_b32 s4, s50, 10
    v_mfma_f32_32x32x16_bf16 v[160:175], a[168:171], v[240:243], v[160:175]
    ds_read_b128 v[116:119], v44 offset:49152
    s_waitcnt vmcnt(11)
    ds_read_b64_tr_b16 a[0:1], v37 offset:0
    s_add_u32 s6, s6, s4
    v_mfma_f32_32x32x16_bf16 v[176:191], a[172:175], v[240:243], v[176:191]
    buffer_load_dwordx4 v23, s[24:27], s45 offen offset:2048 lds
    ds_read_b64_tr_b16 a[4:5], v38 offset:0
    ds_read_b64_tr_b16 a[8:9], v39 offset:0
    ds_read_b64_tr_b16 a[12:13], v40 offset:0
    s_add_u32 s6, s6, 1048576
    s_waitcnt lgkmcnt(14)
    v_mfma_f32_32x32x16_bf16 v[192:207], a[160:163], v[244:247], v[192:207]
    s_waitcnt vmcnt(11)
    ds_read_b64_tr_b16 a[2:3], v37 offset:1024
    ds_read_b64_tr_b16 a[6:7], v38 offset:1024
    s_lshl_b32 s7, s43, 1
    v_mfma_f32_32x32x16_bf16 v[208:223], a[164:167], v[244:247], v[208:223]
    buffer_load_dwordx4 v24, s[24:27], s45 offen offset:3072 lds
    ds_read_b64_tr_b16 a[10:11], v39 offset:1024
    ds_read_b64_tr_b16 a[14:15], v40 offset:1024
    s_and_b32 s4, s51, 1
    v_mfma_f32_32x32x16_bf16 v[224:239], a[168:171], v[244:247], v[224:239]
    s_add_u32 s7, s7, s4
    s_waitcnt lgkmcnt(11)
    v_mfma_f32_32x32x16_bf16 v[128:143], a[176:179], v[248:251], v[128:143]
    s_add_u32 m0, s44, 16384
    s_xor_b32 s45, s61, 12
    s_mulk_i32 s45, 14336
    buffer_load_dwordx4 v21, s[24:27], s45 offen lds
    s_mul_i32 s7, s7, 57344
    s_mul_i32 s4, s41, 896
    v_mfma_f32_32x32x16_bf16 v[144:159], a[180:183], v[248:251], v[144:159]
    buffer_load_dwordx4 v22, s[24:27], s45 offen offset:1024 lds
    ds_read_b128 v[240:243], v43 offset:16384
    ds_read_b128 v[244:247], v44 offset:16384
    ds_read_b128 v[120:123], v43 offset:51200
    s_add_u32 s7, s7, s4
    v_mfma_f32_32x32x16_bf16 v[160:175], a[184:187], v[248:251], v[160:175]
    ds_read_b128 v[124:127], v44 offset:51200
    s_waitcnt vmcnt(11)
    ds_read_b64_tr_b16 a[16:17], v37 offset:4096
    s_lshr_b32 s4, s51, 1
    v_mfma_f32_32x32x16_bf16 v[176:191], a[188:191], v[248:251], v[176:191]
    buffer_load_dwordx4 v23, s[24:27], s45 offen offset:2048 lds
    ds_read_b64_tr_b16 a[20:21], v38 offset:4096
    ds_read_b64_tr_b16 a[24:25], v39 offset:4096
    ds_read_b64_tr_b16 a[28:29], v40 offset:4096
    s_lshl_b32 s4, s4, 7
    s_waitcnt lgkmcnt(14)
    v_mfma_f32_32x32x16_bf16 v[192:207], a[176:179], v[252:255], v[192:207]
    s_waitcnt vmcnt(11)
    ds_read_b64_tr_b16 a[18:19], v37 offset:5120
    ds_read_b64_tr_b16 a[22:23], v38 offset:5120
    s_add_u32 s7, s7, s4
    v_mfma_f32_32x32x16_bf16 v[208:223], a[180:183], v[252:255], v[208:223]
    buffer_load_dwordx4 v24, s[24:27], s45 offen offset:3072 lds
    ds_read_b64_tr_b16 a[26:27], v39 offset:5120
    ds_read_b64_tr_b16 a[30:31], v40 offset:5120
    s_lshl_b32 s4, s40, 5
    v_mfma_f32_32x32x16_bf16 v[224:239], a[184:187], v[252:255], v[224:239]
    s_add_u32 s7, s7, s4
    s_waitcnt lgkmcnt(11)
    v_mfma_f32_32x32x16_bf16 v[128:143], a[192:195], v[240:243], v[128:143]
    s_add_u32 m0, s44, 20480
    s_xor_b32 s45, s61, 13
    s_mulk_i32 s45, 14336
    buffer_load_dwordx4 v21, s[24:27], s45 offen lds
    v_and_b32 v2, 31, v1
    v_mul_u32_u24 v2, 1792, v2
    v_mfma_f32_32x32x16_bf16 v[144:159], a[196:199], v[240:243], v[144:159]
    buffer_load_dwordx4 v22, s[24:27], s45 offen offset:1024 lds
    ds_read_b128 v[248:251], v43 offset:18432
    ds_read_b128 v[252:255], v44 offset:18432
    ds_read_b128 v[64:67], v43 offset:53248
    v_lshrrev_b32 v3, 5, v1
    v_mfma_f32_32x32x16_bf16 v[160:175], a[200:203], v[240:243], v[160:175]
    ds_read_b128 v[68:71], v44 offset:53248
    s_waitcnt vmcnt(11)
    ds_read_b64_tr_b16 a[32:33], v37 offset:8192
    v_lshl_add_u32 v2, v3, 4, v2
    v_mfma_f32_32x32x16_bf16 v[176:191], a[204:207], v[240:243], v[176:191]
    buffer_load_dwordx4 v23, s[24:27], s45 offen offset:2048 lds
    ds_read_b64_tr_b16 a[36:37], v38 offset:8192
    ds_read_b64_tr_b16 a[40:41], v39 offset:8192
    ds_read_b64_tr_b16 a[44:45], v40 offset:8192
    v_bfe_u32 v9, v1, 2, 1
    s_waitcnt lgkmcnt(14)
    v_mfma_f32_32x32x16_bf16 v[192:207], a[192:195], v[244:247], v[192:207]
    s_waitcnt vmcnt(11)
    ds_read_b64_tr_b16 a[34:35], v37 offset:9216
    ds_read_b64_tr_b16 a[38:39], v38 offset:9216
    v_xor_b32 v9, v9, v3
    v_mfma_f32_32x32x16_bf16 v[208:223], a[196:199], v[244:247], v[208:223]
    buffer_load_dwordx4 v24, s[24:27], s45 offen offset:3072 lds
    ds_read_b64_tr_b16 a[42:43], v39 offset:9216
    ds_read_b64_tr_b16 a[46:47], v40 offset:9216
    v_bfe_u32 v10, v1, 4, 1
    v_mfma_f32_32x32x16_bf16 v[224:239], a[200:203], v[244:247], v[224:239]
    v_or_b32 v9, v9, v10
    s_waitcnt lgkmcnt(11)
    v_mfma_f32_32x32x16_bf16 v[128:143], a[208:211], v[248:251], v[128:143]
    s_add_u32 m0, s44, 0
    s_xor_b32 s45, s61, 14
    s_mulk_i32 s45, 14336
    buffer_load_dwordx4 v21, s[24:27], s45 offen lds
    v_lshlrev_b32 v9, 2, v9
    v_bfe_u32 v10, v1, 3, 1
    v_mfma_f32_32x32x16_bf16 v[144:159], a[212:215], v[248:251], v[144:159]
    buffer_load_dwordx4 v22, s[24:27], s45 offen offset:1024 lds
    ds_read_b128 v[240:243], v43 offset:20480
    ds_read_b128 v[244:247], v44 offset:20480
    ds_read_b128 v[72:75], v43 offset:55296
    v_lshl_add_u32 v9, v10, 1, v9
    v_mfma_f32_32x32x16_bf16 v[160:175], a[216:219], v[248:251], v[160:175]
    ds_read_b128 v[76:79], v44 offset:55296
    s_waitcnt vmcnt(11)
    ds_read_b64_tr_b16 a[48:49], v37 offset:12288
    v_bfe_u32 v10, v1, 1, 1
    v_mfma_f32_32x32x16_bf16 v[176:191], a[220:223], v[248:251], v[176:191]
    buffer_load_dwordx4 v23, s[24:27], s45 offen offset:2048 lds
    ds_read_b64_tr_b16 a[52:53], v38 offset:12288
    ds_read_b64_tr_b16 a[56:57], v39 offset:12288
    ds_read_b64_tr_b16 a[60:61], v40 offset:12288
    v_add_u32 v9, v9, v10
    s_waitcnt lgkmcnt(14)
    v_mfma_f32_32x32x16_bf16 v[192:207], a[208:211], v[252:255], v[192:207]
    s_waitcnt vmcnt(11)
    ds_read_b64_tr_b16 a[50:51], v37 offset:13312
    ds_read_b64_tr_b16 a[54:55], v38 offset:13312
    v_and_b32 v10, 1, v1
    v_mfma_f32_32x32x16_bf16 v[208:223], a[212:215], v[252:255], v[208:223]
    buffer_load_dwordx4 v24, s[24:27], s45 offen offset:3072 lds
    ds_read_b64_tr_b16 a[58:59], v39 offset:13312
    ds_read_b64_tr_b16 a[62:63], v40 offset:13312
    v_lshlrev_b32 v10, 4, v10
    v_mfma_f32_32x32x16_bf16 v[224:239], a[216:219], v[252:255], v[224:239]
    v_mov_b32 v11, 0x3f80
    s_waitcnt lgkmcnt(11)
    v_mfma_f32_32x32x16_bf16 v[128:143], a[224:227], v[240:243], v[128:143]
    s_add_u32 m0, s44, 4096
    s_xor_b32 s45, s61, 15
    s_mulk_i32 s45, 14336
    buffer_load_dwordx4 v21, s[24:27], s45 offen lds
    v_lshlrev_b32 v10, v10, v11
    v_cmp_eq_u32 vcc, 0, v9
    v_mfma_f32_32x32x16_bf16 v[144:159], a[228:231], v[240:243], v[144:159]
    buffer_load_dwordx4 v22, s[24:27], s45 offen offset:1024 lds
    ds_read_b128 v[248:251], v43 offset:22528
    ds_read_b128 v[252:255], v44 offset:22528
    v_cndmask_b32 v16, 0, v10, vcc
    v_mfma_f32_32x32x16_bf16 v[160:175], a[232:235], v[240:243], v[160:175]
    s_waitcnt vmcnt(11)
    ds_read_b64_tr_b16 a[64:65], v37 offset:16384
    ds_read_b64_tr_b16 a[68:69], v38 offset:16384
    v_cmp_eq_u32 vcc, 1, v9
    v_mfma_f32_32x32x16_bf16 v[176:191], a[236:239], v[240:243], v[176:191]
    buffer_load_dwordx4 v23, s[24:27], s45 offen offset:2048 lds
    ds_read_b64_tr_b16 a[72:73], v39 offset:16384
    ds_read_b64_tr_b16 a[76:77], v40 offset:16384
    v_cndmask_b32 v17, 0, v10, vcc
    s_waitcnt lgkmcnt(14)
    v_mfma_f32_32x32x16_bf16 v[192:207], a[224:227], v[244:247], v[192:207]
    s_waitcnt vmcnt(11)
    ds_read_b64_tr_b16 a[66:67], v37 offset:17408
    ds_read_b64_tr_b16 a[70:71], v38 offset:17408
    v_cmp_eq_u32 vcc, 2, v9
    v_mfma_f32_32x32x16_bf16 v[208:223], a[228:231], v[244:247], v[208:223]
    buffer_load_dwordx4 v24, s[24:27], s45 offen offset:3072 lds
    ds_read_b64_tr_b16 a[74:75], v39 offset:17408
    ds_read_b64_tr_b16 a[78:79], v40 offset:17408
    v_cndmask_b32 v18, 0, v10, vcc
    v_mfma_f32_32x32x16_bf16 v[224:239], a[232:235], v[244:247], v[224:239]
    v_cmp_eq_u32 vcc, 3, v9
    s_waitcnt lgkmcnt(9)
    v_mfma_f32_32x32x16_bf16 v[128:143], a[240:243], v[248:251], v[128:143]
    v_cndmask_b32 v19, 0, v10, vcc
    v_mfma_f32_32x32x16_bf16 v[144:159], a[244:247], v[248:251], v[144:159]
    ds_read_b128 v[240:243], v43 offset:32768
    ds_read_b128 v[244:247], v44 offset:32768
    v_mfma_f32_32x32x16_bf16 v[160:175], a[248:251], v[248:251], v[160:175]
    s_waitcnt vmcnt(9)
    ds_read_b64_tr_b16 a[80:81], v37 offset:20480
    ds_read_b64_tr_b16 a[84:85], v38 offset:20480
    v_mfma_f32_32x32x16_bf16 v[176:191], a[252:255], v[248:251], v[176:191]
    ds_read_b64_tr_b16 a[88:89], v39 offset:20480
    ds_read_b64_tr_b16 a[92:93], v40 offset:20480
    s_waitcnt lgkmcnt(14)
    v_mfma_f32_32x32x16_bf16 v[192:207], a[240:243], v[252:255], v[192:207]
    s_waitcnt vmcnt(8)
    ds_read_b64_tr_b16 a[82:83], v37 offset:21504
    ds_read_b64_tr_b16 a[86:87], v38 offset:21504
    v_mfma_f32_32x32x16_bf16 v[208:223], a[244:247], v[252:255], v[208:223]
    ds_read_b64_tr_b16 a[90:91], v39 offset:21504
    ds_read_b64_tr_b16 a[94:95], v40 offset:21504
    v_mfma_f32_32x32x16_bf16 v[224:239], a[248:251], v[252:255], v[224:239]
    s_waitcnt lgkmcnt(9)
    v_mfma_f32_32x32x16_bf16 v[128:143], a[0:3], v[240:243], v[128:143]
    v_mfma_f32_32x32x16_bf16 v[144:159], a[4:7], v[240:243], v[144:159]
    ds_read_b128 v[248:251], v43 offset:34816
    ds_read_b128 v[252:255], v44 offset:34816
    v_mfma_f32_32x32x16_bf16 v[160:175], a[8:11], v[240:243], v[160:175]
    s_waitcnt vmcnt(5)
    ds_read_b64_tr_b16 a[96:97], v37 offset:0
    ds_read_b64_tr_b16 a[100:101], v38 offset:0
    v_mfma_f32_32x32x16_bf16 v[176:191], a[12:15], v[240:243], v[176:191]
    ds_read_b64_tr_b16 a[104:105], v39 offset:0
    ds_read_b64_tr_b16 a[108:109], v40 offset:0
    s_waitcnt lgkmcnt(14)
    v_mfma_f32_32x32x16_bf16 v[192:207], a[0:3], v[244:247], v[192:207]
    s_waitcnt vmcnt(4)
    ds_read_b64_tr_b16 a[98:99], v37 offset:1024
    ds_read_b64_tr_b16 a[102:103], v38 offset:1024
    v_mfma_f32_32x32x16_bf16 v[208:223], a[4:7], v[244:247], v[208:223]
    ds_read_b64_tr_b16 a[106:107], v39 offset:1024
    ds_read_b64_tr_b16 a[110:111], v40 offset:1024
    v_mfma_f32_32x32x16_bf16 v[224:239], a[8:11], v[244:247], v[224:239]
    s_waitcnt lgkmcnt(9)
    v_mfma_f32_32x32x16_bf16 v[128:143], a[16:19], v[248:251], v[128:143]
    v_mfma_f32_32x32x16_bf16 v[144:159], a[20:23], v[248:251], v[144:159]
    s_waitcnt vmcnt(1)
    ds_read_b64_tr_b16 a[112:113], v37 offset:4096
    ds_read_b64_tr_b16 a[116:117], v38 offset:4096
    v_mfma_f32_32x32x16_bf16 v[160:175], a[24:27], v[248:251], v[160:175]
    ds_read_b64_tr_b16 a[120:121], v39 offset:4096
    ds_read_b64_tr_b16 a[124:125], v40 offset:4096
    v_mfma_f32_32x32x16_bf16 v[176:191], a[28:31], v[248:251], v[176:191]
    s_waitcnt vmcnt(0)
    ds_read_b64_tr_b16 a[114:115], v37 offset:5120
    s_waitcnt lgkmcnt(13)
    v_mfma_f32_32x32x16_bf16 v[192:207], a[16:19], v[252:255], v[192:207]
    ds_read_b64_tr_b16 a[118:119], v38 offset:5120
    ds_read_b64_tr_b16 a[122:123], v39 offset:5120
    v_mfma_f32_32x32x16_bf16 v[208:223], a[20:23], v[252:255], v[208:223]
    ds_read_b64_tr_b16 a[126:127], v40 offset:5120
    v_mfma_f32_32x32x16_bf16 v[224:239], a[24:27], v[252:255], v[224:239]
    v_mfma_f32_32x32x16_bf16 v[128:143], a[32:35], v[96:99], v[128:143]
    v_mfma_f32_32x32x16_bf16 v[128:143], a[48:51], v[104:107], v[128:143]
    v_mfma_f32_32x32x16_bf16 v[128:143], a[64:67], v[112:115], v[128:143]
    v_mfma_f32_32x32x16_bf16 v[128:143], a[80:83], v[120:123], v[128:143]
    s_waitcnt lgkmcnt(11)
    v_mfma_f32_32x32x16_bf16 v[128:143], a[96:99], v[64:67], v[128:143]
    s_waitcnt lgkmcnt(3)
    v_mfma_f32_32x32x16_bf16 v[128:143], a[112:115], v[72:75], v[128:143]
    v_mfma_f32_32x32x16_bf16 v[144:159], a[36:39], v[96:99], v[144:159]
    v_mfma_f32_32x32x16_bf16 v[144:159], a[52:55], v[104:107], v[144:159]
    s_nop 9
    v_cvt_pk_bf16_f32 v48, v128, v129
    v_cvt_pk_bf16_f32 v49, v130, v131
    v_mfma_f32_32x32x16_bf16 v[144:159], a[68:71], v[112:115], v[144:159]
    v_cvt_pk_bf16_f32 v50, v132, v133
    v_cvt_pk_bf16_f32 v51, v134, v135
    v_mfma_f32_32x32x16_bf16 v[144:159], a[84:87], v[120:123], v[144:159]
    buffer_store_dwordx4 v[48:51], v41, s[28:31], s52 offen sc0 sc1
    v_cvt_pk_bf16_f32 v52, v136, v137
    v_mfma_f32_32x32x16_bf16 v[144:159], a[100:103], v[64:67], v[144:159]
    v_cvt_pk_bf16_f32 v53, v138, v139
    v_cvt_pk_bf16_f32 v54, v140, v141
    s_waitcnt lgkmcnt(2)
    v_mfma_f32_32x32x16_bf16 v[144:159], a[116:119], v[72:75], v[144:159]
    v_cvt_pk_bf16_f32 v55, v142, v143
    buffer_store_dwordx4 v[52:55], v41, s[28:31], s52 offen offset:1024 sc0 sc1
    v_mfma_f32_32x32x16_bf16 v[160:175], a[40:43], v[96:99], v[160:175]
    v_mfma_f32_32x32x16_bf16 v[160:175], a[56:59], v[104:107], v[160:175]
    s_nop 7
    v_cvt_pk_bf16_f32 v56, v144, v145
    v_cvt_pk_bf16_f32 v57, v146, v147
    v_mfma_f32_32x32x16_bf16 v[160:175], a[72:75], v[112:115], v[160:175]
    v_cvt_pk_bf16_f32 v58, v148, v149
    v_cvt_pk_bf16_f32 v59, v150, v151
    v_mfma_f32_32x32x16_bf16 v[160:175], a[88:91], v[120:123], v[160:175]
    buffer_store_dwordx4 v[56:59], v41, s[28:31], s54 offen sc0 sc1
    v_cvt_pk_bf16_f32 v60, v152, v153
    v_mfma_f32_32x32x16_bf16 v[160:175], a[104:107], v[64:67], v[160:175]
    v_cvt_pk_bf16_f32 v61, v154, v155
    v_cvt_pk_bf16_f32 v62, v156, v157
    s_waitcnt lgkmcnt(1)
    v_mfma_f32_32x32x16_bf16 v[160:175], a[120:123], v[72:75], v[160:175]
    v_cvt_pk_bf16_f32 v63, v158, v159
    buffer_store_dwordx4 v[60:63], v41, s[28:31], s54 offen offset:1024 sc0 sc1
    v_mfma_f32_32x32x16_bf16 v[176:191], a[44:47], v[96:99], v[176:191]
    v_mfma_f32_32x32x16_bf16 v[176:191], a[60:63], v[104:107], v[176:191]
    s_nop 7
    v_cvt_pk_bf16_f32 v32, v160, v161
    v_cvt_pk_bf16_f32 v33, v162, v163
    v_mfma_f32_32x32x16_bf16 v[176:191], a[76:79], v[112:115], v[176:191]
    v_cvt_pk_bf16_f32 v34, v164, v165
    v_cvt_pk_bf16_f32 v35, v166, v167
    v_mfma_f32_32x32x16_bf16 v[176:191], a[92:95], v[120:123], v[176:191]
    buffer_store_dwordx4 v[32:35], v41, s[28:31], s56 offen sc0 sc1
    v_cvt_pk_bf16_f32 v36, v168, v169
    v_mfma_f32_32x32x16_bf16 v[176:191], a[108:111], v[64:67], v[176:191]
    v_cvt_pk_bf16_f32 v37, v170, v171
    v_cvt_pk_bf16_f32 v38, v172, v173
    s_waitcnt lgkmcnt(0)
    v_mfma_f32_32x32x16_bf16 v[176:191], a[124:127], v[72:75], v[176:191]
    v_cvt_pk_bf16_f32 v39, v174, v175
    buffer_store_dwordx4 v[36:39], v41, s[28:31], s56 offen offset:1024 sc0 sc1
    v_mfma_f32_32x32x16_bf16 v[192:207], a[32:35], v[100:103], v[192:207]
    v_mfma_f32_32x32x16_bf16 v[192:207], a[48:51], v[108:111], v[192:207]
    s_nop 7
    v_cvt_pk_bf16_f32 v48, v176, v177
    v_cvt_pk_bf16_f32 v49, v178, v179
    v_mfma_f32_32x32x16_bf16 v[192:207], a[64:67], v[116:119], v[192:207]
    v_cvt_pk_bf16_f32 v50, v180, v181
    v_cvt_pk_bf16_f32 v51, v182, v183
    v_mfma_f32_32x32x16_bf16 v[192:207], a[80:83], v[124:127], v[192:207]
    buffer_store_dwordx4 v[48:51], v41, s[28:31], s58 offen sc0 sc1
    v_cvt_pk_bf16_f32 v52, v184, v185
    v_mfma_f32_32x32x16_bf16 v[192:207], a[96:99], v[68:71], v[192:207]
    v_cvt_pk_bf16_f32 v53, v186, v187
    v_cvt_pk_bf16_f32 v54, v188, v189
    v_mfma_f32_32x32x16_bf16 v[192:207], a[112:115], v[76:79], v[192:207]
    v_cvt_pk_bf16_f32 v55, v190, v191
    buffer_store_dwordx4 v[52:55], v41, s[28:31], s58 offen offset:1024 sc0 sc1
    v_mfma_f32_32x32x16_bf16 v[208:223], a[36:39], v[100:103], v[208:223]
    v_mfma_f32_32x32x16_bf16 v[208:223], a[52:55], v[108:111], v[208:223]
    s_nop 7
    v_cvt_pk_bf16_f32 v56, v192, v193
    v_cvt_pk_bf16_f32 v57, v194, v195
    v_mfma_f32_32x32x16_bf16 v[208:223], a[68:71], v[116:119], v[208:223]
    v_cvt_pk_bf16_f32 v58, v196, v197
    v_cvt_pk_bf16_f32 v59, v198, v199
    v_mfma_f32_32x32x16_bf16 v[208:223], a[84:87], v[124:127], v[208:223]
    buffer_store_dwordx4 v[56:59], v41, s[28:31], s53 offen sc0 sc1
    v_cvt_pk_bf16_f32 v60, v200, v201
    v_mfma_f32_32x32x16_bf16 v[208:223], a[100:103], v[68:71], v[208:223]
    v_cvt_pk_bf16_f32 v61, v202, v203
    v_cvt_pk_bf16_f32 v62, v204, v205
    v_mfma_f32_32x32x16_bf16 v[208:223], a[116:119], v[76:79], v[208:223]
    v_cvt_pk_bf16_f32 v63, v206, v207
    buffer_store_dwordx4 v[60:63], v41, s[28:31], s53 offen offset:1024 sc0 sc1
    v_mfma_f32_32x32x16_bf16 v[224:239], a[40:43], v[100:103], v[224:239]
    v_mfma_f32_32x32x16_bf16 v[224:239], a[56:59], v[108:111], v[224:239]
    s_nop 7
    v_cvt_pk_bf16_f32 v32, v208, v209
    v_cvt_pk_bf16_f32 v33, v210, v211
    v_mfma_f32_32x32x16_bf16 v[224:239], a[72:75], v[116:119], v[224:239]
    v_cvt_pk_bf16_f32 v34, v212, v213
    v_cvt_pk_bf16_f32 v35, v214, v215
    v_mfma_f32_32x32x16_bf16 v[224:239], a[88:91], v[124:127], v[224:239]
    buffer_store_dwordx4 v[32:35], v41, s[28:31], s55 offen sc0 sc1
    v_cvt_pk_bf16_f32 v36, v216, v217
    v_mfma_f32_32x32x16_bf16 v[224:239], a[104:107], v[68:71], v[224:239]
    v_cvt_pk_bf16_f32 v37, v218, v219
    v_cvt_pk_bf16_f32 v38, v220, v221
    v_mfma_f32_32x32x16_bf16 v[224:239], a[120:123], v[76:79], v[224:239]
    v_cvt_pk_bf16_f32 v39, v222, v223
    buffer_store_dwordx4 v[36:39], v41, s[28:31], s55 offen offset:1024 sc0 sc1
    s_nop 9
    v_cvt_pk_bf16_f32 v48, v224, v225
    v_cvt_pk_bf16_f32 v49, v226, v227
    v_cvt_pk_bf16_f32 v50, v228, v229
    v_cvt_pk_bf16_f32 v51, v230, v231
    buffer_store_dwordx4 v[48:51], v41, s[28:31], s57 offen sc0 sc1
    v_cvt_pk_bf16_f32 v52, v232, v233
    v_cvt_pk_bf16_f32 v53, v234, v235
    v_cvt_pk_bf16_f32 v54, v236, v237
    v_cvt_pk_bf16_f32 v55, v238, v239
    buffer_store_dwordx4 v[52:55], v41, s[28:31], s57 offen offset:1024 sc0 sc1
    v_cmp_eq_u32 vcc, 1, v28
    s_mov_b32 s5, 100000
    s_nop 2
    s_cbranch_vccnz L_go3
L_ready3:
    buffer_load_dwordx4 v[28:31], v7, s[36:39], s60 offen sc0 sc1
    s_sub_u32 s5, s5, 1
    s_cmp_eq_u32 s5, 0
    s_waitcnt vmcnt(0)
    s_cbranch_scc1 L_go3
    v_and_b32 v28, v28, v29
    v_and_b32 v30, v30, v31
    v_and_b32 v28, v28, v30
    v_cmp_eq_u32 vcc, 1, v28
    s_nop 3
    s_cbranch_vccz L_ready3
L_go3:
    s_mov_b64 exec, 0x333
    s_waitcnt vmcnt(8)
    buffer_atomic_add v5, v4, s[28:31], s3 offen sc1
    s_mov_b64 exec, 0x300c
    s_waitcnt vmcnt(5)
    buffer_atomic_add v5, v4, s[28:31], s3 offen sc1
    s_mov_b64 exec, 0xcc0
    s_waitcnt vmcnt(2)
    buffer_atomic_add v5, v4, s[28:31], s3 offen sc1
    s_mov_b64 exec, -1
    s_cmp_ge_u32 s51, 14
    s_cbranch_scc1 L_fin3
    s_mov_b32 s5, 100000
    s_mov_b64 exec, 1
L_poll3:
    s_nop 0
    v_mov_b32 v3, 0
    buffer_atomic_add v3, v7, s[28:31], s59 offen sc0 sc1
    s_waitcnt vmcnt(0)
    v_cmp_eq_u32 vcc, 16, v3
    s_nop 3
    s_cbranch_vccnz L_polled3
    s_sub_u32 s5, s5, 1
    s_cmp_lg_u32 s5, 0
    s_cbranch_scc1 L_poll3
L_polled3:
    s_mov_b64 exec, -1
    s_nop 0
    buffer_load_dwordx4 v[64:67], v41, s[28:31], s6 offen sc0 sc1
    buffer_load_dwordx4 v[68:71], v41, s[28:31], s6 offen offset:2048 sc0 sc1
    s_addk_i32 s6, 4096
    buffer_load_dwordx4 v[72:75], v41, s[28:31], s6 offen sc0 sc1
    buffer_load_dwordx4 v[76:79], v41, s[28:31], s6 offen offset:2048 sc0 sc1
    s_addk_i32 s6, 4096
    buffer_load_dwordx4 v[80:83], v41, s[28:31], s6 offen sc0 sc1
    buffer_load_dwordx4 v[84:87], v41, s[28:31], s6 offen offset:2048 sc0 sc1
    s_addk_i32 s6, 4096
    buffer_load_dwordx4 v[88:91], v41, s[28:31], s6 offen sc0 sc1
    buffer_load_dwordx4 v[92:95], v41, s[28:31], s6 offen offset:2048 sc0 sc1
    s_addk_i32 s6, 4096
    buffer_load_dwordx4 v[96:99], v41, s[28:31], s6 offen sc0 sc1
    buffer_load_dwordx4 v[100:103], v41, s[28:31], s6 offen offset:2048 sc0 sc1
    s_addk_i32 s6, 4096
    buffer_load_dwordx4 v[104:107], v41, s[28:31], s6 offen sc0 sc1
    buffer_load_dwordx4 v[108:111], v41, s[28:31], s6 offen offset:2048 sc0 sc1
    s_addk_i32 s6, 4096
    buffer_load_dwordx4 v[112:115], v41, s[28:31], s6 offen sc0 sc1
    buffer_load_dwordx4 v[116:119], v41, s[28:31], s6 offen offset:2048 sc0 sc1
    s_addk_i32 s6, 4096
    buffer_load_dwordx4 v[120:123], v41, s[28:31], s6 offen sc0 sc1
    buffer_load_dwordx4 v[124:127], v41, s[28:31], s6 offen offset:2048 sc0 sc1
    s_waitcnt vmcnt(15)
    v_mfma_f32_32x32x16_bf16 v[128:143], v[16:19], v[64:67], 0
    s_waitcnt vmcnt(14)
    v_mfma_f32_32x32x16_bf16 v[128:143], v[16:19], v[68:71], v[128:143]
    s_waitcnt vmcnt(13)
    v_mfma_f32_32x32x16_bf16 v[128:143], v[16:19], v[72:75], v[128:143]
    s_waitcnt vmcnt(12)
    v_mfma_f32_32x32x16_bf16 v[128:143], v[16:19], v[76:79], v[128:143]
    s_waitcnt vmcnt(11)
    v_mfma_f32_32x32x16_bf16 v[128:143], v[16:19], v[80:83], v[128:143]
    s_waitcnt vmcnt(10)
    v_mfma_f32_32x32x16_bf16 v[128:143], v[16:19], v[84:87], v[128:143]
    s_waitcnt vmcnt(9)
    v_mfma_f32_32x32x16_bf16 v[128:143], v[16:19], v[88:91], v[128:143]
    s_waitcnt vmcnt(8)
    v_mfma_f32_32x32x16_bf16 v[128:143], v[16:19], v[92:95], v[128:143]
    s_waitcnt vmcnt(7)
    v_mfma_f32_32x32x16_bf16 v[128:143], v[16:19], v[96:99], v[128:143]
    s_waitcnt vmcnt(6)
    v_mfma_f32_32x32x16_bf16 v[128:143], v[16:19], v[100:103], v[128:143]
    s_waitcnt vmcnt(5)
    v_mfma_f32_32x32x16_bf16 v[128:143], v[16:19], v[104:107], v[128:143]
    s_waitcnt vmcnt(4)
    v_mfma_f32_32x32x16_bf16 v[128:143], v[16:19], v[108:111], v[128:143]
    s_waitcnt vmcnt(3)
    v_mfma_f32_32x32x16_bf16 v[128:143], v[16:19], v[112:115], v[128:143]
    s_waitcnt vmcnt(2)
    v_mfma_f32_32x32x16_bf16 v[128:143], v[16:19], v[116:119], v[128:143]
    s_waitcnt vmcnt(1)
    v_mfma_f32_32x32x16_bf16 v[128:143], v[16:19], v[120:123], v[128:143]
    s_waitcnt vmcnt(0)
    v_mfma_f32_32x32x16_bf16 v[128:143], v[16:19], v[124:127], v[128:143]
    s_nop 11
    v_cvt_pk_bf16_f32 v56, v128, v129
    v_cvt_pk_bf16_f32 v57, v130, v131
    v_cvt_pk_bf16_f32 v58, v132, v133
    v_cvt_pk_bf16_f32 v59, v134, v135
    buffer_store_dwordx4 v[56:59], v2, s[32:35], s7 offen
L_fin3:
    s_endpgm
L_codeend:
.section .rodata,"a"
.p2align 6
.amdhsa_kernel concat_heads__gqa_block_cached__mha_block_cached__near_ridge_kernel
  .amdhsa_next_free_vgpr 512
  .amdhsa_next_free_sgpr 102
  .amdhsa_accum_offset 256
  .amdhsa_group_segment_fixed_size 0
  .amdhsa_kernarg_size 104
  .amdhsa_user_sgpr_count 2
  .amdhsa_user_sgpr_kernarg_segment_ptr 1
  .amdhsa_system_sgpr_workgroup_id_x 1
.end_amdhsa_kernel
```
